```python
import torch

def _softmax(x, axis=-1):
    return torch.softmax(x, dim=axis)
def _gelu(x):
    return torch.nn.functional.gelu(x, approximate="tanh")
def _silu(x):
    return torch.nn.functional.silu(x)
def _sigmoid(x):
    return torch.sigmoid(x)
def _layernorm(x, axis=-1, eps=1e-5):
    m = x.mean(dim=axis, keepdim=True)
    v = x.var(dim=axis, keepdim=True, unbiased=False)
    return (x - m) / torch.sqrt(v + eps)
def _scatter_add(tgt, idx, src, axis=0):
    return tgt.clone().index_add_(axis, idx, src)
def _segment_sum(src, seg, n):
    out = torch.zeros((n,) + src.shape[1:], dtype=src.dtype)
    return out.index_add_(0, seg, src)
def _pad(x, pw):
    flat = tuple(v for pair in reversed(pw) for v in pair)
    return torch.nn.functional.pad(x, flat)

kernel_name = 'interleave_layers__linear_kernel_hedgehog__grouped_kv_mqa__prompt'

def setup_inputs():

    _w = (lambda a: (lambda t: t.to(torch.bfloat16) if t.is_floating_point() else t)(torch.as_tensor(a)))
    def _A_setup():
        B, S, D, H = 1, 2048, 1024, 32
        Dh = D // H
        return {
            "x": _w((lambda *s: torch.randn(*s, dtype=torch.bfloat16) * 0.05)(B, S, D)),
            "wqkv": _w((lambda *s: torch.randn(*s, dtype=torch.bfloat16) * 0.2)(D, 3 * D)),
            "w_phi": _w((lambda *s: torch.randn(*s, dtype=torch.bfloat16) * 0.2)(H, Dh, Dh) * (Dh ** -0.5)),
            "wo": _w((lambda *s: torch.randn(*s, dtype=torch.bfloat16) * 0.05)(D, D)),
        }
    _A_in = _A_setup()

    def _B_setup():
        B, S, D, H = 1, 2048, 1024, 32
        Dh = D // H
        return {
            "x": _w((lambda *s: torch.randn(*s, dtype=torch.bfloat16) * 0.05)(B, S, D)),
            "wq": _w((lambda *s: torch.randn(*s, dtype=torch.bfloat16) * 0.1)(D, H * Dh)),
            "wk": _w((lambda *s: torch.randn(*s, dtype=torch.bfloat16) * 0.1)(D, Dh)),
            "wv": _w((lambda *s: torch.randn(*s, dtype=torch.bfloat16) * 0.05)(D, Dh)),
            "wo": _w((lambda *s: torch.randn(*s, dtype=torch.bfloat16) * 0.05)(H * Dh, D)),
        }
    _B_in = _B_setup()

    return {
        "A_x": _A_in["x"],
        "A_wqkv": _A_in["wqkv"],
        "A_w_phi": _A_in["w_phi"],
        "A_wo": _A_in["wo"],
        "B_x": _B_in["x"],
        "B_wq": _B_in["wq"],
        "B_wk": _B_in["wk"],
        "B_wv": _B_in["wv"],
        "B_wo": _B_in["wo"],
    }

def reference(A_x, A_wqkv, A_w_phi, A_wo, B_x, B_wq, B_wk, B_wv, B_wo):
    def _A_ref(x, wqkv, w_phi, wo):
        B, S, D = x.shape
        H = 32; Dh = D // H
        qkv = (lambda x, *d: x.permute(*d))((x @ wqkv).reshape(B, S, 3, H, Dh), 2, 0, 3, 1, 4)
        q, k, v = qkv[0], qkv[1], qkv[2]
        pq = torch.einsum("bhsd,hdf->bhsf", q, w_phi)
        pk = torch.einsum("bhsd,hdf->bhsf", k, w_phi)
        phi_q = torch.concatenate([_softmax(pq, axis=-1), _softmax(-pq, axis=-1)], axis=-1)
        phi_k = torch.concatenate([_softmax(pk, axis=-1), _softmax(-pk, axis=-1)], axis=-1)
        kv = torch.einsum("bhsf,bhsd->bhfd", phi_k, v)
        z  = torch.einsum("bhsf->bhf", phi_k)
        num = torch.einsum("bhqf,bhfd->bhqd", phi_q, kv)
        den = torch.einsum("bhqf,bhf->bhq", phi_q, z)[..., None] + 1e-6
        o = num / den
        return (lambda x, *d: x.permute(*d))(o, 0, 2, 1, 3).reshape(B, S, D) @ wo

    def _B_ref(x, wq, wk, wv, wo):
        B, S, D = x.shape
        H = 32
        Dh = D // H
        q = (lambda x, *d: x.permute(*d))((x @ wq).reshape(B, S, H, Dh), 0, 2, 1, 3)
        k = x @ wk
        v = x @ wv
        scores = torch.einsum("bhqd,bkd->bhqk", q, k) * (Dh ** -0.5)
        p = _softmax(scores, axis=-1)
        o = torch.einsum("bhqk,bkd->bhqd", p, v)
        return (lambda x, *d: x.permute(*d))(o, 0, 2, 1, 3).reshape(B, S, H * Dh) @ wo

    x = A_x
    x = x + _A_ref(_layernorm(x, axis=-1), A_wqkv, A_w_phi, A_wo)
    x = x + _B_ref(_layernorm(x, axis=-1), B_wq, B_wk, B_wv, B_wo)
    x = x + _A_ref(_layernorm(x, axis=-1), A_wqkv, A_w_phi, A_wo)
    x = x + _B_ref(_layernorm(x, axis=-1), B_wq, B_wk, B_wv, B_wo)
    return x
```

```asm
; @launch grid=(256,1,1) block=(512,1,1) lds=163840
.amdgcn_target "amdgcn-amd-amdhsa--gfx950"
.text
.p2align 8
.globl interleave_layers__linear_kernel_hedgehog__grouped_kv_mqa__prompt_kernel
.type interleave_layers__linear_kernel_hedgehog__grouped_kv_mqa__prompt_kernel,@function
interleave_layers__linear_kernel_hedgehog__grouped_kv_mqa__prompt_kernel:
    s_cmp_ge_u32 s2, 256
    s_cbranch_scc1 mega_exit
    s_load_dwordx16 s[64:79], s[0:1], 0
    s_load_dwordx8 s[80:87], s[0:1], 64
    v_lshrrev_b32 v1, 6, v0
    s_nop 0
    v_readfirstlane_b32 s3, v1
    v_and_b32 v1, 63, v0
    v_and_b32 v2, 31, v1
    v_lshrrev_b32 v3, 5, v1
    v_cmp_eq_u32 s[40:41], 1, v3
    s_waitcnt lgkmcnt(0)
    s_mov_b32 s16, s86
    s_and_b32 s17, s87, 0xffff
    s_mov_b32 s18, 0x3000000
    s_mov_b32 s19, 0x20000
    s_and_b32 s6, s2, 7
    s_lshr_b32 s7, s2, 3
    s_lshr_b32 s4, s6, 2
    s_lshl_b32 s4, s4, 3
    s_lshr_b32 s5, s7, 2
    s_add_u32 s4, s4, s5
    s_and_b32 s5, s6, 3
    s_lshl_b32 s5, s5, 2
    s_and_b32 s7, s7, 3
    s_add_u32 s5, s5, s7
    s_mov_b32 s8, s64
    s_and_b32 s9, s65, 0xffff
    s_mov_b32 s10, 0x400000
    s_mov_b32 s11, 0x20000
    s_mov_b32 s12, s66
    s_and_b32 s13, s67, 0xffff
    s_mov_b32 s14, 0x600000
    s_mov_b32 s15, 0x20000
    s_mov_b32 s20, s68
    s_and_b32 s21, s69, 0xffff
    s_mov_b32 s22, 0x10000
    s_mov_b32 s23, 0x20000
    s_bfe_u32 s48, s3, 0x10001
    s_and_b32 s49, s3, 1
    s_lshl_b32 s50, s5, 1
    s_add_u32 s50, s50, s49
    s_lshl_b32 s51, s48, 1
    s_lshr_b32 s31, s3, 2
    s_add_u32 s51, s51, s31
    s_cmp_ge_u32 s3, 4
    s_cbranch_scc1 L_qa0_ld_1
    v_lshlrev_b32 v10, 1, v2
    v_lshl_add_u32 v10, v3, 8, v10
    s_lshl_b32 s34, s50, 11
    buffer_load_ushort v220, v10, s[20:23], s34 offen offset:0
    buffer_load_ushort v221, v10, s[20:23], s34 offen offset:64
    buffer_load_ushort v222, v10, s[20:23], s34 offen offset:128
    buffer_load_ushort v223, v10, s[20:23], s34 offen offset:192
    buffer_load_ushort v224, v10, s[20:23], s34 offen offset:512
    buffer_load_ushort v225, v10, s[20:23], s34 offen offset:576
    buffer_load_ushort v226, v10, s[20:23], s34 offen offset:640
    buffer_load_ushort v227, v10, s[20:23], s34 offen offset:704
    buffer_load_ushort v228, v10, s[20:23], s34 offen offset:1024
    buffer_load_ushort v229, v10, s[20:23], s34 offen offset:1088
    buffer_load_ushort v230, v10, s[20:23], s34 offen offset:1152
    buffer_load_ushort v231, v10, s[20:23], s34 offen offset:1216
    buffer_load_ushort v232, v10, s[20:23], s34 offen offset:1536
    buffer_load_ushort v233, v10, s[20:23], s34 offen offset:1600
    buffer_load_ushort v234, v10, s[20:23], s34 offen offset:1664
    buffer_load_ushort v235, v10, s[20:23], s34 offen offset:1728
    s_lshl_b32 s35, s48, 6
    v_add_u32 v4, s35, v2
    v_bfe_u32 v5, v4, 1, 3
    v_lshlrev_b32 v4, 7, v4
    v_add_u32 v6, 0, v3
    v_xor_b32 v6, v6, v5
    v_lshl_add_u32 v12, v6, 4, v4
    v_add_u32 v6, 2, v3
    v_xor_b32 v6, v6, v5
    v_lshl_add_u32 v13, v6, 4, v4
    v_add_u32 v6, 4, v3
    v_xor_b32 v6, v6, v5
    v_lshl_add_u32 v14, v6, 4, v4
    v_add_u32 v6, 6, v3
    v_xor_b32 v6, v6, v5
    v_lshl_add_u32 v15, v6, 4, v4
    s_lshl_b32 s35, s49, 6
    v_and_b32 v4, 15, v1
    v_lshrrev_b32 v5, 2, v4
    v_lshl_add_u32 v5, v3, 3, v5
    v_mul_u32_u24 v5, 128, v5
    v_and_b32 v6, 3, v4
    v_lshlrev_b32 v6, 3, v6
    v_bfe_u32 v7, v1, 4, 1
    v_lshl_add_u32 v6, v7, 5, v6
    v_add_u32 v6, s35, v6
    v_bfe_u32 v7, v1, 3, 1
    v_lshlrev_b32 v7, 6, v7
    v_xor_b32 v6, v6, v7
    v_add_u32 v16, v5, v6
    v_mov_b32 v32, 0
    v_mov_b32 v33, 0
    v_mov_b32 v34, 0
    v_mov_b32 v35, 0
    v_mov_b32 v36, 0
    v_mov_b32 v37, 0
    v_mov_b32 v38, 0
    v_mov_b32 v39, 0
    v_mov_b32 v40, 0
    v_mov_b32 v41, 0
    v_mov_b32 v42, 0
    v_mov_b32 v43, 0
    v_mov_b32 v44, 0
    v_mov_b32 v45, 0
    v_mov_b32 v46, 0
    v_mov_b32 v47, 0
    v_mov_b32 v48, 0
    v_mov_b32 v49, 0
    v_mov_b32 v50, 0
    v_mov_b32 v51, 0
    v_mov_b32 v52, 0
    v_mov_b32 v53, 0
    v_mov_b32 v54, 0
    v_mov_b32 v55, 0
    v_mov_b32 v56, 0
    v_mov_b32 v57, 0
    v_mov_b32 v58, 0
    v_mov_b32 v59, 0
    v_mov_b32 v60, 0
    v_mov_b32 v61, 0
    v_mov_b32 v62, 0
    v_mov_b32 v63, 0
    v_mov_b32 v64, 0
    v_mov_b32 v65, 0
    v_mov_b32 v66, 0
    v_mov_b32 v67, 0
    v_mov_b32 v68, 0
    v_mov_b32 v69, 0
    v_mov_b32 v70, 0
    v_mov_b32 v71, 0
    v_mov_b32 v72, 0
    v_mov_b32 v73, 0
    v_mov_b32 v74, 0
    v_mov_b32 v75, 0
    v_mov_b32 v76, 0
    v_mov_b32 v77, 0
    v_mov_b32 v78, 0
    v_mov_b32 v79, 0
    v_mov_b32 v80, 0
    v_mov_b32 v81, 0
    v_mov_b32 v82, 0
    v_mov_b32 v83, 0
    v_mov_b32 v84, 0
    v_mov_b32 v85, 0
    v_mov_b32 v86, 0
    v_mov_b32 v87, 0
    v_mov_b32 v88, 0
    v_mov_b32 v89, 0
    v_mov_b32 v90, 0
    v_mov_b32 v91, 0
    v_mov_b32 v92, 0
    v_mov_b32 v93, 0
    v_mov_b32 v94, 0
    v_mov_b32 v95, 0
    v_mov_b32 v96, 0
    v_mov_b32 v97, 0
    v_mov_b32 v98, 0
    v_mov_b32 v99, 0
    v_mov_b32 v100, 0
    v_mov_b32 v101, 0
    v_mov_b32 v102, 0
    v_mov_b32 v103, 0
    v_mov_b32 v104, 0
    v_mov_b32 v105, 0
    v_mov_b32 v106, 0
    v_mov_b32 v107, 0
    v_mov_b32 v108, 0
    v_mov_b32 v109, 0
    v_mov_b32 v110, 0
    v_mov_b32 v111, 0
    v_mov_b32 v112, 0
    v_mov_b32 v113, 0
    v_mov_b32 v114, 0
    v_mov_b32 v115, 0
    v_mov_b32 v116, 0
    v_mov_b32 v117, 0
    v_mov_b32 v118, 0
    v_mov_b32 v119, 0
    v_mov_b32 v120, 0
    v_mov_b32 v121, 0
    v_mov_b32 v122, 0
    v_mov_b32 v123, 0
    v_mov_b32 v124, 0
    v_mov_b32 v125, 0
    v_mov_b32 v126, 0
    v_mov_b32 v127, 0
    v_bfe_u32 v4, v1, 2, 1
    v_bfe_u32 v5, v1, 4, 1
    v_cmp_eq_u32 vcc, v4, v5
    v_mov_b32 v4, 0x3f803f80
    s_nop 0
    v_cndmask_b32 v192, 0, v4, vcc
    v_mov_b32 v193, v192
    v_mov_b32 v194, v192
    v_mov_b32 v195, v192
    v_mov_b32 v176, 0
    v_mov_b32 v177, 0
    v_mov_b32 v178, 0
    v_mov_b32 v179, 0
    v_mov_b32 v180, 0
    v_mov_b32 v181, 0
    v_mov_b32 v182, 0
    v_mov_b32 v183, 0
    v_mov_b32 v184, 0
    v_mov_b32 v185, 0
    v_mov_b32 v186, 0
    v_mov_b32 v187, 0
    v_mov_b32 v188, 0
    v_mov_b32 v189, 0
    v_mov_b32 v190, 0
    v_mov_b32 v191, 0
    s_mov_b32 s32, 0
    s_mov_b32 s33, 0
    s_barrier
    v_add_u32 v17, s32, v12
    v_add_u32 v18, s32, v13
    v_add_u32 v19, s32, v14
    v_add_u32 v20, s32, v15
    v_add_u32 v21, s32, v16
    ds_read_b128 v[128:131], v17 offset:0
    ds_read_b128 v[132:135], v17 offset:4096
    ds_read_b64_tr_b16 v[136:137], v21 offset:16384
    ds_read_b64_tr_b16 v[138:139], v21 offset:16896
    ds_read_b64_tr_b16 v[140:141], v21 offset:24576
    ds_read_b64_tr_b16 v[142:143], v21 offset:25088
    ds_read_b64_tr_b16 v[144:145], v21 offset:32768
    ds_read_b64_tr_b16 v[146:147], v21 offset:33280
    s_waitcnt lgkmcnt(0)
    v_mfma_f32_32x32x16_bf16 v[32:47], v[136:139], v[128:131], v[32:47]
    ds_read_b128 v[148:151], v18 offset:0
    ds_read_b128 v[152:155], v18 offset:4096
    v_mfma_f32_32x32x16_bf16 v[48:63], v[136:139], v[132:135], v[48:63]
    ds_read_b64_tr_b16 v[156:157], v21 offset:18432
    ds_read_b64_tr_b16 v[158:159], v21 offset:18944
    v_mfma_f32_32x32x16_bf16 v[64:79], v[140:143], v[128:131], v[64:79]
    ds_read_b64_tr_b16 v[160:161], v21 offset:26624
    ds_read_b64_tr_b16 v[162:163], v21 offset:27136
    v_mfma_f32_32x32x16_bf16 v[80:95], v[140:143], v[132:135], v[80:95]
    ds_read_b64_tr_b16 v[164:165], v21 offset:34816
    ds_read_b64_tr_b16 v[166:167], v21 offset:35328
    v_mfma_f32_32x32x16_bf16 v[96:111], v[144:147], v[128:131], v[96:111]
    s_cmp_eq_u32 s49, 0
    s_cbranch_scc0 L_st_7
    v_mfma_f32_16x16x32_bf16 v[184:187], v[192:195], v[128:131], v[184:187]
    v_lshlrev_b32 v196, 16, v128
    v_and_b32 v197, 0xffff0000, v128
    v_lshlrev_b32 v198, 16, v129
    v_and_b32 v199, 0xffff0000, v129
    v_lshlrev_b32 v200, 16, v130
    v_and_b32 v201, 0xffff0000, v130
    v_lshlrev_b32 v202, 16, v131
    v_and_b32 v203, 0xffff0000, v131
    v_fmac_f32 v188, v196, v196
    v_fmac_f32 v189, v197, v197
    v_fmac_f32 v190, v198, v198
    v_fmac_f32 v191, v199, v199
    v_fmac_f32 v188, v200, v200
    v_fmac_f32 v189, v201, v201
    v_fmac_f32 v190, v202, v202
    v_fmac_f32 v191, v203, v203
    s_branch L_st_8
L_st_7:
    v_mfma_f32_16x16x32_bf16 v[184:187], v[192:195], v[132:135], v[184:187]
    v_lshlrev_b32 v196, 16, v132
    v_and_b32 v197, 0xffff0000, v132
    v_lshlrev_b32 v198, 16, v133
    v_and_b32 v199, 0xffff0000, v133
    v_lshlrev_b32 v200, 16, v134
    v_and_b32 v201, 0xffff0000, v134
    v_lshlrev_b32 v202, 16, v135
    v_and_b32 v203, 0xffff0000, v135
    v_fmac_f32 v188, v196, v196
    v_fmac_f32 v189, v197, v197
    v_fmac_f32 v190, v198, v198
    v_fmac_f32 v191, v199, v199
    v_fmac_f32 v188, v200, v200
    v_fmac_f32 v189, v201, v201
    v_fmac_f32 v190, v202, v202
    v_fmac_f32 v191, v203, v203
L_st_8:
    v_mfma_f32_32x32x16_bf16 v[112:127], v[144:147], v[132:135], v[112:127]
    s_cmp_eq_u32 s48, 0
    s_cbranch_scc0 L_st_9
    v_mfma_f32_16x16x32_bf16 v[176:179], v[192:195], v[136:139], v[176:179]
    v_mfma_f32_16x16x32_bf16 v[180:183], v[192:195], v[140:143], v[180:183]
    s_branch L_st_10
L_st_9:
    v_mfma_f32_16x16x32_bf16 v[176:179], v[192:195], v[144:147], v[176:179]
L_st_10:
    s_waitcnt lgkmcnt(0)
    v_mfma_f32_32x32x16_bf16 v[32:47], v[156:159], v[148:151], v[32:47]
    ds_read_b128 v[128:131], v19 offset:0
    ds_read_b128 v[132:135], v19 offset:4096
    v_mfma_f32_32x32x16_bf16 v[48:63], v[156:159], v[152:155], v[48:63]
    ds_read_b64_tr_b16 v[136:137], v21 offset:20480
    ds_read_b64_tr_b16 v[138:139], v21 offset:20992
    v_mfma_f32_32x32x16_bf16 v[64:79], v[160:163], v[148:151], v[64:79]
    ds_read_b64_tr_b16 v[140:141], v21 offset:28672
    ds_read_b64_tr_b16 v[142:143], v21 offset:29184
    v_mfma_f32_32x32x16_bf16 v[80:95], v[160:163], v[152:155], v[80:95]
    ds_read_b64_tr_b16 v[144:145], v21 offset:36864
    ds_read_b64_tr_b16 v[146:147], v21 offset:37376
    v_mfma_f32_32x32x16_bf16 v[96:111], v[164:167], v[148:151], v[96:111]
    s_cmp_eq_u32 s49, 0
    s_cbranch_scc0 L_st_11
    v_mfma_f32_16x16x32_bf16 v[184:187], v[192:195], v[148:151], v[184:187]
    v_lshlrev_b32 v196, 16, v148
    v_and_b32 v197, 0xffff0000, v148
    v_lshlrev_b32 v198, 16, v149
    v_and_b32 v199, 0xffff0000, v149
    v_lshlrev_b32 v200, 16, v150
    v_and_b32 v201, 0xffff0000, v150
    v_lshlrev_b32 v202, 16, v151
    v_and_b32 v203, 0xffff0000, v151
    v_fmac_f32 v188, v196, v196
    v_fmac_f32 v189, v197, v197
    v_fmac_f32 v190, v198, v198
    v_fmac_f32 v191, v199, v199
    v_fmac_f32 v188, v200, v200
    v_fmac_f32 v189, v201, v201
    v_fmac_f32 v190, v202, v202
    v_fmac_f32 v191, v203, v203
    s_branch L_st_12
L_st_11:
    v_mfma_f32_16x16x32_bf16 v[184:187], v[192:195], v[152:155], v[184:187]
    v_lshlrev_b32 v196, 16, v152
    v_and_b32 v197, 0xffff0000, v152
    v_lshlrev_b32 v198, 16, v153
    v_and_b32 v199, 0xffff0000, v153
    v_lshlrev_b32 v200, 16, v154
    v_and_b32 v201, 0xffff0000, v154
    v_lshlrev_b32 v202, 16, v155
    v_and_b32 v203, 0xffff0000, v155
    v_fmac_f32 v188, v196, v196
    v_fmac_f32 v189, v197, v197
    v_fmac_f32 v190, v198, v198
    v_fmac_f32 v191, v199, v199
    v_fmac_f32 v188, v200, v200
    v_fmac_f32 v189, v201, v201
    v_fmac_f32 v190, v202, v202
    v_fmac_f32 v191, v203, v203
L_st_12:
    v_mfma_f32_32x32x16_bf16 v[112:127], v[164:167], v[152:155], v[112:127]
    s_cmp_eq_u32 s48, 0
    s_cbranch_scc0 L_st_13
    v_mfma_f32_16x16x32_bf16 v[176:179], v[192:195], v[156:159], v[176:179]
    v_mfma_f32_16x16x32_bf16 v[180:183], v[192:195], v[160:163], v[180:183]
    s_branch L_st_14
L_st_13:
    v_mfma_f32_16x16x32_bf16 v[176:179], v[192:195], v[164:167], v[176:179]
L_st_14:
    s_waitcnt lgkmcnt(0)
    v_mfma_f32_32x32x16_bf16 v[32:47], v[136:139], v[128:131], v[32:47]
    ds_read_b128 v[148:151], v20 offset:0
    ds_read_b128 v[152:155], v20 offset:4096
    v_mfma_f32_32x32x16_bf16 v[48:63], v[136:139], v[132:135], v[48:63]
    ds_read_b64_tr_b16 v[156:157], v21 offset:22528
    ds_read_b64_tr_b16 v[158:159], v21 offset:23040
    v_mfma_f32_32x32x16_bf16 v[64:79], v[140:143], v[128:131], v[64:79]
    ds_read_b64_tr_b16 v[160:161], v21 offset:30720
    ds_read_b64_tr_b16 v[162:163], v21 offset:31232
    v_mfma_f32_32x32x16_bf16 v[80:95], v[140:143], v[132:135], v[80:95]
    ds_read_b64_tr_b16 v[164:165], v21 offset:38912
    ds_read_b64_tr_b16 v[166:167], v21 offset:39424
    v_mfma_f32_32x32x16_bf16 v[96:111], v[144:147], v[128:131], v[96:111]
    s_cmp_eq_u32 s49, 0
    s_cbranch_scc0 L_st_15
    v_mfma_f32_16x16x32_bf16 v[184:187], v[192:195], v[128:131], v[184:187]
    v_lshlrev_b32 v196, 16, v128
    v_and_b32 v197, 0xffff0000, v128
    v_lshlrev_b32 v198, 16, v129
    v_and_b32 v199, 0xffff0000, v129
    v_lshlrev_b32 v200, 16, v130
    v_and_b32 v201, 0xffff0000, v130
    v_lshlrev_b32 v202, 16, v131
    v_and_b32 v203, 0xffff0000, v131
    v_fmac_f32 v188, v196, v196
    v_fmac_f32 v189, v197, v197
    v_fmac_f32 v190, v198, v198
    v_fmac_f32 v191, v199, v199
    v_fmac_f32 v188, v200, v200
    v_fmac_f32 v189, v201, v201
    v_fmac_f32 v190, v202, v202
    v_fmac_f32 v191, v203, v203
    s_branch L_st_16
L_st_15:
    v_mfma_f32_16x16x32_bf16 v[184:187], v[192:195], v[132:135], v[184:187]
    v_lshlrev_b32 v196, 16, v132
    v_and_b32 v197, 0xffff0000, v132
    v_lshlrev_b32 v198, 16, v133
    v_and_b32 v199, 0xffff0000, v133
    v_lshlrev_b32 v200, 16, v134
    v_and_b32 v201, 0xffff0000, v134
    v_lshlrev_b32 v202, 16, v135
    v_and_b32 v203, 0xffff0000, v135
    v_fmac_f32 v188, v196, v196
    v_fmac_f32 v189, v197, v197
    v_fmac_f32 v190, v198, v198
    v_fmac_f32 v191, v199, v199
    v_fmac_f32 v188, v200, v200
    v_fmac_f32 v189, v201, v201
    v_fmac_f32 v190, v202, v202
    v_fmac_f32 v191, v203, v203
L_st_16:
    v_mfma_f32_32x32x16_bf16 v[112:127], v[144:147], v[132:135], v[112:127]
    s_cmp_eq_u32 s48, 0
    s_cbranch_scc0 L_st_17
    v_mfma_f32_16x16x32_bf16 v[176:179], v[192:195], v[136:139], v[176:179]
    v_mfma_f32_16x16x32_bf16 v[180:183], v[192:195], v[140:143], v[180:183]
    s_branch L_st_18
L_st_17:
    v_mfma_f32_16x16x32_bf16 v[176:179], v[192:195], v[144:147], v[176:179]
L_st_18:
    s_waitcnt lgkmcnt(0)
    s_add_u32 s32, s32, 40960
    s_cmp_eq_u32 s32, 163840
    s_cselect_b32 s32, 0, s32
    v_mfma_f32_32x32x16_bf16 v[32:47], v[156:159], v[148:151], v[32:47]
    v_mfma_f32_32x32x16_bf16 v[48:63], v[156:159], v[152:155], v[48:63]
    v_add_u32 v17, s32, v12
    v_add_u32 v18, s32, v13
    v_add_u32 v19, s32, v14
    v_add_u32 v20, s32, v15
    v_add_u32 v21, s32, v16
    s_barrier
    ds_read_b128 v[128:131], v17 offset:0
    ds_read_b128 v[132:135], v17 offset:4096
    ds_read_b64_tr_b16 v[136:137], v21 offset:16384
    v_mfma_f32_32x32x16_bf16 v[64:79], v[160:163], v[148:151], v[64:79]
    ds_read_b64_tr_b16 v[138:139], v21 offset:16896
    ds_read_b64_tr_b16 v[140:141], v21 offset:24576
    ds_read_b64_tr_b16 v[142:143], v21 offset:25088
    v_mfma_f32_32x32x16_bf16 v[80:95], v[160:163], v[152:155], v[80:95]
    ds_read_b64_tr_b16 v[144:145], v21 offset:32768
    ds_read_b64_tr_b16 v[146:147], v21 offset:33280
    v_mfma_f32_32x32x16_bf16 v[96:111], v[164:167], v[148:151], v[96:111]
    s_cmp_eq_u32 s49, 0
    s_cbranch_scc0 L_st_19
    v_mfma_f32_16x16x32_bf16 v[184:187], v[192:195], v[148:151], v[184:187]
    v_lshlrev_b32 v196, 16, v148
    v_and_b32 v197, 0xffff0000, v148
    v_lshlrev_b32 v198, 16, v149
    v_and_b32 v199, 0xffff0000, v149
    v_lshlrev_b32 v200, 16, v150
    v_and_b32 v201, 0xffff0000, v150
    v_lshlrev_b32 v202, 16, v151
    v_and_b32 v203, 0xffff0000, v151
    v_fmac_f32 v188, v196, v196
    v_fmac_f32 v189, v197, v197
    v_fmac_f32 v190, v198, v198
    v_fmac_f32 v191, v199, v199
    v_fmac_f32 v188, v200, v200
    v_fmac_f32 v189, v201, v201
    v_fmac_f32 v190, v202, v202
    v_fmac_f32 v191, v203, v203
    s_branch L_st_20
L_st_19:
    v_mfma_f32_16x16x32_bf16 v[184:187], v[192:195], v[152:155], v[184:187]
    v_lshlrev_b32 v196, 16, v152
    v_and_b32 v197, 0xffff0000, v152
    v_lshlrev_b32 v198, 16, v153
    v_and_b32 v199, 0xffff0000, v153
    v_lshlrev_b32 v200, 16, v154
    v_and_b32 v201, 0xffff0000, v154
    v_lshlrev_b32 v202, 16, v155
    v_and_b32 v203, 0xffff0000, v155
    v_fmac_f32 v188, v196, v196
    v_fmac_f32 v189, v197, v197
    v_fmac_f32 v190, v198, v198
    v_fmac_f32 v191, v199, v199
    v_fmac_f32 v188, v200, v200
    v_fmac_f32 v189, v201, v201
    v_fmac_f32 v190, v202, v202
    v_fmac_f32 v191, v203, v203
L_st_20:
    v_mfma_f32_32x32x16_bf16 v[112:127], v[164:167], v[152:155], v[112:127]
    s_cmp_eq_u32 s48, 0
    s_cbranch_scc0 L_st_21
    v_mfma_f32_16x16x32_bf16 v[176:179], v[192:195], v[156:159], v[176:179]
    v_mfma_f32_16x16x32_bf16 v[180:183], v[192:195], v[160:163], v[180:183]
    s_branch L_st_22
L_st_21:
    v_mfma_f32_16x16x32_bf16 v[176:179], v[192:195], v[164:167], v[176:179]
L_st_22:
    s_mov_b32 s33, 1
    v_add_f32 v188, v188, v189
    v_add_f32 v190, v190, v191
    v_add_f32 v188, v188, v190
    v_mov_b32 v189, v188
    s_add_u32 s34, s4, s5
    s_and_b32 s34, s34, 15
    v_permlane32_swap_b32 v188, v189
    s_lshl_b32 s35, s4, 14
    s_lshl_b32 s36, s34, 10
    s_add_u32 s35, s35, s36
    s_lshl_b32 s36, s3, 8
    s_add_u32 s35, s35, s36
    s_add_u32 s35, s35, 0x2600000
    v_add_f32 v188, v188, v189
    v_cndmask_b32 v188, v184, v188, s[40:41]
    v_lshlrev_b32 v10, 2, v1
    buffer_store_dword v188, v10, s[16:19], s35 offen sc1
    s_mul_i32 s35, s50, 6144
    s_lshl_b32 s36, s34, 7
    s_add_u32 s35, s35, s36
    s_lshl_b32 s36, s48, 12
    s_add_u32 s35, s35, s36
    s_add_u32 s35, s35, 0x2700000
    s_cmp_eq_u32 s48, 0
    s_cselect_b32 s36, s35, 0x7ffff000
    v_lshlrev_b32 v10, 2, v2
    buffer_store_dword v176, v10, s[16:19], s35 offen sc1
    buffer_store_dword v180, v10, s[16:19], s36 offen offset:2048 sc1
L_qa0_loop_6:
    s_waitcnt lgkmcnt(0)
    v_mfma_f32_32x32x16_bf16 v[32:47], v[136:139], v[128:131], v[32:47]
    ds_read_b128 v[148:151], v18 offset:0
    ds_read_b128 v[152:155], v18 offset:4096
    v_mfma_f32_32x32x16_bf16 v[48:63], v[136:139], v[132:135], v[48:63]
    ds_read_b64_tr_b16 v[156:157], v21 offset:18432
    ds_read_b64_tr_b16 v[158:159], v21 offset:18944
    v_mfma_f32_32x32x16_bf16 v[64:79], v[140:143], v[128:131], v[64:79]
    ds_read_b64_tr_b16 v[160:161], v21 offset:26624
    ds_read_b64_tr_b16 v[162:163], v21 offset:27136
    v_mfma_f32_32x32x16_bf16 v[80:95], v[140:143], v[132:135], v[80:95]
    ds_read_b64_tr_b16 v[164:165], v21 offset:34816
    ds_read_b64_tr_b16 v[166:167], v21 offset:35328
    v_mfma_f32_32x32x16_bf16 v[96:111], v[144:147], v[128:131], v[96:111]
    v_mfma_f32_32x32x16_bf16 v[112:127], v[144:147], v[132:135], v[112:127]
    s_waitcnt lgkmcnt(0)
    v_mfma_f32_32x32x16_bf16 v[32:47], v[156:159], v[148:151], v[32:47]
    ds_read_b128 v[128:131], v19 offset:0
    ds_read_b128 v[132:135], v19 offset:4096
    v_mfma_f32_32x32x16_bf16 v[48:63], v[156:159], v[152:155], v[48:63]
    ds_read_b64_tr_b16 v[136:137], v21 offset:20480
    ds_read_b64_tr_b16 v[138:139], v21 offset:20992
    v_mfma_f32_32x32x16_bf16 v[64:79], v[160:163], v[148:151], v[64:79]
    ds_read_b64_tr_b16 v[140:141], v21 offset:28672
    ds_read_b64_tr_b16 v[142:143], v21 offset:29184
    v_mfma_f32_32x32x16_bf16 v[80:95], v[160:163], v[152:155], v[80:95]
    ds_read_b64_tr_b16 v[144:145], v21 offset:36864
    ds_read_b64_tr_b16 v[146:147], v21 offset:37376
    v_mfma_f32_32x32x16_bf16 v[96:111], v[164:167], v[148:151], v[96:111]
    v_mfma_f32_32x32x16_bf16 v[112:127], v[164:167], v[152:155], v[112:127]
    s_waitcnt lgkmcnt(0)
    v_mfma_f32_32x32x16_bf16 v[32:47], v[136:139], v[128:131], v[32:47]
    ds_read_b128 v[148:151], v20 offset:0
    ds_read_b128 v[152:155], v20 offset:4096
    v_mfma_f32_32x32x16_bf16 v[48:63], v[136:139], v[132:135], v[48:63]
    ds_read_b64_tr_b16 v[156:157], v21 offset:22528
    ds_read_b64_tr_b16 v[158:159], v21 offset:23040
    v_mfma_f32_32x32x16_bf16 v[64:79], v[140:143], v[128:131], v[64:79]
    ds_read_b64_tr_b16 v[160:161], v21 offset:30720
    ds_read_b64_tr_b16 v[162:163], v21 offset:31232
    v_mfma_f32_32x32x16_bf16 v[80:95], v[140:143], v[132:135], v[80:95]
    ds_read_b64_tr_b16 v[164:165], v21 offset:38912
    ds_read_b64_tr_b16 v[166:167], v21 offset:39424
    v_mfma_f32_32x32x16_bf16 v[96:111], v[144:147], v[128:131], v[96:111]
    v_mfma_f32_32x32x16_bf16 v[112:127], v[144:147], v[132:135], v[112:127]
    s_waitcnt lgkmcnt(0)
    s_add_u32 s32, s32, 40960
    s_cmp_eq_u32 s32, 163840
    s_cselect_b32 s32, 0, s32
    v_mfma_f32_32x32x16_bf16 v[32:47], v[156:159], v[148:151], v[32:47]
    v_mfma_f32_32x32x16_bf16 v[48:63], v[156:159], v[152:155], v[48:63]
    v_add_u32 v17, s32, v12
    v_add_u32 v18, s32, v13
    v_add_u32 v19, s32, v14
    v_add_u32 v20, s32, v15
    v_add_u32 v21, s32, v16
    s_barrier
    ds_read_b128 v[128:131], v17 offset:0
    ds_read_b128 v[132:135], v17 offset:4096
    ds_read_b64_tr_b16 v[136:137], v21 offset:16384
    v_mfma_f32_32x32x16_bf16 v[64:79], v[160:163], v[148:151], v[64:79]
    ds_read_b64_tr_b16 v[138:139], v21 offset:16896
    ds_read_b64_tr_b16 v[140:141], v21 offset:24576
    ds_read_b64_tr_b16 v[142:143], v21 offset:25088
    v_mfma_f32_32x32x16_bf16 v[80:95], v[160:163], v[152:155], v[80:95]
    ds_read_b64_tr_b16 v[144:145], v21 offset:32768
    ds_read_b64_tr_b16 v[146:147], v21 offset:33280
    v_mfma_f32_32x32x16_bf16 v[96:111], v[164:167], v[148:151], v[96:111]
    v_mfma_f32_32x32x16_bf16 v[112:127], v[164:167], v[152:155], v[112:127]
    s_cmp_eq_u32 s33, 3
    s_cbranch_scc0 L_skip_23
    s_waitcnt vmcnt(0)
L_skip_23:
    s_add_u32 s33, s33, 1
    s_cmp_lt_u32 s33, 15
    s_cbranch_scc1 L_qa0_loop_6
    s_waitcnt lgkmcnt(0)
    v_mfma_f32_32x32x16_bf16 v[32:47], v[136:139], v[128:131], v[32:47]
    ds_read_b128 v[148:151], v18 offset:0
    ds_read_b128 v[152:155], v18 offset:4096
    v_lshlrev_b32 v237, 2, v1
    s_lshl_b32 s35, s51, 9
    v_add_u32 v236, s35, v237
    v_mfma_f32_32x32x16_bf16 v[48:63], v[136:139], v[132:135], v[48:63]
    ds_read_b64_tr_b16 v[156:157], v21 offset:18432
    ds_read_b64_tr_b16 v[158:159], v21 offset:18944
    ds_read_b32 v168, v236 offset:0
    ds_read_b32 v240, v236 offset:256
    ds_read_b32 v170, v236 offset:512
    v_mfma_f32_32x32x16_bf16 v[64:79], v[140:143], v[128:131], v[64:79]
    ds_read_b64_tr_b16 v[160:161], v21 offset:26624
    ds_read_b64_tr_b16 v[162:163], v21 offset:27136
    ds_read_b32 v244, v236 offset:768
    s_mul_i32 s35, s49, 768
    v_add_u32 v236, s35, v237
    v_mfma_f32_32x32x16_bf16 v[80:95], v[140:143], v[132:135], v[80:95]
    ds_read_b64_tr_b16 v[164:165], v21 offset:34816
    ds_read_b64_tr_b16 v[166:167], v21 offset:35328
    ds_read_b32 v248, v236 offset:2048
    ds_read_b32 v249, v236 offset:2304
    ds_read_b32 v250, v236 offset:2560
    v_mfma_f32_32x32x16_bf16 v[96:111], v[144:147], v[128:131], v[96:111]
    s_waitcnt vmcnt(0)
    v_lshl_or_b32 v220, v221, 16, v220
    v_lshl_or_b32 v221, v223, 16, v222
    v_lshl_or_b32 v222, v225, 16, v224
    v_lshl_or_b32 v223, v227, 16, v226
    v_mfma_f32_32x32x16_bf16 v[112:127], v[144:147], v[132:135], v[112:127]
    v_lshl_or_b32 v224, v229, 16, v228
    v_lshl_or_b32 v225, v231, 16, v230
    v_lshl_or_b32 v226, v233, 16, v232
    v_lshl_or_b32 v227, v235, 16, v234
    s_lshl_b32 s35, s51, 5
    s_waitcnt lgkmcnt(0)
    v_mfma_f32_32x32x16_bf16 v[32:47], v[156:159], v[148:151], v[32:47]
    ds_read_b128 v[128:131], v19 offset:0
    ds_read_b128 v[132:135], v19 offset:4096
    v_add_u32 v238, s35, v2
    v_mul_u32_u24 v238, 200, v238
    v_lshl_add_u32 v238, v3, 3, v238
    v_mfma_f32_32x32x16_bf16 v[48:63], v[156:159], v[152:155], v[48:63]
    ds_read_b64_tr_b16 v[136:137], v21 offset:20480
    ds_read_b64_tr_b16 v[138:139], v21 offset:20992
    s_mul_i32 s35, s49, 25600
    v_add_u32 v238, s35, v238
    s_and_b32 s35, s3, 3
    v_mfma_f32_32x32x16_bf16 v[64:79], v[160:163], v[148:151], v[64:79]
    ds_read_b64_tr_b16 v[140:141], v21 offset:28672
    ds_read_b64_tr_b16 v[142:143], v21 offset:29184
    s_lshl_b32 s35, s35, 12
    s_add_u32 s35, s35, 51200
    v_lshlrev_b32 v239, 4, v1
    v_mfma_f32_32x32x16_bf16 v[80:95], v[160:163], v[152:155], v[80:95]
    ds_read_b64_tr_b16 v[144:145], v21 offset:36864
    ds_read_b64_tr_b16 v[146:147], v21 offset:37376
    v_add_u32 v239, s35, v239
    s_waitcnt lgkmcnt(0)
    v_mov_b32 v169, v168
    v_mfma_f32_32x32x16_bf16 v[96:111], v[164:167], v[148:151], v[96:111]
    v_mov_b32 v241, v240
    v_mov_b32 v242, v240
    v_mov_b32 v243, v240
    v_mov_b32 v171, v170
    v_mov_b32 v245, v244
    v_mfma_f32_32x32x16_bf16 v[112:127], v[164:167], v[152:155], v[112:127]
    v_mov_b32 v246, v244
    v_mov_b32 v247, v244
    v_mul_f32 v172, 0x3fb8aa3b, v168
    v_mov_b32 v173, v172
    v_mov_b32 v208, v248
    s_waitcnt lgkmcnt(0)
    v_mfma_f32_32x32x16_bf16 v[32:47], v[136:139], v[128:131], v[32:47]
    ds_read_b128 v[148:151], v20 offset:0
    ds_read_b128 v[152:155], v20 offset:4096
    v_mov_b32 v209, 0
    v_mov_b32 v210, 0
    v_mov_b32 v211, 0
    v_mfma_f32_32x32x16_bf16 v[48:63], v[136:139], v[132:135], v[48:63]
    ds_read_b64_tr_b16 v[156:157], v21 offset:22528
    ds_read_b64_tr_b16 v[158:159], v21 offset:23040
    v_mov_b32 v212, v249
    v_mov_b32 v213, 0
    v_mov_b32 v214, 0
    v_mfma_f32_32x32x16_bf16 v[64:79], v[140:143], v[128:131], v[64:79]
    ds_read_b64_tr_b16 v[160:161], v21 offset:30720
    ds_read_b64_tr_b16 v[162:163], v21 offset:31232
    v_mov_b32 v215, 0
    v_mov_b32 v216, v250
    v_mov_b32 v217, 0
    v_mfma_f32_32x32x16_bf16 v[80:95], v[140:143], v[132:135], v[80:95]
    ds_read_b64_tr_b16 v[164:165], v21 offset:38912
    ds_read_b64_tr_b16 v[166:167], v21 offset:39424
    v_mov_b32 v218, 0
    v_mov_b32 v219, 0
    v_mfma_f32_32x32x16_bf16 v[96:111], v[144:147], v[128:131], v[96:111]
    v_mfma_f32_32x32x16_bf16 v[112:127], v[144:147], v[132:135], v[112:127]
    s_waitcnt lgkmcnt(0)
    v_mfma_f32_32x32x16_bf16 v[32:47], v[156:159], v[148:151], v[32:47]
    s_barrier
    v_mfma_f32_32x32x16_bf16 v[48:63], v[156:159], v[152:155], v[48:63]
    v_mfma_f32_32x32x16_bf16 v[64:79], v[160:163], v[148:151], v[64:79]
    v_mfma_f32_32x32x16_bf16 v[80:95], v[160:163], v[152:155], v[80:95]
    v_mfma_f32_32x32x16_bf16 v[96:111], v[164:167], v[148:151], v[96:111]
    v_mfma_f32_32x32x16_bf16 v[112:127], v[164:167], v[152:155], v[112:127]
    v_mfma_f32_32x32x16_bf16 v[80:95], v[212:215], v[244:247], v[80:95]
    v_mfma_f32_32x32x16_bf16 v[48:63], v[208:211], v[244:247], v[48:63]
    v_mfma_f32_32x32x16_bf16 v[64:79], v[212:215], v[240:243], v[64:79]
    v_mfma_f32_32x32x16_bf16 v[96:111], v[216:219], v[240:243], v[96:111]
    v_mfma_f32_32x32x16_bf16 v[112:127], v[216:219], v[244:247], v[112:127]
    v_mfma_f32_32x32x16_bf16 v[32:47], v[208:211], v[240:243], v[32:47]
    v_lshlrev_b32 v4, 3, v1
    v_add_u32 v4, 77824, v4
    v_mov_b32 v6, 0
    v_mov_b32 v7, 0
    ds_write_b64 v4, v[6:7]
    v_mov_b32 v4, 163780
    v_mov_b32 v5, 0
    ds_write_b32 v4, v5
    v_mov_b32 v4, 163784
    v_mov_b32 v5, 0
    ds_write_b32 v4, v5
    v_mov_b32 v4, 163788
    v_mov_b32 v5, 0
    ds_write_b32 v4, v5
    v_cvt_pk_bf16_f32 v128, v80, v81
    v_cvt_pk_bf16_f32 v129, v82, v83
    v_cvt_pk_bf16_f32 v130, v84, v85
    v_cvt_pk_bf16_f32 v131, v86, v87
    v_cvt_pk_bf16_f32 v132, v88, v89
    v_cvt_pk_bf16_f32 v133, v90, v91
    v_cvt_pk_bf16_f32 v134, v92, v93
    v_cvt_pk_bf16_f32 v135, v94, v95
    ds_write_b128 v239, v[128:131] offset:0
    ds_write_b128 v239, v[132:135] offset:1024
    v_cvt_pk_bf16_f32 v136, v48, v49
    v_cvt_pk_bf16_f32 v137, v50, v51
    v_cvt_pk_bf16_f32 v138, v52, v53
    v_cvt_pk_bf16_f32 v139, v54, v55
    v_cvt_pk_bf16_f32 v140, v56, v57
    v_cvt_pk_bf16_f32 v141, v58, v59
    v_cvt_pk_bf16_f32 v142, v60, v61
    v_cvt_pk_bf16_f32 v143, v62, v63
    ds_write_b128 v239, v[136:139] offset:2048
    ds_write_b128 v239, v[140:143] offset:3072
    v_cvt_pk_bf16_f32 v144, v64, v65
    v_cvt_pk_bf16_f32 v145, v66, v67
    v_cvt_pk_bf16_f32 v146, v68, v69
    v_cvt_pk_bf16_f32 v147, v70, v71
    v_cvt_pk_bf16_f32 v148, v72, v73
    v_cvt_pk_bf16_f32 v149, v74, v75
    v_cvt_pk_bf16_f32 v150, v76, v77
    v_cvt_pk_bf16_f32 v151, v78, v79
    s_waitcnt lgkmcnt(0)
    s_barrier
    v_mfma_f32_32x32x16_bf16 v[64:79], v[220:223], v[144:147], 0
    v_mfma_f32_32x32x16_bf16 v[64:79], v[224:227], v[148:151], v[64:79]
    v_pk_mul_f32 v[96:97], v[96:97], v[168:169]
    v_pk_mul_f32 v[98:99], v[98:99], v[168:169]
    v_pk_mul_f32 v[100:101], v[100:101], v[168:169]
    v_pk_mul_f32 v[102:103], v[102:103], v[168:169]
    v_pk_mul_f32 v[104:105], v[104:105], v[168:169]
    v_pk_mul_f32 v[106:107], v[106:107], v[168:169]
    v_pk_mul_f32 v[108:109], v[108:109], v[168:169]
    v_pk_mul_f32 v[110:111], v[110:111], v[168:169]
    v_cvt_pk_bf16_f32 v128, v96, v97
    v_cvt_pk_bf16_f32 v129, v98, v99
    v_cvt_pk_bf16_f32 v130, v100, v101
    v_cvt_pk_bf16_f32 v131, v102, v103
    v_cvt_pk_bf16_f32 v132, v104, v105
    v_cvt_pk_bf16_f32 v133, v106, v107
    v_cvt_pk_bf16_f32 v134, v108, v109
    v_cvt_pk_bf16_f32 v135, v110, v111
    ds_write_b64 v238, v[128:129] offset:128
    ds_write_b64 v238, v[130:131] offset:144
    ds_write_b64 v238, v[132:133] offset:160
    ds_write_b64 v238, v[134:135] offset:176
    v_pk_mul_f32 v[112:113], v[112:113], v[170:171]
    v_pk_mul_f32 v[114:115], v[114:115], v[170:171]
    v_pk_mul_f32 v[116:117], v[116:117], v[170:171]
    v_pk_mul_f32 v[118:119], v[118:119], v[170:171]
    v_pk_mul_f32 v[120:121], v[120:121], v[170:171]
    v_pk_mul_f32 v[122:123], v[122:123], v[170:171]
    v_pk_mul_f32 v[124:125], v[124:125], v[170:171]
    v_pk_mul_f32 v[126:127], v[126:127], v[170:171]
    v_cvt_pk_bf16_f32 v136, v112, v113
    v_cvt_pk_bf16_f32 v137, v114, v115
    v_cvt_pk_bf16_f32 v138, v116, v117
    v_cvt_pk_bf16_f32 v139, v118, v119
    v_cvt_pk_bf16_f32 v140, v120, v121
    v_cvt_pk_bf16_f32 v141, v122, v123
    v_cvt_pk_bf16_f32 v142, v124, v125
    v_cvt_pk_bf16_f32 v143, v126, v127
    ds_write_b64 v238, v[136:137] offset:6528
    ds_write_b64 v238, v[138:139] offset:6544
    ds_write_b64 v238, v[140:141] offset:6560
    ds_write_b64 v238, v[142:143] offset:6576
    v_cvt_pk_bf16_f32 v160, v32, v33
    v_cvt_pk_bf16_f32 v161, v34, v35
    v_cvt_pk_bf16_f32 v162, v36, v37
    v_cvt_pk_bf16_f32 v163, v38, v39
    v_cvt_pk_bf16_f32 v164, v40, v41
    v_cvt_pk_bf16_f32 v165, v42, v43
    v_cvt_pk_bf16_f32 v166, v44, v45
    v_cvt_pk_bf16_f32 v167, v46, v47
    s_branch L_qa0_j0_2
L_qa0_ld_1:
    v_lshlrev_b32 v10, 1, v2
    v_lshl_add_u32 v10, v3, 8, v10
    s_lshl_b32 s34, s50, 11
    buffer_load_ushort v220, v10, s[20:23], s34 offen offset:0
    buffer_load_ushort v221, v10, s[20:23], s34 offen offset:64
    buffer_load_ushort v222, v10, s[20:23], s34 offen offset:128
    buffer_load_ushort v223, v10, s[20:23], s34 offen offset:192
    buffer_load_ushort v224, v10, s[20:23], s34 offen offset:512
    buffer_load_ushort v225, v10, s[20:23], s34 offen offset:576
    buffer_load_ushort v226, v10, s[20:23], s34 offen offset:640
    buffer_load_ushort v227, v10, s[20:23], s34 offen offset:704
    buffer_load_ushort v228, v10, s[20:23], s34 offen offset:1024
    buffer_load_ushort v229, v10, s[20:23], s34 offen offset:1088
    buffer_load_ushort v230, v10, s[20:23], s34 offen offset:1152
    buffer_load_ushort v231, v10, s[20:23], s34 offen offset:1216
    buffer_load_ushort v232, v10, s[20:23], s34 offen offset:1536
    buffer_load_ushort v233, v10, s[20:23], s34 offen offset:1600
    buffer_load_ushort v234, v10, s[20:23], s34 offen offset:1664
    buffer_load_ushort v235, v10, s[20:23], s34 offen offset:1728
    s_sub_u32 s30, s3, 4
    v_lshrrev_b32 v6, 3, v1
    v_and_b32 v7, 7, v1
    s_lshl_b32 s31, s30, 4
    s_mov_b32 s33, 6144
    v_lshrrev_b32 v5, 1, v6
    v_and_b32 v5, 1, v5
    v_lshlrev_b32 v5, 2, v5
    v_xor_b32 v5, v5, v7
    v_lshlrev_b32 v5, 4, v5
    s_lshl_b32 s32, s5, 7
    v_add_u32 v5, s32, v5
    v_add_u32 v4, 0, v6
    v_add_u32 v4, s31, v4
    v_mul_lo_u32 v4, v4, s33
    v_add_u32 v12, v4, v5
    v_add_u32 v4, 8, v6
    v_add_u32 v4, s31, v4
    v_mul_lo_u32 v4, v4, s33
    v_add_u32 v13, v4, v5
    v_subrev_u32 v13, 1024, v13
    v_add_u32 v14, 2048, v12
    v_add_u32 v15, 2048, v13
    v_add_u32 v16, 4096, v12
    v_add_u32 v17, 4096, v13
    v_lshlrev_b32 v8, 4, v1
    s_lshl_b32 s34, s30, 12
    s_lshl_b32 s35, s30, 11
    s_add_u32 s35, s35, 16384
    s_lshl_b32 s36, s30, 10
    s_add_u32 s36, s36, 40960
    s_lshl_b32 s37, s4, 2
    s_add_u32 s37, s37, s30
    s_lshl_b32 s37, s37, 16
    s_mov_b32 s38, 0
    s_mov_b32 s39, 0
    s_lshl_b32 s31, s4, 7
    s_lshl_b32 s32, s30, 5
    s_add_u32 s31, s31, s32
    s_add_u32 s61, s4, s5
    s_and_b32 s61, s61, 15
    s_mov_b32 s62, s61
    s_lshl_b32 s37, s61, 7
    s_mul_i32 s38, s61, 393216
    v_add_u32 v4, 0, v6
    v_lshrrev_b32 v5, 1, v4
    v_and_b32 v5, 7, v5
    v_xor_b32 v5, v5, v7
    v_add_u32 v4, s31, v4
    v_lshlrev_b32 v4, 11, v4
    v_lshl_add_u32 v20, v5, 4, v4
    v_add_u32 v4, 8, v6
    v_lshrrev_b32 v5, 1, v4
    v_and_b32 v5, 7, v5
    v_xor_b32 v5, v5, v7
    v_add_u32 v4, s31, v4
    v_lshlrev_b32 v4, 11, v4
    v_lshl_add_u32 v21, v5, 4, v4
    v_subrev_u32 v21, 1024, v21
    v_add_u32 v4, 16, v6
    v_lshrrev_b32 v5, 1, v4
    v_and_b32 v5, 7, v5
    v_xor_b32 v5, v5, v7
    v_add_u32 v4, s31, v4
    v_lshlrev_b32 v4, 11, v4
    v_lshl_add_u32 v22, v5, 4, v4
    v_subrev_u32 v22, 2048, v22
    v_add_u32 v4, 24, v6
    v_lshrrev_b32 v5, 1, v4
    v_and_b32 v5, 7, v5
    v_xor_b32 v5, v5, v7
    v_add_u32 v4, s31, v4
    v_lshlrev_b32 v4, 11, v4
    v_lshl_add_u32 v23, v5, 4, v4
    v_subrev_u32 v23, 3072, v23
    s_add_u32 m0, s34, 0
    s_nop 0
    buffer_load_dwordx4 v20, s[8:11], s37 offen offset:0 lds
    buffer_load_dwordx4 v21, s[8:11], s37 offen offset:1024 lds
    buffer_load_dwordx4 v22, s[8:11], s37 offen offset:2048 lds
    buffer_load_dwordx4 v23, s[8:11], s37 offen offset:3072 lds
    s_cmp_le_u32 s61, 0
    s_cselect_b32 s62, 1, 0
    s_lshl_b32 s37, s62, 7
    s_add_u32 m0, s35, 0
    s_nop 0
    buffer_load_dwordx4 v12, s[12:15], s38 offen offset:0 lds
    buffer_load_dwordx4 v13, s[12:15], s38 offen offset:1024 lds
    s_add_u32 m0, s35, 8192
    s_nop 0
    buffer_load_dwordx4 v14, s[12:15], s38 offen offset:0 lds
    buffer_load_dwordx4 v15, s[12:15], s38 offen offset:1024 lds
    s_add_u32 m0, s35, 16384
    s_nop 0
    buffer_load_dwordx4 v16, s[12:15], s38 offen offset:0 lds
    buffer_load_dwordx4 v17, s[12:15], s38 offen offset:1024 lds
    s_cmp_le_u32 s61, 0
    s_cselect_b32 s62, 1, 0
    s_mul_i32 s38, s62, 393216
    s_add_u32 m0, s34, 40960
    s_nop 0
    buffer_load_dwordx4 v20, s[8:11], s37 offen offset:0 lds
    buffer_load_dwordx4 v21, s[8:11], s37 offen offset:1024 lds
    buffer_load_dwordx4 v22, s[8:11], s37 offen offset:2048 lds
    buffer_load_dwordx4 v23, s[8:11], s37 offen offset:3072 lds
    s_cmp_le_u32 s61, 1
    s_cselect_b32 s62, 2, 1
    s_lshl_b32 s37, s62, 7
    s_add_u32 m0, s35, 40960
    s_nop 0
    buffer_load_dwordx4 v12, s[12:15], s38 offen offset:0 lds
    buffer_load_dwordx4 v13, s[12:15], s38 offen offset:1024 lds
    s_add_u32 m0, s35, 49152
    s_nop 0
    buffer_load_dwordx4 v14, s[12:15], s38 offen offset:0 lds
    buffer_load_dwordx4 v15, s[12:15], s38 offen offset:1024 lds
    s_add_u32 m0, s35, 57344
    s_nop 0
    buffer_load_dwordx4 v16, s[12:15], s38 offen offset:0 lds
    buffer_load_dwordx4 v17, s[12:15], s38 offen offset:1024 lds
    s_cmp_le_u32 s61, 1
    s_cselect_b32 s62, 2, 1
    s_mul_i32 s38, s62, 393216
    s_waitcnt vmcnt(10)
    s_barrier
    s_add_u32 m0, s34, 81920
    s_nop 0
    buffer_load_dwordx4 v20, s[8:11], s37 offen offset:0 lds
    buffer_load_dwordx4 v21, s[8:11], s37 offen offset:1024 lds
    buffer_load_dwordx4 v22, s[8:11], s37 offen offset:2048 lds
    buffer_load_dwordx4 v23, s[8:11], s37 offen offset:3072 lds
    s_cmp_le_u32 s61, 2
    s_cselect_b32 s62, 3, 2
    s_lshl_b32 s37, s62, 7
    s_add_u32 m0, s35, 81920
    s_nop 0
    buffer_load_dwordx4 v12, s[12:15], s38 offen offset:0 lds
    buffer_load_dwordx4 v13, s[12:15], s38 offen offset:1024 lds
    s_add_u32 m0, s35, 90112
    s_nop 0
    buffer_load_dwordx4 v14, s[12:15], s38 offen offset:0 lds
    buffer_load_dwordx4 v15, s[12:15], s38 offen offset:1024 lds
    s_add_u32 m0, s35, 98304
    s_nop 0
    buffer_load_dwordx4 v16, s[12:15], s38 offen offset:0 lds
    buffer_load_dwordx4 v17, s[12:15], s38 offen offset:1024 lds
    s_cmp_le_u32 s61, 2
    s_cselect_b32 s62, 3, 2
    s_mul_i32 s38, s62, 393216
    s_add_u32 m0, s34, 122880
    s_nop 0
    buffer_load_dwordx4 v20, s[8:11], s37 offen offset:0 lds
    buffer_load_dwordx4 v21, s[8:11], s37 offen offset:1024 lds
    buffer_load_dwordx4 v22, s[8:11], s37 offen offset:2048 lds
    buffer_load_dwordx4 v23, s[8:11], s37 offen offset:3072 lds
    s_cmp_le_u32 s61, 3
    s_cselect_b32 s62, 4, 3
    s_lshl_b32 s37, s62, 7
    s_add_u32 m0, s35, 122880
    s_nop 0
    buffer_load_dwordx4 v12, s[12:15], s38 offen offset:0 lds
    buffer_load_dwordx4 v13, s[12:15], s38 offen offset:1024 lds
    s_add_u32 m0, s35, 131072
    s_nop 0
    buffer_load_dwordx4 v14, s[12:15], s38 offen offset:0 lds
    buffer_load_dwordx4 v15, s[12:15], s38 offen offset:1024 lds
    s_add_u32 m0, s35, 139264
    s_nop 0
    buffer_load_dwordx4 v16, s[12:15], s38 offen offset:0 lds
    buffer_load_dwordx4 v17, s[12:15], s38 offen offset:1024 lds
    s_cmp_le_u32 s61, 3
    s_cselect_b32 s62, 4, 3
    s_mul_i32 s38, s62, 393216
    s_lshl_b32 s56, s2, 2
    s_add_u32 s56, s56, s30
    s_mul_i32 s56, s56, 48
    s_add_u32 s56, s56, 0x2800000
    v_min_u32 v25, 11, v1
    v_lshlrev_b32 v25, 2, v25
    v_mov_b32 v26, 0
    buffer_store_dword v26, v25, s[16:19], s56 offen sc1
    s_waitcnt vmcnt(21)
    s_barrier
    s_add_u32 m0, s34, 0
    s_nop 0
    buffer_load_dwordx4 v20, s[8:11], s37 offen offset:0 lds
    buffer_load_dwordx4 v21, s[8:11], s37 offen offset:1024 lds
    buffer_load_dwordx4 v22, s[8:11], s37 offen offset:2048 lds
    buffer_load_dwordx4 v23, s[8:11], s37 offen offset:3072 lds
    s_cmp_le_u32 s61, 4
    s_cselect_b32 s62, 5, 4
    s_lshl_b32 s37, s62, 7
    s_add_u32 m0, s35, 0
    s_nop 0
    buffer_load_dwordx4 v12, s[12:15], s38 offen offset:0 lds
    buffer_load_dwordx4 v13, s[12:15], s38 offen offset:1024 lds
    s_add_u32 m0, s35, 8192
    s_nop 0
    buffer_load_dwordx4 v14, s[12:15], s38 offen offset:0 lds
    buffer_load_dwordx4 v15, s[12:15], s38 offen offset:1024 lds
    s_add_u32 m0, s35, 16384
    s_nop 0
    buffer_load_dwordx4 v16, s[12:15], s38 offen offset:0 lds
    buffer_load_dwordx4 v17, s[12:15], s38 offen offset:1024 lds
    s_cmp_le_u32 s61, 4
    s_cselect_b32 s62, 5, 4
    s_mul_i32 s38, s62, 393216
    s_waitcnt vmcnt(21)
    s_barrier
    s_add_u32 m0, s34, 40960
    s_nop 0
    buffer_load_dwordx4 v20, s[8:11], s37 offen offset:0 lds
    buffer_load_dwordx4 v21, s[8:11], s37 offen offset:1024 lds
    buffer_load_dwordx4 v22, s[8:11], s37 offen offset:2048 lds
    buffer_load_dwordx4 v23, s[8:11], s37 offen offset:3072 lds
    s_cmp_le_u32 s61, 5
    s_cselect_b32 s62, 6, 5
    s_lshl_b32 s37, s62, 7
    s_add_u32 m0, s35, 40960
    s_nop 0
    buffer_load_dwordx4 v12, s[12:15], s38 offen offset:0 lds
    buffer_load_dwordx4 v13, s[12:15], s38 offen offset:1024 lds
    s_add_u32 m0, s35, 49152
    s_nop 0
    buffer_load_dwordx4 v14, s[12:15], s38 offen offset:0 lds
    buffer_load_dwordx4 v15, s[12:15], s38 offen offset:1024 lds
    s_add_u32 m0, s35, 57344
    s_nop 0
    buffer_load_dwordx4 v16, s[12:15], s38 offen offset:0 lds
    buffer_load_dwordx4 v17, s[12:15], s38 offen offset:1024 lds
    s_cmp_le_u32 s61, 5
    s_cselect_b32 s62, 6, 5
    s_mul_i32 s38, s62, 393216
    s_waitcnt vmcnt(21)
    s_barrier
    s_add_u32 m0, s34, 81920
    s_nop 0
    buffer_load_dwordx4 v20, s[8:11], s37 offen offset:0 lds
    buffer_load_dwordx4 v21, s[8:11], s37 offen offset:1024 lds
    buffer_load_dwordx4 v22, s[8:11], s37 offen offset:2048 lds
    buffer_load_dwordx4 v23, s[8:11], s37 offen offset:3072 lds
    s_cmp_le_u32 s61, 6
    s_cselect_b32 s62, 7, 6
    s_lshl_b32 s37, s62, 7
    s_add_u32 m0, s35, 81920
    s_nop 0
    buffer_load_dwordx4 v12, s[12:15], s38 offen offset:0 lds
    buffer_load_dwordx4 v13, s[12:15], s38 offen offset:1024 lds
    s_add_u32 m0, s35, 90112
    s_nop 0
    buffer_load_dwordx4 v14, s[12:15], s38 offen offset:0 lds
    buffer_load_dwordx4 v15, s[12:15], s38 offen offset:1024 lds
    s_add_u32 m0, s35, 98304
    s_nop 0
    buffer_load_dwordx4 v16, s[12:15], s38 offen offset:0 lds
    buffer_load_dwordx4 v17, s[12:15], s38 offen offset:1024 lds
    s_cmp_le_u32 s61, 6
    s_cselect_b32 s62, 7, 6
    s_mul_i32 s38, s62, 393216
    s_waitcnt vmcnt(30)
    s_waitcnt vmcnt(20)
    s_barrier
    s_add_u32 m0, s34, 122880
    s_nop 0
    buffer_load_dwordx4 v20, s[8:11], s37 offen offset:0 lds
    buffer_load_dwordx4 v21, s[8:11], s37 offen offset:1024 lds
    buffer_load_dwordx4 v22, s[8:11], s37 offen offset:2048 lds
    buffer_load_dwordx4 v23, s[8:11], s37 offen offset:3072 lds
    s_cmp_le_u32 s61, 7
    s_cselect_b32 s62, 8, 7
    s_lshl_b32 s37, s62, 7
    s_add_u32 m0, s35, 122880
    s_nop 0
    buffer_load_dwordx4 v12, s[12:15], s38 offen offset:0 lds
    buffer_load_dwordx4 v13, s[12:15], s38 offen offset:1024 lds
    s_add_u32 m0, s35, 131072
    s_nop 0
    buffer_load_dwordx4 v14, s[12:15], s38 offen offset:0 lds
    buffer_load_dwordx4 v15, s[12:15], s38 offen offset:1024 lds
    s_add_u32 m0, s35, 139264
    s_nop 0
    buffer_load_dwordx4 v16, s[12:15], s38 offen offset:0 lds
    buffer_load_dwordx4 v17, s[12:15], s38 offen offset:1024 lds
    s_cmp_le_u32 s61, 7
    s_cselect_b32 s62, 8, 7
    s_mul_i32 s38, s62, 393216
    s_waitcnt vmcnt(20)
    s_barrier
    s_add_u32 m0, s34, 0
    s_nop 0
    buffer_load_dwordx4 v20, s[8:11], s37 offen offset:0 lds
    buffer_load_dwordx4 v21, s[8:11], s37 offen offset:1024 lds
    buffer_load_dwordx4 v22, s[8:11], s37 offen offset:2048 lds
    buffer_load_dwordx4 v23, s[8:11], s37 offen offset:3072 lds
    s_cmp_le_u32 s61, 8
    s_cselect_b32 s62, 9, 8
    s_lshl_b32 s37, s62, 7
    s_add_u32 m0, s35, 0
    s_nop 0
    buffer_load_dwordx4 v12, s[12:15], s38 offen offset:0 lds
    buffer_load_dwordx4 v13, s[12:15], s38 offen offset:1024 lds
    s_add_u32 m0, s35, 8192
    s_nop 0
    buffer_load_dwordx4 v14, s[12:15], s38 offen offset:0 lds
    buffer_load_dwordx4 v15, s[12:15], s38 offen offset:1024 lds
    s_add_u32 m0, s35, 16384
    s_nop 0
    buffer_load_dwordx4 v16, s[12:15], s38 offen offset:0 lds
    buffer_load_dwordx4 v17, s[12:15], s38 offen offset:1024 lds
    s_cmp_le_u32 s61, 8
    s_cselect_b32 s62, 9, 8
    s_mul_i32 s38, s62, 393216
    s_mov_b32 s24, s84
    s_and_b32 s25, s85, 0xffff
    s_mov_b32 s26, 0x100
    s_mov_b32 s27, 0x20000
    s_and_b32 s56, s2, 1
    s_lshl_b32 s56, s56, 7
    s_cmp_eq_u32 s3, 4
    s_cselect_b32 s56, s56, 0x7ffff000
    v_mov_b32 v4, 1
    v_mov_b32 v5, 0
    s_mov_b64 exec, 1
    buffer_atomic_add v4, v5, s[24:27], s56 offen sc1
    s_mov_b64 exec, -1
    s_waitcnt vmcnt(21)
    s_barrier
    s_add_u32 m0, s34, 40960
    s_nop 0
    buffer_load_dwordx4 v20, s[8:11], s37 offen offset:0 lds
    buffer_load_dwordx4 v21, s[8:11], s37 offen offset:1024 lds
    buffer_load_dwordx4 v22, s[8:11], s37 offen offset:2048 lds
    buffer_load_dwordx4 v23, s[8:11], s37 offen offset:3072 lds
    s_cmp_le_u32 s61, 9
    s_cselect_b32 s62, 10, 9
    s_lshl_b32 s37, s62, 7
    s_add_u32 m0, s35, 40960
    s_nop 0
    buffer_load_dwordx4 v12, s[12:15], s38 offen offset:0 lds
    buffer_load_dwordx4 v13, s[12:15], s38 offen offset:1024 lds
    s_add_u32 m0, s35, 49152
    s_nop 0
    buffer_load_dwordx4 v14, s[12:15], s38 offen offset:0 lds
    buffer_load_dwordx4 v15, s[12:15], s38 offen offset:1024 lds
    s_add_u32 m0, s35, 57344
    s_nop 0
    buffer_load_dwordx4 v16, s[12:15], s38 offen offset:0 lds
    buffer_load_dwordx4 v17, s[12:15], s38 offen offset:1024 lds
    s_cmp_le_u32 s61, 9
    s_cselect_b32 s62, 10, 9
    s_mul_i32 s38, s62, 393216
    s_waitcnt vmcnt(21)
    s_barrier
    s_add_u32 m0, s34, 81920
    s_nop 0
    buffer_load_dwordx4 v20, s[8:11], s37 offen offset:0 lds
    buffer_load_dwordx4 v21, s[8:11], s37 offen offset:1024 lds
    buffer_load_dwordx4 v22, s[8:11], s37 offen offset:2048 lds
    buffer_load_dwordx4 v23, s[8:11], s37 offen offset:3072 lds
    s_cmp_le_u32 s61, 10
    s_cselect_b32 s62, 11, 10
    s_lshl_b32 s37, s62, 7
    s_add_u32 m0, s35, 81920
    s_nop 0
    buffer_load_dwordx4 v12, s[12:15], s38 offen offset:0 lds
    buffer_load_dwordx4 v13, s[12:15], s38 offen offset:1024 lds
    s_add_u32 m0, s35, 90112
    s_nop 0
    buffer_load_dwordx4 v14, s[12:15], s38 offen offset:0 lds
    buffer_load_dwordx4 v15, s[12:15], s38 offen offset:1024 lds
    s_add_u32 m0, s35, 98304
    s_nop 0
    buffer_load_dwordx4 v16, s[12:15], s38 offen offset:0 lds
    buffer_load_dwordx4 v17, s[12:15], s38 offen offset:1024 lds
    s_cmp_le_u32 s61, 10
    s_cselect_b32 s62, 11, 10
    s_mul_i32 s38, s62, 393216
    s_waitcnt vmcnt(21)
    s_barrier
    s_add_u32 m0, s34, 122880
    s_nop 0
    buffer_load_dwordx4 v20, s[8:11], s37 offen offset:0 lds
    buffer_load_dwordx4 v21, s[8:11], s37 offen offset:1024 lds
    buffer_load_dwordx4 v22, s[8:11], s37 offen offset:2048 lds
    buffer_load_dwordx4 v23, s[8:11], s37 offen offset:3072 lds
    s_cmp_le_u32 s61, 11
    s_cselect_b32 s62, 12, 11
    s_lshl_b32 s37, s62, 7
    s_add_u32 m0, s35, 122880
    s_nop 0
    buffer_load_dwordx4 v12, s[12:15], s38 offen offset:0 lds
    buffer_load_dwordx4 v13, s[12:15], s38 offen offset:1024 lds
    s_add_u32 m0, s35, 131072
    s_nop 0
    buffer_load_dwordx4 v14, s[12:15], s38 offen offset:0 lds
    buffer_load_dwordx4 v15, s[12:15], s38 offen offset:1024 lds
    s_add_u32 m0, s35, 139264
    s_nop 0
    buffer_load_dwordx4 v16, s[12:15], s38 offen offset:0 lds
    buffer_load_dwordx4 v17, s[12:15], s38 offen offset:1024 lds
    s_cmp_le_u32 s61, 11
    s_cselect_b32 s62, 12, 11
    s_mul_i32 s38, s62, 393216
    s_waitcnt vmcnt(20)
    s_barrier
    s_add_u32 m0, s34, 0
    s_nop 0
    buffer_load_dwordx4 v20, s[8:11], s37 offen offset:0 lds
    buffer_load_dwordx4 v21, s[8:11], s37 offen offset:1024 lds
    buffer_load_dwordx4 v22, s[8:11], s37 offen offset:2048 lds
    buffer_load_dwordx4 v23, s[8:11], s37 offen offset:3072 lds
    s_cmp_le_u32 s61, 12
    s_cselect_b32 s62, 13, 12
    s_lshl_b32 s37, s62, 7
    s_add_u32 m0, s35, 0
    s_nop 0
    buffer_load_dwordx4 v12, s[12:15], s38 offen offset:0 lds
    buffer_load_dwordx4 v13, s[12:15], s38 offen offset:1024 lds
    s_add_u32 m0, s35, 8192
    s_nop 0
    buffer_load_dwordx4 v14, s[12:15], s38 offen offset:0 lds
    buffer_load_dwordx4 v15, s[12:15], s38 offen offset:1024 lds
    s_add_u32 m0, s35, 16384
    s_nop 0
    buffer_load_dwordx4 v16, s[12:15], s38 offen offset:0 lds
    buffer_load_dwordx4 v17, s[12:15], s38 offen offset:1024 lds
    s_cmp_le_u32 s61, 12
    s_cselect_b32 s62, 13, 12
    s_mul_i32 s38, s62, 393216
    s_cmp_lg_u32 s3, 4
    s_cbranch_scc1 L_ipoll_24_ok
    v_and_b32 v4, 1, v1
    v_lshlrev_b32 v4, 7, v4
    s_mov_b32 s53, 0
L_ipoll_24:
    buffer_load_dword v5, v4, s[24:27], 0 offen sc1
    s_waitcnt vmcnt(0)
    v_cmp_gt_u32 vcc, 128, v5
    s_cbranch_vccz L_ipoll_24_ok
    s_sleep 4
    s_add_u32 s53, s53, 1
    s_cmp_lt_u32 s53, 0x40000
    s_cbranch_scc1 L_ipoll_24
L_ipoll_24_ok:
    s_waitcnt vmcnt(20)
    s_barrier
    s_add_u32 m0, s34, 40960
    s_nop 0
    buffer_load_dwordx4 v20, s[8:11], s37 offen offset:0 lds
    buffer_load_dwordx4 v21, s[8:11], s37 offen offset:1024 lds
    buffer_load_dwordx4 v22, s[8:11], s37 offen offset:2048 lds
    buffer_load_dwordx4 v23, s[8:11], s37 offen offset:3072 lds
    s_cmp_le_u32 s61, 13
    s_cselect_b32 s62, 14, 13
    s_lshl_b32 s37, s62, 7
    s_add_u32 m0, s35, 40960
    s_nop 0
    buffer_load_dwordx4 v12, s[12:15], s38 offen offset:0 lds
    buffer_load_dwordx4 v13, s[12:15], s38 offen offset:1024 lds
    s_add_u32 m0, s35, 49152
    s_nop 0
    buffer_load_dwordx4 v14, s[12:15], s38 offen offset:0 lds
    buffer_load_dwordx4 v15, s[12:15], s38 offen offset:1024 lds
    s_add_u32 m0, s35, 57344
    s_nop 0
    buffer_load_dwordx4 v16, s[12:15], s38 offen offset:0 lds
    buffer_load_dwordx4 v17, s[12:15], s38 offen offset:1024 lds
    s_cmp_le_u32 s61, 13
    s_cselect_b32 s62, 14, 13
    s_mul_i32 s38, s62, 393216
    v_lshlrev_b32 v10, 2, v1
    s_lshl_b32 s54, s4, 14
    s_lshl_b32 s55, s30, 8
    s_add_u32 s54, s54, s55
    s_add_u32 s54, s54, 0x2600000
    buffer_load_dword v176, v10, s[16:19], s54 offen offset:0 sc1
    buffer_load_dword v177, v10, s[16:19], s54 offen offset:1024 sc1
    buffer_load_dword v178, v10, s[16:19], s54 offen offset:2048 sc1
    buffer_load_dword v179, v10, s[16:19], s54 offen offset:3072 sc1
    s_add_u32 s54, s54, 4096
    buffer_load_dword v180, v10, s[16:19], s54 offen offset:0 sc1
    buffer_load_dword v181, v10, s[16:19], s54 offen offset:1024 sc1
    buffer_load_dword v182, v10, s[16:19], s54 offen offset:2048 sc1
    buffer_load_dword v183, v10, s[16:19], s54 offen offset:3072 sc1
    s_add_u32 s54, s54, 4096
    buffer_load_dword v184, v10, s[16:19], s54 offen offset:0 sc1
    buffer_load_dword v185, v10, s[16:19], s54 offen offset:1024 sc1
    buffer_load_dword v186, v10, s[16:19], s54 offen offset:2048 sc1
    buffer_load_dword v187, v10, s[16:19], s54 offen offset:3072 sc1
    s_add_u32 s54, s54, 4096
    buffer_load_dword v188, v10, s[16:19], s54 offen offset:0 sc1
    buffer_load_dword v189, v10, s[16:19], s54 offen offset:1024 sc1
    buffer_load_dword v190, v10, s[16:19], s54 offen offset:2048 sc1
    buffer_load_dword v191, v10, s[16:19], s54 offen offset:3072 sc1
    v_lshlrev_b32 v9, 2, v2
    v_lshl_add_u32 v9, v3, 10, v9
    s_mul_i32 s54, s50, 6144
    s_lshl_b32 s55, s48, 12
    s_add_u32 s54, s54, s55
    s_add_u32 s54, s54, 0x2700000
    buffer_load_dword v32, v9, s[16:19], s54 offen offset:0 sc1
    buffer_load_dword v33, v9, s[16:19], s54 offen offset:128 sc1
    buffer_load_dword v34, v9, s[16:19], s54 offen offset:256 sc1
    buffer_load_dword v35, v9, s[16:19], s54 offen offset:384 sc1
    buffer_load_dword v36, v9, s[16:19], s54 offen offset:512 sc1
    buffer_load_dword v37, v9, s[16:19], s54 offen offset:640 sc1
    buffer_load_dword v38, v9, s[16:19], s54 offen offset:768 sc1
    buffer_load_dword v39, v9, s[16:19], s54 offen offset:896 sc1
    buffer_load_dword v40, v9, s[16:19], s54 offen offset:2048 sc1
    buffer_load_dword v41, v9, s[16:19], s54 offen offset:2176 sc1
    buffer_load_dword v42, v9, s[16:19], s54 offen offset:2304 sc1
    buffer_load_dword v43, v9, s[16:19], s54 offen offset:2432 sc1
    buffer_load_dword v44, v9, s[16:19], s54 offen offset:2560 sc1
    buffer_load_dword v45, v9, s[16:19], s54 offen offset:2688 sc1
    buffer_load_dword v46, v9, s[16:19], s54 offen offset:2816 sc1
    buffer_load_dword v47, v9, s[16:19], s54 offen offset:2944 sc1
    s_waitcnt vmcnt(52)
    s_barrier
    s_add_u32 m0, s34, 81920
    s_nop 0
    buffer_load_dwordx4 v20, s[8:11], s37 offen offset:0 lds
    buffer_load_dwordx4 v21, s[8:11], s37 offen offset:1024 lds
    buffer_load_dwordx4 v22, s[8:11], s37 offen offset:2048 lds
    buffer_load_dwordx4 v23, s[8:11], s37 offen offset:3072 lds
    s_cmp_le_u32 s61, 14
    s_cselect_b32 s62, 15, 14
    s_lshl_b32 s37, s62, 7
    s_add_u32 m0, s35, 81920
    s_nop 0
    buffer_load_dwordx4 v12, s[12:15], s38 offen offset:0 lds
    buffer_load_dwordx4 v13, s[12:15], s38 offen offset:1024 lds
    s_add_u32 m0, s35, 90112
    s_nop 0
    buffer_load_dwordx4 v14, s[12:15], s38 offen offset:0 lds
    buffer_load_dwordx4 v15, s[12:15], s38 offen offset:1024 lds
    s_add_u32 m0, s35, 98304
    s_nop 0
    buffer_load_dwordx4 v16, s[12:15], s38 offen offset:0 lds
    buffer_load_dwordx4 v17, s[12:15], s38 offen offset:1024 lds
    s_cmp_le_u32 s61, 14
    s_cselect_b32 s62, 15, 14
    s_mul_i32 s38, s62, 393216
    s_waitcnt vmcnt(52)
    s_barrier
    s_add_u32 m0, s34, 122880
    s_nop 0
    buffer_load_dwordx4 v20, s[8:11], s37 offen offset:0 lds
    buffer_load_dwordx4 v21, s[8:11], s37 offen offset:1024 lds
    buffer_load_dwordx4 v22, s[8:11], s37 offen offset:2048 lds
    buffer_load_dwordx4 v23, s[8:11], s37 offen offset:3072 lds
    s_cmp_le_u32 s61, 15
    s_cselect_b32 s62, 16, 15
    s_lshl_b32 s37, s62, 7
    s_add_u32 m0, s35, 122880
    s_nop 0
    buffer_load_dwordx4 v12, s[12:15], s38 offen offset:0 lds
    buffer_load_dwordx4 v13, s[12:15], s38 offen offset:1024 lds
    s_add_u32 m0, s35, 131072
    s_nop 0
    buffer_load_dwordx4 v14, s[12:15], s38 offen offset:0 lds
    buffer_load_dwordx4 v15, s[12:15], s38 offen offset:1024 lds
    s_add_u32 m0, s35, 139264
    s_nop 0
    buffer_load_dwordx4 v16, s[12:15], s38 offen offset:0 lds
    buffer_load_dwordx4 v17, s[12:15], s38 offen offset:1024 lds
    s_cmp_le_u32 s61, 15
    s_cselect_b32 s62, 16, 15
    s_mul_i32 s38, s62, 393216
    s_waitcnt vmcnt(52)
    s_barrier
    s_setprio 2
    s_waitcnt vmcnt(20)
    v_pk_add_f32 v[176:177], v[176:177], v[184:185]
    v_pk_add_f32 v[178:179], v[178:179], v[186:187]
    v_pk_add_f32 v[180:181], v[180:181], v[188:189]
    v_pk_add_f32 v[182:183], v[182:183], v[190:191]
    v_pk_add_f32 v[176:177], v[176:177], v[180:181]
    v_pk_add_f32 v[178:179], v[178:179], v[182:183]
    v_pk_add_f32 v[176:177], v[176:177], v[178:179]
    v_add_f32 v176, v176, v177
    v_mul_f32 v176, 0x3a800000, v176
    v_mov_b32 v177, v176
    s_nop 1
    v_permlane32_swap_b32 v176, v177
    v_fma_f32 v177, -v176, v176, v177
    v_max_f32 v177, 0, v177
    v_add_f32 v177, 0x3727c5ac, v177
    v_rsq_f32 v64, v177
    v_sub_f32 v176, 0, v176
    v_cvt_pk_bf16_f32 v178, v176, v176
    v_lshlrev_b32 v179, 16, v178
    v_sub_f32 v179, v176, v179
    v_cvt_pk_bf16_f32 v179, v179, v179
    v_cndmask_b32 v68, v178, v179, s[40:41]
    v_mov_b32 v69, v68
    v_mov_b32 v70, v68
    v_mov_b32 v71, v68
    v_lshlrev_b32 v237, 2, v1
    s_lshl_b32 s54, s30, 9
    v_add_u32 v236, s54, v237
    ds_write_b32 v236, v64 offset:0
    ds_write_b32 v236, v68 offset:256
    s_mul_i32 s54, s49, 768
    s_lshl_b32 s55, s48, 9
    s_add_u32 s54, s54, s55
    v_add_u32 v236, s54, v237
    v_add_f32 v32, v32, v36
    v_add_f32 v33, v33, v37
    v_add_f32 v34, v34, v38
    v_add_f32 v35, v35, v39
    v_add_f32 v32, v32, v34
    v_add_f32 v33, v33, v35
    v_add_f32 v32, v32, v33
    v_mov_b32 v33, v32
    s_nop 1
    v_permlane32_swap_b32 v32, v33
    v_add_f32 v32, v32, v33
    v_cvt_pk_bf16_f32 v33, v32, v32
    v_lshlrev_b32 v33, 16, v33
    v_sub_f32 v33, v32, v33
    v_cvt_pk_bf16_f32 v34, v32, v33
    ds_write_b32 v236, v34 offset:2048
    s_cmp_lg_u32 s48, 0
    s_cbranch_scc1 L_lsk_25
    v_add_f32 v40, v40, v44
    v_add_f32 v41, v41, v45
    v_add_f32 v42, v42, v46
    v_add_f32 v43, v43, v47
    v_add_f32 v40, v40, v42
    v_add_f32 v41, v41, v43
    v_add_f32 v40, v40, v41
    v_mov_b32 v41, v40
    s_nop 1
    v_permlane32_swap_b32 v40, v41
    v_add_f32 v40, v40, v41
    v_cvt_pk_bf16_f32 v41, v40, v40
    v_lshlrev_b32 v41, 16, v41
    v_sub_f32 v41, v40, v41
    v_cvt_pk_bf16_f32 v42, v40, v41
    ds_write_b32 v236, v42 offset:2304
L_lsk_25:
    s_waitcnt lgkmcnt(0)
    s_setprio 0
    s_waitcnt vmcnt(10)
    s_barrier
    s_lshl_b32 s34, s2, 2
    s_add_u32 s34, s34, s30
    s_lshl_b32 s37, s34, 11
    v_lshlrev_b32 v10, 4, v1
    s_mov_b32 s24, s70
    s_and_b32 s25, s71, 0xffff
    s_mov_b32 s26, 0x200000
    s_mov_b32 s27, 0x20000
    buffer_load_dwordx4 v[244:247], v10, s[24:27], s37 offen offset:0
    buffer_load_dwordx4 v[244:247], v10, s[24:27], s37 offen offset:1024
    s_mov_b32 s24, s74
    s_and_b32 s25, s75, 0xffff
    s_mov_b32 s26, 0x200000
    s_mov_b32 s27, 0x20000
    buffer_load_dwordx4 v[244:247], v10, s[24:27], s37 offen offset:0
    buffer_load_dwordx4 v[244:247], v10, s[24:27], s37 offen offset:1024
    s_mov_b32 s24, s80
    s_and_b32 s25, s81, 0xffff
    s_mov_b32 s26, 0x200000
    s_mov_b32 s27, 0x20000
    buffer_load_dwordx4 v[244:247], v10, s[24:27], s37 offen offset:0
    buffer_load_dwordx4 v[244:247], v10, s[24:27], s37 offen offset:1024
    s_mov_b32 s24, s76
    s_and_b32 s25, s77, 0xffff
    s_mov_b32 s26, 0x10000
    s_mov_b32 s27, 0x20000
    buffer_load_dwordx4 v[244:247], v10, s[24:27], s37 offen
    buffer_load_dwordx4 v[244:247], v10, s[24:27], s37 offen offset:1024
    s_mov_b32 s24, s78
    s_and_b32 s25, s79, 0xffff
    s_mov_b32 s26, 0x10000
    s_mov_b32 s27, 0x20000
    buffer_load_dwordx4 v[244:247], v10, s[24:27], s37 offen
    buffer_load_dwordx4 v[244:247], v10, s[24:27], s37 offen offset:1024
    s_waitcnt vmcnt(10)
    s_barrier
    s_lshl_b32 s35, s51, 5
    v_add_u32 v238, s35, v2
    v_mul_u32_u24 v238, 200, v238
    v_lshl_add_u32 v238, v3, 3, v238
    s_mul_i32 s35, s49, 25600
    v_add_u32 v238, s35, v238
    s_and_b32 s35, s3, 3
    s_lshl_b32 s35, s35, 12
    s_add_u32 s35, s35, 51200
    v_lshlrev_b32 v239, 4, v1
    v_add_u32 v239, s35, v239
    v_lshl_or_b32 v220, v221, 16, v220
    v_lshl_or_b32 v221, v223, 16, v222
    v_lshl_or_b32 v222, v225, 16, v224
    v_lshl_or_b32 v223, v227, 16, v226
    v_lshl_or_b32 v224, v229, 16, v228
    v_lshl_or_b32 v225, v231, 16, v230
    v_lshl_or_b32 v226, v233, 16, v232
    v_lshl_or_b32 v227, v235, 16, v234
    s_lshl_b32 s35, s51, 9
    v_add_u32 v236, s35, v237
    ds_read_b32 v172, v236 offset:0
    s_waitcnt lgkmcnt(0)
    v_mul_f32 v172, 0x3fb8aa3b, v172
    v_mov_b32 v173, v172
    s_mov_b32 s24, s70
    s_and_b32 s25, s71, 0xffff
    s_mov_b32 s26, 0x200000
    s_mov_b32 s27, 0x20000
    s_and_b32 s57, s2, 1
    s_lshl_b32 s57, s57, 3
    s_bfe_u32 s58, s2, 0x30003
    s_add_u32 s57, s57, s58
    s_lshl_b32 s57, s57, 7
    v_lshrrev_b32 v241, 3, v1
    v_bfe_u32 v242, v241, 1, 1
    v_lshlrev_b32 v242, 2, v242
    v_and_b32 v243, 7, v1
    v_xor_b32 v242, v242, v243
    v_lshlrev_b32 v242, 4, v242
    s_lshl_b32 s58, s30, 4
    v_add_u32 v241, s58, v241
    v_lshl_add_u32 v241, v241, 11, v242
    v_add_u32 v241, s57, v241
    v_add_u32 v242, 15360, v241
    s_lshl_b32 s60, s30, 11
    s_barrier
    s_barrier
    ds_read_b128 v[144:147], v239
    ds_read_b128 v[148:151], v239 offset:1024
    ds_read_b128 v[160:163], v239 offset:2048
    ds_read_b128 v[164:167], v239 offset:3072
    s_waitcnt lgkmcnt(2)
    v_mfma_f32_32x32x16_bf16 v[64:79], v[220:223], v[144:147], 0
    v_mfma_f32_32x32x16_bf16 v[64:79], v[224:227], v[148:151], v[64:79]
L_qa0_j0_2:
    s_nop 11
    v_max3_f32 v208, v64, v65, v66
    v_min3_f32 v210, v64, v65, v66
    v_max3_f32 v208, v208, v67, v68
    v_min3_f32 v210, v210, v67, v68
    v_max3_f32 v208, v208, v69, v70
    v_min3_f32 v210, v210, v69, v70
    v_max3_f32 v208, v208, v71, v72
    v_min3_f32 v210, v210, v71, v72
    v_max3_f32 v208, v208, v73, v74
    v_min3_f32 v210, v210, v73, v74
    v_max3_f32 v208, v208, v75, v76
    v_min3_f32 v210, v210, v75, v76
    v_max3_f32 v208, v208, v77, v78
    v_min3_f32 v210, v210, v77, v78
    v_max_f32 v208, v208, v79
    v_min_f32 v210, v210, v79
    v_mov_b32 v212, v208
    v_mov_b32 v214, v210
    s_nop 0
    v_permlane32_swap_b32 v208, v212
    v_permlane32_swap_b32 v210, v214
    v_max_f32 v208, v208, v212
    v_min_f32 v210, v210, v214
    v_mul_f32 v208, v208, v172
    v_mul_f32 v210, v210, v172
    v_mov_b32 v209, v208
    v_mov_b32 v211, v210
    v_pk_fma_f32 v[176:177], v[64:65], v[172:173], v[208:209] neg_lo:[0,0,1] neg_hi:[0,0,1]
    v_pk_fma_f32 v[192:193], v[64:65], v[172:173], v[210:211] neg_lo:[1,0,0] neg_hi:[1,0,0]
    v_pk_fma_f32 v[178:179], v[66:67], v[172:173], v[208:209] neg_lo:[0,0,1] neg_hi:[0,0,1]
    v_pk_fma_f32 v[194:195], v[66:67], v[172:173], v[210:211] neg_lo:[1,0,0] neg_hi:[1,0,0]
    v_pk_fma_f32 v[180:181], v[68:69], v[172:173], v[208:209] neg_lo:[0,0,1] neg_hi:[0,0,1]
    v_pk_fma_f32 v[196:197], v[68:69], v[172:173], v[210:211] neg_lo:[1,0,0] neg_hi:[1,0,0]
    v_pk_fma_f32 v[182:183], v[70:71], v[172:173], v[208:209] neg_lo:[0,0,1] neg_hi:[0,0,1]
    v_pk_fma_f32 v[198:199], v[70:71], v[172:173], v[210:211] neg_lo:[1,0,0] neg_hi:[1,0,0]
    v_pk_fma_f32 v[184:185], v[72:73], v[172:173], v[208:209] neg_lo:[0,0,1] neg_hi:[0,0,1]
    v_pk_fma_f32 v[200:201], v[72:73], v[172:173], v[210:211] neg_lo:[1,0,0] neg_hi:[1,0,0]
    v_pk_fma_f32 v[186:187], v[74:75], v[172:173], v[208:209] neg_lo:[0,0,1] neg_hi:[0,0,1]
    v_pk_fma_f32 v[202:203], v[74:75], v[172:173], v[210:211] neg_lo:[1,0,0] neg_hi:[1,0,0]
    v_pk_fma_f32 v[188:189], v[76:77], v[172:173], v[208:209] neg_lo:[0,0,1] neg_hi:[0,0,1]
    v_pk_fma_f32 v[204:205], v[76:77], v[172:173], v[210:211] neg_lo:[1,0,0] neg_hi:[1,0,0]
    v_pk_fma_f32 v[190:191], v[78:79], v[172:173], v[208:209] neg_lo:[0,0,1] neg_hi:[0,0,1]
    v_pk_fma_f32 v[206:207], v[78:79], v[172:173], v[210:211] neg_lo:[1,0,0] neg_hi:[1,0,0]
    v_exp_f32 v176, v176
    v_exp_f32 v177, v177
    v_exp_f32 v178, v178
    v_exp_f32 v179, v179
    v_exp_f32 v180, v180
    v_exp_f32 v181, v181
    v_exp_f32 v182, v182
    v_exp_f32 v183, v183
    v_exp_f32 v184, v184
    v_exp_f32 v185, v185
    v_exp_f32 v186, v186
    v_exp_f32 v187, v187
    v_exp_f32 v188, v188
    v_exp_f32 v189, v189
    v_exp_f32 v190, v190
    v_exp_f32 v191, v191
    v_exp_f32 v192, v192
    v_exp_f32 v193, v193
    v_exp_f32 v194, v194
    v_exp_f32 v195, v195
    v_exp_f32 v196, v196
    v_exp_f32 v197, v197
    v_exp_f32 v198, v198
    v_exp_f32 v199, v199
    v_exp_f32 v200, v200
    v_exp_f32 v201, v201
    v_exp_f32 v202, v202
    v_exp_f32 v203, v203
    v_exp_f32 v204, v204
    v_exp_f32 v205, v205
    v_exp_f32 v206, v206
    v_exp_f32 v207, v207
    v_pk_add_f32 v[208:209], v[176:177], v[178:179]
    v_pk_add_f32 v[210:211], v[192:193], v[194:195]
    v_pk_add_f32 v[208:209], v[208:209], v[180:181]
    v_pk_add_f32 v[210:211], v[210:211], v[196:197]
    v_pk_add_f32 v[208:209], v[208:209], v[182:183]
    v_pk_add_f32 v[210:211], v[210:211], v[198:199]
    v_pk_add_f32 v[208:209], v[208:209], v[184:185]
    v_pk_add_f32 v[210:211], v[210:211], v[200:201]
    v_pk_add_f32 v[208:209], v[208:209], v[186:187]
    v_pk_add_f32 v[210:211], v[210:211], v[202:203]
    v_pk_add_f32 v[208:209], v[208:209], v[188:189]
    v_pk_add_f32 v[210:211], v[210:211], v[204:205]
    v_pk_add_f32 v[208:209], v[208:209], v[190:191]
    v_pk_add_f32 v[210:211], v[210:211], v[206:207]
    v_add_f32 v208, v208, v209
    v_add_f32 v210, v210, v211
    v_mov_b32 v212, v208
    v_mov_b32 v214, v210
    s_nop 0
    v_permlane32_swap_b32 v208, v212
    v_permlane32_swap_b32 v210, v214
    v_add_f32 v208, v208, v212
    v_add_f32 v210, v210, v214
    v_rcp_f32 v208, v208
    v_rcp_f32 v210, v210
    v_mov_b32 v209, v208
    v_mov_b32 v211, v210
    v_pk_mul_f32 v[176:177], v[176:177], v[208:209]
    v_pk_mul_f32 v[178:179], v[178:179], v[208:209]
    v_pk_mul_f32 v[180:181], v[180:181], v[208:209]
    v_pk_mul_f32 v[182:183], v[182:183], v[208:209]
    v_pk_mul_f32 v[184:185], v[184:185], v[208:209]
    v_pk_mul_f32 v[186:187], v[186:187], v[208:209]
    v_pk_mul_f32 v[188:189], v[188:189], v[208:209]
    v_pk_mul_f32 v[190:191], v[190:191], v[208:209]
    v_pk_mul_f32 v[192:193], v[192:193], v[210:211]
    v_pk_mul_f32 v[194:195], v[194:195], v[210:211]
    v_pk_mul_f32 v[196:197], v[196:197], v[210:211]
    v_pk_mul_f32 v[198:199], v[198:199], v[210:211]
    v_pk_mul_f32 v[200:201], v[200:201], v[210:211]
    v_pk_mul_f32 v[202:203], v[202:203], v[210:211]
    v_pk_mul_f32 v[204:205], v[204:205], v[210:211]
    v_pk_mul_f32 v[206:207], v[206:207], v[210:211]
    v_cvt_pk_bf16_f32 v144, v176, v177
    v_cvt_pk_bf16_f32 v145, v178, v179
    v_cvt_pk_bf16_f32 v146, v180, v181
    v_cvt_pk_bf16_f32 v147, v182, v183
    v_cvt_pk_bf16_f32 v148, v184, v185
    v_cvt_pk_bf16_f32 v149, v186, v187
    v_cvt_pk_bf16_f32 v150, v188, v189
    v_cvt_pk_bf16_f32 v151, v190, v191
    v_cvt_pk_bf16_f32 v152, v192, v193
    v_cvt_pk_bf16_f32 v153, v194, v195
    v_cvt_pk_bf16_f32 v154, v196, v197
    v_cvt_pk_bf16_f32 v155, v198, v199
    v_cvt_pk_bf16_f32 v156, v200, v201
    v_cvt_pk_bf16_f32 v157, v202, v203
    v_cvt_pk_bf16_f32 v158, v204, v205
    v_cvt_pk_bf16_f32 v159, v206, v207
    ds_write_b64 v238, v[144:145] offset:0
    ds_write_b64 v238, v[146:147] offset:16
    ds_write_b64 v238, v[148:149] offset:32
    ds_write_b64 v238, v[150:151] offset:48
    ds_write_b64 v238, v[152:153] offset:64
    ds_write_b64 v238, v[154:155] offset:80
    ds_write_b64 v238, v[156:157] offset:96
    ds_write_b64 v238, v[158:159] offset:112
    s_waitcnt lgkmcnt(8)
    v_mfma_f32_32x32x16_bf16 v[96:111], v[220:223], v[160:163], 0
    v_mfma_f32_32x32x16_bf16 v[96:111], v[224:227], v[164:167], v[96:111]
    v_and_b32 v4, 15, v1
    v_lshrrev_b32 v5, 2, v4
    v_lshl_add_u32 v5, v5, 3, v3
    v_mul_u32_u24 v5, 200, v5
    v_and_b32 v6, 3, v4
    v_lshl_add_u32 v5, v6, 3, v5
    v_bfe_u32 v7, v1, 4, 1
    v_lshl_add_u32 v5, v7, 5, v5
    s_mul_i32 s35, s49, 25600
    v_add_u32 v14, s35, v5
    s_lshl_b32 s35, s48, 6
    v_add_u32 v15, s35, v14
    v_bfe_u32 v28, v1, 2, 1
    v_bfe_u32 v29, v1, 4, 1
    v_cmp_eq_u32 vcc, v28, v29
    v_mov_b32 v28, 0x3f803f80
    s_nop 0
    v_cndmask_b32 v24, 0, v28, vcc
    v_mov_b32 v25, v24
    v_mov_b32 v26, v24
    v_mov_b32 v27, v24
    s_lshl_b32 s36, s50, 16
    s_lshl_b32 s35, s4, 12
    s_add_u32 s36, s36, s35
    s_lshl_b32 s35, s48, 11
    s_add_u32 s36, s36, s35
    s_add_u32 s36, s36, 0x1c00000
    s_lshl_b32 s39, s50, 12
    s_lshl_b32 s35, s4, 8
    s_add_u32 s39, s39, s35
    s_lshl_b32 s35, s48, 7
    s_add_u32 s39, s39, s35
    s_add_u32 s39, s39, 0x2500000
    v_lshlrev_b32 v11, 2, v2
    v_lshlrev_b32 v10, 4, v1
    s_waitcnt lgkmcnt(0)
    s_barrier
    s_cmp_ge_u32 s3, 4
    s_cbranch_scc1 L_qa0_j1_3
    ds_read_b64_tr_b16 v[176:177], v15 offset:0
    ds_read_b64_tr_b16 v[180:181], v14 offset:128
    ds_read_b64_tr_b16 v[178:179], v15 offset:400
    ds_read_b64_tr_b16 v[182:183], v14 offset:528
    ds_read_b64_tr_b16 v[184:185], v15 offset:800
    ds_read_b64_tr_b16 v[188:189], v14 offset:928
    ds_read_b64_tr_b16 v[186:187], v15 offset:1200
    ds_read_b64_tr_b16 v[190:191], v14 offset:1328
    ds_read_b64_tr_b16 v[192:193], v15 offset:6400
    ds_read_b64_tr_b16 v[196:197], v14 offset:6528
    ds_read_b64_tr_b16 v[194:195], v15 offset:6800
    ds_read_b64_tr_b16 v[198:199], v14 offset:6928
    s_waitcnt lgkmcnt(8)
    v_mfma_f32_32x32x16_bf16 v[32:47], v[176:179], v[180:183], 0
    v_mfma_f32_16x16x32_bf16 v[48:51], v[24:27], v[176:179], 0
    ds_read_b64_tr_b16 v[200:201], v15 offset:7200
    ds_read_b64_tr_b16 v[204:205], v14 offset:7328
    ds_read_b64_tr_b16 v[202:203], v15 offset:7600
    ds_read_b64_tr_b16 v[206:207], v14 offset:7728
    s_waitcnt lgkmcnt(8)
    v_mfma_f32_32x32x16_bf16 v[32:47], v[184:187], v[188:191], v[32:47]
    v_mfma_f32_16x16x32_bf16 v[48:51], v[24:27], v[184:187], v[48:51]
    ds_read_b64_tr_b16 v[176:177], v15 offset:12800
    ds_read_b64_tr_b16 v[180:181], v14 offset:12928
    ds_read_b64_tr_b16 v[178:179], v15 offset:13200
    ds_read_b64_tr_b16 v[182:183], v14 offset:13328
    s_waitcnt lgkmcnt(8)
    v_mfma_f32_32x32x16_bf16 v[32:47], v[192:195], v[196:199], v[32:47]
    v_mfma_f32_16x16x32_bf16 v[48:51], v[24:27], v[192:195], v[48:51]
    ds_read_b64_tr_b16 v[184:185], v15 offset:13600
    ds_read_b64_tr_b16 v[188:189], v14 offset:13728
    ds_read_b64_tr_b16 v[186:187], v15 offset:14000
    ds_read_b64_tr_b16 v[190:191], v14 offset:14128
    s_waitcnt lgkmcnt(8)
    v_mfma_f32_32x32x16_bf16 v[32:47], v[200:203], v[204:207], v[32:47]
    v_mfma_f32_16x16x32_bf16 v[48:51], v[24:27], v[200:203], v[48:51]
    ds_read_b64_tr_b16 v[192:193], v15 offset:19200
    ds_read_b64_tr_b16 v[196:197], v14 offset:19328
    ds_read_b64_tr_b16 v[194:195], v15 offset:19600
    ds_read_b64_tr_b16 v[198:199], v14 offset:19728
    s_waitcnt lgkmcnt(8)
    v_mfma_f32_32x32x16_bf16 v[32:47], v[176:179], v[180:183], v[32:47]
    v_mfma_f32_16x16x32_bf16 v[48:51], v[24:27], v[176:179], v[48:51]
    ds_read_b64_tr_b16 v[200:201], v15 offset:20000
    ds_read_b64_tr_b16 v[204:205], v14 offset:20128
    ds_read_b64_tr_b16 v[202:203], v15 offset:20400
    ds_read_b64_tr_b16 v[206:207], v14 offset:20528
    s_waitcnt lgkmcnt(8)
    v_mfma_f32_32x32x16_bf16 v[32:47], v[184:187], v[188:191], v[32:47]
    v_mfma_f32_16x16x32_bf16 v[48:51], v[24:27], v[184:187], v[48:51]
    s_waitcnt lgkmcnt(4)
    v_mfma_f32_32x32x16_bf16 v[32:47], v[192:195], v[196:199], v[32:47]
    v_mfma_f32_16x16x32_bf16 v[48:51], v[24:27], v[192:195], v[48:51]
    s_waitcnt lgkmcnt(0)
    v_mfma_f32_32x32x16_bf16 v[32:47], v[200:203], v[204:207], v[32:47]
    v_mfma_f32_16x16x32_bf16 v[48:51], v[24:27], v[200:203], v[48:51]
    s_nop 7
    buffer_store_dword v48, v11, s[16:19], s39 offen sc1
    s_nop 1
    v_cvt_pk_bf16_f32 v56, v32, v33
    v_cvt_pk_bf16_f32 v57, v34, v35
    v_cvt_pk_bf16_f32 v58, v36, v37
    v_cvt_pk_bf16_f32 v59, v38, v39
    v_cvt_pk_bf16_f32 v60, v40, v41
    v_cvt_pk_bf16_f32 v61, v42, v43
    v_cvt_pk_bf16_f32 v62, v44, v45
    v_cvt_pk_bf16_f32 v63, v46, v47
    buffer_store_dwordx4 v[56:59], v10, s[16:19], s36 offen offset:0 sc1
    buffer_store_dwordx4 v[60:63], v10, s[16:19], s36 offen offset:1024 sc1
    v_max3_f32 v208, v96, v97, v98
    v_min3_f32 v210, v96, v97, v98
    v_max3_f32 v208, v208, v99, v100
    v_min3_f32 v210, v210, v99, v100
    v_max3_f32 v208, v208, v101, v102
    v_min3_f32 v210, v210, v101, v102
    v_max3_f32 v208, v208, v103, v104
    v_min3_f32 v210, v210, v103, v104
    v_max3_f32 v208, v208, v105, v106
    v_min3_f32 v210, v210, v105, v106
    v_max3_f32 v208, v208, v107, v108
    v_min3_f32 v210, v210, v107, v108
    v_max3_f32 v208, v208, v109, v110
    v_min3_f32 v210, v210, v109, v110
    v_max_f32 v208, v208, v111
    v_min_f32 v210, v210, v111
    v_mov_b32 v212, v208
    v_mov_b32 v214, v210
    s_nop 0
    v_permlane32_swap_b32 v208, v212
    v_permlane32_swap_b32 v210, v214
    v_max_f32 v208, v208, v212
    v_min_f32 v210, v210, v214
    v_mul_f32 v208, v208, v172
    v_mul_f32 v210, v210, v172
    v_mov_b32 v209, v208
    v_mov_b32 v211, v210
    v_pk_fma_f32 v[176:177], v[96:97], v[172:173], v[208:209] neg_lo:[0,0,1] neg_hi:[0,0,1]
    v_pk_fma_f32 v[192:193], v[96:97], v[172:173], v[210:211] neg_lo:[1,0,0] neg_hi:[1,0,0]
    v_pk_fma_f32 v[178:179], v[98:99], v[172:173], v[208:209] neg_lo:[0,0,1] neg_hi:[0,0,1]
    v_pk_fma_f32 v[194:195], v[98:99], v[172:173], v[210:211] neg_lo:[1,0,0] neg_hi:[1,0,0]
    v_pk_fma_f32 v[180:181], v[100:101], v[172:173], v[208:209] neg_lo:[0,0,1] neg_hi:[0,0,1]
    v_pk_fma_f32 v[196:197], v[100:101], v[172:173], v[210:211] neg_lo:[1,0,0] neg_hi:[1,0,0]
    v_pk_fma_f32 v[182:183], v[102:103], v[172:173], v[208:209] neg_lo:[0,0,1] neg_hi:[0,0,1]
    v_pk_fma_f32 v[198:199], v[102:103], v[172:173], v[210:211] neg_lo:[1,0,0] neg_hi:[1,0,0]
    v_pk_fma_f32 v[184:185], v[104:105], v[172:173], v[208:209] neg_lo:[0,0,1] neg_hi:[0,0,1]
    v_pk_fma_f32 v[200:201], v[104:105], v[172:173], v[210:211] neg_lo:[1,0,0] neg_hi:[1,0,0]
    v_pk_fma_f32 v[186:187], v[106:107], v[172:173], v[208:209] neg_lo:[0,0,1] neg_hi:[0,0,1]
    v_pk_fma_f32 v[202:203], v[106:107], v[172:173], v[210:211] neg_lo:[1,0,0] neg_hi:[1,0,0]
    v_pk_fma_f32 v[188:189], v[108:109], v[172:173], v[208:209] neg_lo:[0,0,1] neg_hi:[0,0,1]
    v_pk_fma_f32 v[204:205], v[108:109], v[172:173], v[210:211] neg_lo:[1,0,0] neg_hi:[1,0,0]
    v_pk_fma_f32 v[190:191], v[110:111], v[172:173], v[208:209] neg_lo:[0,0,1] neg_hi:[0,0,1]
    v_pk_fma_f32 v[206:207], v[110:111], v[172:173], v[210:211] neg_lo:[1,0,0] neg_hi:[1,0,0]
    v_exp_f32 v176, v176
    v_exp_f32 v177, v177
    v_exp_f32 v178, v178
    v_exp_f32 v179, v179
    v_exp_f32 v180, v180
    v_exp_f32 v181, v181
    v_exp_f32 v182, v182
    v_exp_f32 v183, v183
    v_exp_f32 v184, v184
    v_exp_f32 v185, v185
    v_exp_f32 v186, v186
    v_exp_f32 v187, v187
    v_exp_f32 v188, v188
    v_exp_f32 v189, v189
    v_exp_f32 v190, v190
    v_exp_f32 v191, v191
    v_exp_f32 v192, v192
    v_exp_f32 v193, v193
    v_exp_f32 v194, v194
    v_exp_f32 v195, v195
    v_exp_f32 v196, v196
    v_exp_f32 v197, v197
    v_exp_f32 v198, v198
    v_exp_f32 v199, v199
    v_exp_f32 v200, v200
    v_exp_f32 v201, v201
    v_exp_f32 v202, v202
    v_exp_f32 v203, v203
    v_exp_f32 v204, v204
    v_exp_f32 v205, v205
    v_exp_f32 v206, v206
    v_exp_f32 v207, v207
    v_pk_add_f32 v[208:209], v[176:177], v[178:179]
    v_pk_add_f32 v[210:211], v[192:193], v[194:195]
    v_pk_add_f32 v[208:209], v[208:209], v[180:181]
    v_pk_add_f32 v[210:211], v[210:211], v[196:197]
    v_pk_add_f32 v[208:209], v[208:209], v[182:183]
    v_pk_add_f32 v[210:211], v[210:211], v[198:199]
    v_pk_add_f32 v[208:209], v[208:209], v[184:185]
    v_pk_add_f32 v[210:211], v[210:211], v[200:201]
    v_pk_add_f32 v[208:209], v[208:209], v[186:187]
    v_pk_add_f32 v[210:211], v[210:211], v[202:203]
    v_pk_add_f32 v[208:209], v[208:209], v[188:189]
    v_pk_add_f32 v[210:211], v[210:211], v[204:205]
    v_pk_add_f32 v[208:209], v[208:209], v[190:191]
    v_pk_add_f32 v[210:211], v[210:211], v[206:207]
    v_add_f32 v208, v208, v209
    v_add_f32 v210, v210, v211
    v_mov_b32 v212, v208
    v_mov_b32 v214, v210
    s_nop 0
    v_permlane32_swap_b32 v208, v212
    v_permlane32_swap_b32 v210, v214
    v_add_f32 v208, v208, v212
    v_add_f32 v210, v210, v214
    v_rcp_f32 v208, v208
    v_rcp_f32 v210, v210
    v_mov_b32 v209, v208
    v_mov_b32 v211, v210
    v_pk_mul_f32 v[176:177], v[176:177], v[208:209]
    v_pk_mul_f32 v[178:179], v[178:179], v[208:209]
    v_pk_mul_f32 v[180:181], v[180:181], v[208:209]
    v_pk_mul_f32 v[182:183], v[182:183], v[208:209]
    v_pk_mul_f32 v[184:185], v[184:185], v[208:209]
    v_pk_mul_f32 v[186:187], v[186:187], v[208:209]
    v_pk_mul_f32 v[188:189], v[188:189], v[208:209]
    v_pk_mul_f32 v[190:191], v[190:191], v[208:209]
    v_pk_mul_f32 v[192:193], v[192:193], v[210:211]
    v_pk_mul_f32 v[194:195], v[194:195], v[210:211]
    v_pk_mul_f32 v[196:197], v[196:197], v[210:211]
    v_pk_mul_f32 v[198:199], v[198:199], v[210:211]
    v_pk_mul_f32 v[200:201], v[200:201], v[210:211]
    v_pk_mul_f32 v[202:203], v[202:203], v[210:211]
    v_pk_mul_f32 v[204:205], v[204:205], v[210:211]
    v_pk_mul_f32 v[206:207], v[206:207], v[210:211]
    v_cvt_pk_bf16_f32 v144, v176, v177
    v_cvt_pk_bf16_f32 v145, v178, v179
    v_cvt_pk_bf16_f32 v146, v180, v181
    v_cvt_pk_bf16_f32 v147, v182, v183
    v_cvt_pk_bf16_f32 v148, v184, v185
    v_cvt_pk_bf16_f32 v149, v186, v187
    v_cvt_pk_bf16_f32 v150, v188, v189
    v_cvt_pk_bf16_f32 v151, v190, v191
    v_cvt_pk_bf16_f32 v152, v192, v193
    v_cvt_pk_bf16_f32 v153, v194, v195
    v_cvt_pk_bf16_f32 v154, v196, v197
    v_cvt_pk_bf16_f32 v155, v198, v199
    v_cvt_pk_bf16_f32 v156, v200, v201
    v_cvt_pk_bf16_f32 v157, v202, v203
    v_cvt_pk_bf16_f32 v158, v204, v205
    v_cvt_pk_bf16_f32 v159, v206, v207
    s_waitcnt vmcnt(0)
    s_lshl_b32 s34, s5, 8
    s_add_u32 s34, s34, 0x2800000
    v_mov_b32 v4, 1
    v_mov_b32 v5, 0
    s_mov_b64 exec, 1
    v_mov_b32 v6, 163780
    ds_add_rtn_u32 v7, v6, v4
    s_waitcnt lgkmcnt(0)
    v_readfirstlane_b32 s35, v7
    s_nop 0
    s_cmp_eq_u32 s35, 3
    s_cbranch_scc0 L_sig_26
    s_lshl_b32 s35, s4, 2
    s_add_u32 s34, s34, s35
    buffer_store_dword v4, v5, s[16:19], s34 offen sc1
L_sig_26:
    s_mov_b64 exec, -1
    s_branch L_qa0_np_5
L_qa0_j1_3:
    s_add_u32 m0, s60, 81920
    s_mov_b32 s59, 0
    buffer_load_dwordx4 v241, s[24:27], s59 offen lds
    buffer_load_dwordx4 v242, s[24:27], s59 offen offset:1024 lds
    s_add_u32 m0, s60, 90112
    s_mov_b32 s59, 131072
    buffer_load_dwordx4 v241, s[24:27], s59 offen lds
    buffer_load_dwordx4 v242, s[24:27], s59 offen offset:1024 lds
    s_add_u32 m0, s60, 98304
    s_mov_b32 s59, 262144
    buffer_load_dwordx4 v241, s[24:27], s59 offen lds
    buffer_load_dwordx4 v242, s[24:27], s59 offen offset:1024 lds
    s_add_u32 m0, s60, 106496
    s_mov_b32 s59, 524288
    buffer_load_dwordx4 v241, s[24:27], s59 offen lds
    buffer_load_dwordx4 v242, s[24:27], s59 offen offset:1024 lds
    s_add_u32 m0, s60, 114688
    s_mov_b32 s59, 655360
    buffer_load_dwordx4 v241, s[24:27], s59 offen lds
    buffer_load_dwordx4 v242, s[24:27], s59 offen offset:1024 lds
    s_add_u32 m0, s60, 122880
    s_mov_b32 s59, 786432
    buffer_load_dwordx4 v241, s[24:27], s59 offen lds
    buffer_load_dwordx4 v242, s[24:27], s59 offen offset:1024 lds
    s_add_u32 m0, s60, 131072
    s_mov_b32 s59, 917504
    buffer_load_dwordx4 v241, s[24:27], s59 offen lds
    buffer_load_dwordx4 v242, s[24:27], s59 offen offset:1024 lds
    s_add_u32 m0, s60, 139264
    s_mov_b32 s59, 1048576
    buffer_load_dwordx4 v241, s[24:27], s59 offen lds
    buffer_load_dwordx4 v242, s[24:27], s59 offen offset:1024 lds
    s_add_u32 m0, s60, 147456
    s_mov_b32 s59, 1179648
    buffer_load_dwordx4 v241, s[24:27], s59 offen lds
    buffer_load_dwordx4 v242, s[24:27], s59 offen offset:1024 lds
    v_max3_f32 v208, v96, v97, v98
    v_min3_f32 v210, v96, v97, v98
    v_max3_f32 v208, v208, v99, v100
    v_min3_f32 v210, v210, v99, v100
    v_max3_f32 v208, v208, v101, v102
    v_min3_f32 v210, v210, v101, v102
    v_max3_f32 v208, v208, v103, v104
    v_min3_f32 v210, v210, v103, v104
    v_max3_f32 v208, v208, v105, v106
    v_min3_f32 v210, v210, v105, v106
    v_max3_f32 v208, v208, v107, v108
    v_min3_f32 v210, v210, v107, v108
    v_max3_f32 v208, v208, v109, v110
    v_min3_f32 v210, v210, v109, v110
    v_max_f32 v208, v208, v111
    v_min_f32 v210, v210, v111
    v_mov_b32 v212, v208
    v_mov_b32 v214, v210
    s_nop 0
    v_permlane32_swap_b32 v208, v212
    v_permlane32_swap_b32 v210, v214
    v_max_f32 v208, v208, v212
    v_min_f32 v210, v210, v214
    v_mul_f32 v208, v208, v172
    v_mul_f32 v210, v210, v172
    v_mov_b32 v209, v208
    v_mov_b32 v211, v210
    v_pk_fma_f32 v[176:177], v[96:97], v[172:173], v[208:209] neg_lo:[0,0,1] neg_hi:[0,0,1]
    v_pk_fma_f32 v[192:193], v[96:97], v[172:173], v[210:211] neg_lo:[1,0,0] neg_hi:[1,0,0]
    v_pk_fma_f32 v[178:179], v[98:99], v[172:173], v[208:209] neg_lo:[0,0,1] neg_hi:[0,0,1]
    v_pk_fma_f32 v[194:195], v[98:99], v[172:173], v[210:211] neg_lo:[1,0,0] neg_hi:[1,0,0]
    v_pk_fma_f32 v[180:181], v[100:101], v[172:173], v[208:209] neg_lo:[0,0,1] neg_hi:[0,0,1]
    v_pk_fma_f32 v[196:197], v[100:101], v[172:173], v[210:211] neg_lo:[1,0,0] neg_hi:[1,0,0]
    v_pk_fma_f32 v[182:183], v[102:103], v[172:173], v[208:209] neg_lo:[0,0,1] neg_hi:[0,0,1]
    v_pk_fma_f32 v[198:199], v[102:103], v[172:173], v[210:211] neg_lo:[1,0,0] neg_hi:[1,0,0]
    v_pk_fma_f32 v[184:185], v[104:105], v[172:173], v[208:209] neg_lo:[0,0,1] neg_hi:[0,0,1]
    v_pk_fma_f32 v[200:201], v[104:105], v[172:173], v[210:211] neg_lo:[1,0,0] neg_hi:[1,0,0]
    v_pk_fma_f32 v[186:187], v[106:107], v[172:173], v[208:209] neg_lo:[0,0,1] neg_hi:[0,0,1]
    v_pk_fma_f32 v[202:203], v[106:107], v[172:173], v[210:211] neg_lo:[1,0,0] neg_hi:[1,0,0]
    v_pk_fma_f32 v[188:189], v[108:109], v[172:173], v[208:209] neg_lo:[0,0,1] neg_hi:[0,0,1]
    v_pk_fma_f32 v[204:205], v[108:109], v[172:173], v[210:211] neg_lo:[1,0,0] neg_hi:[1,0,0]
    v_pk_fma_f32 v[190:191], v[110:111], v[172:173], v[208:209] neg_lo:[0,0,1] neg_hi:[0,0,1]
    v_pk_fma_f32 v[206:207], v[110:111], v[172:173], v[210:211] neg_lo:[1,0,0] neg_hi:[1,0,0]
    v_exp_f32 v176, v176
    v_exp_f32 v177, v177
    v_exp_f32 v178, v178
    v_exp_f32 v179, v179
    v_exp_f32 v180, v180
    v_exp_f32 v181, v181
    v_exp_f32 v182, v182
    v_exp_f32 v183, v183
    v_exp_f32 v184, v184
    v_exp_f32 v185, v185
    v_exp_f32 v186, v186
    v_exp_f32 v187, v187
    v_exp_f32 v188, v188
    v_exp_f32 v189, v189
    v_exp_f32 v190, v190
    v_exp_f32 v191, v191
    v_exp_f32 v192, v192
    v_exp_f32 v193, v193
    v_exp_f32 v194, v194
    v_exp_f32 v195, v195
    v_exp_f32 v196, v196
    v_exp_f32 v197, v197
    v_exp_f32 v198, v198
    v_exp_f32 v199, v199
    v_exp_f32 v200, v200
    v_exp_f32 v201, v201
    v_exp_f32 v202, v202
    v_exp_f32 v203, v203
    v_exp_f32 v204, v204
    v_exp_f32 v205, v205
    v_exp_f32 v206, v206
    v_exp_f32 v207, v207
    v_pk_add_f32 v[208:209], v[176:177], v[178:179]
    v_pk_add_f32 v[210:211], v[192:193], v[194:195]
    v_pk_add_f32 v[208:209], v[208:209], v[180:181]
    v_pk_add_f32 v[210:211], v[210:211], v[196:197]
    v_pk_add_f32 v[208:209], v[208:209], v[182:183]
    v_pk_add_f32 v[210:211], v[210:211], v[198:199]
    v_pk_add_f32 v[208:209], v[208:209], v[184:185]
    v_pk_add_f32 v[210:211], v[210:211], v[200:201]
    v_pk_add_f32 v[208:209], v[208:209], v[186:187]
    v_pk_add_f32 v[210:211], v[210:211], v[202:203]
    v_pk_add_f32 v[208:209], v[208:209], v[188:189]
    v_pk_add_f32 v[210:211], v[210:211], v[204:205]
    v_pk_add_f32 v[208:209], v[208:209], v[190:191]
    v_pk_add_f32 v[210:211], v[210:211], v[206:207]
    v_add_f32 v208, v208, v209
    v_add_f32 v210, v210, v211
    v_mov_b32 v212, v208
    v_mov_b32 v214, v210
    s_nop 0
    v_permlane32_swap_b32 v208, v212
    v_permlane32_swap_b32 v210, v214
    v_add_f32 v208, v208, v212
    v_add_f32 v210, v210, v214
    v_rcp_f32 v208, v208
    v_rcp_f32 v210, v210
    v_mov_b32 v209, v208
    v_mov_b32 v211, v210
    v_pk_mul_f32 v[176:177], v[176:177], v[208:209]
    v_pk_mul_f32 v[178:179], v[178:179], v[208:209]
    v_pk_mul_f32 v[180:181], v[180:181], v[208:209]
    v_pk_mul_f32 v[182:183], v[182:183], v[208:209]
    v_pk_mul_f32 v[184:185], v[184:185], v[208:209]
    v_pk_mul_f32 v[186:187], v[186:187], v[208:209]
    v_pk_mul_f32 v[188:189], v[188:189], v[208:209]
    v_pk_mul_f32 v[190:191], v[190:191], v[208:209]
    v_pk_mul_f32 v[192:193], v[192:193], v[210:211]
    v_pk_mul_f32 v[194:195], v[194:195], v[210:211]
    v_pk_mul_f32 v[196:197], v[196:197], v[210:211]
    v_pk_mul_f32 v[198:199], v[198:199], v[210:211]
    v_pk_mul_f32 v[200:201], v[200:201], v[210:211]
    v_pk_mul_f32 v[202:203], v[202:203], v[210:211]
    v_pk_mul_f32 v[204:205], v[204:205], v[210:211]
    v_pk_mul_f32 v[206:207], v[206:207], v[210:211]
    v_cvt_pk_bf16_f32 v144, v176, v177
    v_cvt_pk_bf16_f32 v145, v178, v179
    v_cvt_pk_bf16_f32 v146, v180, v181
    v_cvt_pk_bf16_f32 v147, v182, v183
    v_cvt_pk_bf16_f32 v148, v184, v185
    v_cvt_pk_bf16_f32 v149, v186, v187
    v_cvt_pk_bf16_f32 v150, v188, v189
    v_cvt_pk_bf16_f32 v151, v190, v191
    v_cvt_pk_bf16_f32 v152, v192, v193
    v_cvt_pk_bf16_f32 v153, v194, v195
    v_cvt_pk_bf16_f32 v154, v196, v197
    v_cvt_pk_bf16_f32 v155, v198, v199
    v_cvt_pk_bf16_f32 v156, v200, v201
    v_cvt_pk_bf16_f32 v157, v202, v203
    v_cvt_pk_bf16_f32 v158, v204, v205
    v_cvt_pk_bf16_f32 v159, v206, v207
    s_cmp_lg_u32 s3, 7
    s_cbranch_scc1 L_rp_27_ok
    v_and_b32 v4, 15, v1
    v_lshlrev_b32 v4, 2, v4
    s_lshl_b32 s52, s5, 8
    s_add_u32 s52, s52, 0x2800000
    s_mov_b32 s53, 0
    v_mov_b32 v6, 163788
L_rp_27:
    buffer_load_dword v5, v4, s[16:19], s52 offen sc1
    s_waitcnt vmcnt(0)
    v_cmp_ne_u32 vcc, 1, v5
    s_nop 0
    s_or_b32 s63, vcc_lo, 0x10000
    s_ff1_i32_b32 s63, s63
    s_add_u32 s53, s53, 1
    s_cmp_lt_u32 s53, 0x40000
    s_cselect_b32 s63, s63, 16
    v_mov_b32 v7, s63
    ds_write_b32 v6, v7
    s_cmp_lt_u32 s63, 16
    s_cbranch_scc1 L_rp_27
L_rp_27_ok:
L_qa0_np_5:
    s_lshr_b32 s36, s3, 2
    s_and_b32 s37, s3, 3
    s_lshl_b32 s38, s5, 1
    s_add_u32 s38, s38, s36
    v_lshlrev_b32 v11, 2, v1
    s_lshl_b32 s34, s38, 16
    s_lshl_b32 s35, s37, 10
    s_add_u32 s34, s34, s35
    s_add_u32 s34, s34, 0x1c00000
    s_lshl_b32 s39, s38, 12
    s_add_u32 s39, s39, s35
    s_add_u32 s39, s39, 0x2500000
    v_mov_b32 v4, 163788
    s_mov_b32 s63, 0
    s_cmp_gt_u32 s63, 0
    s_cbranch_scc1 L_cp_28_ok
L_cp_28:
    ds_read_b32 v5, v4
    s_waitcnt lgkmcnt(0)
    v_readfirstlane_b32 s63, v5
    s_nop 0
    s_cmp_gt_u32 s63, 0
    s_cbranch_scc0 L_cp_28
L_cp_28_ok:
    buffer_load_dwordx4 v[48:51], v10, s[16:19], s34 offen sc1
    s_add_u32 s34, s34, 4096
    s_cmp_gt_u32 s63, 1
    s_cbranch_scc1 L_cp_29_ok
L_cp_29:
    ds_read_b32 v5, v4
    s_waitcnt lgkmcnt(0)
    v_readfirstlane_b32 s63, v5
    s_nop 0
    s_cmp_gt_u32 s63, 1
    s_cbranch_scc0 L_cp_29
L_cp_29_ok:
    buffer_load_dwordx4 v[52:55], v10, s[16:19], s34 offen sc1
    s_add_u32 s34, s34, 4096
    s_cmp_gt_u32 s63, 2
    s_cbranch_scc1 L_cp_30_ok
L_cp_30:
    ds_read_b32 v5, v4
    s_waitcnt lgkmcnt(0)
    v_readfirstlane_b32 s63, v5
    s_nop 0
    s_cmp_gt_u32 s63, 2
    s_cbranch_scc0 L_cp_30
L_cp_30_ok:
    buffer_load_dwordx4 v[56:59], v10, s[16:19], s34 offen sc1
    s_add_u32 s34, s34, 4096
    s_cmp_gt_u32 s63, 3
    s_cbranch_scc1 L_cp_31_ok
L_cp_31:
    ds_read_b32 v5, v4
    s_waitcnt lgkmcnt(0)
    v_readfirstlane_b32 s63, v5
    s_nop 0
    s_cmp_gt_u32 s63, 3
    s_cbranch_scc0 L_cp_31
L_cp_31_ok:
    buffer_load_dwordx4 v[60:63], v10, s[16:19], s34 offen sc1
    s_add_u32 s34, s34, 4096
    s_cmp_gt_u32 s63, 4
    s_cbranch_scc1 L_cp_32_ok
L_cp_32:
    ds_read_b32 v5, v4
    s_waitcnt lgkmcnt(0)
    v_readfirstlane_b32 s63, v5
    s_nop 0
    s_cmp_gt_u32 s63, 4
    s_cbranch_scc0 L_cp_32
L_cp_32_ok:
    buffer_load_dwordx4 v[64:67], v10, s[16:19], s34 offen sc1
    s_add_u32 s34, s34, 4096
    s_cmp_gt_u32 s63, 5
    s_cbranch_scc1 L_cp_33_ok
L_cp_33:
    ds_read_b32 v5, v4
    s_waitcnt lgkmcnt(0)
    v_readfirstlane_b32 s63, v5
    s_nop 0
    s_cmp_gt_u32 s63, 5
    s_cbranch_scc0 L_cp_33
L_cp_33_ok:
    buffer_load_dwordx4 v[68:71], v10, s[16:19], s34 offen sc1
    s_add_u32 s34, s34, 4096
    s_cmp_gt_u32 s63, 6
    s_cbranch_scc1 L_cp_34_ok
L_cp_34:
    ds_read_b32 v5, v4
    s_waitcnt lgkmcnt(0)
    v_readfirstlane_b32 s63, v5
    s_nop 0
    s_cmp_gt_u32 s63, 6
    s_cbranch_scc0 L_cp_34
L_cp_34_ok:
    buffer_load_dwordx4 v[72:75], v10, s[16:19], s34 offen sc1
    s_add_u32 s34, s34, 4096
    s_cmp_gt_u32 s63, 7
    s_cbranch_scc1 L_cp_35_ok
L_cp_35:
    ds_read_b32 v5, v4
    s_waitcnt lgkmcnt(0)
    v_readfirstlane_b32 s63, v5
    s_nop 0
    s_cmp_gt_u32 s63, 7
    s_cbranch_scc0 L_cp_35
L_cp_35_ok:
    buffer_load_dwordx4 v[76:79], v10, s[16:19], s34 offen sc1
    s_add_u32 s34, s34, 4096
    s_cmp_gt_u32 s63, 8
    s_cbranch_scc1 L_cp_36_ok
L_cp_36:
    ds_read_b32 v5, v4
    s_waitcnt lgkmcnt(0)
    v_readfirstlane_b32 s63, v5
    s_nop 0
    s_cmp_gt_u32 s63, 8
    s_cbranch_scc0 L_cp_36
L_cp_36_ok:
    buffer_load_dwordx4 v[80:83], v10, s[16:19], s34 offen sc1
    s_add_u32 s34, s34, 4096
    s_cmp_gt_u32 s63, 9
    s_cbranch_scc1 L_cp_37_ok
L_cp_37:
    ds_read_b32 v5, v4
    s_waitcnt lgkmcnt(0)
    v_readfirstlane_b32 s63, v5
    s_nop 0
    s_cmp_gt_u32 s63, 9
    s_cbranch_scc0 L_cp_37
L_cp_37_ok:
    buffer_load_dwordx4 v[84:87], v10, s[16:19], s34 offen sc1
    s_add_u32 s34, s34, 4096
    s_cmp_gt_u32 s63, 10
    s_cbranch_scc1 L_cp_38_ok
L_cp_38:
    ds_read_b32 v5, v4
    s_waitcnt lgkmcnt(0)
    v_readfirstlane_b32 s63, v5
    s_nop 0
    s_cmp_gt_u32 s63, 10
    s_cbranch_scc0 L_cp_38
L_cp_38_ok:
    buffer_load_dwordx4 v[88:91], v10, s[16:19], s34 offen sc1
    s_add_u32 s34, s34, 4096
    s_cmp_gt_u32 s63, 11
    s_cbranch_scc1 L_cp_39_ok
L_cp_39:
    ds_read_b32 v5, v4
    s_waitcnt lgkmcnt(0)
    v_readfirstlane_b32 s63, v5
    s_nop 0
    s_cmp_gt_u32 s63, 11
    s_cbranch_scc0 L_cp_39
L_cp_39_ok:
    buffer_load_dwordx4 v[92:95], v10, s[16:19], s34 offen sc1
    s_add_u32 s34, s34, 4096
    s_cmp_gt_u32 s63, 12
    s_cbranch_scc1 L_cp_40_ok
L_cp_40:
    ds_read_b32 v5, v4
    s_waitcnt lgkmcnt(0)
    v_readfirstlane_b32 s63, v5
    s_nop 0
    s_cmp_gt_u32 s63, 12
    s_cbranch_scc0 L_cp_40
L_cp_40_ok:
    buffer_load_dwordx4 v[96:99], v10, s[16:19], s34 offen sc1
    s_add_u32 s34, s34, 4096
    s_cmp_gt_u32 s63, 13
    s_cbranch_scc1 L_cp_41_ok
L_cp_41:
    ds_read_b32 v5, v4
    s_waitcnt lgkmcnt(0)
    v_readfirstlane_b32 s63, v5
    s_nop 0
    s_cmp_gt_u32 s63, 13
    s_cbranch_scc0 L_cp_41
L_cp_41_ok:
    buffer_load_dwordx4 v[100:103], v10, s[16:19], s34 offen sc1
    s_add_u32 s34, s34, 4096
    s_cmp_gt_u32 s63, 14
    s_cbranch_scc1 L_cp_42_ok
L_cp_42:
    ds_read_b32 v5, v4
    s_waitcnt lgkmcnt(0)
    v_readfirstlane_b32 s63, v5
    s_nop 0
    s_cmp_gt_u32 s63, 14
    s_cbranch_scc0 L_cp_42
L_cp_42_ok:
    buffer_load_dwordx4 v[104:107], v10, s[16:19], s34 offen sc1
    s_add_u32 s34, s34, 4096
    s_cmp_gt_u32 s63, 15
    s_cbranch_scc1 L_cp_43_ok
L_cp_43:
    ds_read_b32 v5, v4
    s_waitcnt lgkmcnt(0)
    v_readfirstlane_b32 s63, v5
    s_nop 0
    s_cmp_gt_u32 s63, 15
    s_cbranch_scc0 L_cp_43
L_cp_43_ok:
    buffer_load_dword v24, v11, s[16:19], s39 offen offset:0 sc1
    buffer_load_dword v25, v11, s[16:19], s39 offen offset:256 sc1
    buffer_load_dword v26, v11, s[16:19], s39 offen offset:512 sc1
    buffer_load_dword v27, v11, s[16:19], s39 offen offset:768 sc1
    buffer_load_dwordx4 v[108:111], v10, s[16:19], s34 offen sc1
    s_add_u32 s34, s34, 4096
    v_mov_b32 v32, 0
    v_mov_b32 v33, 0
    v_mov_b32 v34, 0
    v_mov_b32 v35, 0
    v_mov_b32 v36, 0
    v_mov_b32 v37, 0
    v_mov_b32 v38, 0
    v_mov_b32 v39, 0
    s_mov_b32 s52, 0x3f80
    s_mov_b32 s53, 0x3f800000
    s_lshl_b32 s35, s36, 8
    s_add_u32 s35, s35, 77824
    v_add_u32 v13, s35, v11
    s_lshl_b32 s35, s3, 10
    s_add_u32 s35, s35, 69632
    v_add_u32 v12, s35, v10
    s_waitcnt vmcnt(19)
    v_dot2_f32_bf16 v32, v48, s52, v32
    v_dot2_f32_bf16 v33, v48, s53, v33
    v_dot2_f32_bf16 v34, v49, s52, v34
    v_dot2_f32_bf16 v35, v49, s53, v35
    v_dot2_f32_bf16 v36, v50, s52, v36
    v_dot2_f32_bf16 v37, v50, s53, v37
    v_dot2_f32_bf16 v38, v51, s52, v38
    v_dot2_f32_bf16 v39, v51, s53, v39
    s_waitcnt vmcnt(18)
    v_dot2_f32_bf16 v32, v52, s52, v32
    v_dot2_f32_bf16 v33, v52, s53, v33
    v_dot2_f32_bf16 v34, v53, s52, v34
    v_dot2_f32_bf16 v35, v53, s53, v35
    v_dot2_f32_bf16 v36, v54, s52, v36
    v_dot2_f32_bf16 v37, v54, s53, v37
    v_dot2_f32_bf16 v38, v55, s52, v38
    v_dot2_f32_bf16 v39, v55, s53, v39
    s_waitcnt vmcnt(17)
    v_dot2_f32_bf16 v32, v56, s52, v32
    v_dot2_f32_bf16 v33, v56, s53, v33
    v_dot2_f32_bf16 v34, v57, s52, v34
    v_dot2_f32_bf16 v35, v57, s53, v35
    v_dot2_f32_bf16 v36, v58, s52, v36
    v_dot2_f32_bf16 v37, v58, s53, v37
    v_dot2_f32_bf16 v38, v59, s52, v38
    v_dot2_f32_bf16 v39, v59, s53, v39
    s_waitcnt vmcnt(16)
    v_dot2_f32_bf16 v32, v60, s52, v32
    v_dot2_f32_bf16 v33, v60, s53, v33
    v_dot2_f32_bf16 v34, v61, s52, v34
    v_dot2_f32_bf16 v35, v61, s53, v35
    v_dot2_f32_bf16 v36, v62, s52, v36
    v_dot2_f32_bf16 v37, v62, s53, v37
    v_dot2_f32_bf16 v38, v63, s52, v38
    v_dot2_f32_bf16 v39, v63, s53, v39
    s_waitcnt vmcnt(15)
    v_dot2_f32_bf16 v32, v64, s52, v32
    v_dot2_f32_bf16 v33, v64, s53, v33
    v_dot2_f32_bf16 v34, v65, s52, v34
    v_dot2_f32_bf16 v35, v65, s53, v35
    v_dot2_f32_bf16 v36, v66, s52, v36
    v_dot2_f32_bf16 v37, v66, s53, v37
    v_dot2_f32_bf16 v38, v67, s52, v38
    v_dot2_f32_bf16 v39, v67, s53, v39
    s_waitcnt vmcnt(14)
    v_dot2_f32_bf16 v32, v68, s52, v32
    v_dot2_f32_bf16 v33, v68, s53, v33
    v_dot2_f32_bf16 v34, v69, s52, v34
    v_dot2_f32_bf16 v35, v69, s53, v35
    v_dot2_f32_bf16 v36, v70, s52, v36
    v_dot2_f32_bf16 v37, v70, s53, v37
    v_dot2_f32_bf16 v38, v71, s52, v38
    v_dot2_f32_bf16 v39, v71, s53, v39
    s_waitcnt vmcnt(13)
    v_dot2_f32_bf16 v32, v72, s52, v32
    v_dot2_f32_bf16 v33, v72, s53, v33
    v_dot2_f32_bf16 v34, v73, s52, v34
    v_dot2_f32_bf16 v35, v73, s53, v35
    v_dot2_f32_bf16 v36, v74, s52, v36
    v_dot2_f32_bf16 v37, v74, s53, v37
    v_dot2_f32_bf16 v38, v75, s52, v38
    v_dot2_f32_bf16 v39, v75, s53, v39
    s_waitcnt vmcnt(12)
    v_dot2_f32_bf16 v32, v76, s52, v32
    v_dot2_f32_bf16 v33, v76, s53, v33
    v_dot2_f32_bf16 v34, v77, s52, v34
    v_dot2_f32_bf16 v35, v77, s53, v35
    v_dot2_f32_bf16 v36, v78, s52, v36
    v_dot2_f32_bf16 v37, v78, s53, v37
    v_dot2_f32_bf16 v38, v79, s52, v38
    v_dot2_f32_bf16 v39, v79, s53, v39
    s_waitcnt vmcnt(11)
    v_dot2_f32_bf16 v32, v80, s52, v32
    v_dot2_f32_bf16 v33, v80, s53, v33
    v_dot2_f32_bf16 v34, v81, s52, v34
    v_dot2_f32_bf16 v35, v81, s53, v35
    v_dot2_f32_bf16 v36, v82, s52, v36
    v_dot2_f32_bf16 v37, v82, s53, v37
    v_dot2_f32_bf16 v38, v83, s52, v38
    v_dot2_f32_bf16 v39, v83, s53, v39
    s_waitcnt vmcnt(10)
    v_dot2_f32_bf16 v32, v84, s52, v32
    v_dot2_f32_bf16 v33, v84, s53, v33
    v_dot2_f32_bf16 v34, v85, s52, v34
    v_dot2_f32_bf16 v35, v85, s53, v35
    v_dot2_f32_bf16 v36, v86, s52, v36
    v_dot2_f32_bf16 v37, v86, s53, v37
    v_dot2_f32_bf16 v38, v87, s52, v38
    v_dot2_f32_bf16 v39, v87, s53, v39
    s_waitcnt vmcnt(9)
    v_dot2_f32_bf16 v32, v88, s52, v32
    v_dot2_f32_bf16 v33, v88, s53, v33
    v_dot2_f32_bf16 v34, v89, s52, v34
    v_dot2_f32_bf16 v35, v89, s53, v35
    v_dot2_f32_bf16 v36, v90, s52, v36
    v_dot2_f32_bf16 v37, v90, s53, v37
    v_dot2_f32_bf16 v38, v91, s52, v38
    v_dot2_f32_bf16 v39, v91, s53, v39
    s_waitcnt vmcnt(8)
    v_dot2_f32_bf16 v32, v92, s52, v32
    v_dot2_f32_bf16 v33, v92, s53, v33
    v_dot2_f32_bf16 v34, v93, s52, v34
    v_dot2_f32_bf16 v35, v93, s53, v35
    v_dot2_f32_bf16 v36, v94, s52, v36
    v_dot2_f32_bf16 v37, v94, s53, v37
    v_dot2_f32_bf16 v38, v95, s52, v38
    v_dot2_f32_bf16 v39, v95, s53, v39
    s_waitcnt vmcnt(7)
    v_dot2_f32_bf16 v32, v96, s52, v32
    v_dot2_f32_bf16 v33, v96, s53, v33
    v_dot2_f32_bf16 v34, v97, s52, v34
    v_dot2_f32_bf16 v35, v97, s53, v35
    v_dot2_f32_bf16 v36, v98, s52, v36
    v_dot2_f32_bf16 v37, v98, s53, v37
    v_dot2_f32_bf16 v38, v99, s52, v38
    v_dot2_f32_bf16 v39, v99, s53, v39
    s_waitcnt vmcnt(6)
    v_dot2_f32_bf16 v32, v100, s52, v32
    v_dot2_f32_bf16 v33, v100, s53, v33
    v_dot2_f32_bf16 v34, v101, s52, v34
    v_dot2_f32_bf16 v35, v101, s53, v35
    v_dot2_f32_bf16 v36, v102, s52, v36
    v_dot2_f32_bf16 v37, v102, s53, v37
    v_dot2_f32_bf16 v38, v103, s52, v38
    v_dot2_f32_bf16 v39, v103, s53, v39
    s_waitcnt vmcnt(5)
    v_dot2_f32_bf16 v32, v104, s52, v32
    v_dot2_f32_bf16 v33, v104, s53, v33
    v_dot2_f32_bf16 v34, v105, s52, v34
    v_dot2_f32_bf16 v35, v105, s53, v35
    v_dot2_f32_bf16 v36, v106, s52, v36
    v_dot2_f32_bf16 v37, v106, s53, v37
    v_dot2_f32_bf16 v38, v107, s52, v38
    v_dot2_f32_bf16 v39, v107, s53, v39
    s_waitcnt vmcnt(1)
    v_add_f32 v24, v24, v25
    v_add_f32 v26, v26, v27
    v_add_f32 v24, v24, v26
    ds_add_f32 v13, v24
    s_waitcnt vmcnt(0)
    v_dot2_f32_bf16 v32, v108, s52, v32
    v_dot2_f32_bf16 v33, v108, s53, v33
    v_dot2_f32_bf16 v34, v109, s52, v34
    v_dot2_f32_bf16 v35, v109, s53, v35
    v_dot2_f32_bf16 v36, v110, s52, v36
    v_dot2_f32_bf16 v37, v110, s53, v37
    v_dot2_f32_bf16 v38, v111, s52, v38
    v_dot2_f32_bf16 v39, v111, s53, v39
    v_cvt_pk_bf16_f32 v40, v32, v33
    v_cvt_pk_bf16_f32 v41, v34, v35
    v_cvt_pk_bf16_f32 v42, v36, v37
    v_cvt_pk_bf16_f32 v43, v38, v39
    ds_write_b128 v12, v[40:43]
    s_lshl_b32 s35, s49, 12
    s_add_u32 s35, s35, 69632
    v_add_u32 v12, s35, v10
    s_lshl_b32 s35, s49, 8
    s_add_u32 s35, s35, 77824
    v_lshlrev_b32 v13, 4, v3
    v_add_u32 v13, s35, v13
    s_lshl_b32 s36, s4, 2
    s_add_u32 s36, s36, s51
    s_lshl_b32 s36, s36, 16
    s_lshl_b32 s35, s50, 11
    s_add_u32 s36, s36, s35
    s_add_u32 s36, s36, 0xc00000
    s_waitcnt lgkmcnt(0)
    s_barrier
    ds_read_b128 v[32:35], v12 offset:0
    ds_read_b128 v[36:39], v12 offset:1024
    ds_read_b128 v[40:43], v12 offset:2048
    ds_read_b128 v[44:47], v12 offset:3072
    ds_read_b128 v[64:67], v13 offset:0
    ds_read_b128 v[68:71], v13 offset:32
    ds_read_b128 v[72:75], v13 offset:64
    ds_read_b128 v[76:79], v13 offset:96
    ds_read_b128 v[80:83], v13 offset:128
    ds_read_b128 v[84:87], v13 offset:160
    ds_read_b128 v[88:91], v13 offset:192
    ds_read_b128 v[92:95], v13 offset:224
    s_waitcnt lgkmcnt(8)
    v_mfma_f32_32x32x16_bf16 v[176:191], v[32:35], v[144:147], 0
    v_mfma_f32_32x32x16_bf16 v[176:191], v[36:39], v[148:151], v[176:191]
    v_mfma_f32_32x32x16_bf16 v[176:191], v[40:43], v[152:155], v[176:191]
    v_mfma_f32_32x32x16_bf16 v[176:191], v[44:47], v[156:159], v[176:191]
    s_waitcnt lgkmcnt(0)
    s_barrier
    v_cvt_pk_bf16_f32 v48, v64, v65
    v_cvt_pk_bf16_f32 v49, v66, v67
    v_cvt_pk_bf16_f32 v50, v68, v69
    v_cvt_pk_bf16_f32 v51, v70, v71
    v_cvt_pk_bf16_f32 v52, v72, v73
    v_cvt_pk_bf16_f32 v53, v74, v75
    v_cvt_pk_bf16_f32 v54, v76, v77
    v_cvt_pk_bf16_f32 v55, v78, v79
    v_cvt_pk_bf16_f32 v56, v80, v81
    v_cvt_pk_bf16_f32 v57, v82, v83
    v_cvt_pk_bf16_f32 v58, v84, v85
    v_cvt_pk_bf16_f32 v59, v86, v87
    v_cvt_pk_bf16_f32 v60, v88, v89
    v_cvt_pk_bf16_f32 v61, v90, v91
    v_cvt_pk_bf16_f32 v62, v92, v93
    v_cvt_pk_bf16_f32 v63, v94, v95
    v_mfma_f32_32x32x16_bf16 v[96:111], v[48:51], v[144:147], 0
    v_mfma_f32_32x32x16_bf16 v[96:111], v[52:55], v[148:151], v[96:111]
    v_mfma_f32_32x32x16_bf16 v[96:111], v[56:59], v[152:155], v[96:111]
    v_mfma_f32_32x32x16_bf16 v[96:111], v[60:63], v[156:159], v[96:111]
    s_nop 11
    v_add_f32 v96, 0x358637bd, v96
    v_rcp_f32 v96, v96
    s_nop 0
    v_mov_b32 v97, v96
    v_pk_mul_f32 v[176:177], v[176:177], v[96:97]
    v_pk_mul_f32 v[178:179], v[178:179], v[96:97]
    v_pk_mul_f32 v[180:181], v[180:181], v[96:97]
    v_pk_mul_f32 v[182:183], v[182:183], v[96:97]
    v_pk_mul_f32 v[184:185], v[184:185], v[96:97]
    v_pk_mul_f32 v[186:187], v[186:187], v[96:97]
    v_pk_mul_f32 v[188:189], v[188:189], v[96:97]
    v_pk_mul_f32 v[190:191], v[190:191], v[96:97]
    v_cvt_pk_bf16_f32 v112, v176, v177
    v_cvt_pk_bf16_f32 v113, v178, v179
    v_cvt_pk_bf16_f32 v114, v180, v181
    v_cvt_pk_bf16_f32 v115, v182, v183
    v_cvt_pk_bf16_f32 v116, v184, v185
    v_cvt_pk_bf16_f32 v117, v186, v187
    v_cvt_pk_bf16_f32 v118, v188, v189
    v_cvt_pk_bf16_f32 v119, v190, v191
    buffer_store_dwordx4 v[112:115], v10, s[16:19], s36 offen offset:0 sc1
    buffer_store_dwordx4 v[116:119], v10, s[16:19], s36 offen offset:1024 sc1
    s_waitcnt vmcnt(0)
    s_lshl_b32 s34, s4, 8
    s_add_u32 s34, s34, 0x2801000
    v_mov_b32 v4, 1
    v_mov_b32 v5, 0
    s_mov_b64 exec, 1
    v_mov_b32 v6, 163784
    ds_add_rtn_u32 v7, v6, v4
    s_waitcnt lgkmcnt(0)
    v_readfirstlane_b32 s35, v7
    s_nop 0
    s_cmp_eq_u32 s35, 7
    s_cbranch_scc0 L_sig_44
    s_lshl_b32 s35, s5, 2
    s_add_u32 s34, s34, s35
    buffer_store_dword v4, v5, s[16:19], s34 offen sc1
L_sig_44:
    s_mov_b64 exec, -1
    s_and_b32 s6, s2, 7
    s_lshr_b32 s7, s2, 3
    s_lshr_b32 s4, s6, 1
    s_lshl_b32 s4, s4, 2
    s_lshr_b32 s5, s7, 3
    s_add_u32 s4, s4, s5
    s_and_b32 s5, s6, 1
    s_lshl_b32 s5, s5, 3
    s_and_b32 s7, s7, 7
    s_add_u32 s5, s5, s7
    s_add_u32 s8, s86, 0xc00000
    s_addc_u32 s9, s87, 0
    s_and_b32 s9, s9, 0xffff
    s_mov_b32 s10, 0x400000
    s_mov_b32 s11, 0x20000
    s_mov_b32 s12, s70
    s_and_b32 s13, s71, 0xffff
    s_mov_b32 s14, 0x200000
    s_mov_b32 s15, 0x20000
    s_mov_b32 s24, s64
    s_and_b32 s25, s65, 0xffff
    s_mov_b32 s26, 0x400000
    s_mov_b32 s27, 0x20000
    s_cmp_ge_u32 s3, 4
    s_cbranch_scc1 L_wa0_ld_45
    s_lshl_b32 s30, s4, 2
    s_add_u32 s30, s30, s3
    s_lshl_b32 s39, s30, 16
    s_lshl_b32 s31, s5, 12
    s_add_u32 s36, s39, s31
    s_add_u32 s37, s36, 0x0
    v_lshlrev_b32 v10, 4, v1
    s_lshl_b32 s31, s30, 5
    v_add_u32 v9, s31, v2
    v_lshlrev_b32 v9, 11, v9
    v_lshl_add_u32 v9, v3, 4, v9
    s_lshl_b32 s31, s5, 7
    v_add_u32 v9, s31, v9
    buffer_load_dwordx4 v[64:67], v9, s[24:27], 0 offen offset:0
    buffer_load_dwordx4 v[68:71], v9, s[24:27], 0 offen offset:32
    buffer_load_dwordx4 v[72:75], v9, s[24:27], 0 offen offset:64
    buffer_load_dwordx4 v[76:79], v9, s[24:27], 0 offen offset:96
    v_and_b32 v4, 15, v1
    v_lshrrev_b32 v5, 2, v4
    v_lshl_add_u32 v5, v3, 2, v5
    v_mul_u32_u24 v5, 128, v5
    v_and_b32 v6, 3, v4
    v_lshlrev_b32 v6, 3, v6
    v_bfe_u32 v7, v1, 4, 1
    v_lshl_add_u32 v6, v7, 5, v6
    v_add_u32 v6, 0, v6
    v_bfe_u32 v7, v1, 3, 1
    v_lshlrev_b32 v7, 6, v7
    v_xor_b32 v6, v6, v7
    v_add_u32 v12, v5, v6
    v_xor_b32 v13, 64, v12
    v_mov_b32 v4, 163792
    v_mov_b32 v5, 0
    ds_write_b32 v4, v5
    v_mov_b32 v4, 163796
    v_mov_b32 v5, 0
    ds_write_b32 v4, v5
    s_waitcnt lgkmcnt(0)
    v_add_u32 v14, 0x10000, v12
    v_add_u32 v15, 0x10000, v13
    v_add_u32 v16, 0x20000, v12
    v_add_u32 v17, 0x20000, v13
    v_mov_b32 v4, 163796
    s_mov_b32 s63, 0
    s_barrier
    s_waitcnt vmcnt(0)
    v_permlane32_swap_b32 v64, v66
    v_permlane32_swap_b32 v65, v67
    v_permlane32_swap_b32 v68, v70
    v_permlane32_swap_b32 v69, v71
    v_permlane32_swap_b32 v72, v74
    v_permlane32_swap_b32 v73, v75
    v_permlane32_swap_b32 v76, v78
    v_permlane32_swap_b32 v77, v79
    v_lshlrev_b32 v32, 16, v64
    v_and_b32 v33, 0xffff0000, v64
    v_lshlrev_b32 v34, 16, v65
    v_and_b32 v35, 0xffff0000, v65
    v_lshlrev_b32 v36, 16, v66
    v_and_b32 v37, 0xffff0000, v66
    v_lshlrev_b32 v38, 16, v67
    v_and_b32 v39, 0xffff0000, v67
    v_lshlrev_b32 v40, 16, v68
    v_and_b32 v41, 0xffff0000, v68
    v_lshlrev_b32 v42, 16, v69
    v_and_b32 v43, 0xffff0000, v69
    v_lshlrev_b32 v44, 16, v70
    v_and_b32 v45, 0xffff0000, v70
    v_lshlrev_b32 v46, 16, v71
    v_and_b32 v47, 0xffff0000, v71
    v_lshlrev_b32 v48, 16, v72
    v_and_b32 v49, 0xffff0000, v72
    v_lshlrev_b32 v50, 16, v73
    v_and_b32 v51, 0xffff0000, v73
    v_lshlrev_b32 v52, 16, v74
    v_and_b32 v53, 0xffff0000, v74
    v_lshlrev_b32 v54, 16, v75
    v_and_b32 v55, 0xffff0000, v75
    v_lshlrev_b32 v56, 16, v76
    v_and_b32 v57, 0xffff0000, v76
    v_lshlrev_b32 v58, 16, v77
    v_and_b32 v59, 0xffff0000, v77
    v_lshlrev_b32 v60, 16, v78
    v_and_b32 v61, 0xffff0000, v78
    v_lshlrev_b32 v62, 16, v79
    v_and_b32 v63, 0xffff0000, v79
    s_cmp_gt_u32 s63, 0
    s_cbranch_scc1 L_lp_47_ok
L_lp_47:
    ds_read_b32 v5, v4
    s_waitcnt lgkmcnt(0)
    v_readfirstlane_b32 s63, v5
    s_nop 0
    s_cmp_gt_u32 s63, 0
    s_cbranch_scc0 L_lp_47
L_lp_47_ok:
    buffer_load_dwordx4 v[96:99], v10, s[8:11], s39 offen offset:0 sc1
    buffer_load_dwordx4 v[100:103], v10, s[8:11], s39 offen offset:1024 sc1
    buffer_load_dwordx4 v[104:107], v10, s[8:11], s39 offen offset:2048 sc1
    buffer_load_dwordx4 v[108:111], v10, s[8:11], s39 offen offset:3072 sc1
    s_add_u32 s39, s39, 4096
    s_cmp_gt_u32 s63, 1
    s_cbranch_scc1 L_lp_48_ok
L_lp_48:
    ds_read_b32 v5, v4
    s_waitcnt lgkmcnt(0)
    v_readfirstlane_b32 s63, v5
    s_nop 0
    s_cmp_gt_u32 s63, 1
    s_cbranch_scc0 L_lp_48
L_lp_48_ok:
    buffer_load_dwordx4 v[112:115], v10, s[8:11], s39 offen offset:0 sc1
    buffer_load_dwordx4 v[116:119], v10, s[8:11], s39 offen offset:1024 sc1
    buffer_load_dwordx4 v[120:123], v10, s[8:11], s39 offen offset:2048 sc1
    buffer_load_dwordx4 v[124:127], v10, s[8:11], s39 offen offset:3072 sc1
    s_add_u32 s39, s39, 4096
    ds_read_b64_tr_b16 v[64:65], v14 offset:16384
    ds_read_b64_tr_b16 v[66:67], v14 offset:17408
    ds_read_b64_tr_b16 v[68:69], v15 offset:16384
    ds_read_b64_tr_b16 v[70:71], v15 offset:17408
    ds_read_b64_tr_b16 v[72:73], v14 offset:18432
    ds_read_b64_tr_b16 v[74:75], v14 offset:19456
    ds_read_b64_tr_b16 v[76:77], v15 offset:18432
    ds_read_b64_tr_b16 v[78:79], v15 offset:19456
    s_waitcnt vmcnt(7) lgkmcnt(4)
    v_mfma_f32_32x32x16_bf16 v[32:47], v[64:67], v[96:99], v[32:47]
    ds_read_b64_tr_b16 v[80:81], v14 offset:20480
    ds_read_b64_tr_b16 v[82:83], v14 offset:21504
    v_mfma_f32_32x32x16_bf16 v[48:63], v[68:71], v[96:99], v[48:63]
    ds_read_b64_tr_b16 v[84:85], v15 offset:20480
    ds_read_b64_tr_b16 v[86:87], v15 offset:21504
    s_cmp_gt_u32 s63, 2
    s_cbranch_scc1 L_lp_49_ok
L_lp_49:
    ds_read_b32 v5, v4
    s_waitcnt lgkmcnt(0)
    v_readfirstlane_b32 s63, v5
    s_nop 0
    s_cmp_gt_u32 s63, 2
    s_cbranch_scc0 L_lp_49
L_lp_49_ok:
    buffer_load_dwordx4 v[128:131], v10, s[8:11], s39 offen offset:0 sc1
    buffer_load_dwordx4 v[132:135], v10, s[8:11], s39 offen offset:1024 sc1
    s_waitcnt vmcnt(8) lgkmcnt(4)
    v_mfma_f32_32x32x16_bf16 v[32:47], v[72:75], v[100:103], v[32:47]
    ds_read_b64_tr_b16 v[88:89], v14 offset:22528
    ds_read_b64_tr_b16 v[90:91], v14 offset:23552
    v_mfma_f32_32x32x16_bf16 v[48:63], v[76:79], v[100:103], v[48:63]
    ds_read_b64_tr_b16 v[92:93], v15 offset:22528
    ds_read_b64_tr_b16 v[94:95], v15 offset:23552
    buffer_load_dwordx4 v[136:139], v10, s[8:11], s39 offen offset:2048 sc1
    buffer_load_dwordx4 v[140:143], v10, s[8:11], s39 offen offset:3072 sc1
    s_add_u32 s39, s39, 8192
    s_waitcnt vmcnt(9) lgkmcnt(4)
    v_mfma_f32_32x32x16_bf16 v[32:47], v[80:83], v[104:107], v[32:47]
    ds_read_b64_tr_b16 v[64:65], v14 offset:24576
    ds_read_b64_tr_b16 v[66:67], v14 offset:25600
    v_mfma_f32_32x32x16_bf16 v[48:63], v[84:87], v[104:107], v[48:63]
    ds_read_b64_tr_b16 v[68:69], v15 offset:24576
    ds_read_b64_tr_b16 v[70:71], v15 offset:25600
    s_cmp_gt_u32 s63, 3
    s_cbranch_scc1 L_lp_50_ok
L_lp_50:
    ds_read_b32 v5, v4
    s_waitcnt lgkmcnt(0)
    v_readfirstlane_b32 s63, v5
    s_nop 0
    s_cmp_gt_u32 s63, 3
    s_cbranch_scc0 L_lp_50
L_lp_50_ok:
    buffer_load_dwordx4 v[144:147], v10, s[8:11], s39 offen offset:0 sc1
    buffer_load_dwordx4 v[148:151], v10, s[8:11], s39 offen offset:1024 sc1
    s_waitcnt vmcnt(10) lgkmcnt(4)
    v_mfma_f32_32x32x16_bf16 v[32:47], v[88:91], v[108:111], v[32:47]
    ds_read_b64_tr_b16 v[72:73], v14 offset:26624
    ds_read_b64_tr_b16 v[74:75], v14 offset:27648
    v_mfma_f32_32x32x16_bf16 v[48:63], v[92:95], v[108:111], v[48:63]
    ds_read_b64_tr_b16 v[76:77], v15 offset:26624
    ds_read_b64_tr_b16 v[78:79], v15 offset:27648
    buffer_load_dwordx4 v[152:155], v10, s[8:11], s39 offen offset:2048 sc1
    buffer_load_dwordx4 v[156:159], v10, s[8:11], s39 offen offset:3072 sc1
    s_add_u32 s39, s39, 4096
    s_waitcnt vmcnt(11) lgkmcnt(4)
    v_mfma_f32_32x32x16_bf16 v[32:47], v[64:67], v[112:115], v[32:47]
    ds_read_b64_tr_b16 v[80:81], v14 offset:28672
    ds_read_b64_tr_b16 v[82:83], v14 offset:29696
    v_mfma_f32_32x32x16_bf16 v[48:63], v[68:71], v[112:115], v[48:63]
    ds_read_b64_tr_b16 v[84:85], v15 offset:28672
    ds_read_b64_tr_b16 v[86:87], v15 offset:29696
    s_cmp_gt_u32 s63, 4
    s_cbranch_scc1 L_lp_51_ok
L_lp_51:
    ds_read_b32 v5, v4
    s_waitcnt lgkmcnt(0)
    v_readfirstlane_b32 s63, v5
    s_nop 0
    s_cmp_gt_u32 s63, 4
    s_cbranch_scc0 L_lp_51
L_lp_51_ok:
    buffer_load_dwordx4 v[160:163], v10, s[8:11], s39 offen offset:0 sc1
    buffer_load_dwordx4 v[164:167], v10, s[8:11], s39 offen offset:1024 sc1
    s_waitcnt vmcnt(12) lgkmcnt(4)
    v_mfma_f32_32x32x16_bf16 v[32:47], v[72:75], v[116:119], v[32:47]
    ds_read_b64_tr_b16 v[88:89], v14 offset:30720
    ds_read_b64_tr_b16 v[90:91], v14 offset:31744
    v_mfma_f32_32x32x16_bf16 v[48:63], v[76:79], v[116:119], v[48:63]
    ds_read_b64_tr_b16 v[92:93], v15 offset:30720
    ds_read_b64_tr_b16 v[94:95], v15 offset:31744
    buffer_load_dwordx4 v[168:171], v10, s[8:11], s39 offen offset:2048 sc1
    buffer_load_dwordx4 v[172:175], v10, s[8:11], s39 offen offset:3072 sc1
    s_add_u32 s39, s39, 4096
    s_waitcnt vmcnt(13) lgkmcnt(4)
    v_mfma_f32_32x32x16_bf16 v[32:47], v[80:83], v[120:123], v[32:47]
    ds_read_b64_tr_b16 v[64:65], v14 offset:32768
    ds_read_b64_tr_b16 v[66:67], v14 offset:33792
    v_mfma_f32_32x32x16_bf16 v[48:63], v[84:87], v[120:123], v[48:63]
    ds_read_b64_tr_b16 v[68:69], v15 offset:32768
    ds_read_b64_tr_b16 v[70:71], v15 offset:33792
    s_cmp_gt_u32 s63, 5
    s_cbranch_scc1 L_lp_52_ok
L_lp_52:
    ds_read_b32 v5, v4
    s_waitcnt lgkmcnt(0)
    v_readfirstlane_b32 s63, v5
    s_nop 0
    s_cmp_gt_u32 s63, 5
    s_cbranch_scc0 L_lp_52
L_lp_52_ok:
    buffer_load_dwordx4 v[176:179], v10, s[8:11], s39 offen offset:0 sc1
    buffer_load_dwordx4 v[180:183], v10, s[8:11], s39 offen offset:1024 sc1
    s_waitcnt vmcnt(14) lgkmcnt(4)
    v_mfma_f32_32x32x16_bf16 v[32:47], v[88:91], v[124:127], v[32:47]
    ds_read_b64_tr_b16 v[72:73], v14 offset:34816
    ds_read_b64_tr_b16 v[74:75], v14 offset:35840
    v_mfma_f32_32x32x16_bf16 v[48:63], v[92:95], v[124:127], v[48:63]
    ds_read_b64_tr_b16 v[76:77], v15 offset:34816
    ds_read_b64_tr_b16 v[78:79], v15 offset:35840
    buffer_load_dwordx4 v[184:187], v10, s[8:11], s39 offen offset:2048 sc1
    buffer_load_dwordx4 v[188:191], v10, s[8:11], s39 offen offset:3072 sc1
    s_add_u32 s39, s39, 4096
    s_waitcnt vmcnt(15) lgkmcnt(4)
    v_mfma_f32_32x32x16_bf16 v[32:47], v[64:67], v[128:131], v[32:47]
    ds_read_b64_tr_b16 v[80:81], v14 offset:36864
    ds_read_b64_tr_b16 v[82:83], v14 offset:37888
    v_mfma_f32_32x32x16_bf16 v[48:63], v[68:71], v[128:131], v[48:63]
    ds_read_b64_tr_b16 v[84:85], v15 offset:36864
    ds_read_b64_tr_b16 v[86:87], v15 offset:37888
    s_cmp_gt_u32 s63, 6
    s_cbranch_scc1 L_lp_53_ok
L_lp_53:
    ds_read_b32 v5, v4
    s_waitcnt lgkmcnt(0)
    v_readfirstlane_b32 s63, v5
    s_nop 0
    s_cmp_gt_u32 s63, 6
    s_cbranch_scc0 L_lp_53
L_lp_53_ok:
    buffer_load_dwordx4 v[192:195], v10, s[8:11], s39 offen offset:0 sc1
    buffer_load_dwordx4 v[196:199], v10, s[8:11], s39 offen offset:1024 sc1
    s_waitcnt vmcnt(16) lgkmcnt(4)
    v_mfma_f32_32x32x16_bf16 v[32:47], v[72:75], v[132:135], v[32:47]
    ds_read_b64_tr_b16 v[88:89], v14 offset:38912
    ds_read_b64_tr_b16 v[90:91], v14 offset:39936
    v_mfma_f32_32x32x16_bf16 v[48:63], v[76:79], v[132:135], v[48:63]
    ds_read_b64_tr_b16 v[92:93], v15 offset:38912
    ds_read_b64_tr_b16 v[94:95], v15 offset:39936
    buffer_load_dwordx4 v[200:203], v10, s[8:11], s39 offen offset:2048 sc1
    buffer_load_dwordx4 v[204:207], v10, s[8:11], s39 offen offset:3072 sc1
    s_add_u32 s39, s39, 4096
    s_waitcnt vmcnt(17) lgkmcnt(4)
    v_mfma_f32_32x32x16_bf16 v[32:47], v[80:83], v[136:139], v[32:47]
    ds_read_b64_tr_b16 v[64:65], v14 offset:40960
    ds_read_b64_tr_b16 v[66:67], v14 offset:41984
    v_mfma_f32_32x32x16_bf16 v[48:63], v[84:87], v[136:139], v[48:63]
    ds_read_b64_tr_b16 v[68:69], v15 offset:40960
    ds_read_b64_tr_b16 v[70:71], v15 offset:41984
    s_cmp_gt_u32 s63, 7
    s_cbranch_scc1 L_lp_54_ok
L_lp_54:
    ds_read_b32 v5, v4
    s_waitcnt lgkmcnt(0)
    v_readfirstlane_b32 s63, v5
    s_nop 0
    s_cmp_gt_u32 s63, 7
    s_cbranch_scc0 L_lp_54
L_lp_54_ok:
    buffer_load_dwordx4 v[208:211], v10, s[8:11], s39 offen offset:0 sc1
    buffer_load_dwordx4 v[212:215], v10, s[8:11], s39 offen offset:1024 sc1
    s_waitcnt vmcnt(18) lgkmcnt(4)
    v_mfma_f32_32x32x16_bf16 v[32:47], v[88:91], v[140:143], v[32:47]
    ds_read_b64_tr_b16 v[72:73], v14 offset:43008
    ds_read_b64_tr_b16 v[74:75], v14 offset:44032
    v_mfma_f32_32x32x16_bf16 v[48:63], v[92:95], v[140:143], v[48:63]
    ds_read_b64_tr_b16 v[76:77], v15 offset:43008
    ds_read_b64_tr_b16 v[78:79], v15 offset:44032
    buffer_load_dwordx4 v[216:219], v10, s[8:11], s39 offen offset:2048 sc1
    buffer_load_dwordx4 v[220:223], v10, s[8:11], s39 offen offset:3072 sc1
    s_add_u32 s39, s39, 4096
    s_waitcnt vmcnt(19) lgkmcnt(4)
    v_mfma_f32_32x32x16_bf16 v[32:47], v[64:67], v[144:147], v[32:47]
    ds_read_b64_tr_b16 v[80:81], v14 offset:45056
    ds_read_b64_tr_b16 v[82:83], v14 offset:46080
    v_mfma_f32_32x32x16_bf16 v[48:63], v[68:71], v[144:147], v[48:63]
    ds_read_b64_tr_b16 v[84:85], v15 offset:45056
    ds_read_b64_tr_b16 v[86:87], v15 offset:46080
    s_cmp_gt_u32 s63, 8
    s_cbranch_scc1 L_lp_55_ok
L_lp_55:
    ds_read_b32 v5, v4
    s_waitcnt lgkmcnt(0)
    v_readfirstlane_b32 s63, v5
    s_nop 0
    s_cmp_gt_u32 s63, 8
    s_cbranch_scc0 L_lp_55
L_lp_55_ok:
    buffer_load_dwordx4 v[96:99], v10, s[8:11], s39 offen offset:0 sc1
    s_waitcnt vmcnt(19) lgkmcnt(4)
    v_mfma_f32_32x32x16_bf16 v[32:47], v[72:75], v[148:151], v[32:47]
    ds_read_b64_tr_b16 v[88:89], v14 offset:47104
    ds_read_b64_tr_b16 v[90:91], v14 offset:48128
    v_mfma_f32_32x32x16_bf16 v[48:63], v[76:79], v[148:151], v[48:63]
    ds_read_b64_tr_b16 v[92:93], v15 offset:47104
    ds_read_b64_tr_b16 v[94:95], v15 offset:48128
    buffer_load_dwordx4 v[100:103], v10, s[8:11], s39 offen offset:1024 sc1
    s_waitcnt vmcnt(19) lgkmcnt(4)
    v_mfma_f32_32x32x16_bf16 v[32:47], v[80:83], v[152:155], v[32:47]
    ds_read_b64_tr_b16 v[64:65], v14 offset:49152
    ds_read_b64_tr_b16 v[66:67], v14 offset:50176
    v_mfma_f32_32x32x16_bf16 v[48:63], v[84:87], v[152:155], v[48:63]
    ds_read_b64_tr_b16 v[68:69], v15 offset:49152
    ds_read_b64_tr_b16 v[70:71], v15 offset:50176
    buffer_load_dwordx4 v[104:107], v10, s[8:11], s39 offen offset:2048 sc1
    s_waitcnt vmcnt(19) lgkmcnt(4)
    v_mfma_f32_32x32x16_bf16 v[32:47], v[88:91], v[156:159], v[32:47]
    ds_read_b64_tr_b16 v[72:73], v14 offset:51200
    ds_read_b64_tr_b16 v[74:75], v14 offset:52224
    v_mfma_f32_32x32x16_bf16 v[48:63], v[92:95], v[156:159], v[48:63]
    ds_read_b64_tr_b16 v[76:77], v15 offset:51200
    ds_read_b64_tr_b16 v[78:79], v15 offset:52224
    buffer_load_dwordx4 v[108:111], v10, s[8:11], s39 offen offset:3072 sc1
    s_add_u32 s39, s39, 4096
    s_waitcnt vmcnt(19) lgkmcnt(4)
    v_mfma_f32_32x32x16_bf16 v[32:47], v[64:67], v[160:163], v[32:47]
    ds_read_b64_tr_b16 v[80:81], v14 offset:53248
    ds_read_b64_tr_b16 v[82:83], v14 offset:54272
    v_mfma_f32_32x32x16_bf16 v[48:63], v[68:71], v[160:163], v[48:63]
    ds_read_b64_tr_b16 v[84:85], v15 offset:53248
    ds_read_b64_tr_b16 v[86:87], v15 offset:54272
    s_cmp_gt_u32 s63, 9
    s_cbranch_scc1 L_lp_56_ok
L_lp_56:
    ds_read_b32 v5, v4
    s_waitcnt lgkmcnt(0)
    v_readfirstlane_b32 s63, v5
    s_nop 0
    s_cmp_gt_u32 s63, 9
    s_cbranch_scc0 L_lp_56
L_lp_56_ok:
    buffer_load_dwordx4 v[112:115], v10, s[8:11], s39 offen offset:0 sc1
    s_waitcnt vmcnt(19) lgkmcnt(4)
    v_mfma_f32_32x32x16_bf16 v[32:47], v[72:75], v[164:167], v[32:47]
    ds_read_b64_tr_b16 v[88:89], v14 offset:55296
    ds_read_b64_tr_b16 v[90:91], v14 offset:56320
    v_mfma_f32_32x32x16_bf16 v[48:63], v[76:79], v[164:167], v[48:63]
    ds_read_b64_tr_b16 v[92:93], v15 offset:55296
    ds_read_b64_tr_b16 v[94:95], v15 offset:56320
    buffer_load_dwordx4 v[116:119], v10, s[8:11], s39 offen offset:1024 sc1
    s_waitcnt vmcnt(19) lgkmcnt(4)
    v_mfma_f32_32x32x16_bf16 v[32:47], v[80:83], v[168:171], v[32:47]
    ds_read_b64_tr_b16 v[64:65], v14 offset:57344
    ds_read_b64_tr_b16 v[66:67], v14 offset:58368
    v_mfma_f32_32x32x16_bf16 v[48:63], v[84:87], v[168:171], v[48:63]
    ds_read_b64_tr_b16 v[68:69], v15 offset:57344
    ds_read_b64_tr_b16 v[70:71], v15 offset:58368
    buffer_load_dwordx4 v[120:123], v10, s[8:11], s39 offen offset:2048 sc1
    s_waitcnt vmcnt(19) lgkmcnt(4)
    v_mfma_f32_32x32x16_bf16 v[32:47], v[88:91], v[172:175], v[32:47]
    ds_read_b64_tr_b16 v[72:73], v14 offset:59392
    ds_read_b64_tr_b16 v[74:75], v14 offset:60416
    v_mfma_f32_32x32x16_bf16 v[48:63], v[92:95], v[172:175], v[48:63]
    ds_read_b64_tr_b16 v[76:77], v15 offset:59392
    ds_read_b64_tr_b16 v[78:79], v15 offset:60416
    buffer_load_dwordx4 v[124:127], v10, s[8:11], s39 offen offset:3072 sc1
    s_add_u32 s39, s39, 8192
    s_waitcnt vmcnt(19) lgkmcnt(4)
    v_mfma_f32_32x32x16_bf16 v[32:47], v[64:67], v[176:179], v[32:47]
    ds_read_b64_tr_b16 v[80:81], v14 offset:61440
    ds_read_b64_tr_b16 v[82:83], v14 offset:62464
    v_mfma_f32_32x32x16_bf16 v[48:63], v[68:71], v[176:179], v[48:63]
    ds_read_b64_tr_b16 v[84:85], v15 offset:61440
    ds_read_b64_tr_b16 v[86:87], v15 offset:62464
    s_cmp_gt_u32 s63, 10
    s_cbranch_scc1 L_lp_57_ok
L_lp_57:
    ds_read_b32 v5, v4
    s_waitcnt lgkmcnt(0)
    v_readfirstlane_b32 s63, v5
    s_nop 0
    s_cmp_gt_u32 s63, 10
    s_cbranch_scc0 L_lp_57
L_lp_57_ok:
    buffer_load_dwordx4 v[128:131], v10, s[8:11], s39 offen offset:0 sc1
    s_waitcnt vmcnt(19) lgkmcnt(4)
    v_mfma_f32_32x32x16_bf16 v[32:47], v[72:75], v[180:183], v[32:47]
    ds_read_b64_tr_b16 v[88:89], v14 offset:63488
    ds_read_b64_tr_b16 v[90:91], v14 offset:64512
    v_mfma_f32_32x32x16_bf16 v[48:63], v[76:79], v[180:183], v[48:63]
    ds_read_b64_tr_b16 v[92:93], v15 offset:63488
    ds_read_b64_tr_b16 v[94:95], v15 offset:64512
    buffer_load_dwordx4 v[132:135], v10, s[8:11], s39 offen offset:1024 sc1
    s_waitcnt vmcnt(19) lgkmcnt(4)
    v_mfma_f32_32x32x16_bf16 v[32:47], v[80:83], v[184:187], v[32:47]
    ds_read_b64_tr_b16 v[64:65], v16 offset:0
    ds_read_b64_tr_b16 v[66:67], v16 offset:1024
    v_mfma_f32_32x32x16_bf16 v[48:63], v[84:87], v[184:187], v[48:63]
    ds_read_b64_tr_b16 v[68:69], v17 offset:0
    ds_read_b64_tr_b16 v[70:71], v17 offset:1024
    buffer_load_dwordx4 v[136:139], v10, s[8:11], s39 offen offset:2048 sc1
    s_waitcnt vmcnt(19) lgkmcnt(4)
    v_mfma_f32_32x32x16_bf16 v[32:47], v[88:91], v[188:191], v[32:47]
    ds_read_b64_tr_b16 v[72:73], v16 offset:2048
    ds_read_b64_tr_b16 v[74:75], v16 offset:3072
    v_mfma_f32_32x32x16_bf16 v[48:63], v[92:95], v[188:191], v[48:63]
    ds_read_b64_tr_b16 v[76:77], v17 offset:2048
    ds_read_b64_tr_b16 v[78:79], v17 offset:3072
    buffer_load_dwordx4 v[140:143], v10, s[8:11], s39 offen offset:3072 sc1
    s_add_u32 s39, s39, 4096
    s_waitcnt vmcnt(19) lgkmcnt(4)
    v_mfma_f32_32x32x16_bf16 v[32:47], v[64:67], v[192:195], v[32:47]
    ds_read_b64_tr_b16 v[80:81], v16 offset:4096
    ds_read_b64_tr_b16 v[82:83], v16 offset:5120
    v_mfma_f32_32x32x16_bf16 v[48:63], v[68:71], v[192:195], v[48:63]
    ds_read_b64_tr_b16 v[84:85], v17 offset:4096
    ds_read_b64_tr_b16 v[86:87], v17 offset:5120
    s_cmp_gt_u32 s63, 11
    s_cbranch_scc1 L_lp_58_ok
L_lp_58:
    ds_read_b32 v5, v4
    s_waitcnt lgkmcnt(0)
    v_readfirstlane_b32 s63, v5
    s_nop 0
    s_cmp_gt_u32 s63, 11
    s_cbranch_scc0 L_lp_58
L_lp_58_ok:
    buffer_load_dwordx4 v[144:147], v10, s[8:11], s39 offen offset:0 sc1
    s_waitcnt vmcnt(19) lgkmcnt(4)
    v_mfma_f32_32x32x16_bf16 v[32:47], v[72:75], v[196:199], v[32:47]
    ds_read_b64_tr_b16 v[88:89], v16 offset:6144
    ds_read_b64_tr_b16 v[90:91], v16 offset:7168
    v_mfma_f32_32x32x16_bf16 v[48:63], v[76:79], v[196:199], v[48:63]
    ds_read_b64_tr_b16 v[92:93], v17 offset:6144
    ds_read_b64_tr_b16 v[94:95], v17 offset:7168
    buffer_load_dwordx4 v[148:151], v10, s[8:11], s39 offen offset:1024 sc1
    s_waitcnt vmcnt(19) lgkmcnt(4)
    v_mfma_f32_32x32x16_bf16 v[32:47], v[80:83], v[200:203], v[32:47]
    ds_read_b64_tr_b16 v[64:65], v16 offset:8192
    ds_read_b64_tr_b16 v[66:67], v16 offset:9216
    v_mfma_f32_32x32x16_bf16 v[48:63], v[84:87], v[200:203], v[48:63]
    ds_read_b64_tr_b16 v[68:69], v17 offset:8192
    ds_read_b64_tr_b16 v[70:71], v17 offset:9216
    buffer_load_dwordx4 v[152:155], v10, s[8:11], s39 offen offset:2048 sc1
    s_waitcnt vmcnt(19) lgkmcnt(4)
    v_mfma_f32_32x32x16_bf16 v[32:47], v[88:91], v[204:207], v[32:47]
    ds_read_b64_tr_b16 v[72:73], v16 offset:10240
    ds_read_b64_tr_b16 v[74:75], v16 offset:11264
    v_mfma_f32_32x32x16_bf16 v[48:63], v[92:95], v[204:207], v[48:63]
    ds_read_b64_tr_b16 v[76:77], v17 offset:10240
    ds_read_b64_tr_b16 v[78:79], v17 offset:11264
    buffer_load_dwordx4 v[156:159], v10, s[8:11], s39 offen offset:3072 sc1
    s_add_u32 s39, s39, 4096
    s_waitcnt vmcnt(19) lgkmcnt(4)
    v_mfma_f32_32x32x16_bf16 v[32:47], v[64:67], v[208:211], v[32:47]
    ds_read_b64_tr_b16 v[80:81], v16 offset:12288
    ds_read_b64_tr_b16 v[82:83], v16 offset:13312
    v_mfma_f32_32x32x16_bf16 v[48:63], v[68:71], v[208:211], v[48:63]
    ds_read_b64_tr_b16 v[84:85], v17 offset:12288
    ds_read_b64_tr_b16 v[86:87], v17 offset:13312
    s_cmp_gt_u32 s63, 12
    s_cbranch_scc1 L_lp_59_ok
L_lp_59:
    ds_read_b32 v5, v4
    s_waitcnt lgkmcnt(0)
    v_readfirstlane_b32 s63, v5
    s_nop 0
    s_cmp_gt_u32 s63, 12
    s_cbranch_scc0 L_lp_59
L_lp_59_ok:
    buffer_load_dwordx4 v[160:163], v10, s[8:11], s39 offen offset:0 sc1
    s_waitcnt vmcnt(19) lgkmcnt(4)
    v_mfma_f32_32x32x16_bf16 v[32:47], v[72:75], v[212:215], v[32:47]
    ds_read_b64_tr_b16 v[88:89], v16 offset:14336
    ds_read_b64_tr_b16 v[90:91], v16 offset:15360
    v_mfma_f32_32x32x16_bf16 v[48:63], v[76:79], v[212:215], v[48:63]
    ds_read_b64_tr_b16 v[92:93], v17 offset:14336
    ds_read_b64_tr_b16 v[94:95], v17 offset:15360
    buffer_load_dwordx4 v[164:167], v10, s[8:11], s39 offen offset:1024 sc1
    s_waitcnt vmcnt(19) lgkmcnt(4)
    v_mfma_f32_32x32x16_bf16 v[32:47], v[80:83], v[216:219], v[32:47]
    ds_read_b64_tr_b16 v[64:65], v16 offset:16384
    ds_read_b64_tr_b16 v[66:67], v16 offset:17408
    v_mfma_f32_32x32x16_bf16 v[48:63], v[84:87], v[216:219], v[48:63]
    ds_read_b64_tr_b16 v[68:69], v17 offset:16384
    ds_read_b64_tr_b16 v[70:71], v17 offset:17408
    buffer_load_dwordx4 v[168:171], v10, s[8:11], s39 offen offset:2048 sc1
    s_waitcnt vmcnt(19) lgkmcnt(4)
    v_mfma_f32_32x32x16_bf16 v[32:47], v[88:91], v[220:223], v[32:47]
    ds_read_b64_tr_b16 v[72:73], v16 offset:18432
    ds_read_b64_tr_b16 v[74:75], v16 offset:19456
    v_mfma_f32_32x32x16_bf16 v[48:63], v[92:95], v[220:223], v[48:63]
    ds_read_b64_tr_b16 v[76:77], v17 offset:18432
    ds_read_b64_tr_b16 v[78:79], v17 offset:19456
    buffer_load_dwordx4 v[172:175], v10, s[8:11], s39 offen offset:3072 sc1
    s_add_u32 s39, s39, 4096
    s_waitcnt vmcnt(19) lgkmcnt(4)
    v_mfma_f32_32x32x16_bf16 v[32:47], v[64:67], v[96:99], v[32:47]
    ds_read_b64_tr_b16 v[80:81], v16 offset:20480
    ds_read_b64_tr_b16 v[82:83], v16 offset:21504
    v_mfma_f32_32x32x16_bf16 v[48:63], v[68:71], v[96:99], v[48:63]
    ds_read_b64_tr_b16 v[84:85], v17 offset:20480
    ds_read_b64_tr_b16 v[86:87], v17 offset:21504
    s_cmp_gt_u32 s63, 13
    s_cbranch_scc1 L_lp_60_ok
L_lp_60:
    ds_read_b32 v5, v4
    s_waitcnt lgkmcnt(0)
    v_readfirstlane_b32 s63, v5
    s_nop 0
    s_cmp_gt_u32 s63, 13
    s_cbranch_scc0 L_lp_60
L_lp_60_ok:
    buffer_load_dwordx4 v[176:179], v10, s[8:11], s39 offen offset:0 sc1
    s_waitcnt vmcnt(19) lgkmcnt(4)
    v_mfma_f32_32x32x16_bf16 v[32:47], v[72:75], v[100:103], v[32:47]
    ds_read_b64_tr_b16 v[88:89], v16 offset:22528
    ds_read_b64_tr_b16 v[90:91], v16 offset:23552
    v_mfma_f32_32x32x16_bf16 v[48:63], v[76:79], v[100:103], v[48:63]
    ds_read_b64_tr_b16 v[92:93], v17 offset:22528
    ds_read_b64_tr_b16 v[94:95], v17 offset:23552
    buffer_load_dwordx4 v[180:183], v10, s[8:11], s39 offen offset:1024 sc1
    s_waitcnt vmcnt(19) lgkmcnt(4)
    v_mfma_f32_32x32x16_bf16 v[32:47], v[80:83], v[104:107], v[32:47]
    s_barrier
    ds_read_b64_tr_b16 v[64:65], v12 offset:0
    ds_read_b64_tr_b16 v[66:67], v12 offset:1024
    v_mfma_f32_32x32x16_bf16 v[48:63], v[84:87], v[104:107], v[48:63]
    ds_read_b64_tr_b16 v[68:69], v13 offset:0
    ds_read_b64_tr_b16 v[70:71], v13 offset:1024
    buffer_load_dwordx4 v[184:187], v10, s[8:11], s39 offen offset:2048 sc1
    s_waitcnt vmcnt(19) lgkmcnt(4)
    v_mfma_f32_32x32x16_bf16 v[32:47], v[88:91], v[108:111], v[32:47]
    ds_read_b64_tr_b16 v[72:73], v12 offset:2048
    ds_read_b64_tr_b16 v[74:75], v12 offset:3072
    v_mfma_f32_32x32x16_bf16 v[48:63], v[92:95], v[108:111], v[48:63]
    ds_read_b64_tr_b16 v[76:77], v13 offset:2048
    ds_read_b64_tr_b16 v[78:79], v13 offset:3072
    buffer_load_dwordx4 v[188:191], v10, s[8:11], s39 offen offset:3072 sc1
    s_sub_u32 s39, s39, 49152
    s_waitcnt vmcnt(19) lgkmcnt(4)
    v_mfma_f32_32x32x16_bf16 v[32:47], v[64:67], v[112:115], v[32:47]
    ds_read_b64_tr_b16 v[80:81], v12 offset:4096
    ds_read_b64_tr_b16 v[82:83], v12 offset:5120
    v_mfma_f32_32x32x16_bf16 v[48:63], v[68:71], v[112:115], v[48:63]
    ds_read_b64_tr_b16 v[84:85], v13 offset:4096
    ds_read_b64_tr_b16 v[86:87], v13 offset:5120
    s_cmp_gt_u32 s63, 14
    s_cbranch_scc1 L_lp_61_ok
L_lp_61:
    ds_read_b32 v5, v4
    s_waitcnt lgkmcnt(0)
    v_readfirstlane_b32 s63, v5
    s_nop 0
    s_cmp_gt_u32 s63, 14
    s_cbranch_scc0 L_lp_61
L_lp_61_ok:
    buffer_load_dwordx4 v[192:195], v10, s[8:11], s39 offen offset:0 sc1
    s_waitcnt vmcnt(19) lgkmcnt(4)
    v_mfma_f32_32x32x16_bf16 v[32:47], v[72:75], v[116:119], v[32:47]
    ds_read_b64_tr_b16 v[88:89], v12 offset:6144
    ds_read_b64_tr_b16 v[90:91], v12 offset:7168
    v_mfma_f32_32x32x16_bf16 v[48:63], v[76:79], v[116:119], v[48:63]
    ds_read_b64_tr_b16 v[92:93], v13 offset:6144
    ds_read_b64_tr_b16 v[94:95], v13 offset:7168
    buffer_load_dwordx4 v[196:199], v10, s[8:11], s39 offen offset:1024 sc1
    s_waitcnt vmcnt(19) lgkmcnt(4)
    v_mfma_f32_32x32x16_bf16 v[32:47], v[80:83], v[120:123], v[32:47]
    ds_read_b64_tr_b16 v[64:65], v12 offset:8192
    ds_read_b64_tr_b16 v[66:67], v12 offset:9216
    v_mfma_f32_32x32x16_bf16 v[48:63], v[84:87], v[120:123], v[48:63]
    ds_read_b64_tr_b16 v[68:69], v13 offset:8192
    ds_read_b64_tr_b16 v[70:71], v13 offset:9216
    buffer_load_dwordx4 v[200:203], v10, s[8:11], s39 offen offset:2048 sc1
    s_waitcnt vmcnt(19) lgkmcnt(4)
    v_mfma_f32_32x32x16_bf16 v[32:47], v[88:91], v[124:127], v[32:47]
    ds_read_b64_tr_b16 v[72:73], v12 offset:10240
    ds_read_b64_tr_b16 v[74:75], v12 offset:11264
    v_mfma_f32_32x32x16_bf16 v[48:63], v[92:95], v[124:127], v[48:63]
    ds_read_b64_tr_b16 v[76:77], v13 offset:10240
    ds_read_b64_tr_b16 v[78:79], v13 offset:11264
    buffer_load_dwordx4 v[204:207], v10, s[8:11], s39 offen offset:3072 sc1
    s_add_u32 s39, s39, 32768
    s_waitcnt vmcnt(19) lgkmcnt(4)
    v_mfma_f32_32x32x16_bf16 v[32:47], v[64:67], v[128:131], v[32:47]
    ds_read_b64_tr_b16 v[80:81], v12 offset:12288
    ds_read_b64_tr_b16 v[82:83], v12 offset:13312
    v_mfma_f32_32x32x16_bf16 v[48:63], v[68:71], v[128:131], v[48:63]
    ds_read_b64_tr_b16 v[84:85], v13 offset:12288
    ds_read_b64_tr_b16 v[86:87], v13 offset:13312
    s_cmp_gt_u32 s63, 15
    s_cbranch_scc1 L_lp_62_ok
L_lp_62:
    ds_read_b32 v5, v4
    s_waitcnt lgkmcnt(0)
    v_readfirstlane_b32 s63, v5
    s_nop 0
    s_cmp_gt_u32 s63, 15
    s_cbranch_scc0 L_lp_62
L_lp_62_ok:
    buffer_load_dwordx4 v[208:211], v10, s[8:11], s39 offen offset:0 sc1
    s_waitcnt vmcnt(19) lgkmcnt(4)
    v_mfma_f32_32x32x16_bf16 v[32:47], v[72:75], v[132:135], v[32:47]
    ds_read_b64_tr_b16 v[88:89], v12 offset:14336
    ds_read_b64_tr_b16 v[90:91], v12 offset:15360
    v_mfma_f32_32x32x16_bf16 v[48:63], v[76:79], v[132:135], v[48:63]
    ds_read_b64_tr_b16 v[92:93], v13 offset:14336
    ds_read_b64_tr_b16 v[94:95], v13 offset:15360
    buffer_load_dwordx4 v[212:215], v10, s[8:11], s39 offen offset:1024 sc1
    s_waitcnt vmcnt(19) lgkmcnt(4)
    v_mfma_f32_32x32x16_bf16 v[32:47], v[80:83], v[136:139], v[32:47]
    ds_read_b64_tr_b16 v[64:65], v12 offset:16384
    ds_read_b64_tr_b16 v[66:67], v12 offset:17408
    v_mfma_f32_32x32x16_bf16 v[48:63], v[84:87], v[136:139], v[48:63]
    ds_read_b64_tr_b16 v[68:69], v13 offset:16384
    ds_read_b64_tr_b16 v[70:71], v13 offset:17408
    buffer_load_dwordx4 v[216:219], v10, s[8:11], s39 offen offset:2048 sc1
    s_waitcnt vmcnt(19) lgkmcnt(4)
    v_mfma_f32_32x32x16_bf16 v[32:47], v[88:91], v[140:143], v[32:47]
    ds_read_b64_tr_b16 v[72:73], v12 offset:18432
    ds_read_b64_tr_b16 v[74:75], v12 offset:19456
    v_mfma_f32_32x32x16_bf16 v[48:63], v[92:95], v[140:143], v[48:63]
    ds_read_b64_tr_b16 v[76:77], v13 offset:18432
    ds_read_b64_tr_b16 v[78:79], v13 offset:19456
    buffer_load_dwordx4 v[220:223], v10, s[8:11], s39 offen offset:3072 sc1
    s_waitcnt vmcnt(19) lgkmcnt(4)
    v_mfma_f32_32x32x16_bf16 v[32:47], v[64:67], v[144:147], v[32:47]
    ds_read_b64_tr_b16 v[80:81], v12 offset:20480
    ds_read_b64_tr_b16 v[82:83], v12 offset:21504
    v_mfma_f32_32x32x16_bf16 v[48:63], v[68:71], v[144:147], v[48:63]
    ds_read_b64_tr_b16 v[84:85], v13 offset:20480
    ds_read_b64_tr_b16 v[86:87], v13 offset:21504
    s_waitcnt vmcnt(18) lgkmcnt(4)
    v_mfma_f32_32x32x16_bf16 v[32:47], v[72:75], v[148:151], v[32:47]
    ds_read_b64_tr_b16 v[88:89], v12 offset:22528
    ds_read_b64_tr_b16 v[90:91], v12 offset:23552
    v_mfma_f32_32x32x16_bf16 v[48:63], v[76:79], v[148:151], v[48:63]
    ds_read_b64_tr_b16 v[92:93], v13 offset:22528
    ds_read_b64_tr_b16 v[94:95], v13 offset:23552
    s_waitcnt vmcnt(17) lgkmcnt(4)
    v_mfma_f32_32x32x16_bf16 v[32:47], v[80:83], v[152:155], v[32:47]
    ds_read_b64_tr_b16 v[64:65], v12 offset:24576
    ds_read_b64_tr_b16 v[66:67], v12 offset:25600
    v_mfma_f32_32x32x16_bf16 v[48:63], v[84:87], v[152:155], v[48:63]
    ds_read_b64_tr_b16 v[68:69], v13 offset:24576
    ds_read_b64_tr_b16 v[70:71], v13 offset:25600
    s_waitcnt vmcnt(16) lgkmcnt(4)
    v_mfma_f32_32x32x16_bf16 v[32:47], v[88:91], v[156:159], v[32:47]
    ds_read_b64_tr_b16 v[72:73], v12 offset:26624
    ds_read_b64_tr_b16 v[74:75], v12 offset:27648
    v_mfma_f32_32x32x16_bf16 v[48:63], v[92:95], v[156:159], v[48:63]
    ds_read_b64_tr_b16 v[76:77], v13 offset:26624
    ds_read_b64_tr_b16 v[78:79], v13 offset:27648
    s_waitcnt vmcnt(15) lgkmcnt(4)
    v_mfma_f32_32x32x16_bf16 v[32:47], v[64:67], v[160:163], v[32:47]
    ds_read_b64_tr_b16 v[80:81], v12 offset:28672
    ds_read_b64_tr_b16 v[82:83], v12 offset:29696
    s_add_u32 s37, s36, 0x0
    s_mov_b32 s35, 0x3f803f80
    v_mfma_f32_32x32x16_bf16 v[48:63], v[68:71], v[160:163], v[48:63]
    ds_read_b64_tr_b16 v[84:85], v13 offset:28672
    ds_read_b64_tr_b16 v[86:87], v13 offset:29696
    v_mov_b32 v24, 0
    v_mov_b32 v25, 0
    s_waitcnt vmcnt(14) lgkmcnt(4)
    v_mfma_f32_32x32x16_bf16 v[32:47], v[72:75], v[164:167], v[32:47]
    ds_read_b64_tr_b16 v[88:89], v12 offset:30720
    ds_read_b64_tr_b16 v[90:91], v12 offset:31744
    s_lshl_b32 s38, s4, 14
    s_lshl_b32 s31, s5, 10
    v_mfma_f32_32x32x16_bf16 v[48:63], v[76:79], v[164:167], v[48:63]
    ds_read_b64_tr_b16 v[92:93], v13 offset:30720
    ds_read_b64_tr_b16 v[94:95], v13 offset:31744
    s_add_u32 s38, s38, s31
    s_lshl_b32 s31, s3, 8
    s_waitcnt vmcnt(13) lgkmcnt(4)
    v_mfma_f32_32x32x16_bf16 v[32:47], v[80:83], v[168:171], v[32:47]
    ds_read_b64_tr_b16 v[64:65], v12 offset:32768
    ds_read_b64_tr_b16 v[66:67], v12 offset:33792
    s_add_u32 s38, s38, s31
    s_add_u32 s38, s38, 0x2640000
    v_mfma_f32_32x32x16_bf16 v[48:63], v[84:87], v[168:171], v[48:63]
    ds_read_b64_tr_b16 v[68:69], v13 offset:32768
    ds_read_b64_tr_b16 v[70:71], v13 offset:33792
    v_lshlrev_b32 v9, 2, v1
    s_waitcnt vmcnt(12) lgkmcnt(4)
    v_mfma_f32_32x32x16_bf16 v[32:47], v[88:91], v[172:175], v[32:47]
    ds_read_b64_tr_b16 v[72:73], v12 offset:34816
    ds_read_b64_tr_b16 v[74:75], v12 offset:35840
    v_mfma_f32_32x32x16_bf16 v[48:63], v[92:95], v[172:175], v[48:63]
    ds_read_b64_tr_b16 v[76:77], v13 offset:34816
    ds_read_b64_tr_b16 v[78:79], v13 offset:35840
    s_waitcnt vmcnt(11) lgkmcnt(4)
    v_mfma_f32_32x32x16_bf16 v[32:47], v[64:67], v[176:179], v[32:47]
    ds_read_b64_tr_b16 v[80:81], v12 offset:36864
    ds_read_b64_tr_b16 v[82:83], v12 offset:37888
    v_mfma_f32_32x32x16_bf16 v[48:63], v[68:71], v[176:179], v[48:63]
    ds_read_b64_tr_b16 v[84:85], v13 offset:36864
    ds_read_b64_tr_b16 v[86:87], v13 offset:37888
    s_waitcnt vmcnt(10) lgkmcnt(4)
    v_mfma_f32_32x32x16_bf16 v[32:47], v[72:75], v[180:183], v[32:47]
    ds_read_b64_tr_b16 v[88:89], v12 offset:38912
    ds_read_b64_tr_b16 v[90:91], v12 offset:39936
    v_mfma_f32_32x32x16_bf16 v[48:63], v[76:79], v[180:183], v[48:63]
    ds_read_b64_tr_b16 v[92:93], v13 offset:38912
    ds_read_b64_tr_b16 v[94:95], v13 offset:39936
    s_waitcnt vmcnt(9) lgkmcnt(4)
    v_mfma_f32_32x32x16_bf16 v[32:47], v[80:83], v[184:187], v[32:47]
    ds_read_b64_tr_b16 v[64:65], v12 offset:40960
    ds_read_b64_tr_b16 v[66:67], v12 offset:41984
    v_mfma_f32_32x32x16_bf16 v[48:63], v[84:87], v[184:187], v[48:63]
    ds_read_b64_tr_b16 v[68:69], v13 offset:40960
    ds_read_b64_tr_b16 v[70:71], v13 offset:41984
    s_waitcnt vmcnt(8) lgkmcnt(4)
    v_mfma_f32_32x32x16_bf16 v[32:47], v[88:91], v[188:191], v[32:47]
    ds_read_b64_tr_b16 v[72:73], v12 offset:43008
    ds_read_b64_tr_b16 v[74:75], v12 offset:44032
    v_mfma_f32_32x32x16_bf16 v[48:63], v[92:95], v[188:191], v[48:63]
    ds_read_b64_tr_b16 v[76:77], v13 offset:43008
    ds_read_b64_tr_b16 v[78:79], v13 offset:44032
    s_waitcnt vmcnt(7) lgkmcnt(4)
    v_mfma_f32_32x32x16_bf16 v[32:47], v[64:67], v[192:195], v[32:47]
    ds_read_b64_tr_b16 v[80:81], v12 offset:45056
    ds_read_b64_tr_b16 v[82:83], v12 offset:46080
    v_mfma_f32_32x32x16_bf16 v[48:63], v[68:71], v[192:195], v[48:63]
    ds_read_b64_tr_b16 v[84:85], v13 offset:45056
    ds_read_b64_tr_b16 v[86:87], v13 offset:46080
    s_waitcnt vmcnt(6) lgkmcnt(4)
    v_mfma_f32_32x32x16_bf16 v[32:47], v[72:75], v[196:199], v[32:47]
    ds_read_b64_tr_b16 v[88:89], v12 offset:47104
    ds_read_b64_tr_b16 v[90:91], v12 offset:48128
    v_mfma_f32_32x32x16_bf16 v[48:63], v[76:79], v[196:199], v[48:63]
    ds_read_b64_tr_b16 v[92:93], v13 offset:47104
    ds_read_b64_tr_b16 v[94:95], v13 offset:48128
    s_waitcnt vmcnt(5) lgkmcnt(4)
    v_mfma_f32_32x32x16_bf16 v[32:47], v[80:83], v[200:203], v[32:47]
    ds_read_b64_tr_b16 v[64:65], v12 offset:49152
    ds_read_b64_tr_b16 v[66:67], v12 offset:50176
    v_mfma_f32_32x32x16_bf16 v[48:63], v[84:87], v[200:203], v[48:63]
    ds_read_b64_tr_b16 v[68:69], v13 offset:49152
    ds_read_b64_tr_b16 v[70:71], v13 offset:50176
    s_waitcnt vmcnt(4) lgkmcnt(4)
    v_mfma_f32_32x32x16_bf16 v[32:47], v[88:91], v[204:207], v[32:47]
    ds_read_b64_tr_b16 v[72:73], v12 offset:51200
    ds_read_b64_tr_b16 v[74:75], v12 offset:52224
    v_mfma_f32_32x32x16_bf16 v[48:63], v[92:95], v[204:207], v[48:63]
    ds_read_b64_tr_b16 v[76:77], v13 offset:51200
    ds_read_b64_tr_b16 v[78:79], v13 offset:52224
    s_waitcnt vmcnt(3) lgkmcnt(4)
    v_mfma_f32_32x32x16_bf16 v[32:47], v[64:67], v[208:211], v[32:47]
    ds_read_b64_tr_b16 v[80:81], v12 offset:53248
    ds_read_b64_tr_b16 v[82:83], v12 offset:54272
    v_mfma_f32_32x32x16_bf16 v[48:63], v[68:71], v[208:211], v[48:63]
    ds_read_b64_tr_b16 v[84:85], v13 offset:53248
    ds_read_b64_tr_b16 v[86:87], v13 offset:54272
    s_waitcnt vmcnt(2) lgkmcnt(4)
    v_mfma_f32_32x32x16_bf16 v[32:47], v[72:75], v[212:215], v[32:47]
    ds_read_b64_tr_b16 v[88:89], v12 offset:55296
    ds_read_b64_tr_b16 v[90:91], v12 offset:56320
    v_mfma_f32_32x32x16_bf16 v[48:63], v[76:79], v[212:215], v[48:63]
    ds_read_b64_tr_b16 v[92:93], v13 offset:55296
    ds_read_b64_tr_b16 v[94:95], v13 offset:56320
    s_waitcnt vmcnt(1) lgkmcnt(4)
    v_mfma_f32_32x32x16_bf16 v[32:47], v[80:83], v[216:219], v[32:47]
    v_mfma_f32_32x32x16_bf16 v[48:63], v[84:87], v[216:219], v[48:63]
    s_waitcnt vmcnt(0) lgkmcnt(0)
    v_mfma_f32_32x32x16_bf16 v[32:47], v[88:91], v[220:223], v[32:47]
    s_barrier
    v_mfma_f32_32x32x16_bf16 v[48:63], v[92:95], v[220:223], v[48:63]
    s_nop 9
    v_cvt_pk_bf16_f32 v96, v32, v33
    v_cvt_pk_bf16_f32 v97, v34, v35
    v_cvt_pk_bf16_f32 v98, v36, v37
    v_cvt_pk_bf16_f32 v99, v38, v39
    buffer_store_dwordx4 v[96:99], v10, s[16:19], s37 offen offset:0 sc1
    v_cvt_pk_bf16_f32 v100, v40, v41
    v_cvt_pk_bf16_f32 v101, v42, v43
    v_cvt_pk_bf16_f32 v102, v44, v45
    v_cvt_pk_bf16_f32 v103, v46, v47
    buffer_store_dwordx4 v[100:103], v10, s[16:19], s37 offen offset:1024 sc1
    v_cvt_pk_bf16_f32 v104, v48, v49
    v_cvt_pk_bf16_f32 v105, v50, v51
    v_cvt_pk_bf16_f32 v106, v52, v53
    v_cvt_pk_bf16_f32 v107, v54, v55
    buffer_store_dwordx4 v[104:107], v10, s[16:19], s37 offen offset:2048 sc1
    v_cvt_pk_bf16_f32 v108, v56, v57
    v_cvt_pk_bf16_f32 v109, v58, v59
    v_cvt_pk_bf16_f32 v110, v60, v61
    v_cvt_pk_bf16_f32 v111, v62, v63
    buffer_store_dwordx4 v[108:111], v10, s[16:19], s37 offen offset:3072 sc1
    v_dot2_f32_bf16 v24, v96, s35, v24
    v_dot2_f32_bf16 v25, v96, v96, v25
    v_dot2_f32_bf16 v24, v97, s35, v24
    v_dot2_f32_bf16 v25, v97, v97, v25
    v_dot2_f32_bf16 v24, v98, s35, v24
    v_dot2_f32_bf16 v25, v98, v98, v25
    v_dot2_f32_bf16 v24, v99, s35, v24
    v_dot2_f32_bf16 v25, v99, v99, v25
    v_dot2_f32_bf16 v24, v100, s35, v24
    v_dot2_f32_bf16 v25, v100, v100, v25
    v_dot2_f32_bf16 v24, v101, s35, v24
    v_dot2_f32_bf16 v25, v101, v101, v25
    v_dot2_f32_bf16 v24, v102, s35, v24
    v_dot2_f32_bf16 v25, v102, v102, v25
    v_dot2_f32_bf16 v24, v103, s35, v24
    v_dot2_f32_bf16 v25, v103, v103, v25
    v_dot2_f32_bf16 v24, v104, s35, v24
    v_dot2_f32_bf16 v25, v104, v104, v25
    v_dot2_f32_bf16 v24, v105, s35, v24
    v_dot2_f32_bf16 v25, v105, v105, v25
    v_dot2_f32_bf16 v24, v106, s35, v24
    v_dot2_f32_bf16 v25, v106, v106, v25
    v_dot2_f32_bf16 v24, v107, s35, v24
    v_dot2_f32_bf16 v25, v107, v107, v25
    v_dot2_f32_bf16 v24, v108, s35, v24
    v_dot2_f32_bf16 v25, v108, v108, v25
    v_dot2_f32_bf16 v24, v109, s35, v24
    v_dot2_f32_bf16 v25, v109, v109, v25
    v_dot2_f32_bf16 v24, v110, s35, v24
    v_dot2_f32_bf16 v25, v110, v110, v25
    v_dot2_f32_bf16 v24, v111, s35, v24
    v_dot2_f32_bf16 v25, v111, v111, v25
    s_nop 2
    v_permlane32_swap_b32 v24, v25
    v_add_f32 v24, v24, v25
    buffer_store_dword v24, v9, s[16:19], s38 offen sc1
    s_waitcnt vmcnt(0)
    s_lshl_b32 s34, s4, 8
    s_add_u32 s34, s34, 0x2802000
    v_mov_b32 v4, 1
    v_mov_b32 v5, 0
    s_mov_b64 exec, 1
    v_mov_b32 v6, 163792
    ds_add_rtn_u32 v7, v6, v4
    s_waitcnt lgkmcnt(0)
    v_readfirstlane_b32 s35, v7
    s_nop 0
    s_cmp_eq_u32 s35, 3
    s_cbranch_scc0 L_sig_63
    s_lshl_b32 s35, s5, 2
    s_add_u32 s34, s34, s35
    buffer_store_dword v4, v5, s[16:19], s34 offen sc1
L_sig_63:
    s_mov_b64 exec, -1
    s_branch L_wa0_end_46
L_wa0_ld_45:
    s_sub_u32 s30, s3, 4
    v_lshrrev_b32 v6, 3, v1
    v_and_b32 v7, 7, v1
    s_lshl_b32 s31, s30, 4
    v_lshrrev_b32 v5, 1, v6
    v_and_b32 v5, 1, v5
    v_lshlrev_b32 v5, 2, v5
    v_xor_b32 v5, v5, v7
    v_lshlrev_b32 v5, 4, v5
    s_lshl_b32 s32, s5, 7
    v_add_u32 v5, s32, v5
    v_add_u32 v4, s31, v6
    v_lshl_add_u32 v12, v4, 11, v5
    v_add_u32 v13, 15360, v12
    v_lshlrev_b32 v8, 4, v1
    s_lshl_b32 s35, s30, 11
    s_add_u32 m0, s35, 0
    s_mov_b32 s38, 1310720
    buffer_load_dwordx4 v12, s[12:15], s38 offen offset:0 lds
    buffer_load_dwordx4 v13, s[12:15], s38 offen offset:1024 lds
    s_add_u32 m0, s35, 8192
    s_mov_b32 s38, 1572864
    buffer_load_dwordx4 v12, s[12:15], s38 offen offset:0 lds
    buffer_load_dwordx4 v13, s[12:15], s38 offen offset:1024 lds
    s_add_u32 m0, s35, 16384
    s_mov_b32 s38, 1703936
    buffer_load_dwordx4 v12, s[12:15], s38 offen offset:0 lds
    buffer_load_dwordx4 v13, s[12:15], s38 offen offset:1024 lds
    s_add_u32 m0, s35, 24576
    s_mov_b32 s38, 1835008
    buffer_load_dwordx4 v12, s[12:15], s38 offen offset:0 lds
    buffer_load_dwordx4 v13, s[12:15], s38 offen offset:1024 lds
    s_add_u32 m0, s35, 32768
    s_mov_b32 s38, 1966080
    buffer_load_dwordx4 v12, s[12:15], s38 offen offset:0 lds
    buffer_load_dwordx4 v13, s[12:15], s38 offen offset:1024 lds
    s_add_u32 m0, s35, 40960
    s_mov_b32 s38, 393216
    buffer_load_dwordx4 v12, s[12:15], s38 offen offset:0 lds
    buffer_load_dwordx4 v13, s[12:15], s38 offen offset:1024 lds
    s_add_u32 m0, s35, 49152
    s_mov_b32 s38, 1441792
    buffer_load_dwordx4 v12, s[12:15], s38 offen offset:0 lds
    buffer_load_dwordx4 v13, s[12:15], s38 offen offset:1024 lds
    s_barrier
    s_cmp_lg_u32 s3, 7
    s_cbranch_scc1 L_rp_64_ok
    v_and_b32 v4, 15, v1
    v_mov_b32 v5, 0x87654210
    v_mov_b32 v6, 0xb3fedca9
    v_cmp_lt_u32 vcc, 7, v4
    s_nop 1
    v_cndmask_b32 v5, v5, v6, vcc
    v_and_b32 v4, 7, v4
    v_lshlrev_b32 v4, 2, v4
    v_bfe_u32 v4, v5, v4, 4
    v_lshlrev_b32 v4, 2, v4
    s_lshl_b32 s52, s4, 8
    s_add_u32 s52, s52, 0x2801000
    s_mov_b32 s53, 0
    v_mov_b32 v6, 163796
L_rp_64:
    buffer_load_dword v5, v4, s[16:19], s52 offen sc1
    s_waitcnt vmcnt(0)
    v_cmp_ne_u32 vcc, 1, v5
    s_nop 0
    s_or_b32 s63, vcc_lo, 0x10000
    s_ff1_i32_b32 s63, s63
    s_add_u32 s53, s53, 1
    s_cmp_lt_u32 s53, 0x40000
    s_cselect_b32 s63, s63, 16
    v_mov_b32 v7, s63
    ds_write_b32 v6, v7
    s_cmp_lt_u32 s63, 14
    s_cbranch_scc1 L_rp_64
L_rp_64_ok:
    s_waitcnt vmcnt(0)
    s_barrier
    s_cmp_lg_u32 s3, 7
    s_cbranch_scc1 L_rp_65_ok
    v_and_b32 v4, 15, v1
    v_mov_b32 v5, 0x87654210
    v_mov_b32 v6, 0xb3fedca9
    v_cmp_lt_u32 vcc, 7, v4
    s_nop 1
    v_cndmask_b32 v5, v5, v6, vcc
    v_and_b32 v4, 7, v4
    v_lshlrev_b32 v4, 2, v4
    v_bfe_u32 v4, v5, v4, 4
    v_lshlrev_b32 v4, 2, v4
    s_lshl_b32 s52, s4, 8
    s_add_u32 s52, s52, 0x2801000
    s_mov_b32 s53, 0
    v_mov_b32 v6, 163796
L_rp_65:
    buffer_load_dword v5, v4, s[16:19], s52 offen sc1
    s_waitcnt vmcnt(0)
    v_cmp_ne_u32 vcc, 1, v5
    s_nop 0
    s_or_b32 s63, vcc_lo, 0x10000
    s_ff1_i32_b32 s63, s63
    s_add_u32 s53, s53, 1
    s_cmp_lt_u32 s53, 0x40000
    s_cselect_b32 s63, s63, 16
    v_mov_b32 v7, s63
    ds_write_b32 v6, v7
    s_cmp_lt_u32 s63, 16
    s_cbranch_scc1 L_rp_65
L_rp_65_ok:
    s_mov_b32 s24, s74
    s_and_b32 s25, s75, 0xffff
    s_mov_b32 s26, 0x200000
    s_mov_b32 s27, 0x20000
    s_and_b32 s57, s2, 1
    s_lshl_b32 s57, s57, 3
    s_bfe_u32 s58, s2, 0x30003
    s_add_u32 s57, s57, s58
    s_lshl_b32 s57, s57, 7
    v_lshrrev_b32 v241, 3, v1
    v_bfe_u32 v242, v241, 1, 1
    v_lshlrev_b32 v242, 2, v242
    v_and_b32 v243, 7, v1
    v_xor_b32 v242, v242, v243
    v_lshlrev_b32 v242, 4, v242
    s_lshl_b32 s58, s30, 4
    v_add_u32 v241, s58, v241
    v_lshl_add_u32 v241, v241, 11, v242
    v_add_u32 v241, s57, v241
    v_add_u32 v242, 15360, v241
    s_lshl_b32 s60, s30, 11
    s_add_u32 m0, s60, 57344
    s_mov_b32 s59, 0
    buffer_load_dwordx4 v241, s[24:27], s59 offen lds
    buffer_load_dwordx4 v242, s[24:27], s59 offen offset:1024 lds
    s_add_u32 m0, s60, 65536
    s_mov_b32 s59, 131072
    buffer_load_dwordx4 v241, s[24:27], s59 offen lds
    buffer_load_dwordx4 v242, s[24:27], s59 offen offset:1024 lds
    s_add_u32 m0, s60, 73728
    s_mov_b32 s59, 262144
    buffer_load_dwordx4 v241, s[24:27], s59 offen lds
    buffer_load_dwordx4 v242, s[24:27], s59 offen offset:1024 lds
    s_cmp_ge_u32 s5, 8
    s_cbranch_scc1 L_qe_66
    s_bitcmp1_b32 s5, 0
    s_cselect_b32 s46, s78, s76
    s_cselect_b32 s47, s79, s77
    s_mov_b32 s20, s46
    s_and_b32 s21, s47, 0xffff
    s_mov_b32 s22, 0x10000
    s_mov_b32 s23, 0x20000
    s_lshl_b32 s39, s30, 14
    s_add_u32 s31, s39, 81920
    s_add_u32 m0, s31, 0
    s_nop 0
    buffer_load_dwordx4 v8, s[20:23], s39 offen offset:0 lds
    buffer_load_dwordx4 v8, s[20:23], s39 offen offset:1024 lds
    buffer_load_dwordx4 v8, s[20:23], s39 offen offset:2048 lds
    buffer_load_dwordx4 v8, s[20:23], s39 offen offset:3072 lds
    s_add_u32 s39, s39, 4096
    s_add_u32 m0, s31, 4096
    s_nop 0
    buffer_load_dwordx4 v8, s[20:23], s39 offen offset:0 lds
    buffer_load_dwordx4 v8, s[20:23], s39 offen offset:1024 lds
    buffer_load_dwordx4 v8, s[20:23], s39 offen offset:2048 lds
    buffer_load_dwordx4 v8, s[20:23], s39 offen offset:3072 lds
    s_add_u32 s39, s39, 4096
    s_add_u32 m0, s31, 8192
    s_nop 0
    buffer_load_dwordx4 v8, s[20:23], s39 offen offset:0 lds
    buffer_load_dwordx4 v8, s[20:23], s39 offen offset:1024 lds
    buffer_load_dwordx4 v8, s[20:23], s39 offen offset:2048 lds
    buffer_load_dwordx4 v8, s[20:23], s39 offen offset:3072 lds
    s_add_u32 s39, s39, 4096
    s_add_u32 m0, s31, 12288
    s_nop 0
    buffer_load_dwordx4 v8, s[20:23], s39 offen offset:0 lds
    buffer_load_dwordx4 v8, s[20:23], s39 offen offset:1024 lds
    buffer_load_dwordx4 v8, s[20:23], s39 offen offset:2048 lds
    buffer_load_dwordx4 v8, s[20:23], s39 offen offset:3072 lds
    s_add_u32 s39, s39, 4096
    s_branch L_qe_67
L_qe_66:
    s_add_u32 m0, s60, 90112
    s_mov_b32 s59, 1441792
    buffer_load_dwordx4 v241, s[24:27], s59 offen lds
    buffer_load_dwordx4 v242, s[24:27], s59 offen offset:1024 lds
    s_add_u32 m0, s60, 106496
    s_mov_b32 s59, 1572864
    buffer_load_dwordx4 v241, s[24:27], s59 offen lds
    buffer_load_dwordx4 v242, s[24:27], s59 offen offset:1024 lds
    s_add_u32 m0, s60, 122880
    s_mov_b32 s59, 1703936
    buffer_load_dwordx4 v241, s[24:27], s59 offen lds
    buffer_load_dwordx4 v242, s[24:27], s59 offen offset:1024 lds
    s_add_u32 m0, s60, 139264
    s_mov_b32 s59, 1835008
    buffer_load_dwordx4 v241, s[24:27], s59 offen lds
    buffer_load_dwordx4 v242, s[24:27], s59 offen offset:1024 lds
    s_add_u32 m0, s60, 81920
    s_mov_b32 s59, 1966080
    buffer_load_dwordx4 v241, s[24:27], s59 offen lds
    buffer_load_dwordx4 v242, s[24:27], s59 offen offset:1024 lds
L_qe_67:
    s_barrier
L_wa0_end_46:
    s_and_b32 s6, s2, 7
    s_lshr_b32 s7, s2, 3
    s_lshr_b32 s4, s6, 1
    s_lshl_b32 s4, s4, 2
    s_lshr_b32 s5, s7, 3
    s_add_u32 s4, s4, s5
    s_and_b32 s5, s6, 1
    s_lshl_b32 s5, s5, 3
    s_and_b32 s7, s7, 7
    s_add_u32 s5, s5, s7
    s_add_u32 s8, s86, 0x0
    s_addc_u32 s9, s87, 0
    s_and_b32 s9, s9, 0xffff
    s_mov_b32 s10, 0x400000
    s_mov_b32 s11, 0x20000
    s_mov_b32 s12, s74
    s_and_b32 s13, s75, 0xffff
    s_mov_b32 s14, 0x200000
    s_mov_b32 s15, 0x20000
    s_lshr_b32 s48, s5, 1
    s_cmp_ge_u32 s3, 4
    s_cbranch_scc1 L_qb0_ld_68
    v_lshlrev_b32 v10, 4, v1
    s_lshl_b32 s39, s4, 2
    s_add_u32 s36, s39, s48
    s_add_u32 s39, s39, s3
    s_lshl_b32 s39, s39, 16
    s_lshl_b32 s36, s36, 16
    s_lshl_b32 s31, s3, 14
    s_add_u32 s36, s36, s31
    v_and_b32 v4, 15, v1
    v_lshrrev_b32 v5, 2, v4
    v_lshl_add_u32 v5, v3, 2, v5
    v_mul_u32_u24 v5, 128, v5
    v_and_b32 v6, 3, v4
    v_lshlrev_b32 v6, 3, v6
    v_bfe_u32 v7, v1, 4, 1
    v_lshl_add_u32 v6, v7, 5, v6
    v_add_u32 v6, 0, v6
    v_bfe_u32 v7, v1, 3, 1
    v_lshlrev_b32 v7, 6, v7
    v_xor_b32 v6, v6, v7
    v_add_u32 v12, v5, v6
    v_xor_b32 v13, 64, v12
    v_and_b32 v4, 15, v1
    v_lshrrev_b32 v5, 2, v4
    v_lshl_add_u32 v5, v3, 2, v5
    v_mul_u32_u24 v5, 64, v5
    v_and_b32 v6, 3, v4
    v_lshlrev_b32 v6, 3, v6
    v_bfe_u32 v7, v1, 4, 1
    v_lshl_add_u32 v6, v7, 5, v6
    v_add_u32 v6, 0, v6
    v_add_u32 v30, v5, v6
    s_lshl_b32 s31, s3, 14
    s_add_u32 s31, s31, 81920
    v_add_u32 v30, s31, v30
    v_add_u32 v31, s31, v10
    v_mov_b32 v4, 163800
    v_mov_b32 v5, 0
    ds_write_b32 v4, v5
    v_mov_b32 v32, 0
    v_mov_b32 v33, 0
    v_mov_b32 v34, 0
    v_mov_b32 v35, 0
    v_mov_b32 v36, 0
    v_mov_b32 v37, 0
    v_mov_b32 v38, 0
    v_mov_b32 v39, 0
    v_mov_b32 v40, 0
    v_mov_b32 v41, 0
    v_mov_b32 v42, 0
    v_mov_b32 v43, 0
    v_mov_b32 v44, 0
    v_mov_b32 v45, 0
    v_mov_b32 v46, 0
    v_mov_b32 v47, 0
    v_mov_b32 v48, 0
    v_mov_b32 v49, 0
    v_mov_b32 v50, 0
    v_mov_b32 v51, 0
    v_mov_b32 v52, 0
    v_mov_b32 v53, 0
    v_mov_b32 v54, 0
    v_mov_b32 v55, 0
    v_mov_b32 v56, 0
    v_mov_b32 v57, 0
    v_mov_b32 v58, 0
    v_mov_b32 v59, 0
    v_mov_b32 v60, 0
    v_mov_b32 v61, 0
    v_mov_b32 v62, 0
    v_mov_b32 v63, 0
    v_bfe_u32 v4, v1, 2, 1
    v_bfe_u32 v5, v1, 4, 1
    v_cmp_eq_u32 vcc, v4, v5
    v_mov_b32 v4, 0x3f803f80
    s_nop 0
    v_cndmask_b32 v216, 0, v4, vcc
    v_mov_b32 v217, v216
    v_mov_b32 v218, v216
    v_mov_b32 v219, v216
    v_mov_b32 v208, 0
    v_mov_b32 v209, 0
    v_mov_b32 v210, 0
    v_mov_b32 v211, 0
    v_mov_b32 v212, 0
    v_mov_b32 v213, 0
    v_mov_b32 v214, 0
    v_mov_b32 v215, 0
    s_waitcnt lgkmcnt(0)
    v_add_u32 v14, 0x10000, v12
    v_add_u32 v15, 0x10000, v13
    v_add_u32 v16, 0x20000, v12
    v_add_u32 v17, 0x20000, v13
    v_mov_b32 v4, 163800
    s_mov_b32 s63, 0
    s_barrier
    s_cmp_ge_u32 s5, 8
    s_cbranch_scc1 L_qb0_nokv_70_a
    s_lshl_b32 s31, s3, 2
    s_add_u32 s31, s31, 3
L_pp_72:
    ds_read_b32 v5, v4
    s_waitcnt lgkmcnt(0)
    v_readfirstlane_b32 s63, v5
    s_nop 0
    s_cmp_gt_u32 s63, s31
    s_cbranch_scc0 L_pp_72
    buffer_load_dwordx4 v[128:131], v10, s[8:11], s36 offen offset:0 sc1
    buffer_load_dwordx4 v[132:135], v10, s[8:11], s36 offen offset:1024 sc1
    buffer_load_dwordx4 v[136:139], v10, s[8:11], s36 offen offset:2048 sc1
    buffer_load_dwordx4 v[140:143], v10, s[8:11], s36 offen offset:3072 sc1
    s_add_u32 s36, s36, 4096
    buffer_load_dwordx4 v[144:147], v10, s[8:11], s36 offen offset:0 sc1
    buffer_load_dwordx4 v[148:151], v10, s[8:11], s36 offen offset:1024 sc1
    buffer_load_dwordx4 v[152:155], v10, s[8:11], s36 offen offset:2048 sc1
    buffer_load_dwordx4 v[156:159], v10, s[8:11], s36 offen offset:3072 sc1
    s_add_u32 s36, s36, 4096
    buffer_load_dwordx4 v[160:163], v10, s[8:11], s36 offen offset:0 sc1
    buffer_load_dwordx4 v[164:167], v10, s[8:11], s36 offen offset:1024 sc1
    buffer_load_dwordx4 v[168:171], v10, s[8:11], s36 offen offset:2048 sc1
    buffer_load_dwordx4 v[172:175], v10, s[8:11], s36 offen offset:3072 sc1
    s_add_u32 s36, s36, 4096
    buffer_load_dwordx4 v[176:179], v10, s[8:11], s36 offen offset:0 sc1
    buffer_load_dwordx4 v[180:183], v10, s[8:11], s36 offen offset:1024 sc1
    buffer_load_dwordx4 v[184:187], v10, s[8:11], s36 offen offset:2048 sc1
    buffer_load_dwordx4 v[188:191], v10, s[8:11], s36 offen offset:3072 sc1
    s_add_u32 s36, s36, 4096
L_qb0_nokv_70_a:
    s_cmp_gt_u32 s63, 0
    s_cbranch_scc1 L_lp_73_ok
L_lp_73:
    ds_read_b32 v5, v4
    s_waitcnt lgkmcnt(0)
    v_readfirstlane_b32 s63, v5
    s_nop 0
    s_cmp_gt_u32 s63, 0
    s_cbranch_scc0 L_lp_73
L_lp_73_ok:
    buffer_load_dwordx4 v[96:99], v10, s[8:11], s39 offen offset:0 sc1
    buffer_load_dwordx4 v[100:103], v10, s[8:11], s39 offen offset:1024 sc1
    buffer_load_dwordx4 v[104:107], v10, s[8:11], s39 offen offset:2048 sc1
    buffer_load_dwordx4 v[108:111], v10, s[8:11], s39 offen offset:3072 sc1
    s_add_u32 s39, s39, 4096
    s_cmp_gt_u32 s63, 1
    s_cbranch_scc1 L_lp_74_ok
L_lp_74:
    ds_read_b32 v5, v4
    s_waitcnt lgkmcnt(0)
    v_readfirstlane_b32 s63, v5
    s_nop 0
    s_cmp_gt_u32 s63, 1
    s_cbranch_scc0 L_lp_74
L_lp_74_ok:
    buffer_load_dwordx4 v[112:115], v10, s[8:11], s39 offen offset:0 sc1
    buffer_load_dwordx4 v[116:119], v10, s[8:11], s39 offen offset:1024 sc1
    buffer_load_dwordx4 v[120:123], v10, s[8:11], s39 offen offset:2048 sc1
    buffer_load_dwordx4 v[124:127], v10, s[8:11], s39 offen offset:3072 sc1
    s_add_u32 s39, s39, 4096
    s_cmp_ge_u32 s5, 8
    s_cbranch_scc1 L_qb0_nokv_70
    ds_read_b64_tr_b16 v[64:65], v30 offset:0
    ds_read_b64_tr_b16 v[66:67], v30 offset:512
    ds_read_b64_tr_b16 v[68:69], v30 offset:1024
    ds_read_b64_tr_b16 v[70:71], v30 offset:1536
    ds_read_b64_tr_b16 v[72:73], v30 offset:2048
    ds_read_b64_tr_b16 v[74:75], v30 offset:2560
    ds_read_b64_tr_b16 v[76:77], v30 offset:3072
    ds_read_b64_tr_b16 v[78:79], v30 offset:3584
    ds_read_b64_tr_b16 v[80:81], v30 offset:4096
    ds_read_b64_tr_b16 v[82:83], v30 offset:4608
    ds_read_b64_tr_b16 v[84:85], v30 offset:5120
    ds_read_b64_tr_b16 v[86:87], v30 offset:5632
    ds_read_b64_tr_b16 v[88:89], v30 offset:6144
    ds_read_b64_tr_b16 v[90:91], v30 offset:6656
    s_waitcnt vmcnt(23) lgkmcnt(12)
    v_mfma_f32_32x32x16_bf16 v[192:207], v[64:67], v[128:131], 0
    v_mfma_f32_16x16x32_bf16 v[224:227], v[216:219], v[64:67], 0
    ds_read_b64_tr_b16 v[92:93], v30 offset:7168
    ds_read_b64_tr_b16 v[94:95], v30 offset:7680
    s_waitcnt vmcnt(22) lgkmcnt(12)
    v_mfma_f32_32x32x16_bf16 v[192:207], v[68:71], v[132:135], v[192:207]
    v_mfma_f32_16x16x32_bf16 v[224:227], v[216:219], v[68:71], v[224:227]
    ds_read_b64_tr_b16 v[64:65], v30 offset:8192
    ds_read_b64_tr_b16 v[66:67], v30 offset:8704
    s_waitcnt vmcnt(21) lgkmcnt(12)
    v_mfma_f32_32x32x16_bf16 v[192:207], v[72:75], v[136:139], v[192:207]
    v_mfma_f32_16x16x32_bf16 v[224:227], v[216:219], v[72:75], v[224:227]
    ds_read_b64_tr_b16 v[68:69], v30 offset:9216
    ds_read_b64_tr_b16 v[70:71], v30 offset:9728
    s_waitcnt vmcnt(20) lgkmcnt(12)
    v_mfma_f32_32x32x16_bf16 v[192:207], v[76:79], v[140:143], v[192:207]
    v_mfma_f32_16x16x32_bf16 v[224:227], v[216:219], v[76:79], v[224:227]
    ds_read_b64_tr_b16 v[72:73], v30 offset:10240
    ds_read_b64_tr_b16 v[74:75], v30 offset:10752
    s_waitcnt vmcnt(19) lgkmcnt(12)
    v_mfma_f32_32x32x16_bf16 v[192:207], v[80:83], v[144:147], v[192:207]
    v_mfma_f32_16x16x32_bf16 v[224:227], v[216:219], v[80:83], v[224:227]
    ds_read_b64_tr_b16 v[76:77], v30 offset:11264
    ds_read_b64_tr_b16 v[78:79], v30 offset:11776
    s_waitcnt vmcnt(18) lgkmcnt(12)
    v_mfma_f32_32x32x16_bf16 v[192:207], v[84:87], v[148:151], v[192:207]
    v_mfma_f32_16x16x32_bf16 v[224:227], v[216:219], v[84:87], v[224:227]
    ds_read_b64_tr_b16 v[80:81], v30 offset:12288
    ds_read_b64_tr_b16 v[82:83], v30 offset:12800
    s_waitcnt vmcnt(17) lgkmcnt(12)
    v_mfma_f32_32x32x16_bf16 v[192:207], v[88:91], v[152:155], v[192:207]
    v_mfma_f32_16x16x32_bf16 v[224:227], v[216:219], v[88:91], v[224:227]
    ds_read_b64_tr_b16 v[84:85], v30 offset:13312
    ds_read_b64_tr_b16 v[86:87], v30 offset:13824
    s_waitcnt vmcnt(16) lgkmcnt(12)
    v_mfma_f32_32x32x16_bf16 v[192:207], v[92:95], v[156:159], v[192:207]
    v_mfma_f32_16x16x32_bf16 v[224:227], v[216:219], v[92:95], v[224:227]
    ds_read_b64_tr_b16 v[88:89], v30 offset:14336
    ds_read_b64_tr_b16 v[90:91], v30 offset:14848
    s_waitcnt vmcnt(15) lgkmcnt(12)
    v_mfma_f32_32x32x16_bf16 v[192:207], v[64:67], v[160:163], v[192:207]
    v_mfma_f32_16x16x32_bf16 v[224:227], v[216:219], v[64:67], v[224:227]
    ds_read_b64_tr_b16 v[92:93], v30 offset:15360
    ds_read_b64_tr_b16 v[94:95], v30 offset:15872
    s_waitcnt vmcnt(14) lgkmcnt(12)
    v_mfma_f32_32x32x16_bf16 v[192:207], v[68:71], v[164:167], v[192:207]
    v_mfma_f32_16x16x32_bf16 v[224:227], v[216:219], v[68:71], v[224:227]
    s_waitcnt vmcnt(13) lgkmcnt(10)
    v_mfma_f32_32x32x16_bf16 v[192:207], v[72:75], v[168:171], v[192:207]
    v_mfma_f32_16x16x32_bf16 v[224:227], v[216:219], v[72:75], v[224:227]
    s_waitcnt vmcnt(12) lgkmcnt(8)
    v_mfma_f32_32x32x16_bf16 v[192:207], v[76:79], v[172:175], v[192:207]
    v_mfma_f32_16x16x32_bf16 v[224:227], v[216:219], v[76:79], v[224:227]
    s_waitcnt vmcnt(11) lgkmcnt(6)
    v_mfma_f32_32x32x16_bf16 v[192:207], v[80:83], v[176:179], v[192:207]
    v_mfma_f32_16x16x32_bf16 v[224:227], v[216:219], v[80:83], v[224:227]
    s_waitcnt vmcnt(10) lgkmcnt(4)
    v_mfma_f32_32x32x16_bf16 v[192:207], v[84:87], v[180:183], v[192:207]
    v_mfma_f32_16x16x32_bf16 v[224:227], v[216:219], v[84:87], v[224:227]
    s_waitcnt vmcnt(9) lgkmcnt(2)
    v_mfma_f32_32x32x16_bf16 v[192:207], v[88:91], v[184:187], v[192:207]
    v_mfma_f32_16x16x32_bf16 v[224:227], v[216:219], v[88:91], v[224:227]
    s_waitcnt vmcnt(8) lgkmcnt(0)
    v_mfma_f32_32x32x16_bf16 v[192:207], v[92:95], v[188:191], v[192:207]
    v_mfma_f32_16x16x32_bf16 v[224:227], v[216:219], v[92:95], v[224:227]
    s_nop 10
    ds_write_b128 v31, v[192:195] offset:0
    ds_write_b128 v31, v[196:199] offset:1024
    ds_write_b128 v31, v[200:203] offset:2048
    ds_write_b128 v31, v[204:207] offset:3072
    s_lshl_b32 s31, s3, 8
    s_add_u32 s31, s31, 157952
    v_lshlrev_b32 v9, 2, v1
    v_add_u32 v9, s31, v9
    ds_write_b32 v9, v224
    s_waitcnt lgkmcnt(0)
L_qb0_nokv_70:
    s_barrier
    ds_read_b64_tr_b16 v[64:65], v12 offset:57344
    ds_read_b64_tr_b16 v[66:67], v12 offset:58368
    ds_read_b64_tr_b16 v[68:69], v13 offset:57344
    ds_read_b64_tr_b16 v[70:71], v13 offset:58368
    ds_read_b64_tr_b16 v[72:73], v12 offset:59392
    ds_read_b64_tr_b16 v[74:75], v12 offset:60416
    ds_read_b64_tr_b16 v[76:77], v13 offset:59392
    ds_read_b64_tr_b16 v[78:79], v13 offset:60416
    s_waitcnt vmcnt(7) lgkmcnt(4)
    v_mfma_f32_32x32x16_bf16 v[32:47], v[64:67], v[96:99], v[32:47]
    ds_read_b64_tr_b16 v[80:81], v12 offset:61440
    ds_read_b64_tr_b16 v[82:83], v12 offset:62464
    v_mfma_f32_32x32x16_bf16 v[48:63], v[68:71], v[96:99], v[48:63]
    s_cmp_eq_u32 s3, 0
    s_cbranch_scc0 L_cs_75
    v_mfma_f32_16x16x32_bf16 v[208:211], v[216:219], v[64:67], v[208:211]
    v_mfma_f32_16x16x32_bf16 v[212:215], v[216:219], v[68:71], v[212:215]
L_cs_75:
    ds_read_b64_tr_b16 v[84:85], v13 offset:61440
    ds_read_b64_tr_b16 v[86:87], v13 offset:62464
    s_cmp_gt_u32 s63, 2
    s_cbranch_scc1 L_lp_76_ok
L_lp_76:
    ds_read_b32 v5, v4
    s_waitcnt lgkmcnt(0)
    v_readfirstlane_b32 s63, v5
    s_nop 0
    s_cmp_gt_u32 s63, 2
    s_cbranch_scc0 L_lp_76
L_lp_76_ok:
    buffer_load_dwordx4 v[128:131], v10, s[8:11], s39 offen offset:0 sc1
    buffer_load_dwordx4 v[132:135], v10, s[8:11], s39 offen offset:1024 sc1
    s_waitcnt vmcnt(8) lgkmcnt(4)
    v_mfma_f32_32x32x16_bf16 v[32:47], v[72:75], v[100:103], v[32:47]
    ds_read_b64_tr_b16 v[88:89], v12 offset:63488
    ds_read_b64_tr_b16 v[90:91], v12 offset:64512
    v_mfma_f32_32x32x16_bf16 v[48:63], v[76:79], v[100:103], v[48:63]
    s_cmp_eq_u32 s3, 1
    s_cbranch_scc0 L_cs_77
    v_mfma_f32_16x16x32_bf16 v[208:211], v[216:219], v[72:75], v[208:211]
    v_mfma_f32_16x16x32_bf16 v[212:215], v[216:219], v[76:79], v[212:215]
L_cs_77:
    ds_read_b64_tr_b16 v[92:93], v13 offset:63488
    ds_read_b64_tr_b16 v[94:95], v13 offset:64512
    buffer_load_dwordx4 v[136:139], v10, s[8:11], s39 offen offset:2048 sc1
    buffer_load_dwordx4 v[140:143], v10, s[8:11], s39 offen offset:3072 sc1
    s_add_u32 s39, s39, 4096
    s_waitcnt vmcnt(9) lgkmcnt(4)
    v_mfma_f32_32x32x16_bf16 v[32:47], v[80:83], v[104:107], v[32:47]
    ds_read_b64_tr_b16 v[64:65], v14 offset:0
    ds_read_b64_tr_b16 v[66:67], v14 offset:1024
    v_mfma_f32_32x32x16_bf16 v[48:63], v[84:87], v[104:107], v[48:63]
    s_cmp_eq_u32 s3, 2
    s_cbranch_scc0 L_cs_78
    v_mfma_f32_16x16x32_bf16 v[208:211], v[216:219], v[80:83], v[208:211]
    v_mfma_f32_16x16x32_bf16 v[212:215], v[216:219], v[84:87], v[212:215]
L_cs_78:
    ds_read_b64_tr_b16 v[68:69], v15 offset:0
    ds_read_b64_tr_b16 v[70:71], v15 offset:1024
    s_cmp_gt_u32 s63, 3
    s_cbranch_scc1 L_lp_79_ok
L_lp_79:
    ds_read_b32 v5, v4
    s_waitcnt lgkmcnt(0)
    v_readfirstlane_b32 s63, v5
    s_nop 0
    s_cmp_gt_u32 s63, 3
    s_cbranch_scc0 L_lp_79
L_lp_79_ok:
    buffer_load_dwordx4 v[144:147], v10, s[8:11], s39 offen offset:0 sc1
    buffer_load_dwordx4 v[148:151], v10, s[8:11], s39 offen offset:1024 sc1
    s_waitcnt vmcnt(10) lgkmcnt(4)
    v_mfma_f32_32x32x16_bf16 v[32:47], v[88:91], v[108:111], v[32:47]
    ds_read_b64_tr_b16 v[72:73], v14 offset:2048
    ds_read_b64_tr_b16 v[74:75], v14 offset:3072
    v_mfma_f32_32x32x16_bf16 v[48:63], v[92:95], v[108:111], v[48:63]
    s_cmp_eq_u32 s3, 3
    s_cbranch_scc0 L_cs_80
    v_mfma_f32_16x16x32_bf16 v[208:211], v[216:219], v[88:91], v[208:211]
    v_mfma_f32_16x16x32_bf16 v[212:215], v[216:219], v[92:95], v[212:215]
L_cs_80:
    ds_read_b64_tr_b16 v[76:77], v15 offset:2048
    ds_read_b64_tr_b16 v[78:79], v15 offset:3072
    buffer_load_dwordx4 v[152:155], v10, s[8:11], s39 offen offset:2048 sc1
    buffer_load_dwordx4 v[156:159], v10, s[8:11], s39 offen offset:3072 sc1
    s_add_u32 s39, s39, 4096
    s_waitcnt vmcnt(11) lgkmcnt(4)
    v_mfma_f32_32x32x16_bf16 v[32:47], v[64:67], v[112:115], v[32:47]
    ds_read_b64_tr_b16 v[80:81], v14 offset:4096
    ds_read_b64_tr_b16 v[82:83], v14 offset:5120
    v_mfma_f32_32x32x16_bf16 v[48:63], v[68:71], v[112:115], v[48:63]
    s_cmp_eq_u32 s3, 0
    s_cbranch_scc0 L_cs_81
    v_mfma_f32_16x16x32_bf16 v[208:211], v[216:219], v[64:67], v[208:211]
    v_mfma_f32_16x16x32_bf16 v[212:215], v[216:219], v[68:71], v[212:215]
L_cs_81:
    ds_read_b64_tr_b16 v[84:85], v15 offset:4096
    ds_read_b64_tr_b16 v[86:87], v15 offset:5120
    s_cmp_gt_u32 s63, 4
    s_cbranch_scc1 L_lp_82_ok
L_lp_82:
    ds_read_b32 v5, v4
    s_waitcnt lgkmcnt(0)
    v_readfirstlane_b32 s63, v5
    s_nop 0
    s_cmp_gt_u32 s63, 4
    s_cbranch_scc0 L_lp_82
L_lp_82_ok:
    buffer_load_dwordx4 v[160:163], v10, s[8:11], s39 offen offset:0 sc1
    buffer_load_dwordx4 v[164:167], v10, s[8:11], s39 offen offset:1024 sc1
    s_waitcnt vmcnt(12) lgkmcnt(4)
    v_mfma_f32_32x32x16_bf16 v[32:47], v[72:75], v[116:119], v[32:47]
    ds_read_b64_tr_b16 v[88:89], v14 offset:6144
    ds_read_b64_tr_b16 v[90:91], v14 offset:7168
    v_mfma_f32_32x32x16_bf16 v[48:63], v[76:79], v[116:119], v[48:63]
    s_cmp_eq_u32 s3, 1
    s_cbranch_scc0 L_cs_83
    v_mfma_f32_16x16x32_bf16 v[208:211], v[216:219], v[72:75], v[208:211]
    v_mfma_f32_16x16x32_bf16 v[212:215], v[216:219], v[76:79], v[212:215]
L_cs_83:
    ds_read_b64_tr_b16 v[92:93], v15 offset:6144
    ds_read_b64_tr_b16 v[94:95], v15 offset:7168
    buffer_load_dwordx4 v[168:171], v10, s[8:11], s39 offen offset:2048 sc1
    buffer_load_dwordx4 v[172:175], v10, s[8:11], s39 offen offset:3072 sc1
    s_add_u32 s39, s39, 4096
    s_waitcnt vmcnt(13) lgkmcnt(4)
    v_mfma_f32_32x32x16_bf16 v[32:47], v[80:83], v[120:123], v[32:47]
    ds_read_b64_tr_b16 v[64:65], v14 offset:8192
    ds_read_b64_tr_b16 v[66:67], v14 offset:9216
    v_mfma_f32_32x32x16_bf16 v[48:63], v[84:87], v[120:123], v[48:63]
    s_cmp_eq_u32 s3, 2
    s_cbranch_scc0 L_cs_84
    v_mfma_f32_16x16x32_bf16 v[208:211], v[216:219], v[80:83], v[208:211]
    v_mfma_f32_16x16x32_bf16 v[212:215], v[216:219], v[84:87], v[212:215]
L_cs_84:
    ds_read_b64_tr_b16 v[68:69], v15 offset:8192
    ds_read_b64_tr_b16 v[70:71], v15 offset:9216
    s_cmp_gt_u32 s63, 5
    s_cbranch_scc1 L_lp_85_ok
L_lp_85:
    ds_read_b32 v5, v4
    s_waitcnt lgkmcnt(0)
    v_readfirstlane_b32 s63, v5
    s_nop 0
    s_cmp_gt_u32 s63, 5
    s_cbranch_scc0 L_lp_85
L_lp_85_ok:
    buffer_load_dwordx4 v[176:179], v10, s[8:11], s39 offen offset:0 sc1
    buffer_load_dwordx4 v[180:183], v10, s[8:11], s39 offen offset:1024 sc1
    s_waitcnt vmcnt(14) lgkmcnt(4)
    v_mfma_f32_32x32x16_bf16 v[32:47], v[88:91], v[124:127], v[32:47]
    ds_read_b64_tr_b16 v[72:73], v14 offset:10240
    ds_read_b64_tr_b16 v[74:75], v14 offset:11264
    v_mfma_f32_32x32x16_bf16 v[48:63], v[92:95], v[124:127], v[48:63]
    s_cmp_eq_u32 s3, 3
    s_cbranch_scc0 L_cs_86
    v_mfma_f32_16x16x32_bf16 v[208:211], v[216:219], v[88:91], v[208:211]
    v_mfma_f32_16x16x32_bf16 v[212:215], v[216:219], v[92:95], v[212:215]
L_cs_86:
    ds_read_b64_tr_b16 v[76:77], v15 offset:10240
    ds_read_b64_tr_b16 v[78:79], v15 offset:11264
    buffer_load_dwordx4 v[184:187], v10, s[8:11], s39 offen offset:2048 sc1
    buffer_load_dwordx4 v[188:191], v10, s[8:11], s39 offen offset:3072 sc1
    s_add_u32 s39, s39, 4096
    s_waitcnt vmcnt(15) lgkmcnt(4)
    v_mfma_f32_32x32x16_bf16 v[32:47], v[64:67], v[128:131], v[32:47]
    ds_read_b64_tr_b16 v[80:81], v14 offset:12288
    ds_read_b64_tr_b16 v[82:83], v14 offset:13312
    v_mfma_f32_32x32x16_bf16 v[48:63], v[68:71], v[128:131], v[48:63]
    s_cmp_eq_u32 s3, 0
    s_cbranch_scc0 L_cs_87
    v_mfma_f32_16x16x32_bf16 v[208:211], v[216:219], v[64:67], v[208:211]
    v_mfma_f32_16x16x32_bf16 v[212:215], v[216:219], v[68:71], v[212:215]
L_cs_87:
    ds_read_b64_tr_b16 v[84:85], v15 offset:12288
    ds_read_b64_tr_b16 v[86:87], v15 offset:13312
    s_cmp_gt_u32 s63, 6
    s_cbranch_scc1 L_lp_88_ok
L_lp_88:
    ds_read_b32 v5, v4
    s_waitcnt lgkmcnt(0)
    v_readfirstlane_b32 s63, v5
    s_nop 0
    s_cmp_gt_u32 s63, 6
    s_cbranch_scc0 L_lp_88
L_lp_88_ok:
    buffer_load_dwordx4 v[192:195], v10, s[8:11], s39 offen offset:0 sc1
    buffer_load_dwordx4 v[196:199], v10, s[8:11], s39 offen offset:1024 sc1
    s_waitcnt vmcnt(16) lgkmcnt(4)
    v_mfma_f32_32x32x16_bf16 v[32:47], v[72:75], v[132:135], v[32:47]
    ds_read_b64_tr_b16 v[88:89], v14 offset:14336
    ds_read_b64_tr_b16 v[90:91], v14 offset:15360
    v_mfma_f32_32x32x16_bf16 v[48:63], v[76:79], v[132:135], v[48:63]
    s_cmp_eq_u32 s3, 1
    s_cbranch_scc0 L_cs_89
    v_mfma_f32_16x16x32_bf16 v[208:211], v[216:219], v[72:75], v[208:211]
    v_mfma_f32_16x16x32_bf16 v[212:215], v[216:219], v[76:79], v[212:215]
L_cs_89:
    ds_read_b64_tr_b16 v[92:93], v15 offset:14336
    ds_read_b64_tr_b16 v[94:95], v15 offset:15360
    buffer_load_dwordx4 v[200:203], v10, s[8:11], s39 offen offset:2048 sc1
    buffer_load_dwordx4 v[204:207], v10, s[8:11], s39 offen offset:3072 sc1
    s_add_u32 s39, s39, 4096
    s_waitcnt vmcnt(17) lgkmcnt(4)
    v_mfma_f32_32x32x16_bf16 v[32:47], v[80:83], v[136:139], v[32:47]
    ds_read_b64_tr_b16 v[64:65], v12 offset:0
    ds_read_b64_tr_b16 v[66:67], v12 offset:1024
    v_mfma_f32_32x32x16_bf16 v[48:63], v[84:87], v[136:139], v[48:63]
    s_cmp_eq_u32 s3, 2
    s_cbranch_scc0 L_cs_90
    v_mfma_f32_16x16x32_bf16 v[208:211], v[216:219], v[80:83], v[208:211]
    v_mfma_f32_16x16x32_bf16 v[212:215], v[216:219], v[84:87], v[212:215]
L_cs_90:
    ds_read_b64_tr_b16 v[68:69], v13 offset:0
    ds_read_b64_tr_b16 v[70:71], v13 offset:1024
    s_cmp_gt_u32 s63, 7
    s_cbranch_scc1 L_lp_91_ok
L_lp_91:
    ds_read_b32 v5, v4
    s_waitcnt lgkmcnt(0)
    v_readfirstlane_b32 s63, v5
    s_nop 0
    s_cmp_gt_u32 s63, 7
    s_cbranch_scc0 L_lp_91
L_lp_91_ok:
    buffer_load_dwordx4 v[96:99], v10, s[8:11], s39 offen offset:0 sc1
    buffer_load_dwordx4 v[100:103], v10, s[8:11], s39 offen offset:1024 sc1
    s_waitcnt vmcnt(18) lgkmcnt(4)
    v_mfma_f32_32x32x16_bf16 v[32:47], v[88:91], v[140:143], v[32:47]
    ds_read_b64_tr_b16 v[72:73], v12 offset:2048
    ds_read_b64_tr_b16 v[74:75], v12 offset:3072
    v_mfma_f32_32x32x16_bf16 v[48:63], v[92:95], v[140:143], v[48:63]
    s_cmp_eq_u32 s3, 3
    s_cbranch_scc0 L_cs_92
    v_mfma_f32_16x16x32_bf16 v[208:211], v[216:219], v[88:91], v[208:211]
    v_mfma_f32_16x16x32_bf16 v[212:215], v[216:219], v[92:95], v[212:215]
L_cs_92:
    ds_read_b64_tr_b16 v[76:77], v13 offset:2048
    ds_read_b64_tr_b16 v[78:79], v13 offset:3072
    buffer_load_dwordx4 v[104:107], v10, s[8:11], s39 offen offset:2048 sc1
    buffer_load_dwordx4 v[108:111], v10, s[8:11], s39 offen offset:3072 sc1
    s_add_u32 s39, s39, 4096
    s_waitcnt vmcnt(19) lgkmcnt(4)
    v_mfma_f32_32x32x16_bf16 v[32:47], v[64:67], v[144:147], v[32:47]
    ds_read_b64_tr_b16 v[80:81], v12 offset:4096
    ds_read_b64_tr_b16 v[82:83], v12 offset:5120
    v_mfma_f32_32x32x16_bf16 v[48:63], v[68:71], v[144:147], v[48:63]
    s_cmp_eq_u32 s3, 0
    s_cbranch_scc0 L_cs_93
    v_mfma_f32_16x16x32_bf16 v[208:211], v[216:219], v[64:67], v[208:211]
    v_mfma_f32_16x16x32_bf16 v[212:215], v[216:219], v[68:71], v[212:215]
L_cs_93:
    ds_read_b64_tr_b16 v[84:85], v13 offset:4096
    ds_read_b64_tr_b16 v[86:87], v13 offset:5120
    s_cmp_gt_u32 s63, 8
    s_cbranch_scc1 L_lp_94_ok
L_lp_94:
    ds_read_b32 v5, v4
    s_waitcnt lgkmcnt(0)
    v_readfirstlane_b32 s63, v5
    s_nop 0
    s_cmp_gt_u32 s63, 8
    s_cbranch_scc0 L_lp_94
L_lp_94_ok:
    buffer_load_dwordx4 v[112:115], v10, s[8:11], s39 offen offset:0 sc1
    s_waitcnt vmcnt(19) lgkmcnt(4)
    v_mfma_f32_32x32x16_bf16 v[32:47], v[72:75], v[148:151], v[32:47]
    ds_read_b64_tr_b16 v[88:89], v12 offset:6144
    ds_read_b64_tr_b16 v[90:91], v12 offset:7168
    v_mfma_f32_32x32x16_bf16 v[48:63], v[76:79], v[148:151], v[48:63]
    s_cmp_eq_u32 s3, 1
    s_cbranch_scc0 L_cs_95
    v_mfma_f32_16x16x32_bf16 v[208:211], v[216:219], v[72:75], v[208:211]
    v_mfma_f32_16x16x32_bf16 v[212:215], v[216:219], v[76:79], v[212:215]
L_cs_95:
    ds_read_b64_tr_b16 v[92:93], v13 offset:6144
    ds_read_b64_tr_b16 v[94:95], v13 offset:7168
    buffer_load_dwordx4 v[116:119], v10, s[8:11], s39 offen offset:1024 sc1
    s_waitcnt vmcnt(19) lgkmcnt(4)
    v_mfma_f32_32x32x16_bf16 v[32:47], v[80:83], v[152:155], v[32:47]
    ds_read_b64_tr_b16 v[64:65], v12 offset:8192
    ds_read_b64_tr_b16 v[66:67], v12 offset:9216
    v_mfma_f32_32x32x16_bf16 v[48:63], v[84:87], v[152:155], v[48:63]
    s_cmp_eq_u32 s3, 2
    s_cbranch_scc0 L_cs_96
    v_mfma_f32_16x16x32_bf16 v[208:211], v[216:219], v[80:83], v[208:211]
    v_mfma_f32_16x16x32_bf16 v[212:215], v[216:219], v[84:87], v[212:215]
L_cs_96:
    ds_read_b64_tr_b16 v[68:69], v13 offset:8192
    ds_read_b64_tr_b16 v[70:71], v13 offset:9216
    buffer_load_dwordx4 v[120:123], v10, s[8:11], s39 offen offset:2048 sc1
    s_waitcnt vmcnt(19) lgkmcnt(4)
    v_mfma_f32_32x32x16_bf16 v[32:47], v[88:91], v[156:159], v[32:47]
    ds_read_b64_tr_b16 v[72:73], v12 offset:10240
    ds_read_b64_tr_b16 v[74:75], v12 offset:11264
    v_mfma_f32_32x32x16_bf16 v[48:63], v[92:95], v[156:159], v[48:63]
    s_cmp_eq_u32 s3, 3
    s_cbranch_scc0 L_cs_97
    v_mfma_f32_16x16x32_bf16 v[208:211], v[216:219], v[88:91], v[208:211]
    v_mfma_f32_16x16x32_bf16 v[212:215], v[216:219], v[92:95], v[212:215]
L_cs_97:
    ds_read_b64_tr_b16 v[76:77], v13 offset:10240
    ds_read_b64_tr_b16 v[78:79], v13 offset:11264
    buffer_load_dwordx4 v[124:127], v10, s[8:11], s39 offen offset:3072 sc1
    s_add_u32 s39, s39, 4096
    s_waitcnt vmcnt(19) lgkmcnt(4)
    v_mfma_f32_32x32x16_bf16 v[32:47], v[64:67], v[160:163], v[32:47]
    ds_read_b64_tr_b16 v[80:81], v12 offset:12288
    ds_read_b64_tr_b16 v[82:83], v12 offset:13312
    v_mfma_f32_32x32x16_bf16 v[48:63], v[68:71], v[160:163], v[48:63]
    s_cmp_eq_u32 s3, 0
    s_cbranch_scc0 L_cs_98
    v_mfma_f32_16x16x32_bf16 v[208:211], v[216:219], v[64:67], v[208:211]
    v_mfma_f32_16x16x32_bf16 v[212:215], v[216:219], v[68:71], v[212:215]
L_cs_98:
    ds_read_b64_tr_b16 v[84:85], v13 offset:12288
    ds_read_b64_tr_b16 v[86:87], v13 offset:13312
    s_cmp_gt_u32 s63, 9
    s_cbranch_scc1 L_lp_99_ok
L_lp_99:
    ds_read_b32 v5, v4
    s_waitcnt lgkmcnt(0)
    v_readfirstlane_b32 s63, v5
    s_nop 0
    s_cmp_gt_u32 s63, 9
    s_cbranch_scc0 L_lp_99
L_lp_99_ok:
    buffer_load_dwordx4 v[128:131], v10, s[8:11], s39 offen offset:0 sc1
    s_waitcnt vmcnt(19) lgkmcnt(4)
    v_mfma_f32_32x32x16_bf16 v[32:47], v[72:75], v[164:167], v[32:47]
    ds_read_b64_tr_b16 v[88:89], v12 offset:14336
    ds_read_b64_tr_b16 v[90:91], v12 offset:15360
    v_mfma_f32_32x32x16_bf16 v[48:63], v[76:79], v[164:167], v[48:63]
    s_cmp_eq_u32 s3, 1
    s_cbranch_scc0 L_cs_100
    v_mfma_f32_16x16x32_bf16 v[208:211], v[216:219], v[72:75], v[208:211]
    v_mfma_f32_16x16x32_bf16 v[212:215], v[216:219], v[76:79], v[212:215]
L_cs_100:
    ds_read_b64_tr_b16 v[92:93], v13 offset:14336
    ds_read_b64_tr_b16 v[94:95], v13 offset:15360
    buffer_load_dwordx4 v[132:135], v10, s[8:11], s39 offen offset:1024 sc1
    s_waitcnt vmcnt(19) lgkmcnt(4)
    v_mfma_f32_32x32x16_bf16 v[32:47], v[80:83], v[168:171], v[32:47]
    ds_read_b64_tr_b16 v[64:65], v12 offset:16384
    ds_read_b64_tr_b16 v[66:67], v12 offset:17408
    v_mfma_f32_32x32x16_bf16 v[48:63], v[84:87], v[168:171], v[48:63]
    s_cmp_eq_u32 s3, 2
    s_cbranch_scc0 L_cs_101
    v_mfma_f32_16x16x32_bf16 v[208:211], v[216:219], v[80:83], v[208:211]
    v_mfma_f32_16x16x32_bf16 v[212:215], v[216:219], v[84:87], v[212:215]
L_cs_101:
    ds_read_b64_tr_b16 v[68:69], v13 offset:16384
    ds_read_b64_tr_b16 v[70:71], v13 offset:17408
    buffer_load_dwordx4 v[136:139], v10, s[8:11], s39 offen offset:2048 sc1
    s_waitcnt vmcnt(19) lgkmcnt(4)
    v_mfma_f32_32x32x16_bf16 v[32:47], v[88:91], v[172:175], v[32:47]
    ds_read_b64_tr_b16 v[72:73], v12 offset:18432
    ds_read_b64_tr_b16 v[74:75], v12 offset:19456
    v_mfma_f32_32x32x16_bf16 v[48:63], v[92:95], v[172:175], v[48:63]
    s_cmp_eq_u32 s3, 3
    s_cbranch_scc0 L_cs_102
    v_mfma_f32_16x16x32_bf16 v[208:211], v[216:219], v[88:91], v[208:211]
    v_mfma_f32_16x16x32_bf16 v[212:215], v[216:219], v[92:95], v[212:215]
L_cs_102:
    ds_read_b64_tr_b16 v[76:77], v13 offset:18432
    ds_read_b64_tr_b16 v[78:79], v13 offset:19456
    buffer_load_dwordx4 v[140:143], v10, s[8:11], s39 offen offset:3072 sc1
    s_add_u32 s39, s39, 4096
    s_waitcnt vmcnt(19) lgkmcnt(4)
    v_mfma_f32_32x32x16_bf16 v[32:47], v[64:67], v[176:179], v[32:47]
    ds_read_b64_tr_b16 v[80:81], v12 offset:20480
    ds_read_b64_tr_b16 v[82:83], v12 offset:21504
    v_mfma_f32_32x32x16_bf16 v[48:63], v[68:71], v[176:179], v[48:63]
    s_cmp_eq_u32 s3, 0
    s_cbranch_scc0 L_cs_103
    v_mfma_f32_16x16x32_bf16 v[208:211], v[216:219], v[64:67], v[208:211]
    v_mfma_f32_16x16x32_bf16 v[212:215], v[216:219], v[68:71], v[212:215]
L_cs_103:
    ds_read_b64_tr_b16 v[84:85], v13 offset:20480
    ds_read_b64_tr_b16 v[86:87], v13 offset:21504
    s_cmp_gt_u32 s63, 10
    s_cbranch_scc1 L_lp_104_ok
L_lp_104:
    ds_read_b32 v5, v4
    s_waitcnt lgkmcnt(0)
    v_readfirstlane_b32 s63, v5
    s_nop 0
    s_cmp_gt_u32 s63, 10
    s_cbranch_scc0 L_lp_104
L_lp_104_ok:
    buffer_load_dwordx4 v[144:147], v10, s[8:11], s39 offen offset:0 sc1
    s_waitcnt vmcnt(19) lgkmcnt(4)
    v_mfma_f32_32x32x16_bf16 v[32:47], v[72:75], v[180:183], v[32:47]
    ds_read_b64_tr_b16 v[88:89], v12 offset:22528
    ds_read_b64_tr_b16 v[90:91], v12 offset:23552
    v_mfma_f32_32x32x16_bf16 v[48:63], v[76:79], v[180:183], v[48:63]
    s_cmp_eq_u32 s3, 1
    s_cbranch_scc0 L_cs_105
    v_mfma_f32_16x16x32_bf16 v[208:211], v[216:219], v[72:75], v[208:211]
    v_mfma_f32_16x16x32_bf16 v[212:215], v[216:219], v[76:79], v[212:215]
L_cs_105:
    ds_read_b64_tr_b16 v[92:93], v13 offset:22528
    ds_read_b64_tr_b16 v[94:95], v13 offset:23552
    buffer_load_dwordx4 v[148:151], v10, s[8:11], s39 offen offset:1024 sc1
    s_waitcnt vmcnt(19) lgkmcnt(4)
    v_mfma_f32_32x32x16_bf16 v[32:47], v[80:83], v[184:187], v[32:47]
    ds_read_b64_tr_b16 v[64:65], v12 offset:24576
    ds_read_b64_tr_b16 v[66:67], v12 offset:25600
    v_mfma_f32_32x32x16_bf16 v[48:63], v[84:87], v[184:187], v[48:63]
    s_cmp_eq_u32 s3, 2
    s_cbranch_scc0 L_cs_106
    v_mfma_f32_16x16x32_bf16 v[208:211], v[216:219], v[80:83], v[208:211]
    v_mfma_f32_16x16x32_bf16 v[212:215], v[216:219], v[84:87], v[212:215]
L_cs_106:
    ds_read_b64_tr_b16 v[68:69], v13 offset:24576
    ds_read_b64_tr_b16 v[70:71], v13 offset:25600
    buffer_load_dwordx4 v[152:155], v10, s[8:11], s39 offen offset:2048 sc1
    s_waitcnt vmcnt(19) lgkmcnt(4)
    v_mfma_f32_32x32x16_bf16 v[32:47], v[88:91], v[188:191], v[32:47]
    ds_read_b64_tr_b16 v[72:73], v12 offset:26624
    ds_read_b64_tr_b16 v[74:75], v12 offset:27648
    v_mfma_f32_32x32x16_bf16 v[48:63], v[92:95], v[188:191], v[48:63]
    s_cmp_eq_u32 s3, 3
    s_cbranch_scc0 L_cs_107
    v_mfma_f32_16x16x32_bf16 v[208:211], v[216:219], v[88:91], v[208:211]
    v_mfma_f32_16x16x32_bf16 v[212:215], v[216:219], v[92:95], v[212:215]
L_cs_107:
    ds_read_b64_tr_b16 v[76:77], v13 offset:26624
    ds_read_b64_tr_b16 v[78:79], v13 offset:27648
    buffer_load_dwordx4 v[156:159], v10, s[8:11], s39 offen offset:3072 sc1
    s_add_u32 s39, s39, 4096
    s_waitcnt vmcnt(19) lgkmcnt(4)
    v_mfma_f32_32x32x16_bf16 v[32:47], v[64:67], v[192:195], v[32:47]
    ds_read_b64_tr_b16 v[80:81], v12 offset:28672
    ds_read_b64_tr_b16 v[82:83], v12 offset:29696
    v_mfma_f32_32x32x16_bf16 v[48:63], v[68:71], v[192:195], v[48:63]
    s_cmp_eq_u32 s3, 0
    s_cbranch_scc0 L_cs_108
    v_mfma_f32_16x16x32_bf16 v[208:211], v[216:219], v[64:67], v[208:211]
    v_mfma_f32_16x16x32_bf16 v[212:215], v[216:219], v[68:71], v[212:215]
L_cs_108:
    ds_read_b64_tr_b16 v[84:85], v13 offset:28672
    ds_read_b64_tr_b16 v[86:87], v13 offset:29696
    s_cmp_gt_u32 s63, 11
    s_cbranch_scc1 L_lp_109_ok
L_lp_109:
    ds_read_b32 v5, v4
    s_waitcnt lgkmcnt(0)
    v_readfirstlane_b32 s63, v5
    s_nop 0
    s_cmp_gt_u32 s63, 11
    s_cbranch_scc0 L_lp_109
L_lp_109_ok:
    buffer_load_dwordx4 v[160:163], v10, s[8:11], s39 offen offset:0 sc1
    s_waitcnt vmcnt(19) lgkmcnt(4)
    v_mfma_f32_32x32x16_bf16 v[32:47], v[72:75], v[196:199], v[32:47]
    ds_read_b64_tr_b16 v[88:89], v12 offset:30720
    ds_read_b64_tr_b16 v[90:91], v12 offset:31744
    v_mfma_f32_32x32x16_bf16 v[48:63], v[76:79], v[196:199], v[48:63]
    s_cmp_eq_u32 s3, 1
    s_cbranch_scc0 L_cs_110
    v_mfma_f32_16x16x32_bf16 v[208:211], v[216:219], v[72:75], v[208:211]
    v_mfma_f32_16x16x32_bf16 v[212:215], v[216:219], v[76:79], v[212:215]
L_cs_110:
    ds_read_b64_tr_b16 v[92:93], v13 offset:30720
    ds_read_b64_tr_b16 v[94:95], v13 offset:31744
    buffer_load_dwordx4 v[164:167], v10, s[8:11], s39 offen offset:1024 sc1
    s_waitcnt vmcnt(19) lgkmcnt(4)
    v_mfma_f32_32x32x16_bf16 v[32:47], v[80:83], v[200:203], v[32:47]
    ds_read_b64_tr_b16 v[64:65], v12 offset:32768
    ds_read_b64_tr_b16 v[66:67], v12 offset:33792
    v_mfma_f32_32x32x16_bf16 v[48:63], v[84:87], v[200:203], v[48:63]
    s_cmp_eq_u32 s3, 2
    s_cbranch_scc0 L_cs_111
    v_mfma_f32_16x16x32_bf16 v[208:211], v[216:219], v[80:83], v[208:211]
    v_mfma_f32_16x16x32_bf16 v[212:215], v[216:219], v[84:87], v[212:215]
L_cs_111:
    ds_read_b64_tr_b16 v[68:69], v13 offset:32768
    ds_read_b64_tr_b16 v[70:71], v13 offset:33792
    buffer_load_dwordx4 v[168:171], v10, s[8:11], s39 offen offset:2048 sc1
    s_waitcnt vmcnt(19) lgkmcnt(4)
    v_mfma_f32_32x32x16_bf16 v[32:47], v[88:91], v[204:207], v[32:47]
    ds_read_b64_tr_b16 v[72:73], v12 offset:34816
    ds_read_b64_tr_b16 v[74:75], v12 offset:35840
    v_mfma_f32_32x32x16_bf16 v[48:63], v[92:95], v[204:207], v[48:63]
    s_cmp_eq_u32 s3, 3
    s_cbranch_scc0 L_cs_112
    v_mfma_f32_16x16x32_bf16 v[208:211], v[216:219], v[88:91], v[208:211]
    v_mfma_f32_16x16x32_bf16 v[212:215], v[216:219], v[92:95], v[212:215]
L_cs_112:
    ds_read_b64_tr_b16 v[76:77], v13 offset:34816
    ds_read_b64_tr_b16 v[78:79], v13 offset:35840
    buffer_load_dwordx4 v[172:175], v10, s[8:11], s39 offen offset:3072 sc1
    s_add_u32 s39, s39, 4096
    s_waitcnt vmcnt(19) lgkmcnt(4)
    v_mfma_f32_32x32x16_bf16 v[32:47], v[64:67], v[96:99], v[32:47]
    ds_read_b64_tr_b16 v[80:81], v12 offset:36864
    ds_read_b64_tr_b16 v[82:83], v12 offset:37888
    v_mfma_f32_32x32x16_bf16 v[48:63], v[68:71], v[96:99], v[48:63]
    s_cmp_eq_u32 s3, 0
    s_cbranch_scc0 L_cs_113
    v_mfma_f32_16x16x32_bf16 v[208:211], v[216:219], v[64:67], v[208:211]
    v_mfma_f32_16x16x32_bf16 v[212:215], v[216:219], v[68:71], v[212:215]
L_cs_113:
    ds_read_b64_tr_b16 v[84:85], v13 offset:36864
    ds_read_b64_tr_b16 v[86:87], v13 offset:37888
    s_cmp_gt_u32 s63, 12
    s_cbranch_scc1 L_lp_114_ok
L_lp_114:
    ds_read_b32 v5, v4
    s_waitcnt lgkmcnt(0)
    v_readfirstlane_b32 s63, v5
    s_nop 0
    s_cmp_gt_u32 s63, 12
    s_cbranch_scc0 L_lp_114
L_lp_114_ok:
    buffer_load_dwordx4 v[176:179], v10, s[8:11], s39 offen offset:0 sc1
    s_waitcnt vmcnt(19) lgkmcnt(4)
    v_mfma_f32_32x32x16_bf16 v[32:47], v[72:75], v[100:103], v[32:47]
    ds_read_b64_tr_b16 v[88:89], v12 offset:38912
    ds_read_b64_tr_b16 v[90:91], v12 offset:39936
    v_mfma_f32_32x32x16_bf16 v[48:63], v[76:79], v[100:103], v[48:63]
    s_cmp_eq_u32 s3, 1
    s_cbranch_scc0 L_cs_115
    v_mfma_f32_16x16x32_bf16 v[208:211], v[216:219], v[72:75], v[208:211]
    v_mfma_f32_16x16x32_bf16 v[212:215], v[216:219], v[76:79], v[212:215]
L_cs_115:
    ds_read_b64_tr_b16 v[92:93], v13 offset:38912
    ds_read_b64_tr_b16 v[94:95], v13 offset:39936
    buffer_load_dwordx4 v[180:183], v10, s[8:11], s39 offen offset:1024 sc1
    s_waitcnt vmcnt(19) lgkmcnt(4)
    v_mfma_f32_32x32x16_bf16 v[32:47], v[80:83], v[104:107], v[32:47]
    ds_read_b64_tr_b16 v[64:65], v12 offset:40960
    ds_read_b64_tr_b16 v[66:67], v12 offset:41984
    v_mfma_f32_32x32x16_bf16 v[48:63], v[84:87], v[104:107], v[48:63]
    s_cmp_eq_u32 s3, 2
    s_cbranch_scc0 L_cs_116
    v_mfma_f32_16x16x32_bf16 v[208:211], v[216:219], v[80:83], v[208:211]
    v_mfma_f32_16x16x32_bf16 v[212:215], v[216:219], v[84:87], v[212:215]
L_cs_116:
    ds_read_b64_tr_b16 v[68:69], v13 offset:40960
    ds_read_b64_tr_b16 v[70:71], v13 offset:41984
    buffer_load_dwordx4 v[184:187], v10, s[8:11], s39 offen offset:2048 sc1
    s_waitcnt vmcnt(19) lgkmcnt(4)
    v_mfma_f32_32x32x16_bf16 v[32:47], v[88:91], v[108:111], v[32:47]
    ds_read_b64_tr_b16 v[72:73], v12 offset:43008
    ds_read_b64_tr_b16 v[74:75], v12 offset:44032
    v_mfma_f32_32x32x16_bf16 v[48:63], v[92:95], v[108:111], v[48:63]
    s_cmp_eq_u32 s3, 3
    s_cbranch_scc0 L_cs_117
    v_mfma_f32_16x16x32_bf16 v[208:211], v[216:219], v[88:91], v[208:211]
    v_mfma_f32_16x16x32_bf16 v[212:215], v[216:219], v[92:95], v[212:215]
L_cs_117:
    ds_read_b64_tr_b16 v[76:77], v13 offset:43008
    ds_read_b64_tr_b16 v[78:79], v13 offset:44032
    buffer_load_dwordx4 v[188:191], v10, s[8:11], s39 offen offset:3072 sc1
    s_add_u32 s39, s39, 4096
    s_waitcnt vmcnt(19) lgkmcnt(4)
    v_mfma_f32_32x32x16_bf16 v[32:47], v[64:67], v[112:115], v[32:47]
    ds_read_b64_tr_b16 v[80:81], v12 offset:45056
    ds_read_b64_tr_b16 v[82:83], v12 offset:46080
    v_mfma_f32_32x32x16_bf16 v[48:63], v[68:71], v[112:115], v[48:63]
    s_cmp_eq_u32 s3, 0
    s_cbranch_scc0 L_cs_118
    v_mfma_f32_16x16x32_bf16 v[208:211], v[216:219], v[64:67], v[208:211]
    v_mfma_f32_16x16x32_bf16 v[212:215], v[216:219], v[68:71], v[212:215]
L_cs_118:
    ds_read_b64_tr_b16 v[84:85], v13 offset:45056
    ds_read_b64_tr_b16 v[86:87], v13 offset:46080
    s_cmp_gt_u32 s63, 13
    s_cbranch_scc1 L_lp_119_ok
L_lp_119:
    ds_read_b32 v5, v4
    s_waitcnt lgkmcnt(0)
    v_readfirstlane_b32 s63, v5
    s_nop 0
    s_cmp_gt_u32 s63, 13
    s_cbranch_scc0 L_lp_119
L_lp_119_ok:
    buffer_load_dwordx4 v[192:195], v10, s[8:11], s39 offen offset:0 sc1
    s_waitcnt vmcnt(19) lgkmcnt(4)
    v_mfma_f32_32x32x16_bf16 v[32:47], v[72:75], v[116:119], v[32:47]
    ds_read_b64_tr_b16 v[88:89], v12 offset:47104
    ds_read_b64_tr_b16 v[90:91], v12 offset:48128
    v_mfma_f32_32x32x16_bf16 v[48:63], v[76:79], v[116:119], v[48:63]
    s_cmp_eq_u32 s3, 1
    s_cbranch_scc0 L_cs_120
    v_mfma_f32_16x16x32_bf16 v[208:211], v[216:219], v[72:75], v[208:211]
    v_mfma_f32_16x16x32_bf16 v[212:215], v[216:219], v[76:79], v[212:215]
L_cs_120:
    ds_read_b64_tr_b16 v[92:93], v13 offset:47104
    ds_read_b64_tr_b16 v[94:95], v13 offset:48128
    buffer_load_dwordx4 v[196:199], v10, s[8:11], s39 offen offset:1024 sc1
    s_waitcnt vmcnt(19) lgkmcnt(4)
    v_mfma_f32_32x32x16_bf16 v[32:47], v[80:83], v[120:123], v[32:47]
    ds_read_b64_tr_b16 v[64:65], v12 offset:49152
    ds_read_b64_tr_b16 v[66:67], v12 offset:50176
    v_mfma_f32_32x32x16_bf16 v[48:63], v[84:87], v[120:123], v[48:63]
    s_cmp_eq_u32 s3, 2
    s_cbranch_scc0 L_cs_121
    v_mfma_f32_16x16x32_bf16 v[208:211], v[216:219], v[80:83], v[208:211]
    v_mfma_f32_16x16x32_bf16 v[212:215], v[216:219], v[84:87], v[212:215]
L_cs_121:
    ds_read_b64_tr_b16 v[68:69], v13 offset:49152
    ds_read_b64_tr_b16 v[70:71], v13 offset:50176
    buffer_load_dwordx4 v[200:203], v10, s[8:11], s39 offen offset:2048 sc1
    s_waitcnt vmcnt(19) lgkmcnt(4)
    v_mfma_f32_32x32x16_bf16 v[32:47], v[88:91], v[124:127], v[32:47]
    ds_read_b64_tr_b16 v[72:73], v12 offset:51200
    ds_read_b64_tr_b16 v[74:75], v12 offset:52224
    v_mfma_f32_32x32x16_bf16 v[48:63], v[92:95], v[124:127], v[48:63]
    s_cmp_eq_u32 s3, 3
    s_cbranch_scc0 L_cs_122
    v_mfma_f32_16x16x32_bf16 v[208:211], v[216:219], v[88:91], v[208:211]
    v_mfma_f32_16x16x32_bf16 v[212:215], v[216:219], v[92:95], v[212:215]
L_cs_122:
    ds_read_b64_tr_b16 v[76:77], v13 offset:51200
    ds_read_b64_tr_b16 v[78:79], v13 offset:52224
    buffer_load_dwordx4 v[204:207], v10, s[8:11], s39 offen offset:3072 sc1
    s_add_u32 s39, s39, 4096
    s_waitcnt vmcnt(19) lgkmcnt(4)
    v_mfma_f32_32x32x16_bf16 v[32:47], v[64:67], v[128:131], v[32:47]
    ds_read_b64_tr_b16 v[80:81], v12 offset:53248
    ds_read_b64_tr_b16 v[82:83], v12 offset:54272
    v_mfma_f32_32x32x16_bf16 v[48:63], v[68:71], v[128:131], v[48:63]
    s_cmp_eq_u32 s3, 0
    s_cbranch_scc0 L_cs_123
    v_mfma_f32_16x16x32_bf16 v[208:211], v[216:219], v[64:67], v[208:211]
    v_mfma_f32_16x16x32_bf16 v[212:215], v[216:219], v[68:71], v[212:215]
L_cs_123:
    ds_read_b64_tr_b16 v[84:85], v13 offset:53248
    ds_read_b64_tr_b16 v[86:87], v13 offset:54272
    s_cmp_gt_u32 s63, 14
    s_cbranch_scc1 L_lp_124_ok
L_lp_124:
    ds_read_b32 v5, v4
    s_waitcnt lgkmcnt(0)
    v_readfirstlane_b32 s63, v5
    s_nop 0
    s_cmp_gt_u32 s63, 14
    s_cbranch_scc0 L_lp_124
L_lp_124_ok:
    buffer_load_dwordx4 v[96:99], v10, s[8:11], s39 offen offset:0 sc1
    s_waitcnt vmcnt(19) lgkmcnt(4)
    v_mfma_f32_32x32x16_bf16 v[32:47], v[72:75], v[132:135], v[32:47]
    ds_read_b64_tr_b16 v[88:89], v12 offset:55296
    ds_read_b64_tr_b16 v[90:91], v12 offset:56320
    v_mfma_f32_32x32x16_bf16 v[48:63], v[76:79], v[132:135], v[48:63]
    s_cmp_eq_u32 s3, 1
    s_cbranch_scc0 L_cs_125
    v_mfma_f32_16x16x32_bf16 v[208:211], v[216:219], v[72:75], v[208:211]
    v_mfma_f32_16x16x32_bf16 v[212:215], v[216:219], v[76:79], v[212:215]
L_cs_125:
    ds_read_b64_tr_b16 v[92:93], v13 offset:55296
    ds_read_b64_tr_b16 v[94:95], v13 offset:56320
    buffer_load_dwordx4 v[100:103], v10, s[8:11], s39 offen offset:1024 sc1
    s_waitcnt vmcnt(19) lgkmcnt(4)
    v_mfma_f32_32x32x16_bf16 v[32:47], v[80:83], v[136:139], v[32:47]
    ds_read_b64_tr_b16 v[64:65], v16 offset:16384
    ds_read_b64_tr_b16 v[66:67], v16 offset:17408
    v_mfma_f32_32x32x16_bf16 v[48:63], v[84:87], v[136:139], v[48:63]
    s_cmp_eq_u32 s3, 2
    s_cbranch_scc0 L_cs_126
    v_mfma_f32_16x16x32_bf16 v[208:211], v[216:219], v[80:83], v[208:211]
    v_mfma_f32_16x16x32_bf16 v[212:215], v[216:219], v[84:87], v[212:215]
L_cs_126:
    ds_read_b64_tr_b16 v[68:69], v17 offset:16384
    ds_read_b64_tr_b16 v[70:71], v17 offset:17408
    buffer_load_dwordx4 v[104:107], v10, s[8:11], s39 offen offset:2048 sc1
    s_waitcnt vmcnt(19) lgkmcnt(4)
    v_mfma_f32_32x32x16_bf16 v[32:47], v[88:91], v[140:143], v[32:47]
    ds_read_b64_tr_b16 v[72:73], v16 offset:18432
    ds_read_b64_tr_b16 v[74:75], v16 offset:19456
    v_mfma_f32_32x32x16_bf16 v[48:63], v[92:95], v[140:143], v[48:63]
    s_cmp_eq_u32 s3, 3
    s_cbranch_scc0 L_cs_127
    v_mfma_f32_16x16x32_bf16 v[208:211], v[216:219], v[88:91], v[208:211]
    v_mfma_f32_16x16x32_bf16 v[212:215], v[216:219], v[92:95], v[212:215]
L_cs_127:
    ds_read_b64_tr_b16 v[76:77], v17 offset:18432
    ds_read_b64_tr_b16 v[78:79], v17 offset:19456
    buffer_load_dwordx4 v[108:111], v10, s[8:11], s39 offen offset:3072 sc1
    s_add_u32 s39, s39, 4096
    s_waitcnt vmcnt(19) lgkmcnt(4)
    v_mfma_f32_32x32x16_bf16 v[32:47], v[64:67], v[144:147], v[32:47]
    ds_read_b64_tr_b16 v[80:81], v16 offset:20480
    ds_read_b64_tr_b16 v[82:83], v16 offset:21504
    v_mfma_f32_32x32x16_bf16 v[48:63], v[68:71], v[144:147], v[48:63]
    s_cmp_eq_u32 s3, 0
    s_cbranch_scc0 L_cs_128
    v_mfma_f32_16x16x32_bf16 v[208:211], v[216:219], v[64:67], v[208:211]
    v_mfma_f32_16x16x32_bf16 v[212:215], v[216:219], v[68:71], v[212:215]
L_cs_128:
    ds_read_b64_tr_b16 v[84:85], v17 offset:20480
    ds_read_b64_tr_b16 v[86:87], v17 offset:21504
    s_cmp_gt_u32 s63, 15
    s_cbranch_scc1 L_lp_129_ok
L_lp_129:
    ds_read_b32 v5, v4
    s_waitcnt lgkmcnt(0)
    v_readfirstlane_b32 s63, v5
    s_nop 0
    s_cmp_gt_u32 s63, 15
    s_cbranch_scc0 L_lp_129
L_lp_129_ok:
    buffer_load_dwordx4 v[112:115], v10, s[8:11], s39 offen offset:0 sc1
    s_waitcnt vmcnt(19) lgkmcnt(4)
    v_mfma_f32_32x32x16_bf16 v[32:47], v[72:75], v[148:151], v[32:47]
    ds_read_b64_tr_b16 v[88:89], v16 offset:22528
    ds_read_b64_tr_b16 v[90:91], v16 offset:23552
    v_mfma_f32_32x32x16_bf16 v[48:63], v[76:79], v[148:151], v[48:63]
    s_cmp_eq_u32 s3, 1
    s_cbranch_scc0 L_cs_130
    v_mfma_f32_16x16x32_bf16 v[208:211], v[216:219], v[72:75], v[208:211]
    v_mfma_f32_16x16x32_bf16 v[212:215], v[216:219], v[76:79], v[212:215]
L_cs_130:
    ds_read_b64_tr_b16 v[92:93], v17 offset:22528
    ds_read_b64_tr_b16 v[94:95], v17 offset:23552
    buffer_load_dwordx4 v[116:119], v10, s[8:11], s39 offen offset:1024 sc1
    s_waitcnt vmcnt(19) lgkmcnt(4)
    v_mfma_f32_32x32x16_bf16 v[32:47], v[80:83], v[152:155], v[32:47]
    s_barrier
    ds_read_b64_tr_b16 v[64:65], v14 offset:24576
    ds_read_b64_tr_b16 v[66:67], v14 offset:25600
    v_mfma_f32_32x32x16_bf16 v[48:63], v[84:87], v[152:155], v[48:63]
    s_cmp_eq_u32 s3, 2
    s_cbranch_scc0 L_cs_131
    v_mfma_f32_16x16x32_bf16 v[208:211], v[216:219], v[80:83], v[208:211]
    v_mfma_f32_16x16x32_bf16 v[212:215], v[216:219], v[84:87], v[212:215]
L_cs_131:
    ds_read_b64_tr_b16 v[68:69], v15 offset:24576
    ds_read_b64_tr_b16 v[70:71], v15 offset:25600
    buffer_load_dwordx4 v[120:123], v10, s[8:11], s39 offen offset:2048 sc1
    s_waitcnt vmcnt(19) lgkmcnt(4)
    v_mfma_f32_32x32x16_bf16 v[32:47], v[88:91], v[156:159], v[32:47]
    ds_read_b64_tr_b16 v[72:73], v14 offset:26624
    ds_read_b64_tr_b16 v[74:75], v14 offset:27648
    v_mfma_f32_32x32x16_bf16 v[48:63], v[92:95], v[156:159], v[48:63]
    s_cmp_eq_u32 s3, 3
    s_cbranch_scc0 L_cs_132
    v_mfma_f32_16x16x32_bf16 v[208:211], v[216:219], v[88:91], v[208:211]
    v_mfma_f32_16x16x32_bf16 v[212:215], v[216:219], v[92:95], v[212:215]
L_cs_132:
    ds_read_b64_tr_b16 v[76:77], v15 offset:26624
    ds_read_b64_tr_b16 v[78:79], v15 offset:27648
    buffer_load_dwordx4 v[124:127], v10, s[8:11], s39 offen offset:3072 sc1
    s_waitcnt vmcnt(19) lgkmcnt(4)
    v_mfma_f32_32x32x16_bf16 v[32:47], v[64:67], v[160:163], v[32:47]
    ds_read_b64_tr_b16 v[80:81], v14 offset:28672
    ds_read_b64_tr_b16 v[82:83], v14 offset:29696
    v_mfma_f32_32x32x16_bf16 v[48:63], v[68:71], v[160:163], v[48:63]
    s_cmp_eq_u32 s3, 0
    s_cbranch_scc0 L_cs_133
    v_mfma_f32_16x16x32_bf16 v[208:211], v[216:219], v[64:67], v[208:211]
    v_mfma_f32_16x16x32_bf16 v[212:215], v[216:219], v[68:71], v[212:215]
L_cs_133:
    ds_read_b64_tr_b16 v[84:85], v15 offset:28672
    ds_read_b64_tr_b16 v[86:87], v15 offset:29696
    s_waitcnt vmcnt(18) lgkmcnt(4)
    v_mfma_f32_32x32x16_bf16 v[32:47], v[72:75], v[164:167], v[32:47]
    ds_read_b64_tr_b16 v[88:89], v14 offset:30720
    ds_read_b64_tr_b16 v[90:91], v14 offset:31744
    v_mfma_f32_32x32x16_bf16 v[48:63], v[76:79], v[164:167], v[48:63]
    s_cmp_eq_u32 s3, 1
    s_cbranch_scc0 L_cs_134
    v_mfma_f32_16x16x32_bf16 v[208:211], v[216:219], v[72:75], v[208:211]
    v_mfma_f32_16x16x32_bf16 v[212:215], v[216:219], v[76:79], v[212:215]
L_cs_134:
    ds_read_b64_tr_b16 v[92:93], v15 offset:30720
    ds_read_b64_tr_b16 v[94:95], v15 offset:31744
    v_lshlrev_b32 v9, 2, v1
    s_lshl_b32 s54, s4, 14
    s_lshl_b32 s55, s3, 8
    s_add_u32 s54, s54, s55
    s_add_u32 s54, s54, 0x2640000
    buffer_load_dword v224, v9, s[16:19], s54 offen offset:0 sc1
    buffer_load_dword v225, v9, s[16:19], s54 offen offset:1024 sc1
    buffer_load_dword v226, v9, s[16:19], s54 offen offset:2048 sc1
    buffer_load_dword v227, v9, s[16:19], s54 offen offset:3072 sc1
    s_add_u32 s54, s54, 4096
    buffer_load_dword v228, v9, s[16:19], s54 offen offset:0 sc1
    buffer_load_dword v229, v9, s[16:19], s54 offen offset:1024 sc1
    buffer_load_dword v230, v9, s[16:19], s54 offen offset:2048 sc1
    buffer_load_dword v231, v9, s[16:19], s54 offen offset:3072 sc1
    s_add_u32 s54, s54, 4096
    buffer_load_dword v232, v9, s[16:19], s54 offen offset:0 sc1
    buffer_load_dword v233, v9, s[16:19], s54 offen offset:1024 sc1
    buffer_load_dword v234, v9, s[16:19], s54 offen offset:2048 sc1
    buffer_load_dword v235, v9, s[16:19], s54 offen offset:3072 sc1
    s_add_u32 s54, s54, 4096
    buffer_load_dword v236, v9, s[16:19], s54 offen offset:0 sc1
    buffer_load_dword v237, v9, s[16:19], s54 offen offset:1024 sc1
    buffer_load_dword v238, v9, s[16:19], s54 offen offset:2048 sc1
    buffer_load_dword v239, v9, s[16:19], s54 offen offset:3072 sc1
    s_waitcnt vmcnt(33) lgkmcnt(4)
    v_mfma_f32_32x32x16_bf16 v[32:47], v[80:83], v[168:171], v[32:47]
    ds_read_b64_tr_b16 v[64:65], v14 offset:40960
    ds_read_b64_tr_b16 v[66:67], v14 offset:41984
    v_mfma_f32_32x32x16_bf16 v[48:63], v[84:87], v[168:171], v[48:63]
    s_cmp_eq_u32 s3, 2
    s_cbranch_scc0 L_cs_135
    v_mfma_f32_16x16x32_bf16 v[208:211], v[216:219], v[80:83], v[208:211]
    v_mfma_f32_16x16x32_bf16 v[212:215], v[216:219], v[84:87], v[212:215]
L_cs_135:
    ds_read_b64_tr_b16 v[68:69], v15 offset:40960
    ds_read_b64_tr_b16 v[70:71], v15 offset:41984
    s_waitcnt vmcnt(32) lgkmcnt(4)
    v_mfma_f32_32x32x16_bf16 v[32:47], v[88:91], v[172:175], v[32:47]
    ds_read_b64_tr_b16 v[72:73], v14 offset:43008
    ds_read_b64_tr_b16 v[74:75], v14 offset:44032
    v_mfma_f32_32x32x16_bf16 v[48:63], v[92:95], v[172:175], v[48:63]
    s_cmp_eq_u32 s3, 3
    s_cbranch_scc0 L_cs_136
    v_mfma_f32_16x16x32_bf16 v[208:211], v[216:219], v[88:91], v[208:211]
    v_mfma_f32_16x16x32_bf16 v[212:215], v[216:219], v[92:95], v[212:215]
L_cs_136:
    ds_read_b64_tr_b16 v[76:77], v15 offset:43008
    ds_read_b64_tr_b16 v[78:79], v15 offset:44032
    s_waitcnt vmcnt(31) lgkmcnt(4)
    v_mfma_f32_32x32x16_bf16 v[32:47], v[64:67], v[176:179], v[32:47]
    ds_read_b64_tr_b16 v[80:81], v14 offset:45056
    ds_read_b64_tr_b16 v[82:83], v14 offset:46080
    v_mfma_f32_32x32x16_bf16 v[48:63], v[68:71], v[176:179], v[48:63]
    s_cmp_eq_u32 s3, 0
    s_cbranch_scc0 L_cs_137
    v_mfma_f32_16x16x32_bf16 v[208:211], v[216:219], v[64:67], v[208:211]
    v_mfma_f32_16x16x32_bf16 v[212:215], v[216:219], v[68:71], v[212:215]
L_cs_137:
    ds_read_b64_tr_b16 v[84:85], v15 offset:45056
    ds_read_b64_tr_b16 v[86:87], v15 offset:46080
    s_waitcnt vmcnt(30) lgkmcnt(4)
    v_mfma_f32_32x32x16_bf16 v[32:47], v[72:75], v[180:183], v[32:47]
    ds_read_b64_tr_b16 v[88:89], v14 offset:47104
    ds_read_b64_tr_b16 v[90:91], v14 offset:48128
    v_mfma_f32_32x32x16_bf16 v[48:63], v[76:79], v[180:183], v[48:63]
    s_cmp_eq_u32 s3, 1
    s_cbranch_scc0 L_cs_138
    v_mfma_f32_16x16x32_bf16 v[208:211], v[216:219], v[72:75], v[208:211]
    v_mfma_f32_16x16x32_bf16 v[212:215], v[216:219], v[76:79], v[212:215]
L_cs_138:
    ds_read_b64_tr_b16 v[92:93], v15 offset:47104
    ds_read_b64_tr_b16 v[94:95], v15 offset:48128
    s_waitcnt vmcnt(29) lgkmcnt(4)
    v_mfma_f32_32x32x16_bf16 v[32:47], v[80:83], v[184:187], v[32:47]
    ds_read_b64_tr_b16 v[64:65], v14 offset:57344
    ds_read_b64_tr_b16 v[66:67], v14 offset:58368
    v_mfma_f32_32x32x16_bf16 v[48:63], v[84:87], v[184:187], v[48:63]
    s_cmp_eq_u32 s3, 2
    s_cbranch_scc0 L_cs_139
    v_mfma_f32_16x16x32_bf16 v[208:211], v[216:219], v[80:83], v[208:211]
    v_mfma_f32_16x16x32_bf16 v[212:215], v[216:219], v[84:87], v[212:215]
L_cs_139:
    ds_read_b64_tr_b16 v[68:69], v15 offset:57344
    ds_read_b64_tr_b16 v[70:71], v15 offset:58368
    s_waitcnt vmcnt(28) lgkmcnt(4)
    v_mfma_f32_32x32x16_bf16 v[32:47], v[88:91], v[188:191], v[32:47]
    ds_read_b64_tr_b16 v[72:73], v14 offset:59392
    ds_read_b64_tr_b16 v[74:75], v14 offset:60416
    v_mfma_f32_32x32x16_bf16 v[48:63], v[92:95], v[188:191], v[48:63]
    s_cmp_eq_u32 s3, 3
    s_cbranch_scc0 L_cs_140
    v_mfma_f32_16x16x32_bf16 v[208:211], v[216:219], v[88:91], v[208:211]
    v_mfma_f32_16x16x32_bf16 v[212:215], v[216:219], v[92:95], v[212:215]
L_cs_140:
    ds_read_b64_tr_b16 v[76:77], v15 offset:59392
    ds_read_b64_tr_b16 v[78:79], v15 offset:60416
    s_waitcnt vmcnt(27) lgkmcnt(4)
    v_mfma_f32_32x32x16_bf16 v[32:47], v[64:67], v[192:195], v[32:47]
    ds_read_b64_tr_b16 v[80:81], v14 offset:61440
    ds_read_b64_tr_b16 v[82:83], v14 offset:62464
    v_mfma_f32_32x32x16_bf16 v[48:63], v[68:71], v[192:195], v[48:63]
    s_cmp_eq_u32 s3, 0
    s_cbranch_scc0 L_cs_141
    v_mfma_f32_16x16x32_bf16 v[208:211], v[216:219], v[64:67], v[208:211]
    v_mfma_f32_16x16x32_bf16 v[212:215], v[216:219], v[68:71], v[212:215]
L_cs_141:
    ds_read_b64_tr_b16 v[84:85], v15 offset:61440
    ds_read_b64_tr_b16 v[86:87], v15 offset:62464
    s_waitcnt vmcnt(26) lgkmcnt(4)
    v_mfma_f32_32x32x16_bf16 v[32:47], v[72:75], v[196:199], v[32:47]
    ds_read_b64_tr_b16 v[88:89], v14 offset:63488
    ds_read_b64_tr_b16 v[90:91], v14 offset:64512
    v_mfma_f32_32x32x16_bf16 v[48:63], v[76:79], v[196:199], v[48:63]
    s_cmp_eq_u32 s3, 1
    s_cbranch_scc0 L_cs_142
    v_mfma_f32_16x16x32_bf16 v[208:211], v[216:219], v[72:75], v[208:211]
    v_mfma_f32_16x16x32_bf16 v[212:215], v[216:219], v[76:79], v[212:215]
L_cs_142:
    ds_read_b64_tr_b16 v[92:93], v15 offset:63488
    ds_read_b64_tr_b16 v[94:95], v15 offset:64512
    s_waitcnt vmcnt(25) lgkmcnt(4)
    v_mfma_f32_32x32x16_bf16 v[32:47], v[80:83], v[200:203], v[32:47]
    ds_read_b64_tr_b16 v[64:65], v16 offset:8192
    ds_read_b64_tr_b16 v[66:67], v16 offset:9216
    v_mfma_f32_32x32x16_bf16 v[48:63], v[84:87], v[200:203], v[48:63]
    s_cmp_eq_u32 s3, 2
    s_cbranch_scc0 L_cs_143
    v_mfma_f32_16x16x32_bf16 v[208:211], v[216:219], v[80:83], v[208:211]
    v_mfma_f32_16x16x32_bf16 v[212:215], v[216:219], v[84:87], v[212:215]
L_cs_143:
    ds_read_b64_tr_b16 v[68:69], v17 offset:8192
    ds_read_b64_tr_b16 v[70:71], v17 offset:9216
    s_waitcnt vmcnt(24) lgkmcnt(4)
    v_mfma_f32_32x32x16_bf16 v[32:47], v[88:91], v[204:207], v[32:47]
    ds_read_b64_tr_b16 v[72:73], v16 offset:10240
    ds_read_b64_tr_b16 v[74:75], v16 offset:11264
    v_mfma_f32_32x32x16_bf16 v[48:63], v[92:95], v[204:207], v[48:63]
    s_cmp_eq_u32 s3, 3
    s_cbranch_scc0 L_cs_144
    v_mfma_f32_16x16x32_bf16 v[208:211], v[216:219], v[88:91], v[208:211]
    v_mfma_f32_16x16x32_bf16 v[212:215], v[216:219], v[92:95], v[212:215]
L_cs_144:
    ds_read_b64_tr_b16 v[76:77], v17 offset:10240
    ds_read_b64_tr_b16 v[78:79], v17 offset:11264
    s_waitcnt vmcnt(23) lgkmcnt(4)
    v_mfma_f32_32x32x16_bf16 v[32:47], v[64:67], v[96:99], v[32:47]
    ds_read_b64_tr_b16 v[80:81], v16 offset:12288
    ds_read_b64_tr_b16 v[82:83], v16 offset:13312
    v_mfma_f32_32x32x16_bf16 v[48:63], v[68:71], v[96:99], v[48:63]
    s_cmp_eq_u32 s3, 0
    s_cbranch_scc0 L_cs_145
    v_mfma_f32_16x16x32_bf16 v[208:211], v[216:219], v[64:67], v[208:211]
    v_mfma_f32_16x16x32_bf16 v[212:215], v[216:219], v[68:71], v[212:215]
L_cs_145:
    ds_read_b64_tr_b16 v[84:85], v17 offset:12288
    ds_read_b64_tr_b16 v[86:87], v17 offset:13312
    s_waitcnt vmcnt(22) lgkmcnt(4)
    v_mfma_f32_32x32x16_bf16 v[32:47], v[72:75], v[100:103], v[32:47]
    ds_read_b64_tr_b16 v[88:89], v16 offset:14336
    ds_read_b64_tr_b16 v[90:91], v16 offset:15360
    v_mfma_f32_32x32x16_bf16 v[48:63], v[76:79], v[100:103], v[48:63]
    s_cmp_eq_u32 s3, 1
    s_cbranch_scc0 L_cs_146
    v_mfma_f32_16x16x32_bf16 v[208:211], v[216:219], v[72:75], v[208:211]
    v_mfma_f32_16x16x32_bf16 v[212:215], v[216:219], v[76:79], v[212:215]
L_cs_146:
    ds_read_b64_tr_b16 v[92:93], v17 offset:14336
    ds_read_b64_tr_b16 v[94:95], v17 offset:15360
    s_waitcnt vmcnt(21) lgkmcnt(4)
    v_mfma_f32_32x32x16_bf16 v[32:47], v[80:83], v[104:107], v[32:47]
    s_barrier
    ds_read_b64_tr_b16 v[64:65], v14 offset:16384
    ds_read_b64_tr_b16 v[66:67], v14 offset:17408
    s_waitcnt vmcnt(0)
    v_pk_add_f32 v[224:225], v[224:225], v[232:233]
    v_mfma_f32_32x32x16_bf16 v[48:63], v[84:87], v[104:107], v[48:63]
    s_cmp_eq_u32 s3, 2
    s_cbranch_scc0 L_cs_147
    v_mfma_f32_16x16x32_bf16 v[208:211], v[216:219], v[80:83], v[208:211]
    v_mfma_f32_16x16x32_bf16 v[212:215], v[216:219], v[84:87], v[212:215]
L_cs_147:
    ds_read_b64_tr_b16 v[68:69], v15 offset:16384
    ds_read_b64_tr_b16 v[70:71], v15 offset:17408
    v_pk_add_f32 v[226:227], v[226:227], v[234:235]
    v_pk_add_f32 v[228:229], v[228:229], v[236:237]
    s_waitcnt vmcnt(20) lgkmcnt(4)
    v_mfma_f32_32x32x16_bf16 v[32:47], v[88:91], v[108:111], v[32:47]
    ds_read_b64_tr_b16 v[72:73], v14 offset:18432
    ds_read_b64_tr_b16 v[74:75], v14 offset:19456
    v_pk_add_f32 v[230:231], v[230:231], v[238:239]
    v_pk_add_f32 v[224:225], v[224:225], v[228:229]
    v_mfma_f32_32x32x16_bf16 v[48:63], v[92:95], v[108:111], v[48:63]
    s_cmp_eq_u32 s3, 3
    s_cbranch_scc0 L_cs_148
    v_mfma_f32_16x16x32_bf16 v[208:211], v[216:219], v[88:91], v[208:211]
    v_mfma_f32_16x16x32_bf16 v[212:215], v[216:219], v[92:95], v[212:215]
L_cs_148:
    ds_read_b64_tr_b16 v[76:77], v15 offset:18432
    ds_read_b64_tr_b16 v[78:79], v15 offset:19456
    v_pk_add_f32 v[226:227], v[226:227], v[230:231]
    v_pk_add_f32 v[224:225], v[224:225], v[226:227]
    s_waitcnt vmcnt(19) lgkmcnt(4)
    v_mfma_f32_32x32x16_bf16 v[32:47], v[64:67], v[112:115], v[32:47]
    ds_read_b64_tr_b16 v[80:81], v14 offset:20480
    ds_read_b64_tr_b16 v[82:83], v14 offset:21504
    v_add_f32 v224, v224, v225
    v_mul_f32 v224, 0x3a800000, v224
    v_mfma_f32_32x32x16_bf16 v[48:63], v[68:71], v[112:115], v[48:63]
    s_cmp_eq_u32 s3, 0
    s_cbranch_scc0 L_cs_149
    v_mfma_f32_16x16x32_bf16 v[208:211], v[216:219], v[64:67], v[208:211]
    v_mfma_f32_16x16x32_bf16 v[212:215], v[216:219], v[68:71], v[212:215]
L_cs_149:
    ds_read_b64_tr_b16 v[84:85], v15 offset:20480
    ds_read_b64_tr_b16 v[86:87], v15 offset:21504
    v_mov_b32 v225, v224
    s_nop 1
    v_permlane32_swap_b32 v224, v225
    s_waitcnt vmcnt(18) lgkmcnt(4)
    v_mfma_f32_32x32x16_bf16 v[32:47], v[72:75], v[116:119], v[32:47]
    ds_read_b64_tr_b16 v[88:89], v14 offset:22528
    ds_read_b64_tr_b16 v[90:91], v14 offset:23552
    v_fma_f32 v225, -v224, v224, v225
    v_max_f32 v225, 0, v225
    v_mfma_f32_32x32x16_bf16 v[48:63], v[76:79], v[116:119], v[48:63]
    s_cmp_eq_u32 s3, 1
    s_cbranch_scc0 L_cs_150
    v_mfma_f32_16x16x32_bf16 v[208:211], v[216:219], v[72:75], v[208:211]
    v_mfma_f32_16x16x32_bf16 v[212:215], v[216:219], v[76:79], v[212:215]
L_cs_150:
    ds_read_b64_tr_b16 v[92:93], v15 offset:22528
    ds_read_b64_tr_b16 v[94:95], v15 offset:23552
    v_add_f32 v225, 0x3727c5ac, v225
    v_rsq_f32 v18, v225
    s_waitcnt vmcnt(17) lgkmcnt(4)
    v_mfma_f32_32x32x16_bf16 v[32:47], v[80:83], v[120:123], v[32:47]
    v_sub_f32 v224, 0, v224
    v_cvt_pk_bf16_f32 v226, v224, v224
    v_mfma_f32_32x32x16_bf16 v[48:63], v[84:87], v[120:123], v[48:63]
    s_cmp_eq_u32 s3, 2
    s_cbranch_scc0 L_cs_151
    v_mfma_f32_16x16x32_bf16 v[208:211], v[216:219], v[80:83], v[208:211]
    v_mfma_f32_16x16x32_bf16 v[212:215], v[216:219], v[84:87], v[212:215]
L_cs_151:
    v_lshlrev_b32 v227, 16, v226
    v_sub_f32 v227, v224, v227
    s_waitcnt vmcnt(16) lgkmcnt(0)
    v_mfma_f32_32x32x16_bf16 v[32:47], v[88:91], v[124:127], v[32:47]
    s_barrier
    v_cvt_pk_bf16_f32 v227, v227, v227
    v_cndmask_b32 v240, v226, v227, s[40:41]
    v_mfma_f32_32x32x16_bf16 v[48:63], v[92:95], v[124:127], v[48:63]
    s_cmp_eq_u32 s3, 3
    s_cbranch_scc0 L_cs_152
    v_mfma_f32_16x16x32_bf16 v[208:211], v[216:219], v[88:91], v[208:211]
    v_mfma_f32_16x16x32_bf16 v[212:215], v[216:219], v[92:95], v[212:215]
L_cs_152:
    v_mov_b32 v241, v240
    v_mov_b32 v242, v240
    v_mov_b32 v243, v240
    v_mul_f32 v28, 0x3e8293ee, v18
    v_mov_b32 v29, v28
    s_lshl_b32 s34, s3, 11
    s_add_u32 s34, s34, 147456
    v_add_u32 v11, s34, v10
    v_lshlrev_b32 v9, 2, v1
    v_add_u32 v9, 131072, v9
    s_lshl_b32 s31, s3, 9
    v_add_u32 v4, s31, v9
    ds_write_b32 v4, v208
    ds_write_b32 v4, v212 offset:256
    s_waitcnt lgkmcnt(0)
    s_barrier
    ds_read_b32 v144, v9 offset:0
    ds_read_b32 v148, v9 offset:256
    ds_read_b32 v145, v9 offset:512
    ds_read_b32 v149, v9 offset:768
    ds_read_b32 v146, v9 offset:1024
    ds_read_b32 v150, v9 offset:1280
    ds_read_b32 v147, v9 offset:1536
    ds_read_b32 v151, v9 offset:1792
    s_waitcnt lgkmcnt(0)
    v_add_f32 v144, v144, v145
    v_add_f32 v146, v146, v147
    v_add_f32 v144, v144, v146
    v_cvt_pk_bf16_f32 v4, v144, v144
    v_lshlrev_b32 v4, 16, v4
    v_sub_f32 v4, v144, v4
    v_cvt_pk_bf16_f32 v251, v144, v4
    v_mov_b32 v20, v251
    v_mov_b32 v21, 0
    v_mov_b32 v22, 0
    v_mov_b32 v23, 0
    v_add_f32 v148, v148, v149
    v_add_f32 v150, v150, v151
    v_add_f32 v148, v148, v150
    v_cvt_pk_bf16_f32 v4, v148, v148
    v_lshlrev_b32 v4, 16, v4
    v_sub_f32 v4, v148, v4
    v_cvt_pk_bf16_f32 v252, v148, v4
    v_mov_b32 v24, v252
    v_mov_b32 v25, 0
    v_mov_b32 v26, 0
    v_mov_b32 v27, 0
    s_nop 1
    v_mfma_f32_32x32x16_bf16 v[48:63], v[24:27], v[240:243], v[48:63]
    v_mfma_f32_32x32x16_bf16 v[32:47], v[20:23], v[240:243], v[32:47]
    s_nop 10
    v_pk_mul_f32 v[48:49], v[48:49], v[28:29]
    v_pk_mul_f32 v[50:51], v[50:51], v[28:29]
    v_pk_mul_f32 v[52:53], v[52:53], v[28:29]
    v_pk_mul_f32 v[54:55], v[54:55], v[28:29]
    v_pk_mul_f32 v[56:57], v[56:57], v[28:29]
    v_pk_mul_f32 v[58:59], v[58:59], v[28:29]
    v_pk_mul_f32 v[60:61], v[60:61], v[28:29]
    v_pk_mul_f32 v[62:63], v[62:63], v[28:29]
    v_cvt_pk_bf16_f32 v88, v48, v49
    v_cvt_pk_bf16_f32 v89, v50, v51
    v_cvt_pk_bf16_f32 v90, v52, v53
    v_cvt_pk_bf16_f32 v91, v54, v55
    v_cvt_pk_bf16_f32 v92, v56, v57
    v_cvt_pk_bf16_f32 v93, v58, v59
    v_cvt_pk_bf16_f32 v94, v60, v61
    v_cvt_pk_bf16_f32 v95, v62, v63
    ds_write_b128 v11, v[88:91] offset:0
    ds_write_b128 v11, v[92:95] offset:1024
    v_pk_mul_f32 v[32:33], v[32:33], v[28:29]
    v_pk_mul_f32 v[34:35], v[34:35], v[28:29]
    v_pk_mul_f32 v[36:37], v[36:37], v[28:29]
    v_pk_mul_f32 v[38:39], v[38:39], v[28:29]
    v_pk_mul_f32 v[40:41], v[40:41], v[28:29]
    v_pk_mul_f32 v[42:43], v[42:43], v[28:29]
    v_pk_mul_f32 v[44:45], v[44:45], v[28:29]
    v_pk_mul_f32 v[46:47], v[46:47], v[28:29]
    v_cvt_pk_bf16_f32 v180, v32, v33
    v_cvt_pk_bf16_f32 v181, v34, v35
    v_cvt_pk_bf16_f32 v182, v36, v37
    v_cvt_pk_bf16_f32 v183, v38, v39
    v_cvt_pk_bf16_f32 v184, v40, v41
    v_cvt_pk_bf16_f32 v185, v42, v43
    v_cvt_pk_bf16_f32 v186, v44, v45
    v_cvt_pk_bf16_f32 v187, v46, v47
    s_branch L_qb0_end_69
L_qb0_ld_68:
    s_sub_u32 s30, s3, 4
    v_lshrrev_b32 v6, 3, v1
    v_and_b32 v7, 7, v1
    s_lshl_b32 s31, s30, 4
    v_lshrrev_b32 v5, 1, v6
    v_and_b32 v5, 1, v5
    v_lshlrev_b32 v5, 2, v5
    v_xor_b32 v5, v5, v7
    v_lshlrev_b32 v5, 4, v5
    s_lshl_b32 s32, s5, 7
    v_add_u32 v5, s32, v5
    v_add_u32 v4, s31, v6
    v_lshl_add_u32 v12, v4, 11, v5
    v_add_u32 v13, 15360, v12
    v_lshlrev_b32 v8, 4, v1
    s_lshl_b32 s35, s30, 11
    s_add_u32 m0, s35, 0
    s_mov_b32 s38, 393216
    buffer_load_dwordx4 v12, s[12:15], s38 offen offset:0 lds
    buffer_load_dwordx4 v13, s[12:15], s38 offen offset:1024 lds
    s_add_u32 m0, s35, 8192
    s_mov_b32 s38, 524288
    buffer_load_dwordx4 v12, s[12:15], s38 offen offset:0 lds
    buffer_load_dwordx4 v13, s[12:15], s38 offen offset:1024 lds
    s_add_u32 m0, s35, 16384
    s_mov_b32 s38, 655360
    buffer_load_dwordx4 v12, s[12:15], s38 offen offset:0 lds
    buffer_load_dwordx4 v13, s[12:15], s38 offen offset:1024 lds
    s_add_u32 m0, s35, 24576
    s_mov_b32 s38, 786432
    buffer_load_dwordx4 v12, s[12:15], s38 offen offset:0 lds
    buffer_load_dwordx4 v13, s[12:15], s38 offen offset:1024 lds
    s_add_u32 m0, s35, 32768
    s_mov_b32 s38, 917504
    buffer_load_dwordx4 v12, s[12:15], s38 offen offset:0 lds
    buffer_load_dwordx4 v13, s[12:15], s38 offen offset:1024 lds
    s_add_u32 m0, s35, 40960
    s_mov_b32 s38, 1048576
    buffer_load_dwordx4 v12, s[12:15], s38 offen offset:0 lds
    buffer_load_dwordx4 v13, s[12:15], s38 offen offset:1024 lds
    s_add_u32 m0, s35, 49152
    s_mov_b32 s38, 1179648
    buffer_load_dwordx4 v12, s[12:15], s38 offen offset:0 lds
    buffer_load_dwordx4 v13, s[12:15], s38 offen offset:1024 lds
    s_add_u32 m0, s35, 147456
    s_mov_b32 s38, 1310720
    buffer_load_dwordx4 v12, s[12:15], s38 offen offset:0 lds
    buffer_load_dwordx4 v13, s[12:15], s38 offen offset:1024 lds
    s_waitcnt vmcnt(16)
    s_barrier
    s_cmp_lg_u32 s3, 7
    s_cbranch_scc1 L_rp_153_ok
    v_and_b32 v4, 15, v1
    v_lshlrev_b32 v4, 2, v4
    s_lshl_b32 s52, s4, 8
    s_add_u32 s52, s52, 0x2802000
    s_mov_b32 s53, 0
    v_mov_b32 v6, 163800
L_rp_153:
    buffer_load_dword v5, v4, s[16:19], s52 offen sc1
    s_waitcnt vmcnt(0)
    v_cmp_ne_u32 vcc, 1, v5
    s_nop 0
    s_or_b32 s63, vcc_lo, 0x10000
    s_ff1_i32_b32 s63, s63
    s_add_u32 s53, s53, 1
    s_cmp_lt_u32 s53, 0x40000
    s_cselect_b32 s63, s63, 16
    v_mov_b32 v7, s63
    ds_write_b32 v6, v7
    s_cmp_lt_u32 s63, 16
    s_cbranch_scc1 L_rp_153
L_rp_153_ok:
    s_cmp_lg_u32 s3, 6
    s_cbranch_scc1 L_s6_154
    s_setprio 3
    v_mov_b32 v4, 163800
L_l6_155:
    ds_read_b32 v5, v4
    s_waitcnt lgkmcnt(0)
    v_readfirstlane_b32 s63, v5
    s_nop 0
    s_cmp_gt_u32 s63, 15
    s_cbranch_scc0 L_l6_155
    s_and_b32 s49, s48, 3
    v_lshlrev_b32 v9, 2, v1
    s_lshl_b32 s54, s4, 14
    s_lshl_b32 s55, s49, 8
    s_add_u32 s54, s54, s55
    s_add_u32 s54, s54, 0x2640000
    buffer_load_dword v224, v9, s[16:19], s54 offen offset:0 sc1
    buffer_load_dword v225, v9, s[16:19], s54 offen offset:1024 sc1
    buffer_load_dword v226, v9, s[16:19], s54 offen offset:2048 sc1
    buffer_load_dword v227, v9, s[16:19], s54 offen offset:3072 sc1
    s_add_u32 s54, s54, 4096
    buffer_load_dword v228, v9, s[16:19], s54 offen offset:0 sc1
    buffer_load_dword v229, v9, s[16:19], s54 offen offset:1024 sc1
    buffer_load_dword v230, v9, s[16:19], s54 offen offset:2048 sc1
    buffer_load_dword v231, v9, s[16:19], s54 offen offset:3072 sc1
    s_add_u32 s54, s54, 4096
    buffer_load_dword v232, v9, s[16:19], s54 offen offset:0 sc1
    buffer_load_dword v233, v9, s[16:19], s54 offen offset:1024 sc1
    buffer_load_dword v234, v9, s[16:19], s54 offen offset:2048 sc1
    buffer_load_dword v235, v9, s[16:19], s54 offen offset:3072 sc1
    s_add_u32 s54, s54, 4096
    buffer_load_dword v236, v9, s[16:19], s54 offen offset:0 sc1
    buffer_load_dword v237, v9, s[16:19], s54 offen offset:1024 sc1
    buffer_load_dword v238, v9, s[16:19], s54 offen offset:2048 sc1
    buffer_load_dword v239, v9, s[16:19], s54 offen offset:3072 sc1
    s_lshl_b32 s54, s4, 2
    s_add_u32 s54, s54, s48
    s_lshl_b32 s54, s54, 12
    s_add_u32 s54, s54, 0x2400000
    v_mul_u32_u24 v26, 72, v2
    v_lshl_add_u32 v26, v3, 3, v26
    v_add_u32 v26, 155648, v26
    v_and_b32 v24, 15, v1
    v_lshrrev_b32 v25, 2, v24
    v_lshl_add_u32 v25, v3, 2, v25
    v_mul_u32_u24 v25, 72, v25
    v_and_b32 v24, 3, v24
    v_lshl_add_u32 v25, v24, 3, v25
    v_bfe_u32 v24, v1, 4, 1
    v_lshl_add_u32 v25, v24, 5, v25
    v_add_u32 v25, 155648, v25
    s_waitcnt vmcnt(0)
    v_pk_add_f32 v[224:225], v[224:225], v[232:233]
    v_pk_add_f32 v[226:227], v[226:227], v[234:235]
    v_pk_add_f32 v[228:229], v[228:229], v[236:237]
    v_pk_add_f32 v[230:231], v[230:231], v[238:239]
    v_pk_add_f32 v[224:225], v[224:225], v[228:229]
    v_pk_add_f32 v[226:227], v[226:227], v[230:231]
    v_pk_add_f32 v[224:225], v[224:225], v[226:227]
    v_add_f32 v224, v224, v225
    v_mul_f32 v224, 0x3a800000, v224
    v_mov_b32 v225, v224
    s_nop 1
    v_permlane32_swap_b32 v224, v225
    v_fma_f32 v225, -v224, v224, v225
    v_max_f32 v225, 0, v225
    v_add_f32 v225, 0x3727c5ac, v225
    v_rsq_f32 v18, v225
    v_sub_f32 v224, 0, v224
    v_cvt_pk_bf16_f32 v226, v224, v224
    v_lshlrev_b32 v227, 16, v226
    v_sub_f32 v227, v224, v227
    v_cvt_pk_bf16_f32 v227, v227, v227
    v_cndmask_b32 v240, v226, v227, s[40:41]
    v_mov_b32 v241, v240
    v_mov_b32 v242, v240
    v_mov_b32 v243, v240
    v_mov_b32 v19, v18
L_s6_154:
    s_waitcnt vmcnt(0)
    s_barrier
    s_cmp_ge_u32 s5, 8
    s_cbranch_scc1 L_kvs_156
    s_cmp_eq_u32 s3, 6
    s_cbranch_scc1 L_kvs_158
    s_add_u32 m0, s35, 90112
    s_mov_b32 s38, 1441792
    buffer_load_dwordx4 v12, s[12:15], s38 offen offset:0 lds
    buffer_load_dwordx4 v13, s[12:15], s38 offen offset:1024 lds
    s_add_u32 m0, s35, 106496
    s_mov_b32 s38, 1572864
    buffer_load_dwordx4 v12, s[12:15], s38 offen offset:0 lds
    buffer_load_dwordx4 v13, s[12:15], s38 offen offset:1024 lds
    s_add_u32 m0, s35, 122880
    s_mov_b32 s38, 1703936
    buffer_load_dwordx4 v12, s[12:15], s38 offen offset:0 lds
    buffer_load_dwordx4 v13, s[12:15], s38 offen offset:1024 lds
    s_add_u32 m0, s35, 139264
    s_mov_b32 s38, 1835008
    buffer_load_dwordx4 v12, s[12:15], s38 offen offset:0 lds
    buffer_load_dwordx4 v13, s[12:15], s38 offen offset:1024 lds
    s_branch L_kvs_156
L_kvs_158:
    v_add_u32 v9, 81920, v8
    ds_read_b128 v[32:35], v9 offset:0
    ds_read_b128 v[36:39], v9 offset:1024
    ds_read_b128 v[40:43], v9 offset:2048
    ds_read_b128 v[44:47], v9 offset:3072
    ds_read_b128 v[48:51], v9 offset:16384
    ds_read_b128 v[52:55], v9 offset:17408
    ds_read_b128 v[56:59], v9 offset:18432
    ds_read_b128 v[60:63], v9 offset:19456
    ds_read_b128 v[64:67], v9 offset:32768
    ds_read_b128 v[68:71], v9 offset:33792
    ds_read_b128 v[72:75], v9 offset:34816
    ds_read_b128 v[76:79], v9 offset:35840
    ds_read_b128 v[80:83], v9 offset:49152
    ds_read_b128 v[84:87], v9 offset:50176
    ds_read_b128 v[88:91], v9 offset:51200
    ds_read_b128 v[92:95], v9 offset:52224
    v_lshlrev_b32 v9, 2, v1
    v_add_u32 v9, 157952, v9
    ds_read_b32 v100, v9 offset:0
    ds_read_b32 v101, v9 offset:256
    ds_read_b32 v102, v9 offset:512
    ds_read_b32 v103, v9 offset:768
    s_waitcnt lgkmcnt(0)
    v_pk_add_f32 v[32:33], v[32:33], v[48:49]
    v_pk_add_f32 v[64:65], v[64:65], v[80:81]
    v_pk_add_f32 v[32:33], v[32:33], v[64:65]
    v_pk_add_f32 v[34:35], v[34:35], v[50:51]
    v_pk_add_f32 v[66:67], v[66:67], v[82:83]
    v_pk_add_f32 v[34:35], v[34:35], v[66:67]
    v_pk_add_f32 v[36:37], v[36:37], v[52:53]
    v_pk_add_f32 v[68:69], v[68:69], v[84:85]
    v_pk_add_f32 v[36:37], v[36:37], v[68:69]
    v_pk_add_f32 v[38:39], v[38:39], v[54:55]
    v_pk_add_f32 v[70:71], v[70:71], v[86:87]
    v_pk_add_f32 v[38:39], v[38:39], v[70:71]
    v_pk_add_f32 v[40:41], v[40:41], v[56:57]
    v_pk_add_f32 v[72:73], v[72:73], v[88:89]
    v_pk_add_f32 v[40:41], v[40:41], v[72:73]
    v_pk_add_f32 v[42:43], v[42:43], v[58:59]
    v_pk_add_f32 v[74:75], v[74:75], v[90:91]
    v_pk_add_f32 v[42:43], v[42:43], v[74:75]
    v_pk_add_f32 v[44:45], v[44:45], v[60:61]
    v_pk_add_f32 v[76:77], v[76:77], v[92:93]
    v_pk_add_f32 v[44:45], v[44:45], v[76:77]
    v_pk_add_f32 v[46:47], v[46:47], v[62:63]
    v_pk_add_f32 v[78:79], v[78:79], v[94:95]
    v_pk_add_f32 v[46:47], v[46:47], v[78:79]
    v_add_f32 v100, v100, v101
    v_add_f32 v102, v102, v103
    v_add_f32 v100, v100, v102
    v_cvt_pk_bf16_f32 v4, v100, v100
    v_lshlrev_b32 v4, 16, v4
    v_sub_f32 v4, v100, v4
    v_cvt_pk_bf16_f32 v248, v100, v4
    v_mov_b32 v20, v248
    v_mov_b32 v21, 0
    v_mov_b32 v22, 0
    v_mov_b32 v23, 0
    s_nop 1
    v_mfma_f32_32x32x16_bf16 v[32:47], v[20:23], v[240:243], v[32:47]
    s_nop 11
    v_pk_mul_f32 v[32:33], v[32:33], v[18:19]
    v_pk_mul_f32 v[34:35], v[34:35], v[18:19]
    v_pk_mul_f32 v[36:37], v[36:37], v[18:19]
    v_pk_mul_f32 v[38:39], v[38:39], v[18:19]
    v_pk_mul_f32 v[40:41], v[40:41], v[18:19]
    v_pk_mul_f32 v[42:43], v[42:43], v[18:19]
    v_pk_mul_f32 v[44:45], v[44:45], v[18:19]
    v_pk_mul_f32 v[46:47], v[46:47], v[18:19]
    v_cvt_pk_bf16_f32 v96, v32, v33
    v_cvt_pk_bf16_f32 v97, v34, v35
    v_cvt_pk_bf16_f32 v98, v36, v37
    v_cvt_pk_bf16_f32 v99, v38, v39
    v_cvt_pk_bf16_f32 v100, v40, v41
    v_cvt_pk_bf16_f32 v101, v42, v43
    v_cvt_pk_bf16_f32 v102, v44, v45
    v_cvt_pk_bf16_f32 v103, v46, v47
    s_bitcmp1_b32 s5, 0
    s_cbranch_scc0 L_qb0_sg_71
    ds_write_b64 v26, v[96:97] offset:0
    ds_write_b64 v26, v[98:99] offset:16
    ds_write_b64 v26, v[100:101] offset:32
    ds_write_b64 v26, v[102:103] offset:48
    s_waitcnt lgkmcnt(0)
    ds_read_b64_tr_b16 v[96:97], v25 offset:0
    ds_read_b64_tr_b16 v[98:99], v25 offset:576
    ds_read_b64_tr_b16 v[100:101], v25 offset:1152
    ds_read_b64_tr_b16 v[102:103], v25 offset:1728
    s_waitcnt lgkmcnt(0)
    s_add_u32 s54, s54, 2048
L_qb0_sg_71:
    buffer_store_dwordx4 v[96:99], v8, s[16:19], s54 offen offset:0 sc1
    buffer_store_dwordx4 v[100:103], v8, s[16:19], s54 offen offset:1024 sc1
    s_waitcnt vmcnt(0)
    s_mov_b32 s61, s35
    s_lshl_b32 s34, s4, 8
    s_add_u32 s34, s34, 0x2803000
    v_mov_b32 v4, 1
    v_mov_b32 v5, 0
    s_mov_b64 exec, 1
    buffer_atomic_add v4, v5, s[16:19], s34 offen sc1
L_sig_159:
    s_mov_b64 exec, -1
    s_mov_b32 s35, s61
    s_add_u32 m0, s35, 90112
    s_mov_b32 s38, 1441792
    buffer_load_dwordx4 v12, s[12:15], s38 offen offset:0 lds
    buffer_load_dwordx4 v13, s[12:15], s38 offen offset:1024 lds
    s_add_u32 m0, s35, 106496
    s_mov_b32 s38, 1572864
    buffer_load_dwordx4 v12, s[12:15], s38 offen offset:0 lds
    buffer_load_dwordx4 v13, s[12:15], s38 offen offset:1024 lds
    s_add_u32 m0, s35, 122880
    s_mov_b32 s38, 1703936
    buffer_load_dwordx4 v12, s[12:15], s38 offen offset:0 lds
    buffer_load_dwordx4 v13, s[12:15], s38 offen offset:1024 lds
    s_add_u32 m0, s35, 139264
    s_mov_b32 s38, 1835008
    buffer_load_dwordx4 v12, s[12:15], s38 offen offset:0 lds
    buffer_load_dwordx4 v13, s[12:15], s38 offen offset:1024 lds
L_kvs_156:
    s_setprio 0
    s_waitcnt vmcnt(0)
    s_barrier
    s_cmp_ge_u32 s5, 8
    s_cbranch_scc1 L_kvs_157
    s_add_u32 m0, s35, 81920
    s_mov_b32 s38, 1966080
    buffer_load_dwordx4 v12, s[12:15], s38 offen offset:0 lds
    buffer_load_dwordx4 v13, s[12:15], s38 offen offset:1024 lds
L_kvs_157:
    s_cmp_lg_u32 s3, 7
    s_cbranch_scc1 L_npk_160
    v_and_b32 v4, 15, v1
    v_lshlrev_b32 v4, 8, v4
    s_mov_b32 s52, 0x2803000
    s_mov_b32 s53, 0
L_poll_161:
    buffer_load_dword v5, v4, s[16:19], s52 offen sc1
    s_waitcnt vmcnt(0)
    v_cmp_gt_u32 vcc, 8, v5
    s_cbranch_vccz L_poll_161_ok
    s_add_u32 s53, s53, 1
    s_cmp_lt_u32 s53, 0x40000
    s_cbranch_scc1 L_poll_161
L_poll_161_ok:
L_npk_160:
    s_waitcnt vmcnt(0)
    s_barrier
    s_lshl_b32 s31, s30, 13
    s_add_u32 s39, s31, 0x2400000
    s_add_u32 m0, s31, 0
    s_nop 0
    buffer_load_dwordx4 v8, s[16:19], s39 offen offset:0 sc1 lds
    buffer_load_dwordx4 v8, s[16:19], s39 offen offset:1024 sc1 lds
    buffer_load_dwordx4 v8, s[16:19], s39 offen offset:2048 sc1 lds
    buffer_load_dwordx4 v8, s[16:19], s39 offen offset:3072 sc1 lds
    s_add_u32 s39, s39, 4096
    s_add_u32 m0, s31, 4096
    s_nop 0
    buffer_load_dwordx4 v8, s[16:19], s39 offen offset:0 sc1 lds
    buffer_load_dwordx4 v8, s[16:19], s39 offen offset:1024 sc1 lds
    buffer_load_dwordx4 v8, s[16:19], s39 offen offset:2048 sc1 lds
    buffer_load_dwordx4 v8, s[16:19], s39 offen offset:3072 sc1 lds
    s_add_u32 s39, s39, 4096
    s_barrier
    s_barrier
L_qb0_end_69:
    s_lshr_b32 s36, s3, 2
    s_and_b32 s37, s3, 3
    s_lshl_b32 s38, s5, 1
    s_add_u32 s38, s38, s36
    s_lshl_b32 s39, s4, 2
    s_add_u32 s39, s39, s37
    v_lshlrev_b32 v128, 4, v1
    v_mov_b32 v4, 163804
    v_mov_b32 v5, 0
    ds_write_b32 v4, v5
    v_mov_b32 v4, v128
    s_lshl_b32 s30, s3, 12
    s_add_u32 s31, s30, 0x2408000
    s_add_u32 m0, s30, 32768
    s_nop 0
    buffer_load_dwordx4 v4, s[16:19], s31 offen offset:0 sc1 lds
    buffer_load_dwordx4 v4, s[16:19], s31 offen offset:1024 sc1 lds
    buffer_load_dwordx4 v4, s[16:19], s31 offen offset:2048 sc1 lds
    buffer_load_dwordx4 v4, s[16:19], s31 offen offset:3072 sc1 lds
    s_add_u32 s31, s31, 32768
    s_add_u32 m0, s30, 65536
    s_nop 0
    buffer_load_dwordx4 v4, s[16:19], s31 offen offset:0 sc1 lds
    buffer_load_dwordx4 v4, s[16:19], s31 offen offset:1024 sc1 lds
    buffer_load_dwordx4 v4, s[16:19], s31 offen offset:2048 sc1 lds
    buffer_load_dwordx4 v4, s[16:19], s31 offen offset:3072 sc1 lds
    s_add_u32 s31, s31, 32768
    v_bfe_u32 v5, v1, 2, 1
    v_bfe_u32 v6, v1, 4, 1
    v_cmp_eq_u32 vcc, v5, v6
    v_mov_b32 v5, 0x3f803f80
    s_nop 0
    v_cndmask_b32 v100, 0, v5, vcc
    v_mov_b32 v101, v100
    v_mov_b32 v102, v100
    v_mov_b32 v103, v100
    v_mov_b32 v80, 0
    v_mov_b32 v81, 0
    v_mov_b32 v82, 0
    v_mov_b32 v83, 0
    v_mov_b32 v84, 0
    v_mov_b32 v85, 0
    v_mov_b32 v86, 0
    v_mov_b32 v87, 0
    v_mov_b32 v88, 0
    v_mov_b32 v89, 0
    v_mov_b32 v90, 0
    v_mov_b32 v91, 0
    v_mov_b32 v92, 0
    v_mov_b32 v93, 0
    v_mov_b32 v94, 0
    v_mov_b32 v95, 0
    v_mov_b32 v96, 0
    v_mov_b32 v97, 0
    v_mov_b32 v98, 0
    v_mov_b32 v99, 0
    v_mov_b32 v64, 0
    v_mov_b32 v65, 0
    v_mov_b32 v66, 0
    v_mov_b32 v67, 0
    v_mov_b32 v68, 0
    v_mov_b32 v69, 0
    v_mov_b32 v70, 0
    v_mov_b32 v71, 0
    v_mov_b32 v129, v4
    s_waitcnt vmcnt(8) lgkmcnt(0)
    s_barrier
    s_cmp_ge_u32 s3, 4
    s_cbranch_scc1 L_at0_162_qld
    v_mov_b32 v8, v180
    v_mov_b32 v9, v181
    v_mov_b32 v10, v182
    v_mov_b32 v11, v183
    v_mov_b32 v12, v184
    v_mov_b32 v13, v185
    v_mov_b32 v14, v186
    v_mov_b32 v15, v187
    s_branch L_at0_162_go
L_at0_162_qld:
    s_lshl_b32 s34, s37, 11
    s_add_u32 s34, s34, 147456
    v_add_u32 v5, s34, v128
    ds_read_b128 v[8:11], v5
    ds_read_b128 v[12:15], v5 offset:1024
L_at0_162_go:
    ds_read_b128 v[104:107], v129
    ds_read_b128 v[108:111], v129 offset:1024
    s_waitcnt lgkmcnt(0)
    v_mfma_f32_32x32x16_bf16 v[32:47], v[104:107], v[8:11], 0
    v_mfma_f32_32x32x16_bf16 v[32:47], v[108:111], v[12:15], v[32:47]
    s_nop 11
    v_max3_f32 v5, v32, v33, v34
    v_max3_f32 v5, v5, v35, v36
    v_max3_f32 v5, v5, v37, v38
    v_max3_f32 v5, v5, v39, v40
    v_max3_f32 v5, v5, v41, v42
    v_max3_f32 v5, v5, v43, v44
    v_max3_f32 v5, v5, v45, v46
    v_max_f32 v5, v5, v47
    v_mov_b32 v6, v5
    s_nop 1
    v_permlane32_swap_b32 v5, v6
    v_max_f32 v5, v5, v6
    v_sub_f32 v16, 0, v5
    v_sub_f32 v17, 0, v5
    v_sub_f32 v18, 0, v5
    v_sub_f32 v19, 0, v5
    v_sub_f32 v20, 0, v5
    v_sub_f32 v21, 0, v5
    v_sub_f32 v22, 0, v5
    v_sub_f32 v23, 0, v5
    v_sub_f32 v24, 0, v5
    v_sub_f32 v25, 0, v5
    v_sub_f32 v26, 0, v5
    v_sub_f32 v27, 0, v5
    v_sub_f32 v28, 0, v5
    v_sub_f32 v29, 0, v5
    v_sub_f32 v30, 0, v5
    v_sub_f32 v31, 0, v5
    v_sub_f32 v32, v32, v5
    v_sub_f32 v33, v33, v5
    v_sub_f32 v34, v34, v5
    v_sub_f32 v35, v35, v5
    v_sub_f32 v36, v36, v5
    v_sub_f32 v37, v37, v5
    v_sub_f32 v38, v38, v5
    v_sub_f32 v39, v39, v5
    v_sub_f32 v40, v40, v5
    v_sub_f32 v41, v41, v5
    v_sub_f32 v42, v42, v5
    v_sub_f32 v43, v43, v5
    v_sub_f32 v44, v44, v5
    v_sub_f32 v45, v45, v5
    v_sub_f32 v46, v46, v5
    v_sub_f32 v47, v47, v5
    s_mov_b32 s24, s80
    s_and_b32 s25, s81, 0xffff
    s_mov_b32 s26, 0x200000
    s_mov_b32 s27, 0x20000
    s_and_b32 s57, s2, 1
    s_lshl_b32 s57, s57, 3
    s_bfe_u32 s58, s2, 0x30003
    s_add_u32 s57, s57, s58
    s_lshl_b32 s57, s57, 7
    v_lshrrev_b32 v241, 3, v1
    v_bfe_u32 v242, v241, 1, 1
    v_lshlrev_b32 v242, 2, v242
    v_and_b32 v243, 7, v1
    v_xor_b32 v242, v242, v243
    v_lshlrev_b32 v242, 4, v242
    s_lshl_b32 s58, s3, 3
    v_add_u32 v241, s58, v241
    v_lshl_add_u32 v241, v241, 11, v242
    v_add_u32 v241, s57, v241
    v_add_u32 v242, 15360, v241
    s_lshl_b32 s60, s3, 10
    s_mov_b32 s92, s24
    s_mov_b32 s93, s25
    s_mov_b32 s94, s26
    s_mov_b32 s95, 0x20000
    v_mov_b32 v130, v241
    s_add_u32 s96, s60, 131072
    s_mov_b32 s97, 1572864
    s_movk_i32 s98, 8192
    s_mov_b32 s99, 0x20000
    ds_read_b128 v[124:127], v129 offset:3072
    ds_read_b128 v[104:107], v129 offset:4096
    ds_read_b128 v[108:111], v129 offset:5120
    ds_read_b128 v[120:123], v129 offset:2048
    s_mov_b32 s32, 0
    v_mov_b32 v5, v129
    v_add_u32 v6, 32768, v4
    s_mov_b32 s33, 0x18000
L_at0_162_loop:
    s_waitcnt lgkmcnt(3)
    v_mfma_f32_32x32x16_bf16 v[80:95], v[124:127], v[68:71], v[80:95]
    ds_read_b128 v[124:127], v5 offset:3072
    v_exp_f32 v32, v32
    v_exp_f32 v33, v33
    v_exp_f32 v34, v34
    v_exp_f32 v35, v35
    v_mfma_f32_16x16x32_bf16 v[96:99], v[100:103], v[68:71], v[96:99]
    v_exp_f32 v36, v36
    v_exp_f32 v37, v37
    s_setprio 2
    s_waitcnt lgkmcnt(3)
    v_mfma_f32_32x32x16_bf16 v[48:63], v[104:107], v[8:11], v[16:31]
    ds_read_b128 v[104:107], v5 offset:8192
    v_exp_f32 v38, v38
    v_exp_f32 v39, v39
    v_cvt_pk_bf16_f32 v64, v32, v33
    v_cvt_pk_bf16_f32 v65, v34, v35
    v_cvt_pk_bf16_f32 v66, v36, v37
    v_cvt_pk_bf16_f32 v67, v38, v39
    s_waitcnt lgkmcnt(3)
    v_mfma_f32_32x32x16_bf16 v[48:63], v[108:111], v[12:15], v[48:63]
    ds_read_b128 v[108:111], v5 offset:9216
    v_exp_f32 v40, v40
    v_exp_f32 v41, v41
    v_exp_f32 v42, v42
    v_exp_f32 v43, v43
    s_mov_b32 m0, s96
    s_add_u32 s96, s96, s98
    buffer_load_dwordx4 v130, s[92:95], s97 offen sc1 lds
    s_add_u32 s97, s97, s99
    s_waitcnt lgkmcnt(3)
    v_mfma_f32_32x32x16_bf16 v[80:95], v[120:123], v[64:67], v[80:95]
    ds_read_b128 v[120:123], v5 offset:6144
    v_exp_f32 v44, v44
    v_exp_f32 v45, v45
    v_exp_f32 v46, v46
    v_exp_f32 v47, v47
    v_mfma_f32_16x16x32_bf16 v[96:99], v[100:103], v[64:67], v[96:99]
    v_cvt_pk_bf16_f32 v68, v40, v41
    v_cvt_pk_bf16_f32 v69, v42, v43
    v_cvt_pk_bf16_f32 v70, v44, v45
    v_cvt_pk_bf16_f32 v71, v46, v47
    s_waitcnt lgkmcnt(3)
    s_nop 0
    v_mfma_f32_32x32x16_bf16 v[80:95], v[124:127], v[68:71], v[80:95]
    ds_read_b128 v[124:127], v5 offset:7168
    v_exp_f32 v48, v48
    v_exp_f32 v49, v49
    v_exp_f32 v50, v50
    v_exp_f32 v51, v51
    v_mfma_f32_16x16x32_bf16 v[96:99], v[100:103], v[68:71], v[96:99]
    v_exp_f32 v52, v52
    v_exp_f32 v53, v53
    s_waitcnt lgkmcnt(3)
    v_mfma_f32_32x32x16_bf16 v[32:47], v[104:107], v[8:11], v[16:31]
    ds_read_b128 v[104:107], v5 offset:12288
    v_exp_f32 v54, v54
    v_exp_f32 v55, v55
    v_cvt_pk_bf16_f32 v64, v48, v49
    v_cvt_pk_bf16_f32 v65, v50, v51
    v_cvt_pk_bf16_f32 v66, v52, v53
    v_cvt_pk_bf16_f32 v67, v54, v55
    s_waitcnt lgkmcnt(3)
    v_mfma_f32_32x32x16_bf16 v[32:47], v[108:111], v[12:15], v[32:47]
    ds_read_b128 v[108:111], v5 offset:13312
    v_exp_f32 v56, v56
    v_exp_f32 v57, v57
    v_exp_f32 v58, v58
    v_exp_f32 v59, v59
    s_mov_b32 m0, s96
    s_add_u32 s96, s96, s98
    buffer_load_dwordx4 v130, s[92:95], s97 offen sc1 lds
    s_add_u32 s97, s97, s99
    s_waitcnt lgkmcnt(3)
    v_mfma_f32_32x32x16_bf16 v[80:95], v[120:123], v[64:67], v[80:95]
    ds_read_b128 v[120:123], v5 offset:10240
    v_exp_f32 v60, v60
    v_exp_f32 v61, v61
    v_exp_f32 v62, v62
    v_exp_f32 v63, v63
    v_mfma_f32_16x16x32_bf16 v[96:99], v[100:103], v[64:67], v[96:99]
    v_cvt_pk_bf16_f32 v68, v56, v57
    v_cvt_pk_bf16_f32 v69, v58, v59
    v_cvt_pk_bf16_f32 v70, v60, v61
    v_cvt_pk_bf16_f32 v71, v62, v63
    s_waitcnt lgkmcnt(3)
    s_nop 0
    v_mfma_f32_32x32x16_bf16 v[80:95], v[124:127], v[68:71], v[80:95]
    ds_read_b128 v[124:127], v5 offset:11264
    v_exp_f32 v32, v32
    v_exp_f32 v33, v33
    v_exp_f32 v34, v34
    v_exp_f32 v35, v35
    v_mfma_f32_16x16x32_bf16 v[96:99], v[100:103], v[68:71], v[96:99]
    v_exp_f32 v36, v36
    v_exp_f32 v37, v37
    s_setprio 1
    s_waitcnt lgkmcnt(3)
    v_mfma_f32_32x32x16_bf16 v[48:63], v[104:107], v[8:11], v[16:31]
    ds_read_b128 v[104:107], v5 offset:16384
    v_exp_f32 v38, v38
    v_exp_f32 v39, v39
    v_cvt_pk_bf16_f32 v64, v32, v33
    v_cvt_pk_bf16_f32 v65, v34, v35
    v_cvt_pk_bf16_f32 v66, v36, v37
    v_cvt_pk_bf16_f32 v67, v38, v39
    s_waitcnt lgkmcnt(3)
    v_mfma_f32_32x32x16_bf16 v[48:63], v[108:111], v[12:15], v[48:63]
    ds_read_b128 v[108:111], v5 offset:17408
    v_exp_f32 v40, v40
    v_exp_f32 v41, v41
    v_exp_f32 v42, v42
    v_exp_f32 v43, v43
    s_waitcnt lgkmcnt(3)
    v_mfma_f32_32x32x16_bf16 v[80:95], v[120:123], v[64:67], v[80:95]
    ds_read_b128 v[120:123], v5 offset:14336
    v_exp_f32 v44, v44
    v_exp_f32 v45, v45
    v_exp_f32 v46, v46
    v_exp_f32 v47, v47
    v_mfma_f32_16x16x32_bf16 v[96:99], v[100:103], v[64:67], v[96:99]
    v_cvt_pk_bf16_f32 v68, v40, v41
    v_cvt_pk_bf16_f32 v69, v42, v43
    v_cvt_pk_bf16_f32 v70, v44, v45
    v_cvt_pk_bf16_f32 v71, v46, v47
    s_waitcnt lgkmcnt(3)
    s_nop 0
    v_mfma_f32_32x32x16_bf16 v[80:95], v[124:127], v[68:71], v[80:95]
    ds_read_b128 v[124:127], v5 offset:15360
    v_exp_f32 v48, v48
    v_exp_f32 v49, v49
    v_exp_f32 v50, v50
    v_exp_f32 v51, v51
    v_mfma_f32_16x16x32_bf16 v[96:99], v[100:103], v[68:71], v[96:99]
    v_exp_f32 v52, v52
    v_exp_f32 v53, v53
    s_waitcnt lgkmcnt(3)
    v_mfma_f32_32x32x16_bf16 v[32:47], v[104:107], v[8:11], v[16:31]
    ds_read_b128 v[104:107], v5 offset:20480
    v_exp_f32 v54, v54
    v_exp_f32 v55, v55
    v_cvt_pk_bf16_f32 v64, v48, v49
    v_cvt_pk_bf16_f32 v65, v50, v51
    v_cvt_pk_bf16_f32 v66, v52, v53
    v_cvt_pk_bf16_f32 v67, v54, v55
    s_waitcnt lgkmcnt(3)
    v_mfma_f32_32x32x16_bf16 v[32:47], v[108:111], v[12:15], v[32:47]
    ds_read_b128 v[108:111], v5 offset:21504
    v_exp_f32 v56, v56
    v_exp_f32 v57, v57
    v_exp_f32 v58, v58
    v_exp_f32 v59, v59
    s_waitcnt lgkmcnt(3)
    v_mfma_f32_32x32x16_bf16 v[80:95], v[120:123], v[64:67], v[80:95]
    ds_read_b128 v[120:123], v5 offset:18432
    v_exp_f32 v60, v60
    v_exp_f32 v61, v61
    v_exp_f32 v62, v62
    v_exp_f32 v63, v63
    v_mfma_f32_16x16x32_bf16 v[96:99], v[100:103], v[64:67], v[96:99]
    v_cvt_pk_bf16_f32 v68, v56, v57
    v_cvt_pk_bf16_f32 v69, v58, v59
    v_cvt_pk_bf16_f32 v70, v60, v61
    v_cvt_pk_bf16_f32 v71, v62, v63
    s_waitcnt lgkmcnt(3)
    s_nop 0
    v_mfma_f32_32x32x16_bf16 v[80:95], v[124:127], v[68:71], v[80:95]
    ds_read_b128 v[124:127], v5 offset:19456
    v_exp_f32 v32, v32
    v_exp_f32 v33, v33
    v_exp_f32 v34, v34
    v_exp_f32 v35, v35
    v_mfma_f32_16x16x32_bf16 v[96:99], v[100:103], v[68:71], v[96:99]
    v_exp_f32 v36, v36
    v_exp_f32 v37, v37
    s_setprio 0
    s_waitcnt lgkmcnt(3)
    v_mfma_f32_32x32x16_bf16 v[48:63], v[104:107], v[8:11], v[16:31]
    ds_read_b128 v[104:107], v5 offset:24576
    v_exp_f32 v38, v38
    v_exp_f32 v39, v39
    v_cvt_pk_bf16_f32 v64, v32, v33
    v_cvt_pk_bf16_f32 v65, v34, v35
    v_cvt_pk_bf16_f32 v66, v36, v37
    v_cvt_pk_bf16_f32 v67, v38, v39
    s_waitcnt lgkmcnt(3)
    v_mfma_f32_32x32x16_bf16 v[48:63], v[108:111], v[12:15], v[48:63]
    ds_read_b128 v[108:111], v5 offset:25600
    v_exp_f32 v40, v40
    v_exp_f32 v41, v41
    v_exp_f32 v42, v42
    v_exp_f32 v43, v43
    s_waitcnt lgkmcnt(3)
    v_mfma_f32_32x32x16_bf16 v[80:95], v[120:123], v[64:67], v[80:95]
    ds_read_b128 v[120:123], v5 offset:22528
    v_exp_f32 v44, v44
    v_exp_f32 v45, v45
    v_exp_f32 v46, v46
    v_exp_f32 v47, v47
    v_mfma_f32_16x16x32_bf16 v[96:99], v[100:103], v[64:67], v[96:99]
    v_cvt_pk_bf16_f32 v68, v40, v41
    v_cvt_pk_bf16_f32 v69, v42, v43
    v_cvt_pk_bf16_f32 v70, v44, v45
    v_cvt_pk_bf16_f32 v71, v46, v47
    s_waitcnt lgkmcnt(3)
    s_nop 0
    v_mfma_f32_32x32x16_bf16 v[80:95], v[124:127], v[68:71], v[80:95]
    ds_read_b128 v[124:127], v5 offset:23552
    v_exp_f32 v48, v48
    v_exp_f32 v49, v49
    v_exp_f32 v50, v50
    v_exp_f32 v51, v51
    v_mfma_f32_16x16x32_bf16 v[96:99], v[100:103], v[68:71], v[96:99]
    v_exp_f32 v52, v52
    v_exp_f32 v53, v53
    s_waitcnt lgkmcnt(3)
    v_mfma_f32_32x32x16_bf16 v[32:47], v[104:107], v[8:11], v[16:31]
    ds_read_b128 v[104:107], v5 offset:28672
    v_exp_f32 v54, v54
    v_exp_f32 v55, v55
    v_cvt_pk_bf16_f32 v64, v48, v49
    v_cvt_pk_bf16_f32 v65, v50, v51
    v_cvt_pk_bf16_f32 v66, v52, v53
    v_cvt_pk_bf16_f32 v67, v54, v55
    s_waitcnt lgkmcnt(3)
    v_mfma_f32_32x32x16_bf16 v[32:47], v[108:111], v[12:15], v[32:47]
    ds_read_b128 v[108:111], v5 offset:29696
    v_exp_f32 v56, v56
    v_exp_f32 v57, v57
    v_exp_f32 v58, v58
    v_exp_f32 v59, v59
    s_waitcnt lgkmcnt(3)
    v_mfma_f32_32x32x16_bf16 v[80:95], v[120:123], v[64:67], v[80:95]
    ds_read_b128 v[120:123], v5 offset:26624
    v_exp_f32 v60, v60
    v_exp_f32 v61, v61
    v_exp_f32 v62, v62
    v_exp_f32 v63, v63
    v_mfma_f32_16x16x32_bf16 v[96:99], v[100:103], v[64:67], v[96:99]
    v_cvt_pk_bf16_f32 v68, v56, v57
    v_cvt_pk_bf16_f32 v69, v58, v59
    v_cvt_pk_bf16_f32 v70, v60, v61
    v_cvt_pk_bf16_f32 v71, v62, v63
    s_waitcnt lgkmcnt(3)
    s_nop 0
    v_mfma_f32_32x32x16_bf16 v[80:95], v[124:127], v[68:71], v[80:95]
    ds_read_b128 v[124:127], v5 offset:27648
    v_exp_f32 v32, v32
    v_exp_f32 v33, v33
    v_exp_f32 v34, v34
    v_exp_f32 v35, v35
    v_mfma_f32_16x16x32_bf16 v[96:99], v[100:103], v[68:71], v[96:99]
    v_exp_f32 v36, v36
    v_exp_f32 v37, v37
    s_waitcnt vmcnt(4)
    s_barrier
    s_cmp_ge_u32 s32, 5
    s_cbranch_scc1 L_at0_162_wm
    s_mov_b32 s92, s16
    s_mov_b32 s93, s17
    s_mov_b32 s94, s18
    v_mov_b32 v130, v4
    s_add_u32 s96, s30, s33
    s_mov_b32 s97, s31
    s_add_u32 s31, s31, 32768
    s_movk_i32 s98, 1024
    s_movk_i32 s99, 1024
    s_branch L_at0_162_dd
L_at0_162_wm:
    s_mov_b32 s92, s24
    s_mov_b32 s93, s25
    s_mov_b32 s94, s26
    v_mov_b32 v130, v241
    s_sub_u32 s97, s32, 5
    s_lshl_b32 s96, s97, 15
    s_add_u32 s96, s96, s60
    s_lshl_b32 s97, s97, 19
    s_movk_i32 s98, 8192
    s_mov_b32 s99, 0x20000
L_at0_162_dd:
    s_setprio 3
    s_waitcnt lgkmcnt(3)
    v_mfma_f32_32x32x16_bf16 v[48:63], v[104:107], v[8:11], v[16:31]
    ds_read_b128 v[104:107], v6 offset:0
    v_exp_f32 v38, v38
    v_exp_f32 v39, v39
    v_cvt_pk_bf16_f32 v64, v32, v33
    v_cvt_pk_bf16_f32 v65, v34, v35
    v_cvt_pk_bf16_f32 v66, v36, v37
    v_cvt_pk_bf16_f32 v67, v38, v39
    s_waitcnt lgkmcnt(3)
    v_mfma_f32_32x32x16_bf16 v[48:63], v[108:111], v[12:15], v[48:63]
    ds_read_b128 v[108:111], v6 offset:1024
    v_exp_f32 v40, v40
    v_exp_f32 v41, v41
    v_exp_f32 v42, v42
    v_exp_f32 v43, v43
    s_mov_b32 m0, s96
    s_add_u32 s96, s96, s98
    buffer_load_dwordx4 v130, s[92:95], s97 offen sc1 lds
    s_add_u32 s97, s97, s99
    s_waitcnt lgkmcnt(3)
    v_mfma_f32_32x32x16_bf16 v[80:95], v[120:123], v[64:67], v[80:95]
    ds_read_b128 v[120:123], v5 offset:30720
    v_exp_f32 v44, v44
    v_exp_f32 v45, v45
    v_exp_f32 v46, v46
    v_exp_f32 v47, v47
    v_mfma_f32_16x16x32_bf16 v[96:99], v[100:103], v[64:67], v[96:99]
    v_cvt_pk_bf16_f32 v68, v40, v41
    v_cvt_pk_bf16_f32 v69, v42, v43
    v_cvt_pk_bf16_f32 v70, v44, v45
    v_cvt_pk_bf16_f32 v71, v46, v47
    s_waitcnt lgkmcnt(3)
    s_nop 0
    v_mfma_f32_32x32x16_bf16 v[80:95], v[124:127], v[68:71], v[80:95]
    ds_read_b128 v[124:127], v5 offset:31744
    v_exp_f32 v48, v48
    v_exp_f32 v49, v49
    v_exp_f32 v50, v50
    v_exp_f32 v51, v51
    v_mfma_f32_16x16x32_bf16 v[96:99], v[100:103], v[68:71], v[96:99]
    v_exp_f32 v52, v52
    v_exp_f32 v53, v53
    s_waitcnt lgkmcnt(3)
    v_mfma_f32_32x32x16_bf16 v[32:47], v[104:107], v[8:11], v[16:31]
    ds_read_b128 v[104:107], v6 offset:4096
    v_exp_f32 v54, v54
    v_exp_f32 v55, v55
    v_cvt_pk_bf16_f32 v64, v48, v49
    v_cvt_pk_bf16_f32 v65, v50, v51
    v_cvt_pk_bf16_f32 v66, v52, v53
    v_cvt_pk_bf16_f32 v67, v54, v55
    s_waitcnt lgkmcnt(3)
    v_mfma_f32_32x32x16_bf16 v[32:47], v[108:111], v[12:15], v[32:47]
    ds_read_b128 v[108:111], v6 offset:5120
    v_exp_f32 v56, v56
    v_exp_f32 v57, v57
    v_exp_f32 v58, v58
    v_exp_f32 v59, v59
    s_mov_b32 m0, s96
    s_add_u32 s96, s96, s98
    buffer_load_dwordx4 v130, s[92:95], s97 offen sc1 lds
    s_add_u32 s97, s97, s99
    s_waitcnt lgkmcnt(3)
    v_mfma_f32_32x32x16_bf16 v[80:95], v[120:123], v[64:67], v[80:95]
    ds_read_b128 v[120:123], v6 offset:2048
    v_exp_f32 v60, v60
    v_exp_f32 v61, v61
    v_exp_f32 v62, v62
    v_exp_f32 v63, v63
    v_mfma_f32_16x16x32_bf16 v[96:99], v[100:103], v[64:67], v[96:99]
    v_cvt_pk_bf16_f32 v68, v56, v57
    v_cvt_pk_bf16_f32 v69, v58, v59
    v_cvt_pk_bf16_f32 v70, v60, v61
    v_cvt_pk_bf16_f32 v71, v62, v63
    v_mov_b32 v5, v6
    s_add_u32 s33, s33, 0x8000
    s_and_b32 s33, s33, 0x1ffff
    s_add_u32 s34, s33, 0x10000
    s_and_b32 s34, s34, 0x1ffff
    v_add_u32 v6, s34, v4
    s_add_u32 s32, s32, 1
    s_cmp_lt_u32 s32, 8
    s_cbranch_scc1 L_at0_162_loop
    s_waitcnt lgkmcnt(0)
    s_barrier
    v_mfma_f32_32x32x16_bf16 v[80:95], v[124:127], v[68:71], v[80:95]
    v_mfma_f32_16x16x32_bf16 v[96:99], v[100:103], v[68:71], v[96:99]
    s_mov_b32 m0, s96
    s_add_u32 s96, s96, s98
    buffer_load_dwordx4 v130, s[92:95], s97 offen sc1 lds
    s_add_u32 s97, s97, s99
    s_mov_b32 m0, s96
    s_add_u32 s96, s96, s98
    buffer_load_dwordx4 v130, s[92:95], s97 offen sc1 lds
    s_add_u32 s97, s97, s99
    s_add_u32 m0, s60, 147456
    s_mov_b32 s59, 1835008
    buffer_load_dwordx4 v241, s[24:27], s59 offen lds
    s_setprio 0
    v_max3_f32 v5, abs(v80), abs(v81), abs(v82)
    v_max3_f32 v5, v5, abs(v83), abs(v84)
    v_max3_f32 v5, v5, abs(v85), abs(v86)
    v_max3_f32 v5, v5, abs(v87), abs(v88)
    v_max3_f32 v5, v5, abs(v89), abs(v90)
    v_max3_f32 v5, v5, abs(v91), abs(v92)
    v_max3_f32 v5, v5, abs(v93), abs(v94)
    v_max3_f32 v5, v5, abs(v95), v96
    v_mov_b32 v6, 0
    v_fma_f32 v6, v80, 0, v6
    v_fma_f32 v6, v81, 0, v6
    v_fma_f32 v6, v82, 0, v6
    v_fma_f32 v6, v83, 0, v6
    v_fma_f32 v6, v84, 0, v6
    v_fma_f32 v6, v85, 0, v6
    v_fma_f32 v6, v86, 0, v6
    v_fma_f32 v6, v87, 0, v6
    v_fma_f32 v6, v88, 0, v6
    v_fma_f32 v6, v89, 0, v6
    v_fma_f32 v6, v90, 0, v6
    v_fma_f32 v6, v91, 0, v6
    v_fma_f32 v6, v92, 0, v6
    v_fma_f32 v6, v93, 0, v6
    v_fma_f32 v6, v94, 0, v6
    v_fma_f32 v6, v95, 0, v6
    v_fma_f32 v6, v96, 0, v6
    v_add_f32 v5, v5, v6
    s_mov_b32 s34, 0x71800000
    v_cmp_nlt_f32 vcc, v5, s34
    s_cbranch_vccz L_at0_162_fin
    v_mov_b32 v80, 0
    v_mov_b32 v81, 0
    v_mov_b32 v82, 0
    v_mov_b32 v83, 0
    v_mov_b32 v84, 0
    v_mov_b32 v85, 0
    v_mov_b32 v86, 0
    v_mov_b32 v87, 0
    v_mov_b32 v88, 0
    v_mov_b32 v89, 0
    v_mov_b32 v90, 0
    v_mov_b32 v91, 0
    v_mov_b32 v92, 0
    v_mov_b32 v93, 0
    v_mov_b32 v94, 0
    v_mov_b32 v95, 0
    v_mov_b32 v96, 0
    v_mov_b32 v97, 0
    v_mov_b32 v98, 0
    v_mov_b32 v99, 0
    v_mov_b32 v7, 0xff800000
    s_mov_b32 s31, 0x2400000
    s_mov_b32 s32, 0
L_at0_162_sloop:
    buffer_load_dwordx4 v[104:107], v4, s[16:19], s31 offen sc1
    buffer_load_dwordx4 v[108:111], v4, s[16:19], s31 offen offset:1024 sc1
    buffer_load_dwordx4 v[120:123], v4, s[16:19], s31 offen offset:2048 sc1
    buffer_load_dwordx4 v[124:127], v4, s[16:19], s31 offen offset:3072 sc1
    s_waitcnt vmcnt(0)
    v_mfma_f32_32x32x16_bf16 v[32:47], v[104:107], v[8:11], 0
    v_mfma_f32_32x32x16_bf16 v[32:47], v[108:111], v[12:15], v[32:47]
    s_nop 11
    v_max3_f32 v5, v32, v33, v34
    v_max3_f32 v5, v5, v35, v36
    v_max3_f32 v5, v5, v37, v38
    v_max3_f32 v5, v5, v39, v40
    v_max3_f32 v5, v5, v41, v42
    v_max3_f32 v5, v5, v43, v44
    v_max3_f32 v5, v5, v45, v46
    v_max_f32 v5, v5, v47
    v_mov_b32 v6, v5
    s_nop 1
    v_permlane32_swap_b32 v5, v6
    v_max3_f32 v5, v5, v6, v7
    v_sub_f32 v6, v7, v5
    v_exp_f32 v6, v6
    v_mov_b32 v7, v5
    v_sub_f32 v32, v32, v5
    v_sub_f32 v33, v33, v5
    v_sub_f32 v34, v34, v5
    v_sub_f32 v35, v35, v5
    v_sub_f32 v36, v36, v5
    v_sub_f32 v37, v37, v5
    v_sub_f32 v38, v38, v5
    v_sub_f32 v39, v39, v5
    v_sub_f32 v40, v40, v5
    v_sub_f32 v41, v41, v5
    v_sub_f32 v42, v42, v5
    v_sub_f32 v43, v43, v5
    v_sub_f32 v44, v44, v5
    v_sub_f32 v45, v45, v5
    v_sub_f32 v46, v46, v5
    v_sub_f32 v47, v47, v5
    v_exp_f32 v32, v32
    v_exp_f32 v33, v33
    v_exp_f32 v34, v34
    v_exp_f32 v35, v35
    v_exp_f32 v36, v36
    v_exp_f32 v37, v37
    v_exp_f32 v38, v38
    v_exp_f32 v39, v39
    v_exp_f32 v40, v40
    v_exp_f32 v41, v41
    v_exp_f32 v42, v42
    v_exp_f32 v43, v43
    v_exp_f32 v44, v44
    v_exp_f32 v45, v45
    v_exp_f32 v46, v46
    v_exp_f32 v47, v47
    v_mul_f32 v80, v80, v6
    v_mul_f32 v81, v81, v6
    v_mul_f32 v82, v82, v6
    v_mul_f32 v83, v83, v6
    v_mul_f32 v84, v84, v6
    v_mul_f32 v85, v85, v6
    v_mul_f32 v86, v86, v6
    v_mul_f32 v87, v87, v6
    v_mul_f32 v88, v88, v6
    v_mul_f32 v89, v89, v6
    v_mul_f32 v90, v90, v6
    v_mul_f32 v91, v91, v6
    v_mul_f32 v92, v92, v6
    v_mul_f32 v93, v93, v6
    v_mul_f32 v94, v94, v6
    v_mul_f32 v95, v95, v6
    v_mul_f32 v96, v96, v6
    v_mul_f32 v97, v97, v6
    v_mul_f32 v98, v98, v6
    v_mul_f32 v99, v99, v6
    v_cvt_pk_bf16_f32 v64, v32, v33
    v_cvt_pk_bf16_f32 v65, v34, v35
    v_cvt_pk_bf16_f32 v66, v36, v37
    v_cvt_pk_bf16_f32 v67, v38, v39
    v_cvt_pk_bf16_f32 v68, v40, v41
    v_cvt_pk_bf16_f32 v69, v42, v43
    v_cvt_pk_bf16_f32 v70, v44, v45
    v_cvt_pk_bf16_f32 v71, v46, v47
    v_mfma_f32_32x32x16_bf16 v[80:95], v[120:123], v[64:67], v[80:95]
    v_mfma_f32_16x16x32_bf16 v[96:99], v[100:103], v[64:67], v[96:99]
    v_mfma_f32_32x32x16_bf16 v[80:95], v[124:127], v[68:71], v[80:95]
    v_mfma_f32_16x16x32_bf16 v[96:99], v[100:103], v[68:71], v[96:99]
    s_add_u32 s31, s31, 4096
    s_add_u32 s32, s32, 1
    s_cmp_lt_u32 s32, 64
    s_cbranch_scc1 L_at0_162_sloop
L_at0_162_fin:
    s_nop 3
    v_rcp_f32 v6, v96
    s_lshl_b32 s34, s39, 16
    s_lshl_b32 s35, s38, 11
    s_add_u32 s34, s34, s35
    s_add_u32 s34, s34, 0x1000000
    v_mov_b32 v7, v6
    v_pk_mul_f32 v[80:81], v[80:81], v[6:7]
    v_pk_mul_f32 v[82:83], v[82:83], v[6:7]
    v_pk_mul_f32 v[84:85], v[84:85], v[6:7]
    v_pk_mul_f32 v[86:87], v[86:87], v[6:7]
    v_pk_mul_f32 v[88:89], v[88:89], v[6:7]
    v_pk_mul_f32 v[90:91], v[90:91], v[6:7]
    v_pk_mul_f32 v[92:93], v[92:93], v[6:7]
    v_pk_mul_f32 v[94:95], v[94:95], v[6:7]
    v_cvt_pk_bf16_f32 v64, v80, v81
    v_cvt_pk_bf16_f32 v65, v82, v83
    v_cvt_pk_bf16_f32 v66, v84, v85
    v_cvt_pk_bf16_f32 v67, v86, v87
    v_cvt_pk_bf16_f32 v68, v88, v89
    v_cvt_pk_bf16_f32 v69, v90, v91
    v_cvt_pk_bf16_f32 v70, v92, v93
    v_cvt_pk_bf16_f32 v71, v94, v95
    buffer_store_dwordx4 v[64:67], v4, s[16:19], s34 offen offset:0 sc1
    buffer_store_dwordx4 v[68:71], v4, s[16:19], s34 offen offset:1024 sc1
    s_waitcnt vmcnt(0)
    s_lshl_b32 s34, s4, 8
    s_add_u32 s34, s34, 0x2804000
    v_mov_b32 v4, 1
    v_mov_b32 v5, 0
    s_mov_b64 exec, 1
    v_mov_b32 v6, 163804
    ds_add_rtn_u32 v7, v6, v4
    s_waitcnt lgkmcnt(0)
    v_readfirstlane_b32 s35, v7
    s_nop 0
    s_cmp_eq_u32 s35, 7
    s_cbranch_scc0 L_sig_163
    s_lshl_b32 s35, s5, 2
    s_add_u32 s34, s34, s35
    buffer_store_dword v4, v5, s[16:19], s34 offen sc1
L_sig_163:
    s_mov_b64 exec, -1
    s_and_b32 s6, s2, 7
    s_lshr_b32 s7, s2, 3
    s_lshr_b32 s4, s6, 1
    s_lshl_b32 s4, s4, 2
    s_lshr_b32 s5, s7, 3
    s_add_u32 s4, s4, s5
    s_and_b32 s5, s6, 1
    s_lshl_b32 s5, s5, 3
    s_and_b32 s7, s7, 7
    s_add_u32 s5, s5, s7
    s_add_u32 s8, s86, 0x1000000
    s_addc_u32 s9, s87, 0
    s_and_b32 s9, s9, 0xffff
    s_mov_b32 s10, 0x400000
    s_mov_b32 s11, 0x20000
    s_mov_b32 s12, s80
    s_and_b32 s13, s81, 0xffff
    s_mov_b32 s14, 0x200000
    s_mov_b32 s15, 0x20000
    s_cmp_ge_u32 s3, 4
    s_cbranch_scc1 L_wb0_ld_164
    s_lshl_b32 s30, s4, 2
    s_add_u32 s30, s30, s3
    s_lshl_b32 s39, s30, 16
    s_lshl_b32 s31, s5, 12
    s_add_u32 s36, s39, s31
    s_add_u32 s37, s36, 0x0
    v_lshlrev_b32 v10, 4, v1
    buffer_load_dwordx4 v[64:67], v10, s[16:19], s37 offen offset:0 sc1
    buffer_load_dwordx4 v[68:71], v10, s[16:19], s37 offen offset:1024 sc1
    buffer_load_dwordx4 v[72:75], v10, s[16:19], s37 offen offset:2048 sc1
    buffer_load_dwordx4 v[76:79], v10, s[16:19], s37 offen offset:3072 sc1
    v_and_b32 v4, 15, v1
    v_lshrrev_b32 v5, 2, v4
    v_lshl_add_u32 v5, v3, 2, v5
    v_mul_u32_u24 v5, 128, v5
    v_and_b32 v6, 3, v4
    v_lshlrev_b32 v6, 3, v6
    v_bfe_u32 v7, v1, 4, 1
    v_lshl_add_u32 v6, v7, 5, v6
    v_add_u32 v6, 0, v6
    v_bfe_u32 v7, v1, 3, 1
    v_lshlrev_b32 v7, 6, v7
    v_xor_b32 v6, v6, v7
    v_add_u32 v12, v5, v6
    v_xor_b32 v13, 64, v12
    v_mov_b32 v4, 163808
    v_mov_b32 v5, 0
    ds_write_b32 v4, v5
    v_mov_b32 v4, 163812
    v_mov_b32 v5, 0
    ds_write_b32 v4, v5
    s_waitcnt lgkmcnt(0)
    v_add_u32 v14, 0x10000, v12
    v_add_u32 v15, 0x10000, v13
    v_add_u32 v16, 0x20000, v12
    v_add_u32 v17, 0x20000, v13
    v_mov_b32 v4, 163812
    s_mov_b32 s63, 0
    s_barrier
    s_waitcnt vmcnt(0)
    v_lshlrev_b32 v32, 16, v64
    v_and_b32 v33, 0xffff0000, v64
    v_lshlrev_b32 v34, 16, v65
    v_and_b32 v35, 0xffff0000, v65
    v_lshlrev_b32 v36, 16, v66
    v_and_b32 v37, 0xffff0000, v66
    v_lshlrev_b32 v38, 16, v67
    v_and_b32 v39, 0xffff0000, v67
    v_lshlrev_b32 v40, 16, v68
    v_and_b32 v41, 0xffff0000, v68
    v_lshlrev_b32 v42, 16, v69
    v_and_b32 v43, 0xffff0000, v69
    v_lshlrev_b32 v44, 16, v70
    v_and_b32 v45, 0xffff0000, v70
    v_lshlrev_b32 v46, 16, v71
    v_and_b32 v47, 0xffff0000, v71
    v_lshlrev_b32 v48, 16, v72
    v_and_b32 v49, 0xffff0000, v72
    v_lshlrev_b32 v50, 16, v73
    v_and_b32 v51, 0xffff0000, v73
    v_lshlrev_b32 v52, 16, v74
    v_and_b32 v53, 0xffff0000, v74
    v_lshlrev_b32 v54, 16, v75
    v_and_b32 v55, 0xffff0000, v75
    v_lshlrev_b32 v56, 16, v76
    v_and_b32 v57, 0xffff0000, v76
    v_lshlrev_b32 v58, 16, v77
    v_and_b32 v59, 0xffff0000, v77
    v_lshlrev_b32 v60, 16, v78
    v_and_b32 v61, 0xffff0000, v78
    v_lshlrev_b32 v62, 16, v79
    v_and_b32 v63, 0xffff0000, v79
    s_cmp_gt_u32 s63, 0
    s_cbranch_scc1 L_lp_166_ok
L_lp_166:
    ds_read_b32 v5, v4
    s_waitcnt lgkmcnt(0)
    v_readfirstlane_b32 s63, v5
    s_nop 0
    s_cmp_gt_u32 s63, 0
    s_cbranch_scc0 L_lp_166
L_lp_166_ok:
    buffer_load_dwordx4 v[96:99], v10, s[8:11], s39 offen offset:0 sc1
    buffer_load_dwordx4 v[100:103], v10, s[8:11], s39 offen offset:1024 sc1
    buffer_load_dwordx4 v[104:107], v10, s[8:11], s39 offen offset:2048 sc1
    buffer_load_dwordx4 v[108:111], v10, s[8:11], s39 offen offset:3072 sc1
    s_add_u32 s39, s39, 4096
    s_cmp_gt_u32 s63, 1
    s_cbranch_scc1 L_lp_167_ok
L_lp_167:
    ds_read_b32 v5, v4
    s_waitcnt lgkmcnt(0)
    v_readfirstlane_b32 s63, v5
    s_nop 0
    s_cmp_gt_u32 s63, 1
    s_cbranch_scc0 L_lp_167
L_lp_167_ok:
    buffer_load_dwordx4 v[112:115], v10, s[8:11], s39 offen offset:0 sc1
    buffer_load_dwordx4 v[116:119], v10, s[8:11], s39 offen offset:1024 sc1
    buffer_load_dwordx4 v[120:123], v10, s[8:11], s39 offen offset:2048 sc1
    buffer_load_dwordx4 v[124:127], v10, s[8:11], s39 offen offset:3072 sc1
    s_add_u32 s39, s39, 4096
    ds_read_b64_tr_b16 v[64:65], v12 offset:0
    ds_read_b64_tr_b16 v[66:67], v12 offset:1024
    ds_read_b64_tr_b16 v[68:69], v13 offset:0
    ds_read_b64_tr_b16 v[70:71], v13 offset:1024
    ds_read_b64_tr_b16 v[72:73], v12 offset:2048
    ds_read_b64_tr_b16 v[74:75], v12 offset:3072
    ds_read_b64_tr_b16 v[76:77], v13 offset:2048
    ds_read_b64_tr_b16 v[78:79], v13 offset:3072
    s_waitcnt vmcnt(7) lgkmcnt(4)
    v_mfma_f32_32x32x16_bf16 v[32:47], v[64:67], v[96:99], v[32:47]
    ds_read_b64_tr_b16 v[80:81], v12 offset:4096
    ds_read_b64_tr_b16 v[82:83], v12 offset:5120
    v_mfma_f32_32x32x16_bf16 v[48:63], v[68:71], v[96:99], v[48:63]
    ds_read_b64_tr_b16 v[84:85], v13 offset:4096
    ds_read_b64_tr_b16 v[86:87], v13 offset:5120
    s_cmp_gt_u32 s63, 2
    s_cbranch_scc1 L_lp_168_ok
L_lp_168:
    ds_read_b32 v5, v4
    s_waitcnt lgkmcnt(0)
    v_readfirstlane_b32 s63, v5
    s_nop 0
    s_cmp_gt_u32 s63, 2
    s_cbranch_scc0 L_lp_168
L_lp_168_ok:
    buffer_load_dwordx4 v[128:131], v10, s[8:11], s39 offen offset:0 sc1
    buffer_load_dwordx4 v[132:135], v10, s[8:11], s39 offen offset:1024 sc1
    s_waitcnt vmcnt(8) lgkmcnt(4)
    v_mfma_f32_32x32x16_bf16 v[32:47], v[72:75], v[100:103], v[32:47]
    ds_read_b64_tr_b16 v[88:89], v12 offset:6144
    ds_read_b64_tr_b16 v[90:91], v12 offset:7168
    v_mfma_f32_32x32x16_bf16 v[48:63], v[76:79], v[100:103], v[48:63]
    ds_read_b64_tr_b16 v[92:93], v13 offset:6144
    ds_read_b64_tr_b16 v[94:95], v13 offset:7168
    buffer_load_dwordx4 v[136:139], v10, s[8:11], s39 offen offset:2048 sc1
    buffer_load_dwordx4 v[140:143], v10, s[8:11], s39 offen offset:3072 sc1
    s_add_u32 s39, s39, 4096
    s_waitcnt vmcnt(9) lgkmcnt(4)
    v_mfma_f32_32x32x16_bf16 v[32:47], v[80:83], v[104:107], v[32:47]
    ds_read_b64_tr_b16 v[64:65], v12 offset:8192
    ds_read_b64_tr_b16 v[66:67], v12 offset:9216
    v_mfma_f32_32x32x16_bf16 v[48:63], v[84:87], v[104:107], v[48:63]
    ds_read_b64_tr_b16 v[68:69], v13 offset:8192
    ds_read_b64_tr_b16 v[70:71], v13 offset:9216
    s_cmp_gt_u32 s63, 3
    s_cbranch_scc1 L_lp_169_ok
L_lp_169:
    ds_read_b32 v5, v4
    s_waitcnt lgkmcnt(0)
    v_readfirstlane_b32 s63, v5
    s_nop 0
    s_cmp_gt_u32 s63, 3
    s_cbranch_scc0 L_lp_169
L_lp_169_ok:
    buffer_load_dwordx4 v[144:147], v10, s[8:11], s39 offen offset:0 sc1
    buffer_load_dwordx4 v[148:151], v10, s[8:11], s39 offen offset:1024 sc1
    s_waitcnt vmcnt(10) lgkmcnt(4)
    v_mfma_f32_32x32x16_bf16 v[32:47], v[88:91], v[108:111], v[32:47]
    ds_read_b64_tr_b16 v[72:73], v12 offset:10240
    ds_read_b64_tr_b16 v[74:75], v12 offset:11264
    v_mfma_f32_32x32x16_bf16 v[48:63], v[92:95], v[108:111], v[48:63]
    ds_read_b64_tr_b16 v[76:77], v13 offset:10240
    ds_read_b64_tr_b16 v[78:79], v13 offset:11264
    buffer_load_dwordx4 v[152:155], v10, s[8:11], s39 offen offset:2048 sc1
    buffer_load_dwordx4 v[156:159], v10, s[8:11], s39 offen offset:3072 sc1
    s_add_u32 s39, s39, 4096
    s_waitcnt vmcnt(11) lgkmcnt(4)
    v_mfma_f32_32x32x16_bf16 v[32:47], v[64:67], v[112:115], v[32:47]
    ds_read_b64_tr_b16 v[80:81], v12 offset:12288
    ds_read_b64_tr_b16 v[82:83], v12 offset:13312
    v_mfma_f32_32x32x16_bf16 v[48:63], v[68:71], v[112:115], v[48:63]
    ds_read_b64_tr_b16 v[84:85], v13 offset:12288
    ds_read_b64_tr_b16 v[86:87], v13 offset:13312
    s_cmp_gt_u32 s63, 4
    s_cbranch_scc1 L_lp_170_ok
L_lp_170:
    ds_read_b32 v5, v4
    s_waitcnt lgkmcnt(0)
    v_readfirstlane_b32 s63, v5
    s_nop 0
    s_cmp_gt_u32 s63, 4
    s_cbranch_scc0 L_lp_170
L_lp_170_ok:
    buffer_load_dwordx4 v[160:163], v10, s[8:11], s39 offen offset:0 sc1
    buffer_load_dwordx4 v[164:167], v10, s[8:11], s39 offen offset:1024 sc1
    s_waitcnt vmcnt(12) lgkmcnt(4)
    v_mfma_f32_32x32x16_bf16 v[32:47], v[72:75], v[116:119], v[32:47]
    ds_read_b64_tr_b16 v[88:89], v12 offset:14336
    ds_read_b64_tr_b16 v[90:91], v12 offset:15360
    v_mfma_f32_32x32x16_bf16 v[48:63], v[76:79], v[116:119], v[48:63]
    ds_read_b64_tr_b16 v[92:93], v13 offset:14336
    ds_read_b64_tr_b16 v[94:95], v13 offset:15360
    buffer_load_dwordx4 v[168:171], v10, s[8:11], s39 offen offset:2048 sc1
    buffer_load_dwordx4 v[172:175], v10, s[8:11], s39 offen offset:3072 sc1
    s_add_u32 s39, s39, 4096
    s_waitcnt vmcnt(13) lgkmcnt(4)
    v_mfma_f32_32x32x16_bf16 v[32:47], v[80:83], v[120:123], v[32:47]
    ds_read_b64_tr_b16 v[64:65], v12 offset:16384
    ds_read_b64_tr_b16 v[66:67], v12 offset:17408
    v_mfma_f32_32x32x16_bf16 v[48:63], v[84:87], v[120:123], v[48:63]
    ds_read_b64_tr_b16 v[68:69], v13 offset:16384
    ds_read_b64_tr_b16 v[70:71], v13 offset:17408
    s_cmp_gt_u32 s63, 5
    s_cbranch_scc1 L_lp_171_ok
L_lp_171:
    ds_read_b32 v5, v4
    s_waitcnt lgkmcnt(0)
    v_readfirstlane_b32 s63, v5
    s_nop 0
    s_cmp_gt_u32 s63, 5
    s_cbranch_scc0 L_lp_171
L_lp_171_ok:
    buffer_load_dwordx4 v[176:179], v10, s[8:11], s39 offen offset:0 sc1
    buffer_load_dwordx4 v[180:183], v10, s[8:11], s39 offen offset:1024 sc1
    s_waitcnt vmcnt(14) lgkmcnt(4)
    v_mfma_f32_32x32x16_bf16 v[32:47], v[88:91], v[124:127], v[32:47]
    ds_read_b64_tr_b16 v[72:73], v12 offset:18432
    ds_read_b64_tr_b16 v[74:75], v12 offset:19456
    v_mfma_f32_32x32x16_bf16 v[48:63], v[92:95], v[124:127], v[48:63]
    ds_read_b64_tr_b16 v[76:77], v13 offset:18432
    ds_read_b64_tr_b16 v[78:79], v13 offset:19456
    buffer_load_dwordx4 v[184:187], v10, s[8:11], s39 offen offset:2048 sc1
    buffer_load_dwordx4 v[188:191], v10, s[8:11], s39 offen offset:3072 sc1
    s_add_u32 s39, s39, 4096
    s_waitcnt vmcnt(15) lgkmcnt(4)
    v_mfma_f32_32x32x16_bf16 v[32:47], v[64:67], v[128:131], v[32:47]
    ds_read_b64_tr_b16 v[80:81], v12 offset:20480
    ds_read_b64_tr_b16 v[82:83], v12 offset:21504
    v_mfma_f32_32x32x16_bf16 v[48:63], v[68:71], v[128:131], v[48:63]
    ds_read_b64_tr_b16 v[84:85], v13 offset:20480
    ds_read_b64_tr_b16 v[86:87], v13 offset:21504
    s_cmp_gt_u32 s63, 6
    s_cbranch_scc1 L_lp_172_ok
L_lp_172:
    ds_read_b32 v5, v4
    s_waitcnt lgkmcnt(0)
    v_readfirstlane_b32 s63, v5
    s_nop 0
    s_cmp_gt_u32 s63, 6
    s_cbranch_scc0 L_lp_172
L_lp_172_ok:
    buffer_load_dwordx4 v[192:195], v10, s[8:11], s39 offen offset:0 sc1
    buffer_load_dwordx4 v[196:199], v10, s[8:11], s39 offen offset:1024 sc1
    s_waitcnt vmcnt(16) lgkmcnt(4)
    v_mfma_f32_32x32x16_bf16 v[32:47], v[72:75], v[132:135], v[32:47]
    ds_read_b64_tr_b16 v[88:89], v12 offset:22528
    ds_read_b64_tr_b16 v[90:91], v12 offset:23552
    v_mfma_f32_32x32x16_bf16 v[48:63], v[76:79], v[132:135], v[48:63]
    ds_read_b64_tr_b16 v[92:93], v13 offset:22528
    ds_read_b64_tr_b16 v[94:95], v13 offset:23552
    buffer_load_dwordx4 v[200:203], v10, s[8:11], s39 offen offset:2048 sc1
    buffer_load_dwordx4 v[204:207], v10, s[8:11], s39 offen offset:3072 sc1
    s_add_u32 s39, s39, 4096
    s_waitcnt vmcnt(17) lgkmcnt(4)
    v_mfma_f32_32x32x16_bf16 v[32:47], v[80:83], v[136:139], v[32:47]
    ds_read_b64_tr_b16 v[64:65], v12 offset:24576
    ds_read_b64_tr_b16 v[66:67], v12 offset:25600
    v_mfma_f32_32x32x16_bf16 v[48:63], v[84:87], v[136:139], v[48:63]
    ds_read_b64_tr_b16 v[68:69], v13 offset:24576
    ds_read_b64_tr_b16 v[70:71], v13 offset:25600
    s_cmp_gt_u32 s63, 7
    s_cbranch_scc1 L_lp_173_ok
L_lp_173:
    ds_read_b32 v5, v4
    s_waitcnt lgkmcnt(0)
    v_readfirstlane_b32 s63, v5
    s_nop 0
    s_cmp_gt_u32 s63, 7
    s_cbranch_scc0 L_lp_173
L_lp_173_ok:
    buffer_load_dwordx4 v[208:211], v10, s[8:11], s39 offen offset:0 sc1
    buffer_load_dwordx4 v[212:215], v10, s[8:11], s39 offen offset:1024 sc1
    s_waitcnt vmcnt(18) lgkmcnt(4)
    v_mfma_f32_32x32x16_bf16 v[32:47], v[88:91], v[140:143], v[32:47]
    ds_read_b64_tr_b16 v[72:73], v12 offset:26624
    ds_read_b64_tr_b16 v[74:75], v12 offset:27648
    v_mfma_f32_32x32x16_bf16 v[48:63], v[92:95], v[140:143], v[48:63]
    ds_read_b64_tr_b16 v[76:77], v13 offset:26624
    ds_read_b64_tr_b16 v[78:79], v13 offset:27648
    buffer_load_dwordx4 v[216:219], v10, s[8:11], s39 offen offset:2048 sc1
    buffer_load_dwordx4 v[220:223], v10, s[8:11], s39 offen offset:3072 sc1
    s_add_u32 s39, s39, 4096
    s_waitcnt vmcnt(19) lgkmcnt(4)
    v_mfma_f32_32x32x16_bf16 v[32:47], v[64:67], v[144:147], v[32:47]
    ds_read_b64_tr_b16 v[80:81], v12 offset:28672
    ds_read_b64_tr_b16 v[82:83], v12 offset:29696
    v_mfma_f32_32x32x16_bf16 v[48:63], v[68:71], v[144:147], v[48:63]
    ds_read_b64_tr_b16 v[84:85], v13 offset:28672
    ds_read_b64_tr_b16 v[86:87], v13 offset:29696
    s_cmp_gt_u32 s63, 8
    s_cbranch_scc1 L_lp_174_ok
L_lp_174:
    ds_read_b32 v5, v4
    s_waitcnt lgkmcnt(0)
    v_readfirstlane_b32 s63, v5
    s_nop 0
    s_cmp_gt_u32 s63, 8
    s_cbranch_scc0 L_lp_174
L_lp_174_ok:
    buffer_load_dwordx4 v[96:99], v10, s[8:11], s39 offen offset:0 sc1
    s_waitcnt vmcnt(19) lgkmcnt(4)
    v_mfma_f32_32x32x16_bf16 v[32:47], v[72:75], v[148:151], v[32:47]
    ds_read_b64_tr_b16 v[88:89], v12 offset:30720
    ds_read_b64_tr_b16 v[90:91], v12 offset:31744
    v_mfma_f32_32x32x16_bf16 v[48:63], v[76:79], v[148:151], v[48:63]
    ds_read_b64_tr_b16 v[92:93], v13 offset:30720
    ds_read_b64_tr_b16 v[94:95], v13 offset:31744
    buffer_load_dwordx4 v[100:103], v10, s[8:11], s39 offen offset:1024 sc1
    s_waitcnt vmcnt(19) lgkmcnt(4)
    v_mfma_f32_32x32x16_bf16 v[32:47], v[80:83], v[152:155], v[32:47]
    ds_read_b64_tr_b16 v[64:65], v12 offset:32768
    ds_read_b64_tr_b16 v[66:67], v12 offset:33792
    v_mfma_f32_32x32x16_bf16 v[48:63], v[84:87], v[152:155], v[48:63]
    ds_read_b64_tr_b16 v[68:69], v13 offset:32768
    ds_read_b64_tr_b16 v[70:71], v13 offset:33792
    buffer_load_dwordx4 v[104:107], v10, s[8:11], s39 offen offset:2048 sc1
    s_waitcnt vmcnt(19) lgkmcnt(4)
    v_mfma_f32_32x32x16_bf16 v[32:47], v[88:91], v[156:159], v[32:47]
    ds_read_b64_tr_b16 v[72:73], v12 offset:34816
    ds_read_b64_tr_b16 v[74:75], v12 offset:35840
    v_mfma_f32_32x32x16_bf16 v[48:63], v[92:95], v[156:159], v[48:63]
    ds_read_b64_tr_b16 v[76:77], v13 offset:34816
    ds_read_b64_tr_b16 v[78:79], v13 offset:35840
    buffer_load_dwordx4 v[108:111], v10, s[8:11], s39 offen offset:3072 sc1
    s_add_u32 s39, s39, 4096
    s_waitcnt vmcnt(19) lgkmcnt(4)
    v_mfma_f32_32x32x16_bf16 v[32:47], v[64:67], v[160:163], v[32:47]
    ds_read_b64_tr_b16 v[80:81], v12 offset:36864
    ds_read_b64_tr_b16 v[82:83], v12 offset:37888
    v_mfma_f32_32x32x16_bf16 v[48:63], v[68:71], v[160:163], v[48:63]
    ds_read_b64_tr_b16 v[84:85], v13 offset:36864
    ds_read_b64_tr_b16 v[86:87], v13 offset:37888
    s_cmp_gt_u32 s63, 9
    s_cbranch_scc1 L_lp_175_ok
L_lp_175:
    ds_read_b32 v5, v4
    s_waitcnt lgkmcnt(0)
    v_readfirstlane_b32 s63, v5
    s_nop 0
    s_cmp_gt_u32 s63, 9
    s_cbranch_scc0 L_lp_175
L_lp_175_ok:
    buffer_load_dwordx4 v[112:115], v10, s[8:11], s39 offen offset:0 sc1
    s_waitcnt vmcnt(19) lgkmcnt(4)
    v_mfma_f32_32x32x16_bf16 v[32:47], v[72:75], v[164:167], v[32:47]
    ds_read_b64_tr_b16 v[88:89], v12 offset:38912
    ds_read_b64_tr_b16 v[90:91], v12 offset:39936
    v_mfma_f32_32x32x16_bf16 v[48:63], v[76:79], v[164:167], v[48:63]
    ds_read_b64_tr_b16 v[92:93], v13 offset:38912
    ds_read_b64_tr_b16 v[94:95], v13 offset:39936
    buffer_load_dwordx4 v[116:119], v10, s[8:11], s39 offen offset:1024 sc1
    s_waitcnt vmcnt(19) lgkmcnt(4)
    v_mfma_f32_32x32x16_bf16 v[32:47], v[80:83], v[168:171], v[32:47]
    ds_read_b64_tr_b16 v[64:65], v12 offset:40960
    ds_read_b64_tr_b16 v[66:67], v12 offset:41984
    v_mfma_f32_32x32x16_bf16 v[48:63], v[84:87], v[168:171], v[48:63]
    ds_read_b64_tr_b16 v[68:69], v13 offset:40960
    ds_read_b64_tr_b16 v[70:71], v13 offset:41984
    buffer_load_dwordx4 v[120:123], v10, s[8:11], s39 offen offset:2048 sc1
    s_waitcnt vmcnt(19) lgkmcnt(4)
    v_mfma_f32_32x32x16_bf16 v[32:47], v[88:91], v[172:175], v[32:47]
    ds_read_b64_tr_b16 v[72:73], v12 offset:43008
    ds_read_b64_tr_b16 v[74:75], v12 offset:44032
    v_mfma_f32_32x32x16_bf16 v[48:63], v[92:95], v[172:175], v[48:63]
    ds_read_b64_tr_b16 v[76:77], v13 offset:43008
    ds_read_b64_tr_b16 v[78:79], v13 offset:44032
    buffer_load_dwordx4 v[124:127], v10, s[8:11], s39 offen offset:3072 sc1
    s_add_u32 s39, s39, 4096
    s_waitcnt vmcnt(19) lgkmcnt(4)
    v_mfma_f32_32x32x16_bf16 v[32:47], v[64:67], v[176:179], v[32:47]
    ds_read_b64_tr_b16 v[80:81], v12 offset:45056
    ds_read_b64_tr_b16 v[82:83], v12 offset:46080
    v_mfma_f32_32x32x16_bf16 v[48:63], v[68:71], v[176:179], v[48:63]
    ds_read_b64_tr_b16 v[84:85], v13 offset:45056
    ds_read_b64_tr_b16 v[86:87], v13 offset:46080
    s_cmp_gt_u32 s63, 10
    s_cbranch_scc1 L_lp_176_ok
L_lp_176:
    ds_read_b32 v5, v4
    s_waitcnt lgkmcnt(0)
    v_readfirstlane_b32 s63, v5
    s_nop 0
    s_cmp_gt_u32 s63, 10
    s_cbranch_scc0 L_lp_176
L_lp_176_ok:
    buffer_load_dwordx4 v[128:131], v10, s[8:11], s39 offen offset:0 sc1
    s_waitcnt vmcnt(19) lgkmcnt(4)
    v_mfma_f32_32x32x16_bf16 v[32:47], v[72:75], v[180:183], v[32:47]
    ds_read_b64_tr_b16 v[88:89], v12 offset:47104
    ds_read_b64_tr_b16 v[90:91], v12 offset:48128
    v_mfma_f32_32x32x16_bf16 v[48:63], v[76:79], v[180:183], v[48:63]
    ds_read_b64_tr_b16 v[92:93], v13 offset:47104
    ds_read_b64_tr_b16 v[94:95], v13 offset:48128
    buffer_load_dwordx4 v[132:135], v10, s[8:11], s39 offen offset:1024 sc1
    s_waitcnt vmcnt(19) lgkmcnt(4)
    v_mfma_f32_32x32x16_bf16 v[32:47], v[80:83], v[184:187], v[32:47]
    ds_read_b64_tr_b16 v[64:65], v12 offset:49152
    ds_read_b64_tr_b16 v[66:67], v12 offset:50176
    v_mfma_f32_32x32x16_bf16 v[48:63], v[84:87], v[184:187], v[48:63]
    ds_read_b64_tr_b16 v[68:69], v13 offset:49152
    ds_read_b64_tr_b16 v[70:71], v13 offset:50176
    buffer_load_dwordx4 v[136:139], v10, s[8:11], s39 offen offset:2048 sc1
    s_waitcnt vmcnt(19) lgkmcnt(4)
    v_mfma_f32_32x32x16_bf16 v[32:47], v[88:91], v[188:191], v[32:47]
    ds_read_b64_tr_b16 v[72:73], v12 offset:51200
    ds_read_b64_tr_b16 v[74:75], v12 offset:52224
    v_mfma_f32_32x32x16_bf16 v[48:63], v[92:95], v[188:191], v[48:63]
    ds_read_b64_tr_b16 v[76:77], v13 offset:51200
    ds_read_b64_tr_b16 v[78:79], v13 offset:52224
    buffer_load_dwordx4 v[140:143], v10, s[8:11], s39 offen offset:3072 sc1
    s_add_u32 s39, s39, 4096
    s_waitcnt vmcnt(19) lgkmcnt(4)
    v_mfma_f32_32x32x16_bf16 v[32:47], v[64:67], v[192:195], v[32:47]
    ds_read_b64_tr_b16 v[80:81], v12 offset:53248
    ds_read_b64_tr_b16 v[82:83], v12 offset:54272
    v_mfma_f32_32x32x16_bf16 v[48:63], v[68:71], v[192:195], v[48:63]
    ds_read_b64_tr_b16 v[84:85], v13 offset:53248
    ds_read_b64_tr_b16 v[86:87], v13 offset:54272
    s_cmp_gt_u32 s63, 11
    s_cbranch_scc1 L_lp_177_ok
L_lp_177:
    ds_read_b32 v5, v4
    s_waitcnt lgkmcnt(0)
    v_readfirstlane_b32 s63, v5
    s_nop 0
    s_cmp_gt_u32 s63, 11
    s_cbranch_scc0 L_lp_177
L_lp_177_ok:
    buffer_load_dwordx4 v[144:147], v10, s[8:11], s39 offen offset:0 sc1
    s_waitcnt vmcnt(19) lgkmcnt(4)
    v_mfma_f32_32x32x16_bf16 v[32:47], v[72:75], v[196:199], v[32:47]
    ds_read_b64_tr_b16 v[88:89], v12 offset:55296
    ds_read_b64_tr_b16 v[90:91], v12 offset:56320
    v_mfma_f32_32x32x16_bf16 v[48:63], v[76:79], v[196:199], v[48:63]
    ds_read_b64_tr_b16 v[92:93], v13 offset:55296
    ds_read_b64_tr_b16 v[94:95], v13 offset:56320
    buffer_load_dwordx4 v[148:151], v10, s[8:11], s39 offen offset:1024 sc1
    s_waitcnt vmcnt(19) lgkmcnt(4)
    v_mfma_f32_32x32x16_bf16 v[32:47], v[80:83], v[200:203], v[32:47]
    ds_read_b64_tr_b16 v[64:65], v12 offset:57344
    ds_read_b64_tr_b16 v[66:67], v12 offset:58368
    v_mfma_f32_32x32x16_bf16 v[48:63], v[84:87], v[200:203], v[48:63]
    ds_read_b64_tr_b16 v[68:69], v13 offset:57344
    ds_read_b64_tr_b16 v[70:71], v13 offset:58368
    buffer_load_dwordx4 v[152:155], v10, s[8:11], s39 offen offset:2048 sc1
    s_waitcnt vmcnt(19) lgkmcnt(4)
    v_mfma_f32_32x32x16_bf16 v[32:47], v[88:91], v[204:207], v[32:47]
    ds_read_b64_tr_b16 v[72:73], v12 offset:59392
    ds_read_b64_tr_b16 v[74:75], v12 offset:60416
    v_mfma_f32_32x32x16_bf16 v[48:63], v[92:95], v[204:207], v[48:63]
    ds_read_b64_tr_b16 v[76:77], v13 offset:59392
    ds_read_b64_tr_b16 v[78:79], v13 offset:60416
    buffer_load_dwordx4 v[156:159], v10, s[8:11], s39 offen offset:3072 sc1
    s_add_u32 s39, s39, 4096
    s_waitcnt vmcnt(19) lgkmcnt(4)
    v_mfma_f32_32x32x16_bf16 v[32:47], v[64:67], v[208:211], v[32:47]
    ds_read_b64_tr_b16 v[80:81], v12 offset:61440
    ds_read_b64_tr_b16 v[82:83], v12 offset:62464
    v_mfma_f32_32x32x16_bf16 v[48:63], v[68:71], v[208:211], v[48:63]
    ds_read_b64_tr_b16 v[84:85], v13 offset:61440
    ds_read_b64_tr_b16 v[86:87], v13 offset:62464
    s_cmp_gt_u32 s63, 12
    s_cbranch_scc1 L_lp_178_ok
L_lp_178:
    ds_read_b32 v5, v4
    s_waitcnt lgkmcnt(0)
    v_readfirstlane_b32 s63, v5
    s_nop 0
    s_cmp_gt_u32 s63, 12
    s_cbranch_scc0 L_lp_178
L_lp_178_ok:
    buffer_load_dwordx4 v[160:163], v10, s[8:11], s39 offen offset:0 sc1
    s_waitcnt vmcnt(19) lgkmcnt(4)
    v_mfma_f32_32x32x16_bf16 v[32:47], v[72:75], v[212:215], v[32:47]
    ds_read_b64_tr_b16 v[88:89], v12 offset:63488
    ds_read_b64_tr_b16 v[90:91], v12 offset:64512
    v_mfma_f32_32x32x16_bf16 v[48:63], v[76:79], v[212:215], v[48:63]
    ds_read_b64_tr_b16 v[92:93], v13 offset:63488
    ds_read_b64_tr_b16 v[94:95], v13 offset:64512
    buffer_load_dwordx4 v[164:167], v10, s[8:11], s39 offen offset:1024 sc1
    s_waitcnt vmcnt(19) lgkmcnt(4)
    v_mfma_f32_32x32x16_bf16 v[32:47], v[80:83], v[216:219], v[32:47]
    ds_read_b64_tr_b16 v[64:65], v14 offset:0
    ds_read_b64_tr_b16 v[66:67], v14 offset:1024
    v_mfma_f32_32x32x16_bf16 v[48:63], v[84:87], v[216:219], v[48:63]
    ds_read_b64_tr_b16 v[68:69], v15 offset:0
    ds_read_b64_tr_b16 v[70:71], v15 offset:1024
    buffer_load_dwordx4 v[168:171], v10, s[8:11], s39 offen offset:2048 sc1
    s_waitcnt vmcnt(19) lgkmcnt(4)
    v_mfma_f32_32x32x16_bf16 v[32:47], v[88:91], v[220:223], v[32:47]
    ds_read_b64_tr_b16 v[72:73], v14 offset:2048
    ds_read_b64_tr_b16 v[74:75], v14 offset:3072
    v_mfma_f32_32x32x16_bf16 v[48:63], v[92:95], v[220:223], v[48:63]
    ds_read_b64_tr_b16 v[76:77], v15 offset:2048
    ds_read_b64_tr_b16 v[78:79], v15 offset:3072
    buffer_load_dwordx4 v[172:175], v10, s[8:11], s39 offen offset:3072 sc1
    s_add_u32 s39, s39, 4096
    s_waitcnt vmcnt(19) lgkmcnt(4)
    v_mfma_f32_32x32x16_bf16 v[32:47], v[64:67], v[96:99], v[32:47]
    ds_read_b64_tr_b16 v[80:81], v14 offset:4096
    ds_read_b64_tr_b16 v[82:83], v14 offset:5120
    v_mfma_f32_32x32x16_bf16 v[48:63], v[68:71], v[96:99], v[48:63]
    ds_read_b64_tr_b16 v[84:85], v15 offset:4096
    ds_read_b64_tr_b16 v[86:87], v15 offset:5120
    s_cmp_gt_u32 s63, 13
    s_cbranch_scc1 L_lp_179_ok
L_lp_179:
    ds_read_b32 v5, v4
    s_waitcnt lgkmcnt(0)
    v_readfirstlane_b32 s63, v5
    s_nop 0
    s_cmp_gt_u32 s63, 13
    s_cbranch_scc0 L_lp_179
L_lp_179_ok:
    buffer_load_dwordx4 v[176:179], v10, s[8:11], s39 offen offset:0 sc1
    s_waitcnt vmcnt(19) lgkmcnt(4)
    v_mfma_f32_32x32x16_bf16 v[32:47], v[72:75], v[100:103], v[32:47]
    ds_read_b64_tr_b16 v[88:89], v14 offset:6144
    ds_read_b64_tr_b16 v[90:91], v14 offset:7168
    v_mfma_f32_32x32x16_bf16 v[48:63], v[76:79], v[100:103], v[48:63]
    ds_read_b64_tr_b16 v[92:93], v15 offset:6144
    ds_read_b64_tr_b16 v[94:95], v15 offset:7168
    buffer_load_dwordx4 v[180:183], v10, s[8:11], s39 offen offset:1024 sc1
    s_waitcnt vmcnt(19) lgkmcnt(4)
    v_mfma_f32_32x32x16_bf16 v[32:47], v[80:83], v[104:107], v[32:47]
    ds_read_b64_tr_b16 v[64:65], v14 offset:8192
    ds_read_b64_tr_b16 v[66:67], v14 offset:9216
    v_mfma_f32_32x32x16_bf16 v[48:63], v[84:87], v[104:107], v[48:63]
    ds_read_b64_tr_b16 v[68:69], v15 offset:8192
    ds_read_b64_tr_b16 v[70:71], v15 offset:9216
    buffer_load_dwordx4 v[184:187], v10, s[8:11], s39 offen offset:2048 sc1
    s_waitcnt vmcnt(19) lgkmcnt(4)
    v_mfma_f32_32x32x16_bf16 v[32:47], v[88:91], v[108:111], v[32:47]
    ds_read_b64_tr_b16 v[72:73], v14 offset:10240
    ds_read_b64_tr_b16 v[74:75], v14 offset:11264
    v_mfma_f32_32x32x16_bf16 v[48:63], v[92:95], v[108:111], v[48:63]
    ds_read_b64_tr_b16 v[76:77], v15 offset:10240
    ds_read_b64_tr_b16 v[78:79], v15 offset:11264
    buffer_load_dwordx4 v[188:191], v10, s[8:11], s39 offen offset:3072 sc1
    s_add_u32 s39, s39, 4096
    s_waitcnt vmcnt(19) lgkmcnt(4)
    v_mfma_f32_32x32x16_bf16 v[32:47], v[64:67], v[112:115], v[32:47]
    ds_read_b64_tr_b16 v[80:81], v14 offset:12288
    ds_read_b64_tr_b16 v[82:83], v14 offset:13312
    v_mfma_f32_32x32x16_bf16 v[48:63], v[68:71], v[112:115], v[48:63]
    ds_read_b64_tr_b16 v[84:85], v15 offset:12288
    ds_read_b64_tr_b16 v[86:87], v15 offset:13312
    s_cmp_gt_u32 s63, 14
    s_cbranch_scc1 L_lp_180_ok
L_lp_180:
    ds_read_b32 v5, v4
    s_waitcnt lgkmcnt(0)
    v_readfirstlane_b32 s63, v5
    s_nop 0
    s_cmp_gt_u32 s63, 14
    s_cbranch_scc0 L_lp_180
L_lp_180_ok:
    buffer_load_dwordx4 v[192:195], v10, s[8:11], s39 offen offset:0 sc1
    s_waitcnt vmcnt(19) lgkmcnt(4)
    v_mfma_f32_32x32x16_bf16 v[32:47], v[72:75], v[116:119], v[32:47]
    ds_read_b64_tr_b16 v[88:89], v14 offset:14336
    ds_read_b64_tr_b16 v[90:91], v14 offset:15360
    v_mfma_f32_32x32x16_bf16 v[48:63], v[76:79], v[116:119], v[48:63]
    ds_read_b64_tr_b16 v[92:93], v15 offset:14336
    ds_read_b64_tr_b16 v[94:95], v15 offset:15360
    buffer_load_dwordx4 v[196:199], v10, s[8:11], s39 offen offset:1024 sc1
    s_waitcnt vmcnt(19) lgkmcnt(4)
    v_mfma_f32_32x32x16_bf16 v[32:47], v[80:83], v[120:123], v[32:47]
    ds_read_b64_tr_b16 v[64:65], v14 offset:16384
    ds_read_b64_tr_b16 v[66:67], v14 offset:17408
    v_mfma_f32_32x32x16_bf16 v[48:63], v[84:87], v[120:123], v[48:63]
    ds_read_b64_tr_b16 v[68:69], v15 offset:16384
    ds_read_b64_tr_b16 v[70:71], v15 offset:17408
    buffer_load_dwordx4 v[200:203], v10, s[8:11], s39 offen offset:2048 sc1
    s_waitcnt vmcnt(19) lgkmcnt(4)
    v_mfma_f32_32x32x16_bf16 v[32:47], v[88:91], v[124:127], v[32:47]
    ds_read_b64_tr_b16 v[72:73], v14 offset:18432
    ds_read_b64_tr_b16 v[74:75], v14 offset:19456
    v_mfma_f32_32x32x16_bf16 v[48:63], v[92:95], v[124:127], v[48:63]
    ds_read_b64_tr_b16 v[76:77], v15 offset:18432
    ds_read_b64_tr_b16 v[78:79], v15 offset:19456
    buffer_load_dwordx4 v[204:207], v10, s[8:11], s39 offen offset:3072 sc1
    s_add_u32 s39, s39, 4096
    s_waitcnt vmcnt(19) lgkmcnt(4)
    v_mfma_f32_32x32x16_bf16 v[32:47], v[64:67], v[128:131], v[32:47]
    ds_read_b64_tr_b16 v[80:81], v14 offset:20480
    ds_read_b64_tr_b16 v[82:83], v14 offset:21504
    v_mfma_f32_32x32x16_bf16 v[48:63], v[68:71], v[128:131], v[48:63]
    ds_read_b64_tr_b16 v[84:85], v15 offset:20480
    ds_read_b64_tr_b16 v[86:87], v15 offset:21504
    s_cmp_gt_u32 s63, 15
    s_cbranch_scc1 L_lp_181_ok
L_lp_181:
    ds_read_b32 v5, v4
    s_waitcnt lgkmcnt(0)
    v_readfirstlane_b32 s63, v5
    s_nop 0
    s_cmp_gt_u32 s63, 15
    s_cbranch_scc0 L_lp_181
L_lp_181_ok:
    buffer_load_dwordx4 v[208:211], v10, s[8:11], s39 offen offset:0 sc1
    s_waitcnt vmcnt(19) lgkmcnt(4)
    v_mfma_f32_32x32x16_bf16 v[32:47], v[72:75], v[132:135], v[32:47]
    ds_read_b64_tr_b16 v[88:89], v14 offset:22528
    ds_read_b64_tr_b16 v[90:91], v14 offset:23552
    v_mfma_f32_32x32x16_bf16 v[48:63], v[76:79], v[132:135], v[48:63]
    ds_read_b64_tr_b16 v[92:93], v15 offset:22528
    ds_read_b64_tr_b16 v[94:95], v15 offset:23552
    buffer_load_dwordx4 v[212:215], v10, s[8:11], s39 offen offset:1024 sc1
    s_waitcnt vmcnt(19) lgkmcnt(4)
    v_mfma_f32_32x32x16_bf16 v[32:47], v[80:83], v[136:139], v[32:47]
    ds_read_b64_tr_b16 v[64:65], v14 offset:24576
    ds_read_b64_tr_b16 v[66:67], v14 offset:25600
    v_mfma_f32_32x32x16_bf16 v[48:63], v[84:87], v[136:139], v[48:63]
    ds_read_b64_tr_b16 v[68:69], v15 offset:24576
    ds_read_b64_tr_b16 v[70:71], v15 offset:25600
    buffer_load_dwordx4 v[216:219], v10, s[8:11], s39 offen offset:2048 sc1
    s_waitcnt vmcnt(19) lgkmcnt(4)
    v_mfma_f32_32x32x16_bf16 v[32:47], v[88:91], v[140:143], v[32:47]
    ds_read_b64_tr_b16 v[72:73], v14 offset:26624
    ds_read_b64_tr_b16 v[74:75], v14 offset:27648
    v_mfma_f32_32x32x16_bf16 v[48:63], v[92:95], v[140:143], v[48:63]
    ds_read_b64_tr_b16 v[76:77], v15 offset:26624
    ds_read_b64_tr_b16 v[78:79], v15 offset:27648
    buffer_load_dwordx4 v[220:223], v10, s[8:11], s39 offen offset:3072 sc1
    s_waitcnt vmcnt(19) lgkmcnt(4)
    v_mfma_f32_32x32x16_bf16 v[32:47], v[64:67], v[144:147], v[32:47]
    ds_read_b64_tr_b16 v[80:81], v14 offset:28672
    ds_read_b64_tr_b16 v[82:83], v14 offset:29696
    v_mfma_f32_32x32x16_bf16 v[48:63], v[68:71], v[144:147], v[48:63]
    ds_read_b64_tr_b16 v[84:85], v15 offset:28672
    ds_read_b64_tr_b16 v[86:87], v15 offset:29696
    s_waitcnt vmcnt(18) lgkmcnt(4)
    v_mfma_f32_32x32x16_bf16 v[32:47], v[72:75], v[148:151], v[32:47]
    ds_read_b64_tr_b16 v[88:89], v14 offset:30720
    ds_read_b64_tr_b16 v[90:91], v14 offset:31744
    v_mfma_f32_32x32x16_bf16 v[48:63], v[76:79], v[148:151], v[48:63]
    ds_read_b64_tr_b16 v[92:93], v15 offset:30720
    ds_read_b64_tr_b16 v[94:95], v15 offset:31744
    s_waitcnt vmcnt(17) lgkmcnt(4)
    v_mfma_f32_32x32x16_bf16 v[32:47], v[80:83], v[152:155], v[32:47]
    ds_read_b64_tr_b16 v[64:65], v16 offset:0
    ds_read_b64_tr_b16 v[66:67], v16 offset:1024
    v_mfma_f32_32x32x16_bf16 v[48:63], v[84:87], v[152:155], v[48:63]
    ds_read_b64_tr_b16 v[68:69], v17 offset:0
    ds_read_b64_tr_b16 v[70:71], v17 offset:1024
    s_waitcnt vmcnt(16) lgkmcnt(4)
    v_mfma_f32_32x32x16_bf16 v[32:47], v[88:91], v[156:159], v[32:47]
    ds_read_b64_tr_b16 v[72:73], v16 offset:2048
    ds_read_b64_tr_b16 v[74:75], v16 offset:3072
    v_mfma_f32_32x32x16_bf16 v[48:63], v[92:95], v[156:159], v[48:63]
    ds_read_b64_tr_b16 v[76:77], v17 offset:2048
    ds_read_b64_tr_b16 v[78:79], v17 offset:3072
    s_waitcnt vmcnt(15) lgkmcnt(4)
    v_mfma_f32_32x32x16_bf16 v[32:47], v[64:67], v[160:163], v[32:47]
    ds_read_b64_tr_b16 v[80:81], v16 offset:4096
    ds_read_b64_tr_b16 v[82:83], v16 offset:5120
    s_add_u32 s37, s36, 0x400000
    s_mov_b32 s35, 0x3f803f80
    v_mfma_f32_32x32x16_bf16 v[48:63], v[68:71], v[160:163], v[48:63]
    ds_read_b64_tr_b16 v[84:85], v17 offset:4096
    ds_read_b64_tr_b16 v[86:87], v17 offset:5120
    v_mov_b32 v24, 0
    v_mov_b32 v25, 0
    s_waitcnt vmcnt(14) lgkmcnt(4)
    v_mfma_f32_32x32x16_bf16 v[32:47], v[72:75], v[164:167], v[32:47]
    ds_read_b64_tr_b16 v[88:89], v16 offset:6144
    ds_read_b64_tr_b16 v[90:91], v16 offset:7168
    s_lshl_b32 s38, s4, 14
    s_lshl_b32 s31, s5, 10
    v_mfma_f32_32x32x16_bf16 v[48:63], v[76:79], v[164:167], v[48:63]
    ds_read_b64_tr_b16 v[92:93], v17 offset:6144
    ds_read_b64_tr_b16 v[94:95], v17 offset:7168
    s_add_u32 s38, s38, s31
    s_lshl_b32 s31, s3, 8
    s_waitcnt vmcnt(13) lgkmcnt(4)
    v_mfma_f32_32x32x16_bf16 v[32:47], v[80:83], v[168:171], v[32:47]
    ds_read_b64_tr_b16 v[64:65], v16 offset:8192
    ds_read_b64_tr_b16 v[66:67], v16 offset:9216
    s_add_u32 s38, s38, s31
    s_add_u32 s38, s38, 0x2680000
    v_mfma_f32_32x32x16_bf16 v[48:63], v[84:87], v[168:171], v[48:63]
    ds_read_b64_tr_b16 v[68:69], v17 offset:8192
    ds_read_b64_tr_b16 v[70:71], v17 offset:9216
    v_lshlrev_b32 v9, 2, v1
    s_waitcnt vmcnt(12) lgkmcnt(4)
    v_mfma_f32_32x32x16_bf16 v[32:47], v[88:91], v[172:175], v[32:47]
    ds_read_b64_tr_b16 v[72:73], v16 offset:10240
    ds_read_b64_tr_b16 v[74:75], v16 offset:11264
    v_mfma_f32_32x32x16_bf16 v[48:63], v[92:95], v[172:175], v[48:63]
    ds_read_b64_tr_b16 v[76:77], v17 offset:10240
    ds_read_b64_tr_b16 v[78:79], v17 offset:11264
    s_waitcnt vmcnt(11) lgkmcnt(4)
    v_mfma_f32_32x32x16_bf16 v[32:47], v[64:67], v[176:179], v[32:47]
    ds_read_b64_tr_b16 v[80:81], v16 offset:12288
    ds_read_b64_tr_b16 v[82:83], v16 offset:13312
    v_mfma_f32_32x32x16_bf16 v[48:63], v[68:71], v[176:179], v[48:63]
    ds_read_b64_tr_b16 v[84:85], v17 offset:12288
    ds_read_b64_tr_b16 v[86:87], v17 offset:13312
    s_waitcnt vmcnt(10) lgkmcnt(4)
    v_mfma_f32_32x32x16_bf16 v[32:47], v[72:75], v[180:183], v[32:47]
    ds_read_b64_tr_b16 v[88:89], v16 offset:14336
    ds_read_b64_tr_b16 v[90:91], v16 offset:15360
    v_mfma_f32_32x32x16_bf16 v[48:63], v[76:79], v[180:183], v[48:63]
    ds_read_b64_tr_b16 v[92:93], v17 offset:14336
    ds_read_b64_tr_b16 v[94:95], v17 offset:15360
    s_waitcnt vmcnt(9) lgkmcnt(4)
    v_mfma_f32_32x32x16_bf16 v[32:47], v[80:83], v[184:187], v[32:47]
    ds_read_b64_tr_b16 v[64:65], v16 offset:16384
    ds_read_b64_tr_b16 v[66:67], v16 offset:17408
    v_mfma_f32_32x32x16_bf16 v[48:63], v[84:87], v[184:187], v[48:63]
    ds_read_b64_tr_b16 v[68:69], v17 offset:16384
    ds_read_b64_tr_b16 v[70:71], v17 offset:17408
    s_waitcnt vmcnt(8) lgkmcnt(4)
    v_mfma_f32_32x32x16_bf16 v[32:47], v[88:91], v[188:191], v[32:47]
    ds_read_b64_tr_b16 v[72:73], v16 offset:18432
    ds_read_b64_tr_b16 v[74:75], v16 offset:19456
    v_mfma_f32_32x32x16_bf16 v[48:63], v[92:95], v[188:191], v[48:63]
    ds_read_b64_tr_b16 v[76:77], v17 offset:18432
    ds_read_b64_tr_b16 v[78:79], v17 offset:19456
    s_waitcnt vmcnt(7) lgkmcnt(4)
    v_mfma_f32_32x32x16_bf16 v[32:47], v[64:67], v[192:195], v[32:47]
    ds_read_b64_tr_b16 v[80:81], v16 offset:20480
    ds_read_b64_tr_b16 v[82:83], v16 offset:21504
    v_mfma_f32_32x32x16_bf16 v[48:63], v[68:71], v[192:195], v[48:63]
    ds_read_b64_tr_b16 v[84:85], v17 offset:20480
    ds_read_b64_tr_b16 v[86:87], v17 offset:21504
    s_waitcnt vmcnt(6) lgkmcnt(4)
    v_mfma_f32_32x32x16_bf16 v[32:47], v[72:75], v[196:199], v[32:47]
    ds_read_b64_tr_b16 v[88:89], v16 offset:22528
    ds_read_b64_tr_b16 v[90:91], v16 offset:23552
    v_mfma_f32_32x32x16_bf16 v[48:63], v[76:79], v[196:199], v[48:63]
    ds_read_b64_tr_b16 v[92:93], v17 offset:22528
    ds_read_b64_tr_b16 v[94:95], v17 offset:23552
    s_waitcnt vmcnt(5) lgkmcnt(4)
    v_mfma_f32_32x32x16_bf16 v[32:47], v[80:83], v[200:203], v[32:47]
    s_barrier
    ds_read_b64_tr_b16 v[64:65], v14 offset:32768
    ds_read_b64_tr_b16 v[66:67], v14 offset:33792
    v_mfma_f32_32x32x16_bf16 v[48:63], v[84:87], v[200:203], v[48:63]
    ds_read_b64_tr_b16 v[68:69], v15 offset:32768
    ds_read_b64_tr_b16 v[70:71], v15 offset:33792
    s_waitcnt vmcnt(4) lgkmcnt(4)
    v_mfma_f32_32x32x16_bf16 v[32:47], v[88:91], v[204:207], v[32:47]
    ds_read_b64_tr_b16 v[72:73], v14 offset:34816
    ds_read_b64_tr_b16 v[74:75], v14 offset:35840
    v_mfma_f32_32x32x16_bf16 v[48:63], v[92:95], v[204:207], v[48:63]
    ds_read_b64_tr_b16 v[76:77], v15 offset:34816
    ds_read_b64_tr_b16 v[78:79], v15 offset:35840
    s_waitcnt vmcnt(3) lgkmcnt(4)
    v_mfma_f32_32x32x16_bf16 v[32:47], v[64:67], v[208:211], v[32:47]
    ds_read_b64_tr_b16 v[80:81], v14 offset:36864
    ds_read_b64_tr_b16 v[82:83], v14 offset:37888
    v_mfma_f32_32x32x16_bf16 v[48:63], v[68:71], v[208:211], v[48:63]
    ds_read_b64_tr_b16 v[84:85], v15 offset:36864
    ds_read_b64_tr_b16 v[86:87], v15 offset:37888
    s_waitcnt vmcnt(2) lgkmcnt(4)
    v_mfma_f32_32x32x16_bf16 v[32:47], v[72:75], v[212:215], v[32:47]
    ds_read_b64_tr_b16 v[88:89], v14 offset:38912
    ds_read_b64_tr_b16 v[90:91], v14 offset:39936
    v_mfma_f32_32x32x16_bf16 v[48:63], v[76:79], v[212:215], v[48:63]
    ds_read_b64_tr_b16 v[92:93], v15 offset:38912
    ds_read_b64_tr_b16 v[94:95], v15 offset:39936
    s_waitcnt vmcnt(1) lgkmcnt(4)
    v_mfma_f32_32x32x16_bf16 v[32:47], v[80:83], v[216:219], v[32:47]
    v_mfma_f32_32x32x16_bf16 v[48:63], v[84:87], v[216:219], v[48:63]
    s_waitcnt vmcnt(0) lgkmcnt(0)
    v_mfma_f32_32x32x16_bf16 v[32:47], v[88:91], v[220:223], v[32:47]
    s_barrier
    v_mfma_f32_32x32x16_bf16 v[48:63], v[92:95], v[220:223], v[48:63]
    s_nop 9
    v_cvt_pk_bf16_f32 v96, v32, v33
    v_cvt_pk_bf16_f32 v97, v34, v35
    v_cvt_pk_bf16_f32 v98, v36, v37
    v_cvt_pk_bf16_f32 v99, v38, v39
    buffer_store_dwordx4 v[96:99], v10, s[16:19], s37 offen offset:0 sc1
    v_cvt_pk_bf16_f32 v100, v40, v41
    v_cvt_pk_bf16_f32 v101, v42, v43
    v_cvt_pk_bf16_f32 v102, v44, v45
    v_cvt_pk_bf16_f32 v103, v46, v47
    buffer_store_dwordx4 v[100:103], v10, s[16:19], s37 offen offset:1024 sc1
    v_cvt_pk_bf16_f32 v104, v48, v49
    v_cvt_pk_bf16_f32 v105, v50, v51
    v_cvt_pk_bf16_f32 v106, v52, v53
    v_cvt_pk_bf16_f32 v107, v54, v55
    buffer_store_dwordx4 v[104:107], v10, s[16:19], s37 offen offset:2048 sc1
    v_cvt_pk_bf16_f32 v108, v56, v57
    v_cvt_pk_bf16_f32 v109, v58, v59
    v_cvt_pk_bf16_f32 v110, v60, v61
    v_cvt_pk_bf16_f32 v111, v62, v63
    buffer_store_dwordx4 v[108:111], v10, s[16:19], s37 offen offset:3072 sc1
    v_dot2_f32_bf16 v24, v96, s35, v24
    v_dot2_f32_bf16 v25, v96, v96, v25
    v_dot2_f32_bf16 v24, v97, s35, v24
    v_dot2_f32_bf16 v25, v97, v97, v25
    v_dot2_f32_bf16 v24, v98, s35, v24
    v_dot2_f32_bf16 v25, v98, v98, v25
    v_dot2_f32_bf16 v24, v99, s35, v24
    v_dot2_f32_bf16 v25, v99, v99, v25
    v_dot2_f32_bf16 v24, v100, s35, v24
    v_dot2_f32_bf16 v25, v100, v100, v25
    v_dot2_f32_bf16 v24, v101, s35, v24
    v_dot2_f32_bf16 v25, v101, v101, v25
    v_dot2_f32_bf16 v24, v102, s35, v24
    v_dot2_f32_bf16 v25, v102, v102, v25
    v_dot2_f32_bf16 v24, v103, s35, v24
    v_dot2_f32_bf16 v25, v103, v103, v25
    v_dot2_f32_bf16 v24, v104, s35, v24
    v_dot2_f32_bf16 v25, v104, v104, v25
    v_dot2_f32_bf16 v24, v105, s35, v24
    v_dot2_f32_bf16 v25, v105, v105, v25
    v_dot2_f32_bf16 v24, v106, s35, v24
    v_dot2_f32_bf16 v25, v106, v106, v25
    v_dot2_f32_bf16 v24, v107, s35, v24
    v_dot2_f32_bf16 v25, v107, v107, v25
    v_dot2_f32_bf16 v24, v108, s35, v24
    v_dot2_f32_bf16 v25, v108, v108, v25
    v_dot2_f32_bf16 v24, v109, s35, v24
    v_dot2_f32_bf16 v25, v109, v109, v25
    v_dot2_f32_bf16 v24, v110, s35, v24
    v_dot2_f32_bf16 v25, v110, v110, v25
    v_dot2_f32_bf16 v24, v111, s35, v24
    v_dot2_f32_bf16 v25, v111, v111, v25
    s_nop 2
    v_permlane32_swap_b32 v24, v25
    v_add_f32 v24, v24, v25
    buffer_store_dword v24, v9, s[16:19], s38 offen sc1
    s_waitcnt vmcnt(0)
    s_lshl_b32 s34, s4, 8
    s_add_u32 s34, s34, 0x2805000
    v_mov_b32 v4, 1
    v_mov_b32 v5, 0
    s_mov_b64 exec, 1
    v_mov_b32 v6, 163808
    ds_add_rtn_u32 v7, v6, v4
    s_waitcnt lgkmcnt(0)
    v_readfirstlane_b32 s35, v7
    s_nop 0
    s_cmp_eq_u32 s35, 3
    s_cbranch_scc0 L_sig_182
    s_lshl_b32 s35, s5, 2
    s_add_u32 s34, s34, s35
    buffer_store_dword v4, v5, s[16:19], s34 offen sc1
L_sig_182:
    s_mov_b64 exec, -1
    s_branch L_wb0_end_165
L_wb0_ld_164:
    s_sub_u32 s30, s3, 4
    v_lshrrev_b32 v6, 3, v1
    v_and_b32 v7, 7, v1
    s_lshl_b32 s31, s30, 4
    v_lshrrev_b32 v5, 1, v6
    v_and_b32 v5, 1, v5
    v_lshlrev_b32 v5, 2, v5
    v_xor_b32 v5, v5, v7
    v_lshlrev_b32 v5, 4, v5
    s_lshl_b32 s32, s5, 7
    v_add_u32 v5, s32, v5
    v_add_u32 v4, s31, v6
    v_lshl_add_u32 v12, v4, 11, v5
    v_add_u32 v13, 15360, v12
    v_lshlrev_b32 v8, 4, v1
    s_lshl_b32 s35, s30, 11
    s_add_u32 m0, s35, 98304
    s_mov_b32 s38, 1966080
    buffer_load_dwordx4 v12, s[12:15], s38 offen offset:0 lds
    buffer_load_dwordx4 v13, s[12:15], s38 offen offset:1024 lds
    s_barrier
    s_cmp_lg_u32 s3, 7
    s_cbranch_scc1 L_rp_183_ok
    v_and_b32 v4, 15, v1
    v_lshlrev_b32 v4, 2, v4
    s_lshl_b32 s52, s4, 8
    s_add_u32 s52, s52, 0x2804000
    s_mov_b32 s53, 0
    v_mov_b32 v6, 163812
L_rp_183:
    buffer_load_dword v5, v4, s[16:19], s52 offen sc1
    s_waitcnt vmcnt(0)
    v_cmp_ne_u32 vcc, 1, v5
    s_nop 0
    s_or_b32 s63, vcc_lo, 0x10000
    s_ff1_i32_b32 s63, s63
    s_add_u32 s53, s53, 1
    s_cmp_lt_u32 s53, 0x40000
    s_cselect_b32 s63, s63, 16
    v_mov_b32 v7, s63
    ds_write_b32 v6, v7
    s_cmp_lt_u32 s63, 16
    s_cbranch_scc1 L_rp_183
L_rp_183_ok:
    s_waitcnt vmcnt(0)
    s_barrier
    s_barrier
L_wb0_end_165:
    s_and_b32 s6, s2, 7
    s_lshr_b32 s7, s2, 3
    s_lshr_b32 s4, s6, 2
    s_lshl_b32 s4, s4, 3
    s_lshr_b32 s5, s7, 2
    s_add_u32 s4, s4, s5
    s_and_b32 s5, s6, 3
    s_lshl_b32 s5, s5, 2
    s_and_b32 s7, s7, 3
    s_add_u32 s5, s5, s7
    s_add_u32 s8, s86, 0x400000
    s_addc_u32 s9, s87, 0
    s_and_b32 s9, s9, 0xffff
    s_mov_b32 s10, 0x400000
    s_mov_b32 s11, 0x20000
    s_mov_b32 s12, s66
    s_and_b32 s13, s67, 0xffff
    s_mov_b32 s14, 0x600000
    s_mov_b32 s15, 0x20000
    s_mov_b32 s20, s68
    s_and_b32 s21, s69, 0xffff
    s_mov_b32 s22, 0x10000
    s_mov_b32 s23, 0x20000
    s_bfe_u32 s48, s3, 0x10001
    s_and_b32 s49, s3, 1
    s_lshl_b32 s50, s5, 1
    s_add_u32 s50, s50, s49
    s_lshl_b32 s51, s48, 1
    s_lshr_b32 s31, s3, 2
    s_add_u32 s51, s51, s31
    s_cmp_ge_u32 s3, 4
    s_cbranch_scc1 L_qa1_ld_184
    v_lshlrev_b32 v10, 1, v2
    v_lshl_add_u32 v10, v3, 8, v10
    s_lshl_b32 s34, s50, 11
    buffer_load_ushort v220, v10, s[20:23], s34 offen offset:0
    buffer_load_ushort v221, v10, s[20:23], s34 offen offset:64
    buffer_load_ushort v222, v10, s[20:23], s34 offen offset:128
    buffer_load_ushort v223, v10, s[20:23], s34 offen offset:192
    buffer_load_ushort v224, v10, s[20:23], s34 offen offset:512
    buffer_load_ushort v225, v10, s[20:23], s34 offen offset:576
    buffer_load_ushort v226, v10, s[20:23], s34 offen offset:640
    buffer_load_ushort v227, v10, s[20:23], s34 offen offset:704
    buffer_load_ushort v228, v10, s[20:23], s34 offen offset:1024
    buffer_load_ushort v229, v10, s[20:23], s34 offen offset:1088
    buffer_load_ushort v230, v10, s[20:23], s34 offen offset:1152
    buffer_load_ushort v231, v10, s[20:23], s34 offen offset:1216
    buffer_load_ushort v232, v10, s[20:23], s34 offen offset:1536
    buffer_load_ushort v233, v10, s[20:23], s34 offen offset:1600
    buffer_load_ushort v234, v10, s[20:23], s34 offen offset:1664
    buffer_load_ushort v235, v10, s[20:23], s34 offen offset:1728
    v_lshlrev_b32 v12, 4, v1
    s_lshl_b32 s35, s48, 13
    v_add_u32 v12, s35, v12
    s_lshl_b32 s35, s49, 6
    v_and_b32 v4, 15, v1
    v_lshrrev_b32 v5, 2, v4
    v_lshl_add_u32 v5, v3, 2, v5
    v_mul_u32_u24 v5, 128, v5
    v_and_b32 v6, 3, v4
    v_lshlrev_b32 v6, 3, v6
    v_bfe_u32 v7, v1, 4, 1
    v_lshl_add_u32 v6, v7, 5, v6
    v_add_u32 v6, s35, v6
    v_bfe_u32 v7, v1, 3, 1
    v_lshlrev_b32 v7, 6, v7
    v_xor_b32 v6, v6, v7
    v_add_u32 v13, v5, v6
    v_mov_b32 v32, 0
    v_mov_b32 v33, 0
    v_mov_b32 v34, 0
    v_mov_b32 v35, 0
    v_mov_b32 v36, 0
    v_mov_b32 v37, 0
    v_mov_b32 v38, 0
    v_mov_b32 v39, 0
    v_mov_b32 v40, 0
    v_mov_b32 v41, 0
    v_mov_b32 v42, 0
    v_mov_b32 v43, 0
    v_mov_b32 v44, 0
    v_mov_b32 v45, 0
    v_mov_b32 v46, 0
    v_mov_b32 v47, 0
    v_mov_b32 v48, 0
    v_mov_b32 v49, 0
    v_mov_b32 v50, 0
    v_mov_b32 v51, 0
    v_mov_b32 v52, 0
    v_mov_b32 v53, 0
    v_mov_b32 v54, 0
    v_mov_b32 v55, 0
    v_mov_b32 v56, 0
    v_mov_b32 v57, 0
    v_mov_b32 v58, 0
    v_mov_b32 v59, 0
    v_mov_b32 v60, 0
    v_mov_b32 v61, 0
    v_mov_b32 v62, 0
    v_mov_b32 v63, 0
    v_mov_b32 v64, 0
    v_mov_b32 v65, 0
    v_mov_b32 v66, 0
    v_mov_b32 v67, 0
    v_mov_b32 v68, 0
    v_mov_b32 v69, 0
    v_mov_b32 v70, 0
    v_mov_b32 v71, 0
    v_mov_b32 v72, 0
    v_mov_b32 v73, 0
    v_mov_b32 v74, 0
    v_mov_b32 v75, 0
    v_mov_b32 v76, 0
    v_mov_b32 v77, 0
    v_mov_b32 v78, 0
    v_mov_b32 v79, 0
    v_mov_b32 v80, 0
    v_mov_b32 v81, 0
    v_mov_b32 v82, 0
    v_mov_b32 v83, 0
    v_mov_b32 v84, 0
    v_mov_b32 v85, 0
    v_mov_b32 v86, 0
    v_mov_b32 v87, 0
    v_mov_b32 v88, 0
    v_mov_b32 v89, 0
    v_mov_b32 v90, 0
    v_mov_b32 v91, 0
    v_mov_b32 v92, 0
    v_mov_b32 v93, 0
    v_mov_b32 v94, 0
    v_mov_b32 v95, 0
    v_mov_b32 v96, 0
    v_mov_b32 v97, 0
    v_mov_b32 v98, 0
    v_mov_b32 v99, 0
    v_mov_b32 v100, 0
    v_mov_b32 v101, 0
    v_mov_b32 v102, 0
    v_mov_b32 v103, 0
    v_mov_b32 v104, 0
    v_mov_b32 v105, 0
    v_mov_b32 v106, 0
    v_mov_b32 v107, 0
    v_mov_b32 v108, 0
    v_mov_b32 v109, 0
    v_mov_b32 v110, 0
    v_mov_b32 v111, 0
    v_mov_b32 v112, 0
    v_mov_b32 v113, 0
    v_mov_b32 v114, 0
    v_mov_b32 v115, 0
    v_mov_b32 v116, 0
    v_mov_b32 v117, 0
    v_mov_b32 v118, 0
    v_mov_b32 v119, 0
    v_mov_b32 v120, 0
    v_mov_b32 v121, 0
    v_mov_b32 v122, 0
    v_mov_b32 v123, 0
    v_mov_b32 v124, 0
    v_mov_b32 v125, 0
    v_mov_b32 v126, 0
    v_mov_b32 v127, 0
    s_mov_b32 s32, 0
    s_mov_b32 s33, 0
    s_barrier
    v_add_u32 v20, s32, v12
    v_add_u32 v21, s32, v13
    ds_read_b128 v[128:131], v20 offset:0
    ds_read_b128 v[132:135], v20 offset:4096
    ds_read_b64_tr_b16 v[136:137], v21 offset:16384
    ds_read_b64_tr_b16 v[138:139], v21 offset:17408
    ds_read_b64_tr_b16 v[140:141], v21 offset:24576
    ds_read_b64_tr_b16 v[142:143], v21 offset:25600
    ds_read_b64_tr_b16 v[144:145], v21 offset:32768
    ds_read_b64_tr_b16 v[146:147], v21 offset:33792
L_qa1_loop_189:
    s_waitcnt lgkmcnt(0)
    v_mfma_f32_32x32x16_bf16 v[32:47], v[136:139], v[128:131], v[32:47]
    ds_read_b128 v[148:151], v20 offset:1024
    ds_read_b128 v[152:155], v20 offset:5120
    v_mfma_f32_32x32x16_bf16 v[48:63], v[136:139], v[132:135], v[48:63]
    ds_read_b64_tr_b16 v[156:157], v21 offset:18432
    ds_read_b64_tr_b16 v[158:159], v21 offset:19456
    v_mfma_f32_32x32x16_bf16 v[64:79], v[140:143], v[128:131], v[64:79]
    ds_read_b64_tr_b16 v[160:161], v21 offset:26624
    ds_read_b64_tr_b16 v[162:163], v21 offset:27648
    v_mfma_f32_32x32x16_bf16 v[80:95], v[140:143], v[132:135], v[80:95]
    ds_read_b64_tr_b16 v[164:165], v21 offset:34816
    ds_read_b64_tr_b16 v[166:167], v21 offset:35840
    v_mfma_f32_32x32x16_bf16 v[96:111], v[144:147], v[128:131], v[96:111]
    v_mfma_f32_32x32x16_bf16 v[112:127], v[144:147], v[132:135], v[112:127]
    s_waitcnt lgkmcnt(0)
    v_mfma_f32_32x32x16_bf16 v[32:47], v[156:159], v[148:151], v[32:47]
    ds_read_b128 v[128:131], v20 offset:2048
    ds_read_b128 v[132:135], v20 offset:6144
    v_mfma_f32_32x32x16_bf16 v[48:63], v[156:159], v[152:155], v[48:63]
    ds_read_b64_tr_b16 v[136:137], v21 offset:20480
    ds_read_b64_tr_b16 v[138:139], v21 offset:21504
    v_mfma_f32_32x32x16_bf16 v[64:79], v[160:163], v[148:151], v[64:79]
    ds_read_b64_tr_b16 v[140:141], v21 offset:28672
    ds_read_b64_tr_b16 v[142:143], v21 offset:29696
    v_mfma_f32_32x32x16_bf16 v[80:95], v[160:163], v[152:155], v[80:95]
    ds_read_b64_tr_b16 v[144:145], v21 offset:36864
    ds_read_b64_tr_b16 v[146:147], v21 offset:37888
    v_mfma_f32_32x32x16_bf16 v[96:111], v[164:167], v[148:151], v[96:111]
    v_mfma_f32_32x32x16_bf16 v[112:127], v[164:167], v[152:155], v[112:127]
    s_waitcnt lgkmcnt(0)
    v_mfma_f32_32x32x16_bf16 v[32:47], v[136:139], v[128:131], v[32:47]
    ds_read_b128 v[148:151], v20 offset:3072
    ds_read_b128 v[152:155], v20 offset:7168
    v_mfma_f32_32x32x16_bf16 v[48:63], v[136:139], v[132:135], v[48:63]
    ds_read_b64_tr_b16 v[156:157], v21 offset:22528
    ds_read_b64_tr_b16 v[158:159], v21 offset:23552
    v_mfma_f32_32x32x16_bf16 v[64:79], v[140:143], v[128:131], v[64:79]
    ds_read_b64_tr_b16 v[160:161], v21 offset:30720
    ds_read_b64_tr_b16 v[162:163], v21 offset:31744
    v_mfma_f32_32x32x16_bf16 v[80:95], v[140:143], v[132:135], v[80:95]
    ds_read_b64_tr_b16 v[164:165], v21 offset:38912
    ds_read_b64_tr_b16 v[166:167], v21 offset:39936
    v_mfma_f32_32x32x16_bf16 v[96:111], v[144:147], v[128:131], v[96:111]
    v_mfma_f32_32x32x16_bf16 v[112:127], v[144:147], v[132:135], v[112:127]
    s_waitcnt lgkmcnt(0)
    s_add_u32 s32, s32, 40960
    s_cmp_eq_u32 s32, 163840
    s_cselect_b32 s32, 0, s32
    v_mfma_f32_32x32x16_bf16 v[32:47], v[156:159], v[148:151], v[32:47]
    v_mfma_f32_32x32x16_bf16 v[48:63], v[156:159], v[152:155], v[48:63]
    v_add_u32 v20, s32, v12
    v_add_u32 v21, s32, v13
    s_barrier
    ds_read_b128 v[128:131], v20 offset:0
    ds_read_b128 v[132:135], v20 offset:4096
    ds_read_b64_tr_b16 v[136:137], v21 offset:16384
    v_mfma_f32_32x32x16_bf16 v[64:79], v[160:163], v[148:151], v[64:79]
    ds_read_b64_tr_b16 v[138:139], v21 offset:17408
    ds_read_b64_tr_b16 v[140:141], v21 offset:24576
    ds_read_b64_tr_b16 v[142:143], v21 offset:25600
    v_mfma_f32_32x32x16_bf16 v[80:95], v[160:163], v[152:155], v[80:95]
    ds_read_b64_tr_b16 v[144:145], v21 offset:32768
    ds_read_b64_tr_b16 v[146:147], v21 offset:33792
    v_mfma_f32_32x32x16_bf16 v[96:111], v[164:167], v[148:151], v[96:111]
    v_mfma_f32_32x32x16_bf16 v[112:127], v[164:167], v[152:155], v[112:127]
    s_add_u32 s33, s33, 1
    s_cmp_lt_u32 s33, 15
    s_cbranch_scc1 L_qa1_loop_189
    s_waitcnt lgkmcnt(0)
    v_mfma_f32_32x32x16_bf16 v[32:47], v[136:139], v[128:131], v[32:47]
    ds_read_b128 v[148:151], v20 offset:1024
    ds_read_b128 v[152:155], v20 offset:5120
    v_lshlrev_b32 v237, 2, v1
    s_lshl_b32 s35, s51, 9
    v_add_u32 v236, s35, v237
    v_mfma_f32_32x32x16_bf16 v[48:63], v[136:139], v[132:135], v[48:63]
    ds_read_b64_tr_b16 v[156:157], v21 offset:18432
    ds_read_b64_tr_b16 v[158:159], v21 offset:19456
    ds_read_b32 v168, v236 offset:0
    ds_read_b32 v240, v236 offset:256
    ds_read_b32 v170, v236 offset:512
    v_mfma_f32_32x32x16_bf16 v[64:79], v[140:143], v[128:131], v[64:79]
    ds_read_b64_tr_b16 v[160:161], v21 offset:26624
    ds_read_b64_tr_b16 v[162:163], v21 offset:27648
    ds_read_b32 v244, v236 offset:768
    s_waitcnt vmcnt(0)
    v_lshl_or_b32 v220, v221, 16, v220
    v_mfma_f32_32x32x16_bf16 v[80:95], v[140:143], v[132:135], v[80:95]
    ds_read_b64_tr_b16 v[164:165], v21 offset:34816
    ds_read_b64_tr_b16 v[166:167], v21 offset:35840
    v_lshl_or_b32 v221, v223, 16, v222
    v_lshl_or_b32 v222, v225, 16, v224
    v_lshl_or_b32 v223, v227, 16, v226
    v_mfma_f32_32x32x16_bf16 v[96:111], v[144:147], v[128:131], v[96:111]
    v_lshl_or_b32 v224, v229, 16, v228
    v_lshl_or_b32 v225, v231, 16, v230
    v_lshl_or_b32 v226, v233, 16, v232
    v_lshl_or_b32 v227, v235, 16, v234
    s_lshl_b32 s35, s51, 5
    v_mfma_f32_32x32x16_bf16 v[112:127], v[144:147], v[132:135], v[112:127]
    v_add_u32 v238, s35, v2
    v_mul_u32_u24 v238, 200, v238
    v_lshl_add_u32 v238, v3, 3, v238
    s_mul_i32 s35, s49, 25600
    v_add_u32 v238, s35, v238
    s_waitcnt lgkmcnt(0)
    v_mfma_f32_32x32x16_bf16 v[32:47], v[156:159], v[148:151], v[32:47]
    ds_read_b128 v[128:131], v20 offset:2048
    ds_read_b128 v[132:135], v20 offset:6144
    s_and_b32 s35, s3, 3
    s_lshl_b32 s35, s35, 12
    s_add_u32 s35, s35, 51200
    v_mfma_f32_32x32x16_bf16 v[48:63], v[156:159], v[152:155], v[48:63]
    ds_read_b64_tr_b16 v[136:137], v21 offset:20480
    ds_read_b64_tr_b16 v[138:139], v21 offset:21504
    v_lshlrev_b32 v239, 4, v1
    v_add_u32 v239, s35, v239
    s_waitcnt lgkmcnt(0)
    v_mfma_f32_32x32x16_bf16 v[64:79], v[160:163], v[148:151], v[64:79]
    ds_read_b64_tr_b16 v[140:141], v21 offset:28672
    ds_read_b64_tr_b16 v[142:143], v21 offset:29696
    v_mov_b32 v169, v168
    v_mov_b32 v241, v240
    v_mov_b32 v242, v240
    v_mfma_f32_32x32x16_bf16 v[80:95], v[160:163], v[152:155], v[80:95]
    ds_read_b64_tr_b16 v[144:145], v21 offset:36864
    ds_read_b64_tr_b16 v[146:147], v21 offset:37888
    v_mov_b32 v243, v240
    v_mov_b32 v171, v170
    v_mov_b32 v245, v244
    v_mfma_f32_32x32x16_bf16 v[96:111], v[164:167], v[148:151], v[96:111]
    v_mov_b32 v246, v244
    v_mov_b32 v247, v244
    v_mul_f32 v172, 0x3fb8aa3b, v168
    v_mov_b32 v173, v172
    v_mov_b32 v208, v248
    v_mfma_f32_32x32x16_bf16 v[112:127], v[164:167], v[152:155], v[112:127]
    v_mov_b32 v209, 0
    v_mov_b32 v210, 0
    v_mov_b32 v211, 0
    v_mov_b32 v212, v249
    v_mov_b32 v213, 0
    s_waitcnt lgkmcnt(0)
    v_mfma_f32_32x32x16_bf16 v[32:47], v[136:139], v[128:131], v[32:47]
    ds_read_b128 v[148:151], v20 offset:3072
    ds_read_b128 v[152:155], v20 offset:7168
    v_mov_b32 v214, 0
    v_mov_b32 v215, 0
    v_mov_b32 v216, v250
    v_mfma_f32_32x32x16_bf16 v[48:63], v[136:139], v[132:135], v[48:63]
    ds_read_b64_tr_b16 v[156:157], v21 offset:22528
    ds_read_b64_tr_b16 v[158:159], v21 offset:23552
    v_mov_b32 v217, 0
    v_mov_b32 v218, 0
    v_mov_b32 v219, 0
    v_mfma_f32_32x32x16_bf16 v[64:79], v[140:143], v[128:131], v[64:79]
    ds_read_b64_tr_b16 v[160:161], v21 offset:30720
    ds_read_b64_tr_b16 v[162:163], v21 offset:31744
    v_mfma_f32_32x32x16_bf16 v[80:95], v[140:143], v[132:135], v[80:95]
    ds_read_b64_tr_b16 v[164:165], v21 offset:38912
    ds_read_b64_tr_b16 v[166:167], v21 offset:39936
    v_mfma_f32_32x32x16_bf16 v[96:111], v[144:147], v[128:131], v[96:111]
    v_mfma_f32_32x32x16_bf16 v[112:127], v[144:147], v[132:135], v[112:127]
    s_waitcnt lgkmcnt(0)
    v_mfma_f32_32x32x16_bf16 v[32:47], v[156:159], v[148:151], v[32:47]
    s_barrier
    v_mfma_f32_32x32x16_bf16 v[48:63], v[156:159], v[152:155], v[48:63]
    v_mfma_f32_32x32x16_bf16 v[64:79], v[160:163], v[148:151], v[64:79]
    v_mfma_f32_32x32x16_bf16 v[80:95], v[160:163], v[152:155], v[80:95]
    v_mfma_f32_32x32x16_bf16 v[96:111], v[164:167], v[148:151], v[96:111]
    v_mfma_f32_32x32x16_bf16 v[112:127], v[164:167], v[152:155], v[112:127]
    v_mfma_f32_32x32x16_bf16 v[80:95], v[212:215], v[244:247], v[80:95]
    v_mfma_f32_32x32x16_bf16 v[48:63], v[208:211], v[244:247], v[48:63]
    v_mfma_f32_32x32x16_bf16 v[64:79], v[212:215], v[240:243], v[64:79]
    v_mfma_f32_32x32x16_bf16 v[96:111], v[216:219], v[240:243], v[96:111]
    v_mfma_f32_32x32x16_bf16 v[112:127], v[216:219], v[244:247], v[112:127]
    v_mfma_f32_32x32x16_bf16 v[32:47], v[208:211], v[240:243], v[32:47]
    v_lshlrev_b32 v4, 3, v1
    v_add_u32 v4, 77824, v4
    v_mov_b32 v6, 0
    v_mov_b32 v7, 0
    ds_write_b64 v4, v[6:7]
    v_mov_b32 v4, 163816
    v_mov_b32 v5, 0
    ds_write_b32 v4, v5
    v_mov_b32 v4, 163820
    v_mov_b32 v5, 0
    ds_write_b32 v4, v5
    v_mov_b32 v4, 163824
    v_mov_b32 v5, 0
    ds_write_b32 v4, v5
    v_cvt_pk_bf16_f32 v128, v80, v81
    v_cvt_pk_bf16_f32 v129, v82, v83
    v_cvt_pk_bf16_f32 v130, v84, v85
    v_cvt_pk_bf16_f32 v131, v86, v87
    v_cvt_pk_bf16_f32 v132, v88, v89
    v_cvt_pk_bf16_f32 v133, v90, v91
    v_cvt_pk_bf16_f32 v134, v92, v93
    v_cvt_pk_bf16_f32 v135, v94, v95
    ds_write_b128 v239, v[128:131] offset:0
    ds_write_b128 v239, v[132:135] offset:1024
    v_cvt_pk_bf16_f32 v136, v48, v49
    v_cvt_pk_bf16_f32 v137, v50, v51
    v_cvt_pk_bf16_f32 v138, v52, v53
    v_cvt_pk_bf16_f32 v139, v54, v55
    v_cvt_pk_bf16_f32 v140, v56, v57
    v_cvt_pk_bf16_f32 v141, v58, v59
    v_cvt_pk_bf16_f32 v142, v60, v61
    v_cvt_pk_bf16_f32 v143, v62, v63
    ds_write_b128 v239, v[136:139] offset:2048
    ds_write_b128 v239, v[140:143] offset:3072
    v_cvt_pk_bf16_f32 v144, v64, v65
    v_cvt_pk_bf16_f32 v145, v66, v67
    v_cvt_pk_bf16_f32 v146, v68, v69
    v_cvt_pk_bf16_f32 v147, v70, v71
    v_cvt_pk_bf16_f32 v148, v72, v73
    v_cvt_pk_bf16_f32 v149, v74, v75
    v_cvt_pk_bf16_f32 v150, v76, v77
    v_cvt_pk_bf16_f32 v151, v78, v79
    s_waitcnt lgkmcnt(0)
    s_barrier
    v_mfma_f32_32x32x16_bf16 v[64:79], v[220:223], v[144:147], 0
    v_mfma_f32_32x32x16_bf16 v[64:79], v[224:227], v[148:151], v[64:79]
    v_pk_mul_f32 v[96:97], v[96:97], v[168:169]
    v_pk_mul_f32 v[98:99], v[98:99], v[168:169]
    v_pk_mul_f32 v[100:101], v[100:101], v[168:169]
    v_pk_mul_f32 v[102:103], v[102:103], v[168:169]
    v_pk_mul_f32 v[104:105], v[104:105], v[168:169]
    v_pk_mul_f32 v[106:107], v[106:107], v[168:169]
    v_pk_mul_f32 v[108:109], v[108:109], v[168:169]
    v_pk_mul_f32 v[110:111], v[110:111], v[168:169]
    v_cvt_pk_bf16_f32 v128, v96, v97
    v_cvt_pk_bf16_f32 v129, v98, v99
    v_cvt_pk_bf16_f32 v130, v100, v101
    v_cvt_pk_bf16_f32 v131, v102, v103
    v_cvt_pk_bf16_f32 v132, v104, v105
    v_cvt_pk_bf16_f32 v133, v106, v107
    v_cvt_pk_bf16_f32 v134, v108, v109
    v_cvt_pk_bf16_f32 v135, v110, v111
    ds_write_b64 v238, v[128:129] offset:128
    ds_write_b64 v238, v[130:131] offset:144
    ds_write_b64 v238, v[132:133] offset:160
    ds_write_b64 v238, v[134:135] offset:176
    v_pk_mul_f32 v[112:113], v[112:113], v[170:171]
    v_pk_mul_f32 v[114:115], v[114:115], v[170:171]
    v_pk_mul_f32 v[116:117], v[116:117], v[170:171]
    v_pk_mul_f32 v[118:119], v[118:119], v[170:171]
    v_pk_mul_f32 v[120:121], v[120:121], v[170:171]
    v_pk_mul_f32 v[122:123], v[122:123], v[170:171]
    v_pk_mul_f32 v[124:125], v[124:125], v[170:171]
    v_pk_mul_f32 v[126:127], v[126:127], v[170:171]
    v_cvt_pk_bf16_f32 v136, v112, v113
    v_cvt_pk_bf16_f32 v137, v114, v115
    v_cvt_pk_bf16_f32 v138, v116, v117
    v_cvt_pk_bf16_f32 v139, v118, v119
    v_cvt_pk_bf16_f32 v140, v120, v121
    v_cvt_pk_bf16_f32 v141, v122, v123
    v_cvt_pk_bf16_f32 v142, v124, v125
    v_cvt_pk_bf16_f32 v143, v126, v127
    ds_write_b64 v238, v[136:137] offset:6528
    ds_write_b64 v238, v[138:139] offset:6544
    ds_write_b64 v238, v[140:141] offset:6560
    ds_write_b64 v238, v[142:143] offset:6576
    v_cvt_pk_bf16_f32 v160, v32, v33
    v_cvt_pk_bf16_f32 v161, v34, v35
    v_cvt_pk_bf16_f32 v162, v36, v37
    v_cvt_pk_bf16_f32 v163, v38, v39
    v_cvt_pk_bf16_f32 v164, v40, v41
    v_cvt_pk_bf16_f32 v165, v42, v43
    v_cvt_pk_bf16_f32 v166, v44, v45
    v_cvt_pk_bf16_f32 v167, v46, v47
    s_branch L_qa1_j0_185
L_qa1_ld_184:
    v_lshlrev_b32 v10, 1, v2
    v_lshl_add_u32 v10, v3, 8, v10
    s_lshl_b32 s34, s50, 11
    buffer_load_ushort v220, v10, s[20:23], s34 offen offset:0
    buffer_load_ushort v221, v10, s[20:23], s34 offen offset:64
    buffer_load_ushort v222, v10, s[20:23], s34 offen offset:128
    buffer_load_ushort v223, v10, s[20:23], s34 offen offset:192
    buffer_load_ushort v224, v10, s[20:23], s34 offen offset:512
    buffer_load_ushort v225, v10, s[20:23], s34 offen offset:576
    buffer_load_ushort v226, v10, s[20:23], s34 offen offset:640
    buffer_load_ushort v227, v10, s[20:23], s34 offen offset:704
    buffer_load_ushort v228, v10, s[20:23], s34 offen offset:1024
    buffer_load_ushort v229, v10, s[20:23], s34 offen offset:1088
    buffer_load_ushort v230, v10, s[20:23], s34 offen offset:1152
    buffer_load_ushort v231, v10, s[20:23], s34 offen offset:1216
    buffer_load_ushort v232, v10, s[20:23], s34 offen offset:1536
    buffer_load_ushort v233, v10, s[20:23], s34 offen offset:1600
    buffer_load_ushort v234, v10, s[20:23], s34 offen offset:1664
    buffer_load_ushort v235, v10, s[20:23], s34 offen offset:1728
    s_sub_u32 s30, s3, 4
    v_lshrrev_b32 v6, 3, v1
    v_and_b32 v7, 7, v1
    s_lshl_b32 s31, s30, 4
    s_mov_b32 s33, 6144
    v_lshrrev_b32 v5, 1, v6
    v_and_b32 v5, 1, v5
    v_lshlrev_b32 v5, 2, v5
    v_xor_b32 v5, v5, v7
    v_lshlrev_b32 v5, 4, v5
    s_lshl_b32 s32, s5, 7
    v_add_u32 v5, s32, v5
    v_add_u32 v4, 0, v6
    v_add_u32 v4, s31, v4
    v_mul_lo_u32 v4, v4, s33
    v_add_u32 v12, v4, v5
    v_add_u32 v4, 8, v6
    v_add_u32 v4, s31, v4
    v_mul_lo_u32 v4, v4, s33
    v_add_u32 v13, v4, v5
    v_subrev_u32 v13, 1024, v13
    v_add_u32 v14, 2048, v12
    v_add_u32 v15, 2048, v13
    v_add_u32 v16, 4096, v12
    v_add_u32 v17, 4096, v13
    v_lshlrev_b32 v8, 4, v1
    s_lshl_b32 s34, s30, 12
    s_lshl_b32 s35, s30, 11
    s_add_u32 s35, s35, 16384
    s_lshl_b32 s36, s30, 10
    s_add_u32 s36, s36, 40960
    s_lshl_b32 s37, s4, 2
    s_add_u32 s37, s37, s30
    s_lshl_b32 s37, s37, 16
    s_mov_b32 s38, 0
    s_mov_b32 s39, 0
    s_add_u32 m0, s35, 0
    s_nop 0
    buffer_load_dwordx4 v12, s[12:15], s38 offen offset:0 lds
    buffer_load_dwordx4 v13, s[12:15], s38 offen offset:1024 lds
    s_add_u32 m0, s35, 8192
    s_nop 0
    buffer_load_dwordx4 v14, s[12:15], s38 offen offset:0 lds
    buffer_load_dwordx4 v15, s[12:15], s38 offen offset:1024 lds
    s_add_u32 m0, s35, 16384
    s_nop 0
    buffer_load_dwordx4 v16, s[12:15], s38 offen offset:0 lds
    buffer_load_dwordx4 v17, s[12:15], s38 offen offset:1024 lds
    s_add_u32 s38, s38, 393216
    s_add_u32 m0, s35, 40960
    s_nop 0
    buffer_load_dwordx4 v12, s[12:15], s38 offen offset:0 lds
    buffer_load_dwordx4 v13, s[12:15], s38 offen offset:1024 lds
    s_add_u32 m0, s35, 49152
    s_nop 0
    buffer_load_dwordx4 v14, s[12:15], s38 offen offset:0 lds
    buffer_load_dwordx4 v15, s[12:15], s38 offen offset:1024 lds
    s_add_u32 m0, s35, 57344
    s_nop 0
    buffer_load_dwordx4 v16, s[12:15], s38 offen offset:0 lds
    buffer_load_dwordx4 v17, s[12:15], s38 offen offset:1024 lds
    s_add_u32 s38, s38, 393216
    s_add_u32 m0, s35, 81920
    s_nop 0
    buffer_load_dwordx4 v12, s[12:15], s38 offen offset:0 lds
    buffer_load_dwordx4 v13, s[12:15], s38 offen offset:1024 lds
    s_add_u32 m0, s35, 90112
    s_nop 0
    buffer_load_dwordx4 v14, s[12:15], s38 offen offset:0 lds
    buffer_load_dwordx4 v15, s[12:15], s38 offen offset:1024 lds
    s_add_u32 m0, s35, 98304
    s_nop 0
    buffer_load_dwordx4 v16, s[12:15], s38 offen offset:0 lds
    buffer_load_dwordx4 v17, s[12:15], s38 offen offset:1024 lds
    s_add_u32 s38, s38, 393216
    v_and_b32 v4, 15, v1
    v_lshlrev_b32 v4, 2, v4
    s_lshl_b32 s52, s4, 8
    s_add_u32 s52, s52, 0x2805000
    s_mov_b32 s63, 0
    s_cmp_gt_u32 s63, 0
    s_cbranch_scc1 L_sp_190_ok
    s_mov_b32 s53, 0
L_sp_190:
    buffer_load_dword v5, v4, s[16:19], s52 offen sc1
    s_waitcnt vmcnt(0)
    v_cmp_ne_u32 vcc, 1, v5
    s_nop 0
    s_or_b32 s63, vcc_lo, 0x10000
    s_ff1_i32_b32 s63, s63
    s_cmp_gt_u32 s63, 0
    s_cbranch_scc1 L_sp_190_ok
    s_add_u32 s53, s53, 1
    s_cmp_lt_u32 s53, 0x40000
    s_cbranch_scc1 L_sp_190
L_sp_190_ok:
    s_add_u32 m0, s34, 0
    s_nop 0
    buffer_load_dwordx4 v8, s[8:11], s37 offen offset:0 sc1 lds
    buffer_load_dwordx4 v8, s[8:11], s37 offen offset:1024 sc1 lds
    buffer_load_dwordx4 v8, s[8:11], s37 offen offset:2048 sc1 lds
    buffer_load_dwordx4 v8, s[8:11], s37 offen offset:3072 sc1 lds
    s_add_u32 s37, s37, 4096
    s_cmp_gt_u32 s63, 1
    s_cbranch_scc1 L_sp_191_ok
    s_mov_b32 s53, 0
L_sp_191:
    buffer_load_dword v5, v4, s[16:19], s52 offen sc1
    s_waitcnt vmcnt(0)
    v_cmp_ne_u32 vcc, 1, v5
    s_nop 0
    s_or_b32 s63, vcc_lo, 0x10000
    s_ff1_i32_b32 s63, s63
    s_cmp_gt_u32 s63, 1
    s_cbranch_scc1 L_sp_191_ok
    s_add_u32 s53, s53, 1
    s_cmp_lt_u32 s53, 0x40000
    s_cbranch_scc1 L_sp_191
L_sp_191_ok:
    s_add_u32 m0, s34, 40960
    s_nop 0
    buffer_load_dwordx4 v8, s[8:11], s37 offen offset:0 sc1 lds
    buffer_load_dwordx4 v8, s[8:11], s37 offen offset:1024 sc1 lds
    buffer_load_dwordx4 v8, s[8:11], s37 offen offset:2048 sc1 lds
    buffer_load_dwordx4 v8, s[8:11], s37 offen offset:3072 sc1 lds
    s_add_u32 s37, s37, 4096
    s_waitcnt vmcnt(4)
    s_barrier
    s_cmp_gt_u32 s63, 2
    s_cbranch_scc1 L_sp_192_ok
    s_mov_b32 s53, 0
L_sp_192:
    buffer_load_dword v5, v4, s[16:19], s52 offen sc1
    s_waitcnt vmcnt(0)
    v_cmp_ne_u32 vcc, 1, v5
    s_nop 0
    s_or_b32 s63, vcc_lo, 0x10000
    s_ff1_i32_b32 s63, s63
    s_cmp_gt_u32 s63, 2
    s_cbranch_scc1 L_sp_192_ok
    s_add_u32 s53, s53, 1
    s_cmp_lt_u32 s53, 0x40000
    s_cbranch_scc1 L_sp_192
L_sp_192_ok:
    s_add_u32 m0, s34, 81920
    s_nop 0
    buffer_load_dwordx4 v8, s[8:11], s37 offen offset:0 sc1 lds
    buffer_load_dwordx4 v8, s[8:11], s37 offen offset:1024 sc1 lds
    buffer_load_dwordx4 v8, s[8:11], s37 offen offset:2048 sc1 lds
    buffer_load_dwordx4 v8, s[8:11], s37 offen offset:3072 sc1 lds
    s_add_u32 s37, s37, 4096
    s_cmp_gt_u32 s63, 3
    s_cbranch_scc1 L_sp_193_ok
    s_mov_b32 s53, 0
L_sp_193:
    buffer_load_dword v5, v4, s[16:19], s52 offen sc1
    s_waitcnt vmcnt(0)
    v_cmp_ne_u32 vcc, 1, v5
    s_nop 0
    s_or_b32 s63, vcc_lo, 0x10000
    s_ff1_i32_b32 s63, s63
    s_cmp_gt_u32 s63, 3
    s_cbranch_scc1 L_sp_193_ok
    s_add_u32 s53, s53, 1
    s_cmp_lt_u32 s53, 0x40000
    s_cbranch_scc1 L_sp_193
L_sp_193_ok:
    s_add_u32 m0, s34, 122880
    s_nop 0
    buffer_load_dwordx4 v8, s[8:11], s37 offen offset:0 sc1 lds
    buffer_load_dwordx4 v8, s[8:11], s37 offen offset:1024 sc1 lds
    buffer_load_dwordx4 v8, s[8:11], s37 offen offset:2048 sc1 lds
    buffer_load_dwordx4 v8, s[8:11], s37 offen offset:3072 sc1 lds
    s_add_u32 s37, s37, 4096
    s_add_u32 m0, s35, 122880
    s_nop 0
    buffer_load_dwordx4 v12, s[12:15], s38 offen offset:0 lds
    buffer_load_dwordx4 v13, s[12:15], s38 offen offset:1024 lds
    s_add_u32 m0, s35, 131072
    s_nop 0
    buffer_load_dwordx4 v14, s[12:15], s38 offen offset:0 lds
    buffer_load_dwordx4 v15, s[12:15], s38 offen offset:1024 lds
    s_add_u32 m0, s35, 139264
    s_nop 0
    buffer_load_dwordx4 v16, s[12:15], s38 offen offset:0 lds
    buffer_load_dwordx4 v17, s[12:15], s38 offen offset:1024 lds
    s_add_u32 s38, s38, 393216
    s_waitcnt vmcnt(14)
    s_barrier
    s_cmp_gt_u32 s63, 4
    s_cbranch_scc1 L_sp_194_ok
    s_mov_b32 s53, 0
L_sp_194:
    buffer_load_dword v5, v4, s[16:19], s52 offen sc1
    s_waitcnt vmcnt(0)
    v_cmp_ne_u32 vcc, 1, v5
    s_nop 0
    s_or_b32 s63, vcc_lo, 0x10000
    s_ff1_i32_b32 s63, s63
    s_cmp_gt_u32 s63, 4
    s_cbranch_scc1 L_sp_194_ok
    s_add_u32 s53, s53, 1
    s_cmp_lt_u32 s53, 0x40000
    s_cbranch_scc1 L_sp_194
L_sp_194_ok:
    s_add_u32 m0, s34, 0
    s_nop 0
    buffer_load_dwordx4 v8, s[8:11], s37 offen offset:0 sc1 lds
    buffer_load_dwordx4 v8, s[8:11], s37 offen offset:1024 sc1 lds
    buffer_load_dwordx4 v8, s[8:11], s37 offen offset:2048 sc1 lds
    buffer_load_dwordx4 v8, s[8:11], s37 offen offset:3072 sc1 lds
    s_add_u32 s37, s37, 4096
    s_add_u32 m0, s35, 0
    s_nop 0
    buffer_load_dwordx4 v12, s[12:15], s38 offen offset:0 lds
    buffer_load_dwordx4 v13, s[12:15], s38 offen offset:1024 lds
    s_add_u32 m0, s35, 8192
    s_nop 0
    buffer_load_dwordx4 v14, s[12:15], s38 offen offset:0 lds
    buffer_load_dwordx4 v15, s[12:15], s38 offen offset:1024 lds
    s_add_u32 m0, s35, 16384
    s_nop 0
    buffer_load_dwordx4 v16, s[12:15], s38 offen offset:0 lds
    buffer_load_dwordx4 v17, s[12:15], s38 offen offset:1024 lds
    s_add_u32 s38, s38, 393216
    s_waitcnt vmcnt(20)
    s_barrier
    s_cmp_gt_u32 s63, 5
    s_cbranch_scc1 L_sp_195_ok
    s_mov_b32 s53, 0
L_sp_195:
    buffer_load_dword v5, v4, s[16:19], s52 offen sc1
    s_waitcnt vmcnt(0)
    v_cmp_ne_u32 vcc, 1, v5
    s_nop 0
    s_or_b32 s63, vcc_lo, 0x10000
    s_ff1_i32_b32 s63, s63
    s_cmp_gt_u32 s63, 5
    s_cbranch_scc1 L_sp_195_ok
    s_add_u32 s53, s53, 1
    s_cmp_lt_u32 s53, 0x40000
    s_cbranch_scc1 L_sp_195
L_sp_195_ok:
    s_add_u32 m0, s34, 40960
    s_nop 0
    buffer_load_dwordx4 v8, s[8:11], s37 offen offset:0 sc1 lds
    buffer_load_dwordx4 v8, s[8:11], s37 offen offset:1024 sc1 lds
    buffer_load_dwordx4 v8, s[8:11], s37 offen offset:2048 sc1 lds
    buffer_load_dwordx4 v8, s[8:11], s37 offen offset:3072 sc1 lds
    s_add_u32 s37, s37, 4096
    s_add_u32 m0, s35, 40960
    s_nop 0
    buffer_load_dwordx4 v12, s[12:15], s38 offen offset:0 lds
    buffer_load_dwordx4 v13, s[12:15], s38 offen offset:1024 lds
    s_add_u32 m0, s35, 49152
    s_nop 0
    buffer_load_dwordx4 v14, s[12:15], s38 offen offset:0 lds
    buffer_load_dwordx4 v15, s[12:15], s38 offen offset:1024 lds
    s_add_u32 m0, s35, 57344
    s_nop 0
    buffer_load_dwordx4 v16, s[12:15], s38 offen offset:0 lds
    buffer_load_dwordx4 v17, s[12:15], s38 offen offset:1024 lds
    s_add_u32 s38, s38, 393216
    s_waitcnt vmcnt(20)
    s_barrier
    s_cmp_gt_u32 s63, 6
    s_cbranch_scc1 L_sp_196_ok
    s_mov_b32 s53, 0
L_sp_196:
    buffer_load_dword v5, v4, s[16:19], s52 offen sc1
    s_waitcnt vmcnt(0)
    v_cmp_ne_u32 vcc, 1, v5
    s_nop 0
    s_or_b32 s63, vcc_lo, 0x10000
    s_ff1_i32_b32 s63, s63
    s_cmp_gt_u32 s63, 6
    s_cbranch_scc1 L_sp_196_ok
    s_add_u32 s53, s53, 1
    s_cmp_lt_u32 s53, 0x40000
    s_cbranch_scc1 L_sp_196
L_sp_196_ok:
    s_add_u32 m0, s34, 81920
    s_nop 0
    buffer_load_dwordx4 v8, s[8:11], s37 offen offset:0 sc1 lds
    buffer_load_dwordx4 v8, s[8:11], s37 offen offset:1024 sc1 lds
    buffer_load_dwordx4 v8, s[8:11], s37 offen offset:2048 sc1 lds
    buffer_load_dwordx4 v8, s[8:11], s37 offen offset:3072 sc1 lds
    s_add_u32 s37, s37, 4096
    s_add_u32 m0, s35, 81920
    s_nop 0
    buffer_load_dwordx4 v12, s[12:15], s38 offen offset:0 lds
    buffer_load_dwordx4 v13, s[12:15], s38 offen offset:1024 lds
    s_add_u32 m0, s35, 90112
    s_nop 0
    buffer_load_dwordx4 v14, s[12:15], s38 offen offset:0 lds
    buffer_load_dwordx4 v15, s[12:15], s38 offen offset:1024 lds
    s_add_u32 m0, s35, 98304
    s_nop 0
    buffer_load_dwordx4 v16, s[12:15], s38 offen offset:0 lds
    buffer_load_dwordx4 v17, s[12:15], s38 offen offset:1024 lds
    s_add_u32 s38, s38, 393216
    s_waitcnt vmcnt(20)
    s_barrier
    s_cmp_gt_u32 s63, 7
    s_cbranch_scc1 L_sp_197_ok
    s_mov_b32 s53, 0
L_sp_197:
    buffer_load_dword v5, v4, s[16:19], s52 offen sc1
    s_waitcnt vmcnt(0)
    v_cmp_ne_u32 vcc, 1, v5
    s_nop 0
    s_or_b32 s63, vcc_lo, 0x10000
    s_ff1_i32_b32 s63, s63
    s_cmp_gt_u32 s63, 7
    s_cbranch_scc1 L_sp_197_ok
    s_add_u32 s53, s53, 1
    s_cmp_lt_u32 s53, 0x40000
    s_cbranch_scc1 L_sp_197
L_sp_197_ok:
    s_add_u32 m0, s34, 122880
    s_nop 0
    buffer_load_dwordx4 v8, s[8:11], s37 offen offset:0 sc1 lds
    buffer_load_dwordx4 v8, s[8:11], s37 offen offset:1024 sc1 lds
    buffer_load_dwordx4 v8, s[8:11], s37 offen offset:2048 sc1 lds
    buffer_load_dwordx4 v8, s[8:11], s37 offen offset:3072 sc1 lds
    s_add_u32 s37, s37, 4096
    s_add_u32 m0, s35, 122880
    s_nop 0
    buffer_load_dwordx4 v12, s[12:15], s38 offen offset:0 lds
    buffer_load_dwordx4 v13, s[12:15], s38 offen offset:1024 lds
    s_add_u32 m0, s35, 131072
    s_nop 0
    buffer_load_dwordx4 v14, s[12:15], s38 offen offset:0 lds
    buffer_load_dwordx4 v15, s[12:15], s38 offen offset:1024 lds
    s_add_u32 m0, s35, 139264
    s_nop 0
    buffer_load_dwordx4 v16, s[12:15], s38 offen offset:0 lds
    buffer_load_dwordx4 v17, s[12:15], s38 offen offset:1024 lds
    s_add_u32 s38, s38, 393216
    s_waitcnt vmcnt(20)
    s_barrier
    s_cmp_gt_u32 s63, 8
    s_cbranch_scc1 L_sp_198_ok
    s_mov_b32 s53, 0
L_sp_198:
    buffer_load_dword v5, v4, s[16:19], s52 offen sc1
    s_waitcnt vmcnt(0)
    v_cmp_ne_u32 vcc, 1, v5
    s_nop 0
    s_or_b32 s63, vcc_lo, 0x10000
    s_ff1_i32_b32 s63, s63
    s_cmp_gt_u32 s63, 8
    s_cbranch_scc1 L_sp_198_ok
    s_add_u32 s53, s53, 1
    s_cmp_lt_u32 s53, 0x40000
    s_cbranch_scc1 L_sp_198
L_sp_198_ok:
    s_add_u32 m0, s34, 0
    s_nop 0
    buffer_load_dwordx4 v8, s[8:11], s37 offen offset:0 sc1 lds
    buffer_load_dwordx4 v8, s[8:11], s37 offen offset:1024 sc1 lds
    buffer_load_dwordx4 v8, s[8:11], s37 offen offset:2048 sc1 lds
    buffer_load_dwordx4 v8, s[8:11], s37 offen offset:3072 sc1 lds
    s_add_u32 s37, s37, 4096
    s_add_u32 m0, s35, 0
    s_nop 0
    buffer_load_dwordx4 v12, s[12:15], s38 offen offset:0 lds
    buffer_load_dwordx4 v13, s[12:15], s38 offen offset:1024 lds
    s_add_u32 m0, s35, 8192
    s_nop 0
    buffer_load_dwordx4 v14, s[12:15], s38 offen offset:0 lds
    buffer_load_dwordx4 v15, s[12:15], s38 offen offset:1024 lds
    s_add_u32 m0, s35, 16384
    s_nop 0
    buffer_load_dwordx4 v16, s[12:15], s38 offen offset:0 lds
    buffer_load_dwordx4 v17, s[12:15], s38 offen offset:1024 lds
    s_add_u32 s38, s38, 393216
    s_waitcnt vmcnt(20)
    s_barrier
    s_cmp_gt_u32 s63, 9
    s_cbranch_scc1 L_sp_199_ok
    s_mov_b32 s53, 0
L_sp_199:
    buffer_load_dword v5, v4, s[16:19], s52 offen sc1
    s_waitcnt vmcnt(0)
    v_cmp_ne_u32 vcc, 1, v5
    s_nop 0
    s_or_b32 s63, vcc_lo, 0x10000
    s_ff1_i32_b32 s63, s63
    s_cmp_gt_u32 s63, 9
    s_cbranch_scc1 L_sp_199_ok
    s_add_u32 s53, s53, 1
    s_cmp_lt_u32 s53, 0x40000
    s_cbranch_scc1 L_sp_199
L_sp_199_ok:
    s_add_u32 m0, s34, 40960
    s_nop 0
    buffer_load_dwordx4 v8, s[8:11], s37 offen offset:0 sc1 lds
    buffer_load_dwordx4 v8, s[8:11], s37 offen offset:1024 sc1 lds
    buffer_load_dwordx4 v8, s[8:11], s37 offen offset:2048 sc1 lds
    buffer_load_dwordx4 v8, s[8:11], s37 offen offset:3072 sc1 lds
    s_add_u32 s37, s37, 4096
    s_add_u32 m0, s35, 40960
    s_nop 0
    buffer_load_dwordx4 v12, s[12:15], s38 offen offset:0 lds
    buffer_load_dwordx4 v13, s[12:15], s38 offen offset:1024 lds
    s_add_u32 m0, s35, 49152
    s_nop 0
    buffer_load_dwordx4 v14, s[12:15], s38 offen offset:0 lds
    buffer_load_dwordx4 v15, s[12:15], s38 offen offset:1024 lds
    s_add_u32 m0, s35, 57344
    s_nop 0
    buffer_load_dwordx4 v16, s[12:15], s38 offen offset:0 lds
    buffer_load_dwordx4 v17, s[12:15], s38 offen offset:1024 lds
    s_add_u32 s38, s38, 393216
    s_waitcnt vmcnt(20)
    s_barrier
    s_cmp_gt_u32 s63, 10
    s_cbranch_scc1 L_sp_200_ok
    s_mov_b32 s53, 0
L_sp_200:
    buffer_load_dword v5, v4, s[16:19], s52 offen sc1
    s_waitcnt vmcnt(0)
    v_cmp_ne_u32 vcc, 1, v5
    s_nop 0
    s_or_b32 s63, vcc_lo, 0x10000
    s_ff1_i32_b32 s63, s63
    s_cmp_gt_u32 s63, 10
    s_cbranch_scc1 L_sp_200_ok
    s_add_u32 s53, s53, 1
    s_cmp_lt_u32 s53, 0x40000
    s_cbranch_scc1 L_sp_200
L_sp_200_ok:
    s_add_u32 m0, s34, 81920
    s_nop 0
    buffer_load_dwordx4 v8, s[8:11], s37 offen offset:0 sc1 lds
    buffer_load_dwordx4 v8, s[8:11], s37 offen offset:1024 sc1 lds
    buffer_load_dwordx4 v8, s[8:11], s37 offen offset:2048 sc1 lds
    buffer_load_dwordx4 v8, s[8:11], s37 offen offset:3072 sc1 lds
    s_add_u32 s37, s37, 4096
    s_add_u32 m0, s35, 81920
    s_nop 0
    buffer_load_dwordx4 v12, s[12:15], s38 offen offset:0 lds
    buffer_load_dwordx4 v13, s[12:15], s38 offen offset:1024 lds
    s_add_u32 m0, s35, 90112
    s_nop 0
    buffer_load_dwordx4 v14, s[12:15], s38 offen offset:0 lds
    buffer_load_dwordx4 v15, s[12:15], s38 offen offset:1024 lds
    s_add_u32 m0, s35, 98304
    s_nop 0
    buffer_load_dwordx4 v16, s[12:15], s38 offen offset:0 lds
    buffer_load_dwordx4 v17, s[12:15], s38 offen offset:1024 lds
    s_add_u32 s38, s38, 393216
    s_waitcnt vmcnt(20)
    s_barrier
    s_cmp_gt_u32 s63, 11
    s_cbranch_scc1 L_sp_201_ok
    s_mov_b32 s53, 0
L_sp_201:
    buffer_load_dword v5, v4, s[16:19], s52 offen sc1
    s_waitcnt vmcnt(0)
    v_cmp_ne_u32 vcc, 1, v5
    s_nop 0
    s_or_b32 s63, vcc_lo, 0x10000
    s_ff1_i32_b32 s63, s63
    s_cmp_gt_u32 s63, 11
    s_cbranch_scc1 L_sp_201_ok
    s_add_u32 s53, s53, 1
    s_cmp_lt_u32 s53, 0x40000
    s_cbranch_scc1 L_sp_201
L_sp_201_ok:
    s_add_u32 m0, s34, 122880
    s_nop 0
    buffer_load_dwordx4 v8, s[8:11], s37 offen offset:0 sc1 lds
    buffer_load_dwordx4 v8, s[8:11], s37 offen offset:1024 sc1 lds
    buffer_load_dwordx4 v8, s[8:11], s37 offen offset:2048 sc1 lds
    buffer_load_dwordx4 v8, s[8:11], s37 offen offset:3072 sc1 lds
    s_add_u32 s37, s37, 4096
    s_add_u32 m0, s35, 122880
    s_nop 0
    buffer_load_dwordx4 v12, s[12:15], s38 offen offset:0 lds
    buffer_load_dwordx4 v13, s[12:15], s38 offen offset:1024 lds
    s_add_u32 m0, s35, 131072
    s_nop 0
    buffer_load_dwordx4 v14, s[12:15], s38 offen offset:0 lds
    buffer_load_dwordx4 v15, s[12:15], s38 offen offset:1024 lds
    s_add_u32 m0, s35, 139264
    s_nop 0
    buffer_load_dwordx4 v16, s[12:15], s38 offen offset:0 lds
    buffer_load_dwordx4 v17, s[12:15], s38 offen offset:1024 lds
    s_add_u32 s38, s38, 393216
    s_waitcnt vmcnt(20)
    s_barrier
    s_cmp_gt_u32 s63, 12
    s_cbranch_scc1 L_sp_202_ok
    s_mov_b32 s53, 0
L_sp_202:
    buffer_load_dword v5, v4, s[16:19], s52 offen sc1
    s_waitcnt vmcnt(0)
    v_cmp_ne_u32 vcc, 1, v5
    s_nop 0
    s_or_b32 s63, vcc_lo, 0x10000
    s_ff1_i32_b32 s63, s63
    s_cmp_gt_u32 s63, 12
    s_cbranch_scc1 L_sp_202_ok
    s_add_u32 s53, s53, 1
    s_cmp_lt_u32 s53, 0x40000
    s_cbranch_scc1 L_sp_202
L_sp_202_ok:
    s_add_u32 m0, s34, 0
    s_nop 0
    buffer_load_dwordx4 v8, s[8:11], s37 offen offset:0 sc1 lds
    buffer_load_dwordx4 v8, s[8:11], s37 offen offset:1024 sc1 lds
    buffer_load_dwordx4 v8, s[8:11], s37 offen offset:2048 sc1 lds
    buffer_load_dwordx4 v8, s[8:11], s37 offen offset:3072 sc1 lds
    s_add_u32 s37, s37, 4096
    s_add_u32 m0, s35, 0
    s_nop 0
    buffer_load_dwordx4 v12, s[12:15], s38 offen offset:0 lds
    buffer_load_dwordx4 v13, s[12:15], s38 offen offset:1024 lds
    s_add_u32 m0, s35, 8192
    s_nop 0
    buffer_load_dwordx4 v14, s[12:15], s38 offen offset:0 lds
    buffer_load_dwordx4 v15, s[12:15], s38 offen offset:1024 lds
    s_add_u32 m0, s35, 16384
    s_nop 0
    buffer_load_dwordx4 v16, s[12:15], s38 offen offset:0 lds
    buffer_load_dwordx4 v17, s[12:15], s38 offen offset:1024 lds
    s_add_u32 s38, s38, 393216
    s_cmp_gt_u32 s63, 15
    s_cbranch_scc1 L_sp_203_ok
    s_mov_b32 s53, 0
L_sp_203:
    buffer_load_dword v5, v4, s[16:19], s52 offen sc1
    s_waitcnt vmcnt(0)
    v_cmp_ne_u32 vcc, 1, v5
    s_nop 0
    s_or_b32 s63, vcc_lo, 0x10000
    s_ff1_i32_b32 s63, s63
    s_cmp_gt_u32 s63, 15
    s_cbranch_scc1 L_sp_203_ok
    s_add_u32 s53, s53, 1
    s_cmp_lt_u32 s53, 0x40000
    s_cbranch_scc1 L_sp_203
L_sp_203_ok:
    v_lshlrev_b32 v10, 2, v1
    s_lshl_b32 s54, s4, 14
    s_lshl_b32 s55, s30, 8
    s_add_u32 s54, s54, s55
    s_add_u32 s54, s54, 0x2680000
    buffer_load_dword v176, v10, s[16:19], s54 offen offset:0 sc1
    buffer_load_dword v177, v10, s[16:19], s54 offen offset:1024 sc1
    buffer_load_dword v178, v10, s[16:19], s54 offen offset:2048 sc1
    buffer_load_dword v179, v10, s[16:19], s54 offen offset:3072 sc1
    s_add_u32 s54, s54, 4096
    buffer_load_dword v180, v10, s[16:19], s54 offen offset:0 sc1
    buffer_load_dword v181, v10, s[16:19], s54 offen offset:1024 sc1
    buffer_load_dword v182, v10, s[16:19], s54 offen offset:2048 sc1
    buffer_load_dword v183, v10, s[16:19], s54 offen offset:3072 sc1
    s_add_u32 s54, s54, 4096
    buffer_load_dword v184, v10, s[16:19], s54 offen offset:0 sc1
    buffer_load_dword v185, v10, s[16:19], s54 offen offset:1024 sc1
    buffer_load_dword v186, v10, s[16:19], s54 offen offset:2048 sc1
    buffer_load_dword v187, v10, s[16:19], s54 offen offset:3072 sc1
    s_add_u32 s54, s54, 4096
    buffer_load_dword v188, v10, s[16:19], s54 offen offset:0 sc1
    buffer_load_dword v189, v10, s[16:19], s54 offen offset:1024 sc1
    buffer_load_dword v190, v10, s[16:19], s54 offen offset:2048 sc1
    buffer_load_dword v191, v10, s[16:19], s54 offen offset:3072 sc1
    s_waitcnt vmcnt(36)
    s_barrier
    s_cmp_gt_u32 s63, 13
    s_cbranch_scc1 L_sp_204_ok
    s_mov_b32 s53, 0
L_sp_204:
    buffer_load_dword v5, v4, s[16:19], s52 offen sc1
    s_waitcnt vmcnt(0)
    v_cmp_ne_u32 vcc, 1, v5
    s_nop 0
    s_or_b32 s63, vcc_lo, 0x10000
    s_ff1_i32_b32 s63, s63
    s_cmp_gt_u32 s63, 13
    s_cbranch_scc1 L_sp_204_ok
    s_add_u32 s53, s53, 1
    s_cmp_lt_u32 s53, 0x40000
    s_cbranch_scc1 L_sp_204
L_sp_204_ok:
    s_add_u32 m0, s34, 40960
    s_nop 0
    buffer_load_dwordx4 v8, s[8:11], s37 offen offset:0 sc1 lds
    buffer_load_dwordx4 v8, s[8:11], s37 offen offset:1024 sc1 lds
    buffer_load_dwordx4 v8, s[8:11], s37 offen offset:2048 sc1 lds
    buffer_load_dwordx4 v8, s[8:11], s37 offen offset:3072 sc1 lds
    s_add_u32 s37, s37, 4096
    s_add_u32 m0, s35, 40960
    s_nop 0
    buffer_load_dwordx4 v12, s[12:15], s38 offen offset:0 lds
    buffer_load_dwordx4 v13, s[12:15], s38 offen offset:1024 lds
    s_add_u32 m0, s35, 49152
    s_nop 0
    buffer_load_dwordx4 v14, s[12:15], s38 offen offset:0 lds
    buffer_load_dwordx4 v15, s[12:15], s38 offen offset:1024 lds
    s_add_u32 m0, s35, 57344
    s_nop 0
    buffer_load_dwordx4 v16, s[12:15], s38 offen offset:0 lds
    buffer_load_dwordx4 v17, s[12:15], s38 offen offset:1024 lds
    s_add_u32 s38, s38, 393216
    s_waitcnt vmcnt(36)
    s_barrier
    s_cmp_gt_u32 s63, 14
    s_cbranch_scc1 L_sp_205_ok
    s_mov_b32 s53, 0
L_sp_205:
    buffer_load_dword v5, v4, s[16:19], s52 offen sc1
    s_waitcnt vmcnt(0)
    v_cmp_ne_u32 vcc, 1, v5
    s_nop 0
    s_or_b32 s63, vcc_lo, 0x10000
    s_ff1_i32_b32 s63, s63
    s_cmp_gt_u32 s63, 14
    s_cbranch_scc1 L_sp_205_ok
    s_add_u32 s53, s53, 1
    s_cmp_lt_u32 s53, 0x40000
    s_cbranch_scc1 L_sp_205
L_sp_205_ok:
    s_add_u32 m0, s34, 81920
    s_nop 0
    buffer_load_dwordx4 v8, s[8:11], s37 offen offset:0 sc1 lds
    buffer_load_dwordx4 v8, s[8:11], s37 offen offset:1024 sc1 lds
    buffer_load_dwordx4 v8, s[8:11], s37 offen offset:2048 sc1 lds
    buffer_load_dwordx4 v8, s[8:11], s37 offen offset:3072 sc1 lds
    s_add_u32 s37, s37, 4096
    s_add_u32 m0, s35, 81920
    s_nop 0
    buffer_load_dwordx4 v12, s[12:15], s38 offen offset:0 lds
    buffer_load_dwordx4 v13, s[12:15], s38 offen offset:1024 lds
    s_add_u32 m0, s35, 90112
    s_nop 0
    buffer_load_dwordx4 v14, s[12:15], s38 offen offset:0 lds
    buffer_load_dwordx4 v15, s[12:15], s38 offen offset:1024 lds
    s_add_u32 m0, s35, 98304
    s_nop 0
    buffer_load_dwordx4 v16, s[12:15], s38 offen offset:0 lds
    buffer_load_dwordx4 v17, s[12:15], s38 offen offset:1024 lds
    s_add_u32 s38, s38, 393216
    s_waitcnt vmcnt(36)
    s_barrier
    s_cmp_gt_u32 s63, 15
    s_cbranch_scc1 L_sp_206_ok
    s_mov_b32 s53, 0
L_sp_206:
    buffer_load_dword v5, v4, s[16:19], s52 offen sc1
    s_waitcnt vmcnt(0)
    v_cmp_ne_u32 vcc, 1, v5
    s_nop 0
    s_or_b32 s63, vcc_lo, 0x10000
    s_ff1_i32_b32 s63, s63
    s_cmp_gt_u32 s63, 15
    s_cbranch_scc1 L_sp_206_ok
    s_add_u32 s53, s53, 1
    s_cmp_lt_u32 s53, 0x40000
    s_cbranch_scc1 L_sp_206
L_sp_206_ok:
    s_add_u32 m0, s34, 122880
    s_nop 0
    buffer_load_dwordx4 v8, s[8:11], s37 offen offset:0 sc1 lds
    buffer_load_dwordx4 v8, s[8:11], s37 offen offset:1024 sc1 lds
    buffer_load_dwordx4 v8, s[8:11], s37 offen offset:2048 sc1 lds
    buffer_load_dwordx4 v8, s[8:11], s37 offen offset:3072 sc1 lds
    s_add_u32 s37, s37, 4096
    s_add_u32 m0, s35, 122880
    s_nop 0
    buffer_load_dwordx4 v12, s[12:15], s38 offen offset:0 lds
    buffer_load_dwordx4 v13, s[12:15], s38 offen offset:1024 lds
    s_add_u32 m0, s35, 131072
    s_nop 0
    buffer_load_dwordx4 v14, s[12:15], s38 offen offset:0 lds
    buffer_load_dwordx4 v15, s[12:15], s38 offen offset:1024 lds
    s_add_u32 m0, s35, 139264
    s_nop 0
    buffer_load_dwordx4 v16, s[12:15], s38 offen offset:0 lds
    buffer_load_dwordx4 v17, s[12:15], s38 offen offset:1024 lds
    s_add_u32 s38, s38, 393216
    s_waitcnt vmcnt(20)
    s_barrier
    s_setprio 2
    s_waitcnt vmcnt(30)
    v_pk_add_f32 v[176:177], v[176:177], v[184:185]
    v_pk_add_f32 v[178:179], v[178:179], v[186:187]
    v_pk_add_f32 v[180:181], v[180:181], v[188:189]
    v_pk_add_f32 v[182:183], v[182:183], v[190:191]
    v_pk_add_f32 v[176:177], v[176:177], v[180:181]
    v_pk_add_f32 v[178:179], v[178:179], v[182:183]
    v_pk_add_f32 v[176:177], v[176:177], v[178:179]
    v_add_f32 v176, v176, v177
    v_mul_f32 v176, 0x3a800000, v176
    v_mov_b32 v177, v176
    s_nop 1
    v_permlane32_swap_b32 v176, v177
    v_fma_f32 v177, -v176, v176, v177
    v_max_f32 v177, 0, v177
    v_add_f32 v177, 0x3727c5ac, v177
    v_rsq_f32 v64, v177
    v_sub_f32 v176, 0, v176
    v_cvt_pk_bf16_f32 v178, v176, v176
    v_lshlrev_b32 v179, 16, v178
    v_sub_f32 v179, v176, v179
    v_cvt_pk_bf16_f32 v179, v179, v179
    v_cndmask_b32 v68, v178, v179, s[40:41]
    v_mov_b32 v69, v68
    v_mov_b32 v70, v68
    v_mov_b32 v71, v68
    v_lshlrev_b32 v237, 2, v1
    s_lshl_b32 s54, s30, 9
    v_add_u32 v236, s54, v237
    ds_write_b32 v236, v64 offset:0
    ds_write_b32 v236, v68 offset:256
    s_waitcnt lgkmcnt(0)
    s_setprio 0
    s_waitcnt vmcnt(10)
    s_barrier
    s_waitcnt vmcnt(0)
    s_barrier
    s_lshl_b32 s35, s51, 5
    v_add_u32 v238, s35, v2
    v_mul_u32_u24 v238, 200, v238
    v_lshl_add_u32 v238, v3, 3, v238
    s_mul_i32 s35, s49, 25600
    v_add_u32 v238, s35, v238
    s_and_b32 s35, s3, 3
    s_lshl_b32 s35, s35, 12
    s_add_u32 s35, s35, 51200
    v_lshlrev_b32 v239, 4, v1
    v_add_u32 v239, s35, v239
    v_lshl_or_b32 v220, v221, 16, v220
    v_lshl_or_b32 v221, v223, 16, v222
    v_lshl_or_b32 v222, v225, 16, v224
    v_lshl_or_b32 v223, v227, 16, v226
    v_lshl_or_b32 v224, v229, 16, v228
    v_lshl_or_b32 v225, v231, 16, v230
    v_lshl_or_b32 v226, v233, 16, v232
    v_lshl_or_b32 v227, v235, 16, v234
    s_lshl_b32 s35, s51, 9
    v_add_u32 v236, s35, v237
    ds_read_b32 v172, v236 offset:0
    s_waitcnt lgkmcnt(0)
    v_mul_f32 v172, 0x3fb8aa3b, v172
    v_mov_b32 v173, v172
    s_mov_b32 s24, s70
    s_and_b32 s25, s71, 0xffff
    s_mov_b32 s26, 0x200000
    s_mov_b32 s27, 0x20000
    s_and_b32 s57, s2, 1
    s_lshl_b32 s57, s57, 3
    s_bfe_u32 s58, s2, 0x30003
    s_add_u32 s57, s57, s58
    s_lshl_b32 s57, s57, 7
    v_lshrrev_b32 v241, 3, v1
    v_bfe_u32 v242, v241, 1, 1
    v_lshlrev_b32 v242, 2, v242
    v_and_b32 v243, 7, v1
    v_xor_b32 v242, v242, v243
    v_lshlrev_b32 v242, 4, v242
    s_lshl_b32 s58, s30, 4
    v_add_u32 v241, s58, v241
    v_lshl_add_u32 v241, v241, 11, v242
    v_add_u32 v241, s57, v241
    v_add_u32 v242, 15360, v241
    s_lshl_b32 s60, s30, 11
    s_barrier
    s_barrier
    ds_read_b128 v[144:147], v239
    ds_read_b128 v[148:151], v239 offset:1024
    ds_read_b128 v[160:163], v239 offset:2048
    ds_read_b128 v[164:167], v239 offset:3072
    s_waitcnt lgkmcnt(2)
    v_mfma_f32_32x32x16_bf16 v[64:79], v[220:223], v[144:147], 0
    v_mfma_f32_32x32x16_bf16 v[64:79], v[224:227], v[148:151], v[64:79]
L_qa1_j0_185:
    s_nop 11
    v_max3_f32 v208, v64, v65, v66
    v_min3_f32 v210, v64, v65, v66
    v_max3_f32 v208, v208, v67, v68
    v_min3_f32 v210, v210, v67, v68
    v_max3_f32 v208, v208, v69, v70
    v_min3_f32 v210, v210, v69, v70
    v_max3_f32 v208, v208, v71, v72
    v_min3_f32 v210, v210, v71, v72
    v_max3_f32 v208, v208, v73, v74
    v_min3_f32 v210, v210, v73, v74
    v_max3_f32 v208, v208, v75, v76
    v_min3_f32 v210, v210, v75, v76
    v_max3_f32 v208, v208, v77, v78
    v_min3_f32 v210, v210, v77, v78
    v_max_f32 v208, v208, v79
    v_min_f32 v210, v210, v79
    v_mov_b32 v212, v208
    v_mov_b32 v214, v210
    s_nop 0
    v_permlane32_swap_b32 v208, v212
    v_permlane32_swap_b32 v210, v214
    v_max_f32 v208, v208, v212
    v_min_f32 v210, v210, v214
    v_mul_f32 v208, v208, v172
    v_mul_f32 v210, v210, v172
    v_mov_b32 v209, v208
    v_mov_b32 v211, v210
    v_pk_fma_f32 v[176:177], v[64:65], v[172:173], v[208:209] neg_lo:[0,0,1] neg_hi:[0,0,1]
    v_pk_fma_f32 v[192:193], v[64:65], v[172:173], v[210:211] neg_lo:[1,0,0] neg_hi:[1,0,0]
    v_pk_fma_f32 v[178:179], v[66:67], v[172:173], v[208:209] neg_lo:[0,0,1] neg_hi:[0,0,1]
    v_pk_fma_f32 v[194:195], v[66:67], v[172:173], v[210:211] neg_lo:[1,0,0] neg_hi:[1,0,0]
    v_pk_fma_f32 v[180:181], v[68:69], v[172:173], v[208:209] neg_lo:[0,0,1] neg_hi:[0,0,1]
    v_pk_fma_f32 v[196:197], v[68:69], v[172:173], v[210:211] neg_lo:[1,0,0] neg_hi:[1,0,0]
    v_pk_fma_f32 v[182:183], v[70:71], v[172:173], v[208:209] neg_lo:[0,0,1] neg_hi:[0,0,1]
    v_pk_fma_f32 v[198:199], v[70:71], v[172:173], v[210:211] neg_lo:[1,0,0] neg_hi:[1,0,0]
    v_pk_fma_f32 v[184:185], v[72:73], v[172:173], v[208:209] neg_lo:[0,0,1] neg_hi:[0,0,1]
    v_pk_fma_f32 v[200:201], v[72:73], v[172:173], v[210:211] neg_lo:[1,0,0] neg_hi:[1,0,0]
    v_pk_fma_f32 v[186:187], v[74:75], v[172:173], v[208:209] neg_lo:[0,0,1] neg_hi:[0,0,1]
    v_pk_fma_f32 v[202:203], v[74:75], v[172:173], v[210:211] neg_lo:[1,0,0] neg_hi:[1,0,0]
    v_pk_fma_f32 v[188:189], v[76:77], v[172:173], v[208:209] neg_lo:[0,0,1] neg_hi:[0,0,1]
    v_pk_fma_f32 v[204:205], v[76:77], v[172:173], v[210:211] neg_lo:[1,0,0] neg_hi:[1,0,0]
    v_pk_fma_f32 v[190:191], v[78:79], v[172:173], v[208:209] neg_lo:[0,0,1] neg_hi:[0,0,1]
    v_pk_fma_f32 v[206:207], v[78:79], v[172:173], v[210:211] neg_lo:[1,0,0] neg_hi:[1,0,0]
    v_exp_f32 v176, v176
    v_exp_f32 v177, v177
    v_exp_f32 v178, v178
    v_exp_f32 v179, v179
    v_exp_f32 v180, v180
    v_exp_f32 v181, v181
    v_exp_f32 v182, v182
    v_exp_f32 v183, v183
    v_exp_f32 v184, v184
    v_exp_f32 v185, v185
    v_exp_f32 v186, v186
    v_exp_f32 v187, v187
    v_exp_f32 v188, v188
    v_exp_f32 v189, v189
    v_exp_f32 v190, v190
    v_exp_f32 v191, v191
    v_exp_f32 v192, v192
    v_exp_f32 v193, v193
    v_exp_f32 v194, v194
    v_exp_f32 v195, v195
    v_exp_f32 v196, v196
    v_exp_f32 v197, v197
    v_exp_f32 v198, v198
    v_exp_f32 v199, v199
    v_exp_f32 v200, v200
    v_exp_f32 v201, v201
    v_exp_f32 v202, v202
    v_exp_f32 v203, v203
    v_exp_f32 v204, v204
    v_exp_f32 v205, v205
    v_exp_f32 v206, v206
    v_exp_f32 v207, v207
    v_pk_add_f32 v[208:209], v[176:177], v[178:179]
    v_pk_add_f32 v[210:211], v[192:193], v[194:195]
    v_pk_add_f32 v[208:209], v[208:209], v[180:181]
    v_pk_add_f32 v[210:211], v[210:211], v[196:197]
    v_pk_add_f32 v[208:209], v[208:209], v[182:183]
    v_pk_add_f32 v[210:211], v[210:211], v[198:199]
    v_pk_add_f32 v[208:209], v[208:209], v[184:185]
    v_pk_add_f32 v[210:211], v[210:211], v[200:201]
    v_pk_add_f32 v[208:209], v[208:209], v[186:187]
    v_pk_add_f32 v[210:211], v[210:211], v[202:203]
    v_pk_add_f32 v[208:209], v[208:209], v[188:189]
    v_pk_add_f32 v[210:211], v[210:211], v[204:205]
    v_pk_add_f32 v[208:209], v[208:209], v[190:191]
    v_pk_add_f32 v[210:211], v[210:211], v[206:207]
    v_add_f32 v208, v208, v209
    v_add_f32 v210, v210, v211
    v_mov_b32 v212, v208
    v_mov_b32 v214, v210
    s_nop 0
    v_permlane32_swap_b32 v208, v212
    v_permlane32_swap_b32 v210, v214
    v_add_f32 v208, v208, v212
    v_add_f32 v210, v210, v214
    v_rcp_f32 v208, v208
    v_rcp_f32 v210, v210
    v_mov_b32 v209, v208
    v_mov_b32 v211, v210
    v_pk_mul_f32 v[176:177], v[176:177], v[208:209]
    v_pk_mul_f32 v[178:179], v[178:179], v[208:209]
    v_pk_mul_f32 v[180:181], v[180:181], v[208:209]
    v_pk_mul_f32 v[182:183], v[182:183], v[208:209]
    v_pk_mul_f32 v[184:185], v[184:185], v[208:209]
    v_pk_mul_f32 v[186:187], v[186:187], v[208:209]
    v_pk_mul_f32 v[188:189], v[188:189], v[208:209]
    v_pk_mul_f32 v[190:191], v[190:191], v[208:209]
    v_pk_mul_f32 v[192:193], v[192:193], v[210:211]
    v_pk_mul_f32 v[194:195], v[194:195], v[210:211]
    v_pk_mul_f32 v[196:197], v[196:197], v[210:211]
    v_pk_mul_f32 v[198:199], v[198:199], v[210:211]
    v_pk_mul_f32 v[200:201], v[200:201], v[210:211]
    v_pk_mul_f32 v[202:203], v[202:203], v[210:211]
    v_pk_mul_f32 v[204:205], v[204:205], v[210:211]
    v_pk_mul_f32 v[206:207], v[206:207], v[210:211]
    v_cvt_pk_bf16_f32 v144, v176, v177
    v_cvt_pk_bf16_f32 v145, v178, v179
    v_cvt_pk_bf16_f32 v146, v180, v181
    v_cvt_pk_bf16_f32 v147, v182, v183
    v_cvt_pk_bf16_f32 v148, v184, v185
    v_cvt_pk_bf16_f32 v149, v186, v187
    v_cvt_pk_bf16_f32 v150, v188, v189
    v_cvt_pk_bf16_f32 v151, v190, v191
    v_cvt_pk_bf16_f32 v152, v192, v193
    v_cvt_pk_bf16_f32 v153, v194, v195
    v_cvt_pk_bf16_f32 v154, v196, v197
    v_cvt_pk_bf16_f32 v155, v198, v199
    v_cvt_pk_bf16_f32 v156, v200, v201
    v_cvt_pk_bf16_f32 v157, v202, v203
    v_cvt_pk_bf16_f32 v158, v204, v205
    v_cvt_pk_bf16_f32 v159, v206, v207
    ds_write_b64 v238, v[144:145] offset:0
    ds_write_b64 v238, v[146:147] offset:16
    ds_write_b64 v238, v[148:149] offset:32
    ds_write_b64 v238, v[150:151] offset:48
    ds_write_b64 v238, v[152:153] offset:64
    ds_write_b64 v238, v[154:155] offset:80
    ds_write_b64 v238, v[156:157] offset:96
    ds_write_b64 v238, v[158:159] offset:112
    s_waitcnt lgkmcnt(8)
    v_mfma_f32_32x32x16_bf16 v[96:111], v[220:223], v[160:163], 0
    v_mfma_f32_32x32x16_bf16 v[96:111], v[224:227], v[164:167], v[96:111]
    v_and_b32 v4, 15, v1
    v_lshrrev_b32 v5, 2, v4
    v_lshl_add_u32 v5, v5, 3, v3
    v_mul_u32_u24 v5, 200, v5
    v_and_b32 v6, 3, v4
    v_lshl_add_u32 v5, v6, 3, v5
    v_bfe_u32 v7, v1, 4, 1
    v_lshl_add_u32 v5, v7, 5, v5
    s_mul_i32 s35, s49, 25600
    v_add_u32 v14, s35, v5
    s_lshl_b32 s35, s48, 6
    v_add_u32 v15, s35, v14
    v_bfe_u32 v28, v1, 2, 1
    v_bfe_u32 v29, v1, 4, 1
    v_cmp_eq_u32 vcc, v28, v29
    v_mov_b32 v28, 0x3f803f80
    s_nop 0
    v_cndmask_b32 v24, 0, v28, vcc
    v_mov_b32 v25, v24
    v_mov_b32 v26, v24
    v_mov_b32 v27, v24
    s_lshl_b32 s36, s50, 16
    s_lshl_b32 s35, s4, 12
    s_add_u32 s36, s36, s35
    s_lshl_b32 s35, s48, 11
    s_add_u32 s36, s36, s35
    s_add_u32 s36, s36, 0x2000000
    s_lshl_b32 s39, s50, 12
    s_lshl_b32 s35, s4, 8
    s_add_u32 s39, s39, s35
    s_lshl_b32 s35, s48, 7
    s_add_u32 s39, s39, s35
    s_add_u32 s39, s39, 0x2520000
    v_lshlrev_b32 v11, 2, v2
    v_lshlrev_b32 v10, 4, v1
    s_waitcnt lgkmcnt(0)
    s_barrier
    s_cmp_ge_u32 s3, 4
    s_cbranch_scc1 L_qa1_j1_186
    ds_read_b64_tr_b16 v[176:177], v15 offset:0
    ds_read_b64_tr_b16 v[180:181], v14 offset:128
    ds_read_b64_tr_b16 v[178:179], v15 offset:400
    ds_read_b64_tr_b16 v[182:183], v14 offset:528
    ds_read_b64_tr_b16 v[184:185], v15 offset:800
    ds_read_b64_tr_b16 v[188:189], v14 offset:928
    ds_read_b64_tr_b16 v[186:187], v15 offset:1200
    ds_read_b64_tr_b16 v[190:191], v14 offset:1328
    ds_read_b64_tr_b16 v[192:193], v15 offset:6400
    ds_read_b64_tr_b16 v[196:197], v14 offset:6528
    ds_read_b64_tr_b16 v[194:195], v15 offset:6800
    ds_read_b64_tr_b16 v[198:199], v14 offset:6928
    s_waitcnt lgkmcnt(8)
    v_mfma_f32_32x32x16_bf16 v[32:47], v[176:179], v[180:183], 0
    v_mfma_f32_16x16x32_bf16 v[48:51], v[24:27], v[176:179], 0
    ds_read_b64_tr_b16 v[200:201], v15 offset:7200
    ds_read_b64_tr_b16 v[204:205], v14 offset:7328
    ds_read_b64_tr_b16 v[202:203], v15 offset:7600
    ds_read_b64_tr_b16 v[206:207], v14 offset:7728
    s_waitcnt lgkmcnt(8)
    v_mfma_f32_32x32x16_bf16 v[32:47], v[184:187], v[188:191], v[32:47]
    v_mfma_f32_16x16x32_bf16 v[48:51], v[24:27], v[184:187], v[48:51]
    ds_read_b64_tr_b16 v[176:177], v15 offset:12800
    ds_read_b64_tr_b16 v[180:181], v14 offset:12928
    ds_read_b64_tr_b16 v[178:179], v15 offset:13200
    ds_read_b64_tr_b16 v[182:183], v14 offset:13328
    s_waitcnt lgkmcnt(8)
    v_mfma_f32_32x32x16_bf16 v[32:47], v[192:195], v[196:199], v[32:47]
    v_mfma_f32_16x16x32_bf16 v[48:51], v[24:27], v[192:195], v[48:51]
    ds_read_b64_tr_b16 v[184:185], v15 offset:13600
    ds_read_b64_tr_b16 v[188:189], v14 offset:13728
    ds_read_b64_tr_b16 v[186:187], v15 offset:14000
    ds_read_b64_tr_b16 v[190:191], v14 offset:14128
    s_waitcnt lgkmcnt(8)
    v_mfma_f32_32x32x16_bf16 v[32:47], v[200:203], v[204:207], v[32:47]
    v_mfma_f32_16x16x32_bf16 v[48:51], v[24:27], v[200:203], v[48:51]
    ds_read_b64_tr_b16 v[192:193], v15 offset:19200
    ds_read_b64_tr_b16 v[196:197], v14 offset:19328
    ds_read_b64_tr_b16 v[194:195], v15 offset:19600
    ds_read_b64_tr_b16 v[198:199], v14 offset:19728
    s_waitcnt lgkmcnt(8)
    v_mfma_f32_32x32x16_bf16 v[32:47], v[176:179], v[180:183], v[32:47]
    v_mfma_f32_16x16x32_bf16 v[48:51], v[24:27], v[176:179], v[48:51]
    ds_read_b64_tr_b16 v[200:201], v15 offset:20000
    ds_read_b64_tr_b16 v[204:205], v14 offset:20128
    ds_read_b64_tr_b16 v[202:203], v15 offset:20400
    ds_read_b64_tr_b16 v[206:207], v14 offset:20528
    s_waitcnt lgkmcnt(8)
    v_mfma_f32_32x32x16_bf16 v[32:47], v[184:187], v[188:191], v[32:47]
    v_mfma_f32_16x16x32_bf16 v[48:51], v[24:27], v[184:187], v[48:51]
    s_waitcnt lgkmcnt(4)
    v_mfma_f32_32x32x16_bf16 v[32:47], v[192:195], v[196:199], v[32:47]
    v_mfma_f32_16x16x32_bf16 v[48:51], v[24:27], v[192:195], v[48:51]
    s_waitcnt lgkmcnt(0)
    v_mfma_f32_32x32x16_bf16 v[32:47], v[200:203], v[204:207], v[32:47]
    v_mfma_f32_16x16x32_bf16 v[48:51], v[24:27], v[200:203], v[48:51]
    s_nop 7
    buffer_store_dword v48, v11, s[16:19], s39 offen sc1
    s_nop 1
    v_cvt_pk_bf16_f32 v56, v32, v33
    v_cvt_pk_bf16_f32 v57, v34, v35
    v_cvt_pk_bf16_f32 v58, v36, v37
    v_cvt_pk_bf16_f32 v59, v38, v39
    v_cvt_pk_bf16_f32 v60, v40, v41
    v_cvt_pk_bf16_f32 v61, v42, v43
    v_cvt_pk_bf16_f32 v62, v44, v45
    v_cvt_pk_bf16_f32 v63, v46, v47
    buffer_store_dwordx4 v[56:59], v10, s[16:19], s36 offen offset:0 sc1
    buffer_store_dwordx4 v[60:63], v10, s[16:19], s36 offen offset:1024 sc1
    v_max3_f32 v208, v96, v97, v98
    v_min3_f32 v210, v96, v97, v98
    v_max3_f32 v208, v208, v99, v100
    v_min3_f32 v210, v210, v99, v100
    v_max3_f32 v208, v208, v101, v102
    v_min3_f32 v210, v210, v101, v102
    v_max3_f32 v208, v208, v103, v104
    v_min3_f32 v210, v210, v103, v104
    v_max3_f32 v208, v208, v105, v106
    v_min3_f32 v210, v210, v105, v106
    v_max3_f32 v208, v208, v107, v108
    v_min3_f32 v210, v210, v107, v108
    v_max3_f32 v208, v208, v109, v110
    v_min3_f32 v210, v210, v109, v110
    v_max_f32 v208, v208, v111
    v_min_f32 v210, v210, v111
    v_mov_b32 v212, v208
    v_mov_b32 v214, v210
    s_nop 0
    v_permlane32_swap_b32 v208, v212
    v_permlane32_swap_b32 v210, v214
    v_max_f32 v208, v208, v212
    v_min_f32 v210, v210, v214
    v_mul_f32 v208, v208, v172
    v_mul_f32 v210, v210, v172
    v_mov_b32 v209, v208
    v_mov_b32 v211, v210
    v_pk_fma_f32 v[176:177], v[96:97], v[172:173], v[208:209] neg_lo:[0,0,1] neg_hi:[0,0,1]
    v_pk_fma_f32 v[192:193], v[96:97], v[172:173], v[210:211] neg_lo:[1,0,0] neg_hi:[1,0,0]
    v_pk_fma_f32 v[178:179], v[98:99], v[172:173], v[208:209] neg_lo:[0,0,1] neg_hi:[0,0,1]
    v_pk_fma_f32 v[194:195], v[98:99], v[172:173], v[210:211] neg_lo:[1,0,0] neg_hi:[1,0,0]
    v_pk_fma_f32 v[180:181], v[100:101], v[172:173], v[208:209] neg_lo:[0,0,1] neg_hi:[0,0,1]
    v_pk_fma_f32 v[196:197], v[100:101], v[172:173], v[210:211] neg_lo:[1,0,0] neg_hi:[1,0,0]
    v_pk_fma_f32 v[182:183], v[102:103], v[172:173], v[208:209] neg_lo:[0,0,1] neg_hi:[0,0,1]
    v_pk_fma_f32 v[198:199], v[102:103], v[172:173], v[210:211] neg_lo:[1,0,0] neg_hi:[1,0,0]
    v_pk_fma_f32 v[184:185], v[104:105], v[172:173], v[208:209] neg_lo:[0,0,1] neg_hi:[0,0,1]
    v_pk_fma_f32 v[200:201], v[104:105], v[172:173], v[210:211] neg_lo:[1,0,0] neg_hi:[1,0,0]
    v_pk_fma_f32 v[186:187], v[106:107], v[172:173], v[208:209] neg_lo:[0,0,1] neg_hi:[0,0,1]
    v_pk_fma_f32 v[202:203], v[106:107], v[172:173], v[210:211] neg_lo:[1,0,0] neg_hi:[1,0,0]
    v_pk_fma_f32 v[188:189], v[108:109], v[172:173], v[208:209] neg_lo:[0,0,1] neg_hi:[0,0,1]
    v_pk_fma_f32 v[204:205], v[108:109], v[172:173], v[210:211] neg_lo:[1,0,0] neg_hi:[1,0,0]
    v_pk_fma_f32 v[190:191], v[110:111], v[172:173], v[208:209] neg_lo:[0,0,1] neg_hi:[0,0,1]
    v_pk_fma_f32 v[206:207], v[110:111], v[172:173], v[210:211] neg_lo:[1,0,0] neg_hi:[1,0,0]
    v_exp_f32 v176, v176
    v_exp_f32 v177, v177
    v_exp_f32 v178, v178
    v_exp_f32 v179, v179
    v_exp_f32 v180, v180
    v_exp_f32 v181, v181
    v_exp_f32 v182, v182
    v_exp_f32 v183, v183
    v_exp_f32 v184, v184
    v_exp_f32 v185, v185
    v_exp_f32 v186, v186
    v_exp_f32 v187, v187
    v_exp_f32 v188, v188
    v_exp_f32 v189, v189
    v_exp_f32 v190, v190
    v_exp_f32 v191, v191
    v_exp_f32 v192, v192
    v_exp_f32 v193, v193
    v_exp_f32 v194, v194
    v_exp_f32 v195, v195
    v_exp_f32 v196, v196
    v_exp_f32 v197, v197
    v_exp_f32 v198, v198
    v_exp_f32 v199, v199
    v_exp_f32 v200, v200
    v_exp_f32 v201, v201
    v_exp_f32 v202, v202
    v_exp_f32 v203, v203
    v_exp_f32 v204, v204
    v_exp_f32 v205, v205
    v_exp_f32 v206, v206
    v_exp_f32 v207, v207
    v_pk_add_f32 v[208:209], v[176:177], v[178:179]
    v_pk_add_f32 v[210:211], v[192:193], v[194:195]
    v_pk_add_f32 v[208:209], v[208:209], v[180:181]
    v_pk_add_f32 v[210:211], v[210:211], v[196:197]
    v_pk_add_f32 v[208:209], v[208:209], v[182:183]
    v_pk_add_f32 v[210:211], v[210:211], v[198:199]
    v_pk_add_f32 v[208:209], v[208:209], v[184:185]
    v_pk_add_f32 v[210:211], v[210:211], v[200:201]
    v_pk_add_f32 v[208:209], v[208:209], v[186:187]
    v_pk_add_f32 v[210:211], v[210:211], v[202:203]
    v_pk_add_f32 v[208:209], v[208:209], v[188:189]
    v_pk_add_f32 v[210:211], v[210:211], v[204:205]
    v_pk_add_f32 v[208:209], v[208:209], v[190:191]
    v_pk_add_f32 v[210:211], v[210:211], v[206:207]
    v_add_f32 v208, v208, v209
    v_add_f32 v210, v210, v211
    v_mov_b32 v212, v208
    v_mov_b32 v214, v210
    s_nop 0
    v_permlane32_swap_b32 v208, v212
    v_permlane32_swap_b32 v210, v214
    v_add_f32 v208, v208, v212
    v_add_f32 v210, v210, v214
    v_rcp_f32 v208, v208
    v_rcp_f32 v210, v210
    v_mov_b32 v209, v208
    v_mov_b32 v211, v210
    v_pk_mul_f32 v[176:177], v[176:177], v[208:209]
    v_pk_mul_f32 v[178:179], v[178:179], v[208:209]
    v_pk_mul_f32 v[180:181], v[180:181], v[208:209]
    v_pk_mul_f32 v[182:183], v[182:183], v[208:209]
    v_pk_mul_f32 v[184:185], v[184:185], v[208:209]
    v_pk_mul_f32 v[186:187], v[186:187], v[208:209]
    v_pk_mul_f32 v[188:189], v[188:189], v[208:209]
    v_pk_mul_f32 v[190:191], v[190:191], v[208:209]
    v_pk_mul_f32 v[192:193], v[192:193], v[210:211]
    v_pk_mul_f32 v[194:195], v[194:195], v[210:211]
    v_pk_mul_f32 v[196:197], v[196:197], v[210:211]
    v_pk_mul_f32 v[198:199], v[198:199], v[210:211]
    v_pk_mul_f32 v[200:201], v[200:201], v[210:211]
    v_pk_mul_f32 v[202:203], v[202:203], v[210:211]
    v_pk_mul_f32 v[204:205], v[204:205], v[210:211]
    v_pk_mul_f32 v[206:207], v[206:207], v[210:211]
    v_cvt_pk_bf16_f32 v144, v176, v177
    v_cvt_pk_bf16_f32 v145, v178, v179
    v_cvt_pk_bf16_f32 v146, v180, v181
    v_cvt_pk_bf16_f32 v147, v182, v183
    v_cvt_pk_bf16_f32 v148, v184, v185
    v_cvt_pk_bf16_f32 v149, v186, v187
    v_cvt_pk_bf16_f32 v150, v188, v189
    v_cvt_pk_bf16_f32 v151, v190, v191
    v_cvt_pk_bf16_f32 v152, v192, v193
    v_cvt_pk_bf16_f32 v153, v194, v195
    v_cvt_pk_bf16_f32 v154, v196, v197
    v_cvt_pk_bf16_f32 v155, v198, v199
    v_cvt_pk_bf16_f32 v156, v200, v201
    v_cvt_pk_bf16_f32 v157, v202, v203
    v_cvt_pk_bf16_f32 v158, v204, v205
    v_cvt_pk_bf16_f32 v159, v206, v207
    s_waitcnt vmcnt(0)
    s_lshl_b32 s34, s5, 8
    s_add_u32 s34, s34, 0x2806000
    v_mov_b32 v4, 1
    v_mov_b32 v5, 0
    s_mov_b64 exec, 1
    v_mov_b32 v6, 163816
    ds_add_rtn_u32 v7, v6, v4
    s_waitcnt lgkmcnt(0)
    v_readfirstlane_b32 s35, v7
    s_nop 0
    s_cmp_eq_u32 s35, 3
    s_cbranch_scc0 L_sig_207
    s_lshl_b32 s35, s4, 2
    s_add_u32 s34, s34, s35
    buffer_store_dword v4, v5, s[16:19], s34 offen sc1
L_sig_207:
    s_mov_b64 exec, -1
    s_branch L_qa1_np_188
L_qa1_j1_186:
    s_add_u32 m0, s60, 81920
    s_mov_b32 s59, 0
    buffer_load_dwordx4 v241, s[24:27], s59 offen lds
    buffer_load_dwordx4 v242, s[24:27], s59 offen offset:1024 lds
    s_add_u32 m0, s60, 90112
    s_mov_b32 s59, 131072
    buffer_load_dwordx4 v241, s[24:27], s59 offen lds
    buffer_load_dwordx4 v242, s[24:27], s59 offen offset:1024 lds
    s_add_u32 m0, s60, 98304
    s_mov_b32 s59, 262144
    buffer_load_dwordx4 v241, s[24:27], s59 offen lds
    buffer_load_dwordx4 v242, s[24:27], s59 offen offset:1024 lds
    s_add_u32 m0, s60, 106496
    s_mov_b32 s59, 524288
    buffer_load_dwordx4 v241, s[24:27], s59 offen lds
    buffer_load_dwordx4 v242, s[24:27], s59 offen offset:1024 lds
    s_add_u32 m0, s60, 114688
    s_mov_b32 s59, 655360
    buffer_load_dwordx4 v241, s[24:27], s59 offen lds
    buffer_load_dwordx4 v242, s[24:27], s59 offen offset:1024 lds
    s_add_u32 m0, s60, 122880
    s_mov_b32 s59, 786432
    buffer_load_dwordx4 v241, s[24:27], s59 offen lds
    buffer_load_dwordx4 v242, s[24:27], s59 offen offset:1024 lds
    s_add_u32 m0, s60, 131072
    s_mov_b32 s59, 917504
    buffer_load_dwordx4 v241, s[24:27], s59 offen lds
    buffer_load_dwordx4 v242, s[24:27], s59 offen offset:1024 lds
    s_add_u32 m0, s60, 139264
    s_mov_b32 s59, 1048576
    buffer_load_dwordx4 v241, s[24:27], s59 offen lds
    buffer_load_dwordx4 v242, s[24:27], s59 offen offset:1024 lds
    s_add_u32 m0, s60, 147456
    s_mov_b32 s59, 1179648
    buffer_load_dwordx4 v241, s[24:27], s59 offen lds
    buffer_load_dwordx4 v242, s[24:27], s59 offen offset:1024 lds
    v_max3_f32 v208, v96, v97, v98
    v_min3_f32 v210, v96, v97, v98
    v_max3_f32 v208, v208, v99, v100
    v_min3_f32 v210, v210, v99, v100
    v_max3_f32 v208, v208, v101, v102
    v_min3_f32 v210, v210, v101, v102
    v_max3_f32 v208, v208, v103, v104
    v_min3_f32 v210, v210, v103, v104
    v_max3_f32 v208, v208, v105, v106
    v_min3_f32 v210, v210, v105, v106
    v_max3_f32 v208, v208, v107, v108
    v_min3_f32 v210, v210, v107, v108
    v_max3_f32 v208, v208, v109, v110
    v_min3_f32 v210, v210, v109, v110
    v_max_f32 v208, v208, v111
    v_min_f32 v210, v210, v111
    v_mov_b32 v212, v208
    v_mov_b32 v214, v210
    s_nop 0
    v_permlane32_swap_b32 v208, v212
    v_permlane32_swap_b32 v210, v214
    v_max_f32 v208, v208, v212
    v_min_f32 v210, v210, v214
    v_mul_f32 v208, v208, v172
    v_mul_f32 v210, v210, v172
    v_mov_b32 v209, v208
    v_mov_b32 v211, v210
    v_pk_fma_f32 v[176:177], v[96:97], v[172:173], v[208:209] neg_lo:[0,0,1] neg_hi:[0,0,1]
    v_pk_fma_f32 v[192:193], v[96:97], v[172:173], v[210:211] neg_lo:[1,0,0] neg_hi:[1,0,0]
    v_pk_fma_f32 v[178:179], v[98:99], v[172:173], v[208:209] neg_lo:[0,0,1] neg_hi:[0,0,1]
    v_pk_fma_f32 v[194:195], v[98:99], v[172:173], v[210:211] neg_lo:[1,0,0] neg_hi:[1,0,0]
    v_pk_fma_f32 v[180:181], v[100:101], v[172:173], v[208:209] neg_lo:[0,0,1] neg_hi:[0,0,1]
    v_pk_fma_f32 v[196:197], v[100:101], v[172:173], v[210:211] neg_lo:[1,0,0] neg_hi:[1,0,0]
    v_pk_fma_f32 v[182:183], v[102:103], v[172:173], v[208:209] neg_lo:[0,0,1] neg_hi:[0,0,1]
    v_pk_fma_f32 v[198:199], v[102:103], v[172:173], v[210:211] neg_lo:[1,0,0] neg_hi:[1,0,0]
    v_pk_fma_f32 v[184:185], v[104:105], v[172:173], v[208:209] neg_lo:[0,0,1] neg_hi:[0,0,1]
    v_pk_fma_f32 v[200:201], v[104:105], v[172:173], v[210:211] neg_lo:[1,0,0] neg_hi:[1,0,0]
    v_pk_fma_f32 v[186:187], v[106:107], v[172:173], v[208:209] neg_lo:[0,0,1] neg_hi:[0,0,1]
    v_pk_fma_f32 v[202:203], v[106:107], v[172:173], v[210:211] neg_lo:[1,0,0] neg_hi:[1,0,0]
    v_pk_fma_f32 v[188:189], v[108:109], v[172:173], v[208:209] neg_lo:[0,0,1] neg_hi:[0,0,1]
    v_pk_fma_f32 v[204:205], v[108:109], v[172:173], v[210:211] neg_lo:[1,0,0] neg_hi:[1,0,0]
    v_pk_fma_f32 v[190:191], v[110:111], v[172:173], v[208:209] neg_lo:[0,0,1] neg_hi:[0,0,1]
    v_pk_fma_f32 v[206:207], v[110:111], v[172:173], v[210:211] neg_lo:[1,0,0] neg_hi:[1,0,0]
    v_exp_f32 v176, v176
    v_exp_f32 v177, v177
    v_exp_f32 v178, v178
    v_exp_f32 v179, v179
    v_exp_f32 v180, v180
    v_exp_f32 v181, v181
    v_exp_f32 v182, v182
    v_exp_f32 v183, v183
    v_exp_f32 v184, v184
    v_exp_f32 v185, v185
    v_exp_f32 v186, v186
    v_exp_f32 v187, v187
    v_exp_f32 v188, v188
    v_exp_f32 v189, v189
    v_exp_f32 v190, v190
    v_exp_f32 v191, v191
    v_exp_f32 v192, v192
    v_exp_f32 v193, v193
    v_exp_f32 v194, v194
    v_exp_f32 v195, v195
    v_exp_f32 v196, v196
    v_exp_f32 v197, v197
    v_exp_f32 v198, v198
    v_exp_f32 v199, v199
    v_exp_f32 v200, v200
    v_exp_f32 v201, v201
    v_exp_f32 v202, v202
    v_exp_f32 v203, v203
    v_exp_f32 v204, v204
    v_exp_f32 v205, v205
    v_exp_f32 v206, v206
    v_exp_f32 v207, v207
    v_pk_add_f32 v[208:209], v[176:177], v[178:179]
    v_pk_add_f32 v[210:211], v[192:193], v[194:195]
    v_pk_add_f32 v[208:209], v[208:209], v[180:181]
    v_pk_add_f32 v[210:211], v[210:211], v[196:197]
    v_pk_add_f32 v[208:209], v[208:209], v[182:183]
    v_pk_add_f32 v[210:211], v[210:211], v[198:199]
    v_pk_add_f32 v[208:209], v[208:209], v[184:185]
    v_pk_add_f32 v[210:211], v[210:211], v[200:201]
    v_pk_add_f32 v[208:209], v[208:209], v[186:187]
    v_pk_add_f32 v[210:211], v[210:211], v[202:203]
    v_pk_add_f32 v[208:209], v[208:209], v[188:189]
    v_pk_add_f32 v[210:211], v[210:211], v[204:205]
    v_pk_add_f32 v[208:209], v[208:209], v[190:191]
    v_pk_add_f32 v[210:211], v[210:211], v[206:207]
    v_add_f32 v208, v208, v209
    v_add_f32 v210, v210, v211
    v_mov_b32 v212, v208
    v_mov_b32 v214, v210
    s_nop 0
    v_permlane32_swap_b32 v208, v212
    v_permlane32_swap_b32 v210, v214
    v_add_f32 v208, v208, v212
    v_add_f32 v210, v210, v214
    v_rcp_f32 v208, v208
    v_rcp_f32 v210, v210
    v_mov_b32 v209, v208
    v_mov_b32 v211, v210
    v_pk_mul_f32 v[176:177], v[176:177], v[208:209]
    v_pk_mul_f32 v[178:179], v[178:179], v[208:209]
    v_pk_mul_f32 v[180:181], v[180:181], v[208:209]
    v_pk_mul_f32 v[182:183], v[182:183], v[208:209]
    v_pk_mul_f32 v[184:185], v[184:185], v[208:209]
    v_pk_mul_f32 v[186:187], v[186:187], v[208:209]
    v_pk_mul_f32 v[188:189], v[188:189], v[208:209]
    v_pk_mul_f32 v[190:191], v[190:191], v[208:209]
    v_pk_mul_f32 v[192:193], v[192:193], v[210:211]
    v_pk_mul_f32 v[194:195], v[194:195], v[210:211]
    v_pk_mul_f32 v[196:197], v[196:197], v[210:211]
    v_pk_mul_f32 v[198:199], v[198:199], v[210:211]
    v_pk_mul_f32 v[200:201], v[200:201], v[210:211]
    v_pk_mul_f32 v[202:203], v[202:203], v[210:211]
    v_pk_mul_f32 v[204:205], v[204:205], v[210:211]
    v_pk_mul_f32 v[206:207], v[206:207], v[210:211]
    v_cvt_pk_bf16_f32 v144, v176, v177
    v_cvt_pk_bf16_f32 v145, v178, v179
    v_cvt_pk_bf16_f32 v146, v180, v181
    v_cvt_pk_bf16_f32 v147, v182, v183
    v_cvt_pk_bf16_f32 v148, v184, v185
    v_cvt_pk_bf16_f32 v149, v186, v187
    v_cvt_pk_bf16_f32 v150, v188, v189
    v_cvt_pk_bf16_f32 v151, v190, v191
    v_cvt_pk_bf16_f32 v152, v192, v193
    v_cvt_pk_bf16_f32 v153, v194, v195
    v_cvt_pk_bf16_f32 v154, v196, v197
    v_cvt_pk_bf16_f32 v155, v198, v199
    v_cvt_pk_bf16_f32 v156, v200, v201
    v_cvt_pk_bf16_f32 v157, v202, v203
    v_cvt_pk_bf16_f32 v158, v204, v205
    v_cvt_pk_bf16_f32 v159, v206, v207
    s_cmp_lg_u32 s3, 7
    s_cbranch_scc1 L_rp_208_ok
    v_and_b32 v4, 15, v1
    v_lshlrev_b32 v4, 2, v4
    s_lshl_b32 s52, s5, 8
    s_add_u32 s52, s52, 0x2806000
    s_mov_b32 s53, 0
    v_mov_b32 v6, 163824
L_rp_208:
    buffer_load_dword v5, v4, s[16:19], s52 offen sc1
    s_waitcnt vmcnt(0)
    v_cmp_ne_u32 vcc, 1, v5
    s_nop 0
    s_or_b32 s63, vcc_lo, 0x10000
    s_ff1_i32_b32 s63, s63
    s_add_u32 s53, s53, 1
    s_cmp_lt_u32 s53, 0x40000
    s_cselect_b32 s63, s63, 16
    v_mov_b32 v7, s63
    ds_write_b32 v6, v7
    s_cmp_lt_u32 s63, 16
    s_cbranch_scc1 L_rp_208
L_rp_208_ok:
L_qa1_np_188:
    s_lshr_b32 s36, s3, 2
    s_and_b32 s37, s3, 3
    s_lshl_b32 s38, s5, 1
    s_add_u32 s38, s38, s36
    v_lshlrev_b32 v11, 2, v1
    s_lshl_b32 s34, s38, 16
    s_lshl_b32 s35, s37, 10
    s_add_u32 s34, s34, s35
    s_add_u32 s34, s34, 0x2000000
    s_lshl_b32 s39, s38, 12
    s_add_u32 s39, s39, s35
    s_add_u32 s39, s39, 0x2520000
    v_mov_b32 v4, 163824
    s_mov_b32 s63, 0
    s_cmp_gt_u32 s63, 0
    s_cbranch_scc1 L_cp_209_ok
L_cp_209:
    ds_read_b32 v5, v4
    s_waitcnt lgkmcnt(0)
    v_readfirstlane_b32 s63, v5
    s_nop 0
    s_cmp_gt_u32 s63, 0
    s_cbranch_scc0 L_cp_209
L_cp_209_ok:
    buffer_load_dwordx4 v[48:51], v10, s[16:19], s34 offen sc1
    s_add_u32 s34, s34, 4096
    s_cmp_gt_u32 s63, 1
    s_cbranch_scc1 L_cp_210_ok
L_cp_210:
    ds_read_b32 v5, v4
    s_waitcnt lgkmcnt(0)
    v_readfirstlane_b32 s63, v5
    s_nop 0
    s_cmp_gt_u32 s63, 1
    s_cbranch_scc0 L_cp_210
L_cp_210_ok:
    buffer_load_dwordx4 v[52:55], v10, s[16:19], s34 offen sc1
    s_add_u32 s34, s34, 4096
    s_cmp_gt_u32 s63, 2
    s_cbranch_scc1 L_cp_211_ok
L_cp_211:
    ds_read_b32 v5, v4
    s_waitcnt lgkmcnt(0)
    v_readfirstlane_b32 s63, v5
    s_nop 0
    s_cmp_gt_u32 s63, 2
    s_cbranch_scc0 L_cp_211
L_cp_211_ok:
    buffer_load_dwordx4 v[56:59], v10, s[16:19], s34 offen sc1
    s_add_u32 s34, s34, 4096
    s_cmp_gt_u32 s63, 3
    s_cbranch_scc1 L_cp_212_ok
L_cp_212:
    ds_read_b32 v5, v4
    s_waitcnt lgkmcnt(0)
    v_readfirstlane_b32 s63, v5
    s_nop 0
    s_cmp_gt_u32 s63, 3
    s_cbranch_scc0 L_cp_212
L_cp_212_ok:
    buffer_load_dwordx4 v[60:63], v10, s[16:19], s34 offen sc1
    s_add_u32 s34, s34, 4096
    s_cmp_gt_u32 s63, 4
    s_cbranch_scc1 L_cp_213_ok
L_cp_213:
    ds_read_b32 v5, v4
    s_waitcnt lgkmcnt(0)
    v_readfirstlane_b32 s63, v5
    s_nop 0
    s_cmp_gt_u32 s63, 4
    s_cbranch_scc0 L_cp_213
L_cp_213_ok:
    buffer_load_dwordx4 v[64:67], v10, s[16:19], s34 offen sc1
    s_add_u32 s34, s34, 4096
    s_cmp_gt_u32 s63, 5
    s_cbranch_scc1 L_cp_214_ok
L_cp_214:
    ds_read_b32 v5, v4
    s_waitcnt lgkmcnt(0)
    v_readfirstlane_b32 s63, v5
    s_nop 0
    s_cmp_gt_u32 s63, 5
    s_cbranch_scc0 L_cp_214
L_cp_214_ok:
    buffer_load_dwordx4 v[68:71], v10, s[16:19], s34 offen sc1
    s_add_u32 s34, s34, 4096
    s_cmp_gt_u32 s63, 6
    s_cbranch_scc1 L_cp_215_ok
L_cp_215:
    ds_read_b32 v5, v4
    s_waitcnt lgkmcnt(0)
    v_readfirstlane_b32 s63, v5
    s_nop 0
    s_cmp_gt_u32 s63, 6
    s_cbranch_scc0 L_cp_215
L_cp_215_ok:
    buffer_load_dwordx4 v[72:75], v10, s[16:19], s34 offen sc1
    s_add_u32 s34, s34, 4096
    s_cmp_gt_u32 s63, 7
    s_cbranch_scc1 L_cp_216_ok
L_cp_216:
    ds_read_b32 v5, v4
    s_waitcnt lgkmcnt(0)
    v_readfirstlane_b32 s63, v5
    s_nop 0
    s_cmp_gt_u32 s63, 7
    s_cbranch_scc0 L_cp_216
L_cp_216_ok:
    buffer_load_dwordx4 v[76:79], v10, s[16:19], s34 offen sc1
    s_add_u32 s34, s34, 4096
    s_cmp_gt_u32 s63, 8
    s_cbranch_scc1 L_cp_217_ok
L_cp_217:
    ds_read_b32 v5, v4
    s_waitcnt lgkmcnt(0)
    v_readfirstlane_b32 s63, v5
    s_nop 0
    s_cmp_gt_u32 s63, 8
    s_cbranch_scc0 L_cp_217
L_cp_217_ok:
    buffer_load_dwordx4 v[80:83], v10, s[16:19], s34 offen sc1
    s_add_u32 s34, s34, 4096
    s_cmp_gt_u32 s63, 9
    s_cbranch_scc1 L_cp_218_ok
L_cp_218:
    ds_read_b32 v5, v4
    s_waitcnt lgkmcnt(0)
    v_readfirstlane_b32 s63, v5
    s_nop 0
    s_cmp_gt_u32 s63, 9
    s_cbranch_scc0 L_cp_218
L_cp_218_ok:
    buffer_load_dwordx4 v[84:87], v10, s[16:19], s34 offen sc1
    s_add_u32 s34, s34, 4096
    s_cmp_gt_u32 s63, 10
    s_cbranch_scc1 L_cp_219_ok
L_cp_219:
    ds_read_b32 v5, v4
    s_waitcnt lgkmcnt(0)
    v_readfirstlane_b32 s63, v5
    s_nop 0
    s_cmp_gt_u32 s63, 10
    s_cbranch_scc0 L_cp_219
L_cp_219_ok:
    buffer_load_dwordx4 v[88:91], v10, s[16:19], s34 offen sc1
    s_add_u32 s34, s34, 4096
    s_cmp_gt_u32 s63, 11
    s_cbranch_scc1 L_cp_220_ok
L_cp_220:
    ds_read_b32 v5, v4
    s_waitcnt lgkmcnt(0)
    v_readfirstlane_b32 s63, v5
    s_nop 0
    s_cmp_gt_u32 s63, 11
    s_cbranch_scc0 L_cp_220
L_cp_220_ok:
    buffer_load_dwordx4 v[92:95], v10, s[16:19], s34 offen sc1
    s_add_u32 s34, s34, 4096
    s_cmp_gt_u32 s63, 12
    s_cbranch_scc1 L_cp_221_ok
L_cp_221:
    ds_read_b32 v5, v4
    s_waitcnt lgkmcnt(0)
    v_readfirstlane_b32 s63, v5
    s_nop 0
    s_cmp_gt_u32 s63, 12
    s_cbranch_scc0 L_cp_221
L_cp_221_ok:
    buffer_load_dwordx4 v[96:99], v10, s[16:19], s34 offen sc1
    s_add_u32 s34, s34, 4096
    s_cmp_gt_u32 s63, 13
    s_cbranch_scc1 L_cp_222_ok
L_cp_222:
    ds_read_b32 v5, v4
    s_waitcnt lgkmcnt(0)
    v_readfirstlane_b32 s63, v5
    s_nop 0
    s_cmp_gt_u32 s63, 13
    s_cbranch_scc0 L_cp_222
L_cp_222_ok:
    buffer_load_dwordx4 v[100:103], v10, s[16:19], s34 offen sc1
    s_add_u32 s34, s34, 4096
    s_cmp_gt_u32 s63, 14
    s_cbranch_scc1 L_cp_223_ok
L_cp_223:
    ds_read_b32 v5, v4
    s_waitcnt lgkmcnt(0)
    v_readfirstlane_b32 s63, v5
    s_nop 0
    s_cmp_gt_u32 s63, 14
    s_cbranch_scc0 L_cp_223
L_cp_223_ok:
    buffer_load_dwordx4 v[104:107], v10, s[16:19], s34 offen sc1
    s_add_u32 s34, s34, 4096
    s_cmp_gt_u32 s63, 15
    s_cbranch_scc1 L_cp_224_ok
L_cp_224:
    ds_read_b32 v5, v4
    s_waitcnt lgkmcnt(0)
    v_readfirstlane_b32 s63, v5
    s_nop 0
    s_cmp_gt_u32 s63, 15
    s_cbranch_scc0 L_cp_224
L_cp_224_ok:
    buffer_load_dword v24, v11, s[16:19], s39 offen offset:0 sc1
    buffer_load_dword v25, v11, s[16:19], s39 offen offset:256 sc1
    buffer_load_dword v26, v11, s[16:19], s39 offen offset:512 sc1
    buffer_load_dword v27, v11, s[16:19], s39 offen offset:768 sc1
    buffer_load_dwordx4 v[108:111], v10, s[16:19], s34 offen sc1
    s_add_u32 s34, s34, 4096
    v_mov_b32 v32, 0
    v_mov_b32 v33, 0
    v_mov_b32 v34, 0
    v_mov_b32 v35, 0
    v_mov_b32 v36, 0
    v_mov_b32 v37, 0
    v_mov_b32 v38, 0
    v_mov_b32 v39, 0
    s_mov_b32 s52, 0x3f80
    s_mov_b32 s53, 0x3f800000
    s_lshl_b32 s35, s36, 8
    s_add_u32 s35, s35, 77824
    v_add_u32 v13, s35, v11
    s_lshl_b32 s35, s3, 10
    s_add_u32 s35, s35, 69632
    v_add_u32 v12, s35, v10
    s_waitcnt vmcnt(19)
    v_dot2_f32_bf16 v32, v48, s52, v32
    v_dot2_f32_bf16 v33, v48, s53, v33
    v_dot2_f32_bf16 v34, v49, s52, v34
    v_dot2_f32_bf16 v35, v49, s53, v35
    v_dot2_f32_bf16 v36, v50, s52, v36
    v_dot2_f32_bf16 v37, v50, s53, v37
    v_dot2_f32_bf16 v38, v51, s52, v38
    v_dot2_f32_bf16 v39, v51, s53, v39
    s_waitcnt vmcnt(18)
    v_dot2_f32_bf16 v32, v52, s52, v32
    v_dot2_f32_bf16 v33, v52, s53, v33
    v_dot2_f32_bf16 v34, v53, s52, v34
    v_dot2_f32_bf16 v35, v53, s53, v35
    v_dot2_f32_bf16 v36, v54, s52, v36
    v_dot2_f32_bf16 v37, v54, s53, v37
    v_dot2_f32_bf16 v38, v55, s52, v38
    v_dot2_f32_bf16 v39, v55, s53, v39
    s_waitcnt vmcnt(17)
    v_dot2_f32_bf16 v32, v56, s52, v32
    v_dot2_f32_bf16 v33, v56, s53, v33
    v_dot2_f32_bf16 v34, v57, s52, v34
    v_dot2_f32_bf16 v35, v57, s53, v35
    v_dot2_f32_bf16 v36, v58, s52, v36
    v_dot2_f32_bf16 v37, v58, s53, v37
    v_dot2_f32_bf16 v38, v59, s52, v38
    v_dot2_f32_bf16 v39, v59, s53, v39
    s_waitcnt vmcnt(16)
    v_dot2_f32_bf16 v32, v60, s52, v32
    v_dot2_f32_bf16 v33, v60, s53, v33
    v_dot2_f32_bf16 v34, v61, s52, v34
    v_dot2_f32_bf16 v35, v61, s53, v35
    v_dot2_f32_bf16 v36, v62, s52, v36
    v_dot2_f32_bf16 v37, v62, s53, v37
    v_dot2_f32_bf16 v38, v63, s52, v38
    v_dot2_f32_bf16 v39, v63, s53, v39
    s_waitcnt vmcnt(15)
    v_dot2_f32_bf16 v32, v64, s52, v32
    v_dot2_f32_bf16 v33, v64, s53, v33
    v_dot2_f32_bf16 v34, v65, s52, v34
    v_dot2_f32_bf16 v35, v65, s53, v35
    v_dot2_f32_bf16 v36, v66, s52, v36
    v_dot2_f32_bf16 v37, v66, s53, v37
    v_dot2_f32_bf16 v38, v67, s52, v38
    v_dot2_f32_bf16 v39, v67, s53, v39
    s_waitcnt vmcnt(14)
    v_dot2_f32_bf16 v32, v68, s52, v32
    v_dot2_f32_bf16 v33, v68, s53, v33
    v_dot2_f32_bf16 v34, v69, s52, v34
    v_dot2_f32_bf16 v35, v69, s53, v35
    v_dot2_f32_bf16 v36, v70, s52, v36
    v_dot2_f32_bf16 v37, v70, s53, v37
    v_dot2_f32_bf16 v38, v71, s52, v38
    v_dot2_f32_bf16 v39, v71, s53, v39
    s_waitcnt vmcnt(13)
    v_dot2_f32_bf16 v32, v72, s52, v32
    v_dot2_f32_bf16 v33, v72, s53, v33
    v_dot2_f32_bf16 v34, v73, s52, v34
    v_dot2_f32_bf16 v35, v73, s53, v35
    v_dot2_f32_bf16 v36, v74, s52, v36
    v_dot2_f32_bf16 v37, v74, s53, v37
    v_dot2_f32_bf16 v38, v75, s52, v38
    v_dot2_f32_bf16 v39, v75, s53, v39
    s_waitcnt vmcnt(12)
    v_dot2_f32_bf16 v32, v76, s52, v32
    v_dot2_f32_bf16 v33, v76, s53, v33
    v_dot2_f32_bf16 v34, v77, s52, v34
    v_dot2_f32_bf16 v35, v77, s53, v35
    v_dot2_f32_bf16 v36, v78, s52, v36
    v_dot2_f32_bf16 v37, v78, s53, v37
    v_dot2_f32_bf16 v38, v79, s52, v38
    v_dot2_f32_bf16 v39, v79, s53, v39
    s_waitcnt vmcnt(11)
    v_dot2_f32_bf16 v32, v80, s52, v32
    v_dot2_f32_bf16 v33, v80, s53, v33
    v_dot2_f32_bf16 v34, v81, s52, v34
    v_dot2_f32_bf16 v35, v81, s53, v35
    v_dot2_f32_bf16 v36, v82, s52, v36
    v_dot2_f32_bf16 v37, v82, s53, v37
    v_dot2_f32_bf16 v38, v83, s52, v38
    v_dot2_f32_bf16 v39, v83, s53, v39
    s_waitcnt vmcnt(10)
    v_dot2_f32_bf16 v32, v84, s52, v32
    v_dot2_f32_bf16 v33, v84, s53, v33
    v_dot2_f32_bf16 v34, v85, s52, v34
    v_dot2_f32_bf16 v35, v85, s53, v35
    v_dot2_f32_bf16 v36, v86, s52, v36
    v_dot2_f32_bf16 v37, v86, s53, v37
    v_dot2_f32_bf16 v38, v87, s52, v38
    v_dot2_f32_bf16 v39, v87, s53, v39
    s_waitcnt vmcnt(9)
    v_dot2_f32_bf16 v32, v88, s52, v32
    v_dot2_f32_bf16 v33, v88, s53, v33
    v_dot2_f32_bf16 v34, v89, s52, v34
    v_dot2_f32_bf16 v35, v89, s53, v35
    v_dot2_f32_bf16 v36, v90, s52, v36
    v_dot2_f32_bf16 v37, v90, s53, v37
    v_dot2_f32_bf16 v38, v91, s52, v38
    v_dot2_f32_bf16 v39, v91, s53, v39
    s_waitcnt vmcnt(8)
    v_dot2_f32_bf16 v32, v92, s52, v32
    v_dot2_f32_bf16 v33, v92, s53, v33
    v_dot2_f32_bf16 v34, v93, s52, v34
    v_dot2_f32_bf16 v35, v93, s53, v35
    v_dot2_f32_bf16 v36, v94, s52, v36
    v_dot2_f32_bf16 v37, v94, s53, v37
    v_dot2_f32_bf16 v38, v95, s52, v38
    v_dot2_f32_bf16 v39, v95, s53, v39
    s_waitcnt vmcnt(7)
    v_dot2_f32_bf16 v32, v96, s52, v32
    v_dot2_f32_bf16 v33, v96, s53, v33
    v_dot2_f32_bf16 v34, v97, s52, v34
    v_dot2_f32_bf16 v35, v97, s53, v35
    v_dot2_f32_bf16 v36, v98, s52, v36
    v_dot2_f32_bf16 v37, v98, s53, v37
    v_dot2_f32_bf16 v38, v99, s52, v38
    v_dot2_f32_bf16 v39, v99, s53, v39
    s_waitcnt vmcnt(6)
    v_dot2_f32_bf16 v32, v100, s52, v32
    v_dot2_f32_bf16 v33, v100, s53, v33
    v_dot2_f32_bf16 v34, v101, s52, v34
    v_dot2_f32_bf16 v35, v101, s53, v35
    v_dot2_f32_bf16 v36, v102, s52, v36
    v_dot2_f32_bf16 v37, v102, s53, v37
    v_dot2_f32_bf16 v38, v103, s52, v38
    v_dot2_f32_bf16 v39, v103, s53, v39
    s_waitcnt vmcnt(5)
    v_dot2_f32_bf16 v32, v104, s52, v32
    v_dot2_f32_bf16 v33, v104, s53, v33
    v_dot2_f32_bf16 v34, v105, s52, v34
    v_dot2_f32_bf16 v35, v105, s53, v35
    v_dot2_f32_bf16 v36, v106, s52, v36
    v_dot2_f32_bf16 v37, v106, s53, v37
    v_dot2_f32_bf16 v38, v107, s52, v38
    v_dot2_f32_bf16 v39, v107, s53, v39
    s_waitcnt vmcnt(1)
    v_add_f32 v24, v24, v25
    v_add_f32 v26, v26, v27
    v_add_f32 v24, v24, v26
    ds_add_f32 v13, v24
    s_waitcnt vmcnt(0)
    v_dot2_f32_bf16 v32, v108, s52, v32
    v_dot2_f32_bf16 v33, v108, s53, v33
    v_dot2_f32_bf16 v34, v109, s52, v34
    v_dot2_f32_bf16 v35, v109, s53, v35
    v_dot2_f32_bf16 v36, v110, s52, v36
    v_dot2_f32_bf16 v37, v110, s53, v37
    v_dot2_f32_bf16 v38, v111, s52, v38
    v_dot2_f32_bf16 v39, v111, s53, v39
    v_cvt_pk_bf16_f32 v40, v32, v33
    v_cvt_pk_bf16_f32 v41, v34, v35
    v_cvt_pk_bf16_f32 v42, v36, v37
    v_cvt_pk_bf16_f32 v43, v38, v39
    ds_write_b128 v12, v[40:43]
    s_lshl_b32 s35, s49, 12
    s_add_u32 s35, s35, 69632
    v_add_u32 v12, s35, v10
    s_lshl_b32 s35, s49, 8
    s_add_u32 s35, s35, 77824
    v_lshlrev_b32 v13, 4, v3
    v_add_u32 v13, s35, v13
    s_lshl_b32 s36, s4, 2
    s_add_u32 s36, s36, s51
    s_lshl_b32 s36, s36, 16
    s_lshl_b32 s35, s50, 11
    s_add_u32 s36, s36, s35
    s_add_u32 s36, s36, 0x1400000
    s_waitcnt lgkmcnt(0)
    s_barrier
    ds_read_b128 v[32:35], v12 offset:0
    ds_read_b128 v[36:39], v12 offset:1024
    ds_read_b128 v[40:43], v12 offset:2048
    ds_read_b128 v[44:47], v12 offset:3072
    ds_read_b128 v[64:67], v13 offset:0
    ds_read_b128 v[68:71], v13 offset:32
    ds_read_b128 v[72:75], v13 offset:64
    ds_read_b128 v[76:79], v13 offset:96
    ds_read_b128 v[80:83], v13 offset:128
    ds_read_b128 v[84:87], v13 offset:160
    ds_read_b128 v[88:91], v13 offset:192
    ds_read_b128 v[92:95], v13 offset:224
    s_waitcnt lgkmcnt(8)
    v_mfma_f32_32x32x16_bf16 v[176:191], v[32:35], v[144:147], 0
    v_mfma_f32_32x32x16_bf16 v[176:191], v[36:39], v[148:151], v[176:191]
    v_mfma_f32_32x32x16_bf16 v[176:191], v[40:43], v[152:155], v[176:191]
    v_mfma_f32_32x32x16_bf16 v[176:191], v[44:47], v[156:159], v[176:191]
    s_waitcnt lgkmcnt(0)
    s_barrier
    v_cvt_pk_bf16_f32 v48, v64, v65
    v_cvt_pk_bf16_f32 v49, v66, v67
    v_cvt_pk_bf16_f32 v50, v68, v69
    v_cvt_pk_bf16_f32 v51, v70, v71
    v_cvt_pk_bf16_f32 v52, v72, v73
    v_cvt_pk_bf16_f32 v53, v74, v75
    v_cvt_pk_bf16_f32 v54, v76, v77
    v_cvt_pk_bf16_f32 v55, v78, v79
    v_cvt_pk_bf16_f32 v56, v80, v81
    v_cvt_pk_bf16_f32 v57, v82, v83
    v_cvt_pk_bf16_f32 v58, v84, v85
    v_cvt_pk_bf16_f32 v59, v86, v87
    v_cvt_pk_bf16_f32 v60, v88, v89
    v_cvt_pk_bf16_f32 v61, v90, v91
    v_cvt_pk_bf16_f32 v62, v92, v93
    v_cvt_pk_bf16_f32 v63, v94, v95
    v_mfma_f32_32x32x16_bf16 v[96:111], v[48:51], v[144:147], 0
    v_mfma_f32_32x32x16_bf16 v[96:111], v[52:55], v[148:151], v[96:111]
    v_mfma_f32_32x32x16_bf16 v[96:111], v[56:59], v[152:155], v[96:111]
    v_mfma_f32_32x32x16_bf16 v[96:111], v[60:63], v[156:159], v[96:111]
    s_nop 11
    v_add_f32 v96, 0x358637bd, v96
    v_rcp_f32 v96, v96
    s_nop 0
    v_mov_b32 v97, v96
    v_pk_mul_f32 v[176:177], v[176:177], v[96:97]
    v_pk_mul_f32 v[178:179], v[178:179], v[96:97]
    v_pk_mul_f32 v[180:181], v[180:181], v[96:97]
    v_pk_mul_f32 v[182:183], v[182:183], v[96:97]
    v_pk_mul_f32 v[184:185], v[184:185], v[96:97]
    v_pk_mul_f32 v[186:187], v[186:187], v[96:97]
    v_pk_mul_f32 v[188:189], v[188:189], v[96:97]
    v_pk_mul_f32 v[190:191], v[190:191], v[96:97]
    v_cvt_pk_bf16_f32 v112, v176, v177
    v_cvt_pk_bf16_f32 v113, v178, v179
    v_cvt_pk_bf16_f32 v114, v180, v181
    v_cvt_pk_bf16_f32 v115, v182, v183
    v_cvt_pk_bf16_f32 v116, v184, v185
    v_cvt_pk_bf16_f32 v117, v186, v187
    v_cvt_pk_bf16_f32 v118, v188, v189
    v_cvt_pk_bf16_f32 v119, v190, v191
    buffer_store_dwordx4 v[112:115], v10, s[16:19], s36 offen offset:0 sc1
    buffer_store_dwordx4 v[116:119], v10, s[16:19], s36 offen offset:1024 sc1
    s_waitcnt vmcnt(0)
    s_lshl_b32 s34, s4, 8
    s_add_u32 s34, s34, 0x2807000
    v_mov_b32 v4, 1
    v_mov_b32 v5, 0
    s_mov_b64 exec, 1
    v_mov_b32 v6, 163820
    ds_add_rtn_u32 v7, v6, v4
    s_waitcnt lgkmcnt(0)
    v_readfirstlane_b32 s35, v7
    s_nop 0
    s_cmp_eq_u32 s35, 7
    s_cbranch_scc0 L_sig_225
    s_lshl_b32 s35, s5, 2
    s_add_u32 s34, s34, s35
    buffer_store_dword v4, v5, s[16:19], s34 offen sc1
L_sig_225:
    s_mov_b64 exec, -1
    s_and_b32 s6, s2, 7
    s_lshr_b32 s7, s2, 3
    s_lshr_b32 s4, s6, 1
    s_lshl_b32 s4, s4, 2
    s_lshr_b32 s5, s7, 3
    s_add_u32 s4, s4, s5
    s_and_b32 s5, s6, 1
    s_lshl_b32 s5, s5, 3
    s_and_b32 s7, s7, 7
    s_add_u32 s5, s5, s7
    s_add_u32 s8, s86, 0x1400000
    s_addc_u32 s9, s87, 0
    s_and_b32 s9, s9, 0xffff
    s_mov_b32 s10, 0x400000
    s_mov_b32 s11, 0x20000
    s_mov_b32 s12, s70
    s_and_b32 s13, s71, 0xffff
    s_mov_b32 s14, 0x200000
    s_mov_b32 s15, 0x20000
    s_cmp_ge_u32 s3, 4
    s_cbranch_scc1 L_wa1_ld_226
    s_lshl_b32 s30, s4, 2
    s_add_u32 s30, s30, s3
    s_lshl_b32 s39, s30, 16
    s_lshl_b32 s31, s5, 12
    s_add_u32 s36, s39, s31
    s_add_u32 s37, s36, 0x400000
    v_lshlrev_b32 v10, 4, v1
    buffer_load_dwordx4 v[64:67], v10, s[16:19], s37 offen offset:0 sc1
    buffer_load_dwordx4 v[68:71], v10, s[16:19], s37 offen offset:1024 sc1
    buffer_load_dwordx4 v[72:75], v10, s[16:19], s37 offen offset:2048 sc1
    buffer_load_dwordx4 v[76:79], v10, s[16:19], s37 offen offset:3072 sc1
    v_and_b32 v4, 15, v1
    v_lshrrev_b32 v5, 2, v4
    v_lshl_add_u32 v5, v3, 2, v5
    v_mul_u32_u24 v5, 128, v5
    v_and_b32 v6, 3, v4
    v_lshlrev_b32 v6, 3, v6
    v_bfe_u32 v7, v1, 4, 1
    v_lshl_add_u32 v6, v7, 5, v6
    v_add_u32 v6, 0, v6
    v_bfe_u32 v7, v1, 3, 1
    v_lshlrev_b32 v7, 6, v7
    v_xor_b32 v6, v6, v7
    v_add_u32 v12, v5, v6
    v_xor_b32 v13, 64, v12
    v_mov_b32 v4, 163828
    v_mov_b32 v5, 0
    ds_write_b32 v4, v5
    v_mov_b32 v4, 163832
    v_mov_b32 v5, 0
    ds_write_b32 v4, v5
    s_waitcnt lgkmcnt(0)
    v_add_u32 v14, 0x10000, v12
    v_add_u32 v15, 0x10000, v13
    v_add_u32 v16, 0x20000, v12
    v_add_u32 v17, 0x20000, v13
    v_mov_b32 v4, 163832
    s_mov_b32 s63, 0
    s_barrier
    s_waitcnt vmcnt(0)
    v_lshlrev_b32 v32, 16, v64
    v_and_b32 v33, 0xffff0000, v64
    v_lshlrev_b32 v34, 16, v65
    v_and_b32 v35, 0xffff0000, v65
    v_lshlrev_b32 v36, 16, v66
    v_and_b32 v37, 0xffff0000, v66
    v_lshlrev_b32 v38, 16, v67
    v_and_b32 v39, 0xffff0000, v67
    v_lshlrev_b32 v40, 16, v68
    v_and_b32 v41, 0xffff0000, v68
    v_lshlrev_b32 v42, 16, v69
    v_and_b32 v43, 0xffff0000, v69
    v_lshlrev_b32 v44, 16, v70
    v_and_b32 v45, 0xffff0000, v70
    v_lshlrev_b32 v46, 16, v71
    v_and_b32 v47, 0xffff0000, v71
    v_lshlrev_b32 v48, 16, v72
    v_and_b32 v49, 0xffff0000, v72
    v_lshlrev_b32 v50, 16, v73
    v_and_b32 v51, 0xffff0000, v73
    v_lshlrev_b32 v52, 16, v74
    v_and_b32 v53, 0xffff0000, v74
    v_lshlrev_b32 v54, 16, v75
    v_and_b32 v55, 0xffff0000, v75
    v_lshlrev_b32 v56, 16, v76
    v_and_b32 v57, 0xffff0000, v76
    v_lshlrev_b32 v58, 16, v77
    v_and_b32 v59, 0xffff0000, v77
    v_lshlrev_b32 v60, 16, v78
    v_and_b32 v61, 0xffff0000, v78
    v_lshlrev_b32 v62, 16, v79
    v_and_b32 v63, 0xffff0000, v79
    s_cmp_gt_u32 s63, 0
    s_cbranch_scc1 L_lp_228_ok
L_lp_228:
    ds_read_b32 v5, v4
    s_waitcnt lgkmcnt(0)
    v_readfirstlane_b32 s63, v5
    s_nop 0
    s_cmp_gt_u32 s63, 0
    s_cbranch_scc0 L_lp_228
L_lp_228_ok:
    buffer_load_dwordx4 v[96:99], v10, s[8:11], s39 offen offset:0 sc1
    buffer_load_dwordx4 v[100:103], v10, s[8:11], s39 offen offset:1024 sc1
    buffer_load_dwordx4 v[104:107], v10, s[8:11], s39 offen offset:2048 sc1
    buffer_load_dwordx4 v[108:111], v10, s[8:11], s39 offen offset:3072 sc1
    s_add_u32 s39, s39, 4096
    s_cmp_gt_u32 s63, 1
    s_cbranch_scc1 L_lp_229_ok
L_lp_229:
    ds_read_b32 v5, v4
    s_waitcnt lgkmcnt(0)
    v_readfirstlane_b32 s63, v5
    s_nop 0
    s_cmp_gt_u32 s63, 1
    s_cbranch_scc0 L_lp_229
L_lp_229_ok:
    buffer_load_dwordx4 v[112:115], v10, s[8:11], s39 offen offset:0 sc1
    buffer_load_dwordx4 v[116:119], v10, s[8:11], s39 offen offset:1024 sc1
    buffer_load_dwordx4 v[120:123], v10, s[8:11], s39 offen offset:2048 sc1
    buffer_load_dwordx4 v[124:127], v10, s[8:11], s39 offen offset:3072 sc1
    s_add_u32 s39, s39, 4096
    ds_read_b64_tr_b16 v[64:65], v14 offset:16384
    ds_read_b64_tr_b16 v[66:67], v14 offset:17408
    ds_read_b64_tr_b16 v[68:69], v15 offset:16384
    ds_read_b64_tr_b16 v[70:71], v15 offset:17408
    ds_read_b64_tr_b16 v[72:73], v14 offset:18432
    ds_read_b64_tr_b16 v[74:75], v14 offset:19456
    ds_read_b64_tr_b16 v[76:77], v15 offset:18432
    ds_read_b64_tr_b16 v[78:79], v15 offset:19456
    s_waitcnt vmcnt(7) lgkmcnt(4)
    v_mfma_f32_32x32x16_bf16 v[32:47], v[64:67], v[96:99], v[32:47]
    ds_read_b64_tr_b16 v[80:81], v14 offset:20480
    ds_read_b64_tr_b16 v[82:83], v14 offset:21504
    v_mfma_f32_32x32x16_bf16 v[48:63], v[68:71], v[96:99], v[48:63]
    ds_read_b64_tr_b16 v[84:85], v15 offset:20480
    ds_read_b64_tr_b16 v[86:87], v15 offset:21504
    s_cmp_gt_u32 s63, 2
    s_cbranch_scc1 L_lp_230_ok
L_lp_230:
    ds_read_b32 v5, v4
    s_waitcnt lgkmcnt(0)
    v_readfirstlane_b32 s63, v5
    s_nop 0
    s_cmp_gt_u32 s63, 2
    s_cbranch_scc0 L_lp_230
L_lp_230_ok:
    buffer_load_dwordx4 v[128:131], v10, s[8:11], s39 offen offset:0 sc1
    buffer_load_dwordx4 v[132:135], v10, s[8:11], s39 offen offset:1024 sc1
    s_waitcnt vmcnt(8) lgkmcnt(4)
    v_mfma_f32_32x32x16_bf16 v[32:47], v[72:75], v[100:103], v[32:47]
    ds_read_b64_tr_b16 v[88:89], v14 offset:22528
    ds_read_b64_tr_b16 v[90:91], v14 offset:23552
    v_mfma_f32_32x32x16_bf16 v[48:63], v[76:79], v[100:103], v[48:63]
    ds_read_b64_tr_b16 v[92:93], v15 offset:22528
    ds_read_b64_tr_b16 v[94:95], v15 offset:23552
    buffer_load_dwordx4 v[136:139], v10, s[8:11], s39 offen offset:2048 sc1
    buffer_load_dwordx4 v[140:143], v10, s[8:11], s39 offen offset:3072 sc1
    s_add_u32 s39, s39, 8192
    s_waitcnt vmcnt(9) lgkmcnt(4)
    v_mfma_f32_32x32x16_bf16 v[32:47], v[80:83], v[104:107], v[32:47]
    ds_read_b64_tr_b16 v[64:65], v14 offset:24576
    ds_read_b64_tr_b16 v[66:67], v14 offset:25600
    v_mfma_f32_32x32x16_bf16 v[48:63], v[84:87], v[104:107], v[48:63]
    ds_read_b64_tr_b16 v[68:69], v15 offset:24576
    ds_read_b64_tr_b16 v[70:71], v15 offset:25600
    s_cmp_gt_u32 s63, 3
    s_cbranch_scc1 L_lp_231_ok
L_lp_231:
    ds_read_b32 v5, v4
    s_waitcnt lgkmcnt(0)
    v_readfirstlane_b32 s63, v5
    s_nop 0
    s_cmp_gt_u32 s63, 3
    s_cbranch_scc0 L_lp_231
L_lp_231_ok:
    buffer_load_dwordx4 v[144:147], v10, s[8:11], s39 offen offset:0 sc1
    buffer_load_dwordx4 v[148:151], v10, s[8:11], s39 offen offset:1024 sc1
    s_waitcnt vmcnt(10) lgkmcnt(4)
    v_mfma_f32_32x32x16_bf16 v[32:47], v[88:91], v[108:111], v[32:47]
    ds_read_b64_tr_b16 v[72:73], v14 offset:26624
    ds_read_b64_tr_b16 v[74:75], v14 offset:27648
    v_mfma_f32_32x32x16_bf16 v[48:63], v[92:95], v[108:111], v[48:63]
    ds_read_b64_tr_b16 v[76:77], v15 offset:26624
    ds_read_b64_tr_b16 v[78:79], v15 offset:27648
    buffer_load_dwordx4 v[152:155], v10, s[8:11], s39 offen offset:2048 sc1
    buffer_load_dwordx4 v[156:159], v10, s[8:11], s39 offen offset:3072 sc1
    s_add_u32 s39, s39, 4096
    s_waitcnt vmcnt(11) lgkmcnt(4)
    v_mfma_f32_32x32x16_bf16 v[32:47], v[64:67], v[112:115], v[32:47]
    ds_read_b64_tr_b16 v[80:81], v14 offset:28672
    ds_read_b64_tr_b16 v[82:83], v14 offset:29696
    v_mfma_f32_32x32x16_bf16 v[48:63], v[68:71], v[112:115], v[48:63]
    ds_read_b64_tr_b16 v[84:85], v15 offset:28672
    ds_read_b64_tr_b16 v[86:87], v15 offset:29696
    s_cmp_gt_u32 s63, 4
    s_cbranch_scc1 L_lp_232_ok
L_lp_232:
    ds_read_b32 v5, v4
    s_waitcnt lgkmcnt(0)
    v_readfirstlane_b32 s63, v5
    s_nop 0
    s_cmp_gt_u32 s63, 4
    s_cbranch_scc0 L_lp_232
L_lp_232_ok:
    buffer_load_dwordx4 v[160:163], v10, s[8:11], s39 offen offset:0 sc1
    buffer_load_dwordx4 v[164:167], v10, s[8:11], s39 offen offset:1024 sc1
    s_waitcnt vmcnt(12) lgkmcnt(4)
    v_mfma_f32_32x32x16_bf16 v[32:47], v[72:75], v[116:119], v[32:47]
    ds_read_b64_tr_b16 v[88:89], v14 offset:30720
    ds_read_b64_tr_b16 v[90:91], v14 offset:31744
    v_mfma_f32_32x32x16_bf16 v[48:63], v[76:79], v[116:119], v[48:63]
    ds_read_b64_tr_b16 v[92:93], v15 offset:30720
    ds_read_b64_tr_b16 v[94:95], v15 offset:31744
    buffer_load_dwordx4 v[168:171], v10, s[8:11], s39 offen offset:2048 sc1
    buffer_load_dwordx4 v[172:175], v10, s[8:11], s39 offen offset:3072 sc1
    s_add_u32 s39, s39, 4096
    s_waitcnt vmcnt(13) lgkmcnt(4)
    v_mfma_f32_32x32x16_bf16 v[32:47], v[80:83], v[120:123], v[32:47]
    ds_read_b64_tr_b16 v[64:65], v14 offset:32768
    ds_read_b64_tr_b16 v[66:67], v14 offset:33792
    v_mfma_f32_32x32x16_bf16 v[48:63], v[84:87], v[120:123], v[48:63]
    ds_read_b64_tr_b16 v[68:69], v15 offset:32768
    ds_read_b64_tr_b16 v[70:71], v15 offset:33792
    s_cmp_gt_u32 s63, 5
    s_cbranch_scc1 L_lp_233_ok
L_lp_233:
    ds_read_b32 v5, v4
    s_waitcnt lgkmcnt(0)
    v_readfirstlane_b32 s63, v5
    s_nop 0
    s_cmp_gt_u32 s63, 5
    s_cbranch_scc0 L_lp_233
L_lp_233_ok:
    buffer_load_dwordx4 v[176:179], v10, s[8:11], s39 offen offset:0 sc1
    buffer_load_dwordx4 v[180:183], v10, s[8:11], s39 offen offset:1024 sc1
    s_waitcnt vmcnt(14) lgkmcnt(4)
    v_mfma_f32_32x32x16_bf16 v[32:47], v[88:91], v[124:127], v[32:47]
    ds_read_b64_tr_b16 v[72:73], v14 offset:34816
    ds_read_b64_tr_b16 v[74:75], v14 offset:35840
    v_mfma_f32_32x32x16_bf16 v[48:63], v[92:95], v[124:127], v[48:63]
    ds_read_b64_tr_b16 v[76:77], v15 offset:34816
    ds_read_b64_tr_b16 v[78:79], v15 offset:35840
    buffer_load_dwordx4 v[184:187], v10, s[8:11], s39 offen offset:2048 sc1
    buffer_load_dwordx4 v[188:191], v10, s[8:11], s39 offen offset:3072 sc1
    s_add_u32 s39, s39, 4096
    s_waitcnt vmcnt(15) lgkmcnt(4)
    v_mfma_f32_32x32x16_bf16 v[32:47], v[64:67], v[128:131], v[32:47]
    ds_read_b64_tr_b16 v[80:81], v14 offset:36864
    ds_read_b64_tr_b16 v[82:83], v14 offset:37888
    v_mfma_f32_32x32x16_bf16 v[48:63], v[68:71], v[128:131], v[48:63]
    ds_read_b64_tr_b16 v[84:85], v15 offset:36864
    ds_read_b64_tr_b16 v[86:87], v15 offset:37888
    s_cmp_gt_u32 s63, 6
    s_cbranch_scc1 L_lp_234_ok
L_lp_234:
    ds_read_b32 v5, v4
    s_waitcnt lgkmcnt(0)
    v_readfirstlane_b32 s63, v5
    s_nop 0
    s_cmp_gt_u32 s63, 6
    s_cbranch_scc0 L_lp_234
L_lp_234_ok:
    buffer_load_dwordx4 v[192:195], v10, s[8:11], s39 offen offset:0 sc1
    buffer_load_dwordx4 v[196:199], v10, s[8:11], s39 offen offset:1024 sc1
    s_waitcnt vmcnt(16) lgkmcnt(4)
    v_mfma_f32_32x32x16_bf16 v[32:47], v[72:75], v[132:135], v[32:47]
    ds_read_b64_tr_b16 v[88:89], v14 offset:38912
    ds_read_b64_tr_b16 v[90:91], v14 offset:39936
    v_mfma_f32_32x32x16_bf16 v[48:63], v[76:79], v[132:135], v[48:63]
    ds_read_b64_tr_b16 v[92:93], v15 offset:38912
    ds_read_b64_tr_b16 v[94:95], v15 offset:39936
    buffer_load_dwordx4 v[200:203], v10, s[8:11], s39 offen offset:2048 sc1
    buffer_load_dwordx4 v[204:207], v10, s[8:11], s39 offen offset:3072 sc1
    s_add_u32 s39, s39, 4096
    s_waitcnt vmcnt(17) lgkmcnt(4)
    v_mfma_f32_32x32x16_bf16 v[32:47], v[80:83], v[136:139], v[32:47]
    ds_read_b64_tr_b16 v[64:65], v14 offset:40960
    ds_read_b64_tr_b16 v[66:67], v14 offset:41984
    v_mfma_f32_32x32x16_bf16 v[48:63], v[84:87], v[136:139], v[48:63]
    ds_read_b64_tr_b16 v[68:69], v15 offset:40960
    ds_read_b64_tr_b16 v[70:71], v15 offset:41984
    s_cmp_gt_u32 s63, 7
    s_cbranch_scc1 L_lp_235_ok
L_lp_235:
    ds_read_b32 v5, v4
    s_waitcnt lgkmcnt(0)
    v_readfirstlane_b32 s63, v5
    s_nop 0
    s_cmp_gt_u32 s63, 7
    s_cbranch_scc0 L_lp_235
L_lp_235_ok:
    buffer_load_dwordx4 v[208:211], v10, s[8:11], s39 offen offset:0 sc1
    buffer_load_dwordx4 v[212:215], v10, s[8:11], s39 offen offset:1024 sc1
    s_waitcnt vmcnt(18) lgkmcnt(4)
    v_mfma_f32_32x32x16_bf16 v[32:47], v[88:91], v[140:143], v[32:47]
    ds_read_b64_tr_b16 v[72:73], v14 offset:43008
    ds_read_b64_tr_b16 v[74:75], v14 offset:44032
    v_mfma_f32_32x32x16_bf16 v[48:63], v[92:95], v[140:143], v[48:63]
    ds_read_b64_tr_b16 v[76:77], v15 offset:43008
    ds_read_b64_tr_b16 v[78:79], v15 offset:44032
    buffer_load_dwordx4 v[216:219], v10, s[8:11], s39 offen offset:2048 sc1
    buffer_load_dwordx4 v[220:223], v10, s[8:11], s39 offen offset:3072 sc1
    s_add_u32 s39, s39, 4096
    s_waitcnt vmcnt(19) lgkmcnt(4)
    v_mfma_f32_32x32x16_bf16 v[32:47], v[64:67], v[144:147], v[32:47]
    ds_read_b64_tr_b16 v[80:81], v14 offset:45056
    ds_read_b64_tr_b16 v[82:83], v14 offset:46080
    v_mfma_f32_32x32x16_bf16 v[48:63], v[68:71], v[144:147], v[48:63]
    ds_read_b64_tr_b16 v[84:85], v15 offset:45056
    ds_read_b64_tr_b16 v[86:87], v15 offset:46080
    s_cmp_gt_u32 s63, 8
    s_cbranch_scc1 L_lp_236_ok
L_lp_236:
    ds_read_b32 v5, v4
    s_waitcnt lgkmcnt(0)
    v_readfirstlane_b32 s63, v5
    s_nop 0
    s_cmp_gt_u32 s63, 8
    s_cbranch_scc0 L_lp_236
L_lp_236_ok:
    buffer_load_dwordx4 v[96:99], v10, s[8:11], s39 offen offset:0 sc1
    s_waitcnt vmcnt(19) lgkmcnt(4)
    v_mfma_f32_32x32x16_bf16 v[32:47], v[72:75], v[148:151], v[32:47]
    ds_read_b64_tr_b16 v[88:89], v14 offset:47104
    ds_read_b64_tr_b16 v[90:91], v14 offset:48128
    v_mfma_f32_32x32x16_bf16 v[48:63], v[76:79], v[148:151], v[48:63]
    ds_read_b64_tr_b16 v[92:93], v15 offset:47104
    ds_read_b64_tr_b16 v[94:95], v15 offset:48128
    buffer_load_dwordx4 v[100:103], v10, s[8:11], s39 offen offset:1024 sc1
    s_waitcnt vmcnt(19) lgkmcnt(4)
    v_mfma_f32_32x32x16_bf16 v[32:47], v[80:83], v[152:155], v[32:47]
    ds_read_b64_tr_b16 v[64:65], v14 offset:49152
    ds_read_b64_tr_b16 v[66:67], v14 offset:50176
    v_mfma_f32_32x32x16_bf16 v[48:63], v[84:87], v[152:155], v[48:63]
    ds_read_b64_tr_b16 v[68:69], v15 offset:49152
    ds_read_b64_tr_b16 v[70:71], v15 offset:50176
    buffer_load_dwordx4 v[104:107], v10, s[8:11], s39 offen offset:2048 sc1
    s_waitcnt vmcnt(19) lgkmcnt(4)
    v_mfma_f32_32x32x16_bf16 v[32:47], v[88:91], v[156:159], v[32:47]
    ds_read_b64_tr_b16 v[72:73], v14 offset:51200
    ds_read_b64_tr_b16 v[74:75], v14 offset:52224
    v_mfma_f32_32x32x16_bf16 v[48:63], v[92:95], v[156:159], v[48:63]
    ds_read_b64_tr_b16 v[76:77], v15 offset:51200
    ds_read_b64_tr_b16 v[78:79], v15 offset:52224
    buffer_load_dwordx4 v[108:111], v10, s[8:11], s39 offen offset:3072 sc1
    s_add_u32 s39, s39, 4096
    s_waitcnt vmcnt(19) lgkmcnt(4)
    v_mfma_f32_32x32x16_bf16 v[32:47], v[64:67], v[160:163], v[32:47]
    ds_read_b64_tr_b16 v[80:81], v14 offset:53248
    ds_read_b64_tr_b16 v[82:83], v14 offset:54272
    v_mfma_f32_32x32x16_bf16 v[48:63], v[68:71], v[160:163], v[48:63]
    ds_read_b64_tr_b16 v[84:85], v15 offset:53248
    ds_read_b64_tr_b16 v[86:87], v15 offset:54272
    s_cmp_gt_u32 s63, 9
    s_cbranch_scc1 L_lp_237_ok
L_lp_237:
    ds_read_b32 v5, v4
    s_waitcnt lgkmcnt(0)
    v_readfirstlane_b32 s63, v5
    s_nop 0
    s_cmp_gt_u32 s63, 9
    s_cbranch_scc0 L_lp_237
L_lp_237_ok:
    buffer_load_dwordx4 v[112:115], v10, s[8:11], s39 offen offset:0 sc1
    s_waitcnt vmcnt(19) lgkmcnt(4)
    v_mfma_f32_32x32x16_bf16 v[32:47], v[72:75], v[164:167], v[32:47]
    ds_read_b64_tr_b16 v[88:89], v14 offset:55296
    ds_read_b64_tr_b16 v[90:91], v14 offset:56320
    v_mfma_f32_32x32x16_bf16 v[48:63], v[76:79], v[164:167], v[48:63]
    ds_read_b64_tr_b16 v[92:93], v15 offset:55296
    ds_read_b64_tr_b16 v[94:95], v15 offset:56320
    buffer_load_dwordx4 v[116:119], v10, s[8:11], s39 offen offset:1024 sc1
    s_waitcnt vmcnt(19) lgkmcnt(4)
    v_mfma_f32_32x32x16_bf16 v[32:47], v[80:83], v[168:171], v[32:47]
    ds_read_b64_tr_b16 v[64:65], v14 offset:57344
    ds_read_b64_tr_b16 v[66:67], v14 offset:58368
    v_mfma_f32_32x32x16_bf16 v[48:63], v[84:87], v[168:171], v[48:63]
    ds_read_b64_tr_b16 v[68:69], v15 offset:57344
    ds_read_b64_tr_b16 v[70:71], v15 offset:58368
    buffer_load_dwordx4 v[120:123], v10, s[8:11], s39 offen offset:2048 sc1
    s_waitcnt vmcnt(19) lgkmcnt(4)
    v_mfma_f32_32x32x16_bf16 v[32:47], v[88:91], v[172:175], v[32:47]
    ds_read_b64_tr_b16 v[72:73], v14 offset:59392
    ds_read_b64_tr_b16 v[74:75], v14 offset:60416
    v_mfma_f32_32x32x16_bf16 v[48:63], v[92:95], v[172:175], v[48:63]
    ds_read_b64_tr_b16 v[76:77], v15 offset:59392
    ds_read_b64_tr_b16 v[78:79], v15 offset:60416
    buffer_load_dwordx4 v[124:127], v10, s[8:11], s39 offen offset:3072 sc1
    s_add_u32 s39, s39, 8192
    s_waitcnt vmcnt(19) lgkmcnt(4)
    v_mfma_f32_32x32x16_bf16 v[32:47], v[64:67], v[176:179], v[32:47]
    ds_read_b64_tr_b16 v[80:81], v14 offset:61440
    ds_read_b64_tr_b16 v[82:83], v14 offset:62464
    v_mfma_f32_32x32x16_bf16 v[48:63], v[68:71], v[176:179], v[48:63]
    ds_read_b64_tr_b16 v[84:85], v15 offset:61440
    ds_read_b64_tr_b16 v[86:87], v15 offset:62464
    s_cmp_gt_u32 s63, 10
    s_cbranch_scc1 L_lp_238_ok
L_lp_238:
    ds_read_b32 v5, v4
    s_waitcnt lgkmcnt(0)
    v_readfirstlane_b32 s63, v5
    s_nop 0
    s_cmp_gt_u32 s63, 10
    s_cbranch_scc0 L_lp_238
L_lp_238_ok:
    buffer_load_dwordx4 v[128:131], v10, s[8:11], s39 offen offset:0 sc1
    s_waitcnt vmcnt(19) lgkmcnt(4)
    v_mfma_f32_32x32x16_bf16 v[32:47], v[72:75], v[180:183], v[32:47]
    ds_read_b64_tr_b16 v[88:89], v14 offset:63488
    ds_read_b64_tr_b16 v[90:91], v14 offset:64512
    v_mfma_f32_32x32x16_bf16 v[48:63], v[76:79], v[180:183], v[48:63]
    ds_read_b64_tr_b16 v[92:93], v15 offset:63488
    ds_read_b64_tr_b16 v[94:95], v15 offset:64512
    buffer_load_dwordx4 v[132:135], v10, s[8:11], s39 offen offset:1024 sc1
    s_waitcnt vmcnt(19) lgkmcnt(4)
    v_mfma_f32_32x32x16_bf16 v[32:47], v[80:83], v[184:187], v[32:47]
    ds_read_b64_tr_b16 v[64:65], v16 offset:0
    ds_read_b64_tr_b16 v[66:67], v16 offset:1024
    v_mfma_f32_32x32x16_bf16 v[48:63], v[84:87], v[184:187], v[48:63]
    ds_read_b64_tr_b16 v[68:69], v17 offset:0
    ds_read_b64_tr_b16 v[70:71], v17 offset:1024
    buffer_load_dwordx4 v[136:139], v10, s[8:11], s39 offen offset:2048 sc1
    s_waitcnt vmcnt(19) lgkmcnt(4)
    v_mfma_f32_32x32x16_bf16 v[32:47], v[88:91], v[188:191], v[32:47]
    ds_read_b64_tr_b16 v[72:73], v16 offset:2048
    ds_read_b64_tr_b16 v[74:75], v16 offset:3072
    v_mfma_f32_32x32x16_bf16 v[48:63], v[92:95], v[188:191], v[48:63]
    ds_read_b64_tr_b16 v[76:77], v17 offset:2048
    ds_read_b64_tr_b16 v[78:79], v17 offset:3072
    buffer_load_dwordx4 v[140:143], v10, s[8:11], s39 offen offset:3072 sc1
    s_add_u32 s39, s39, 4096
    s_waitcnt vmcnt(19) lgkmcnt(4)
    v_mfma_f32_32x32x16_bf16 v[32:47], v[64:67], v[192:195], v[32:47]
    ds_read_b64_tr_b16 v[80:81], v16 offset:4096
    ds_read_b64_tr_b16 v[82:83], v16 offset:5120
    v_mfma_f32_32x32x16_bf16 v[48:63], v[68:71], v[192:195], v[48:63]
    ds_read_b64_tr_b16 v[84:85], v17 offset:4096
    ds_read_b64_tr_b16 v[86:87], v17 offset:5120
    s_cmp_gt_u32 s63, 11
    s_cbranch_scc1 L_lp_239_ok
L_lp_239:
    ds_read_b32 v5, v4
    s_waitcnt lgkmcnt(0)
    v_readfirstlane_b32 s63, v5
    s_nop 0
    s_cmp_gt_u32 s63, 11
    s_cbranch_scc0 L_lp_239
L_lp_239_ok:
    buffer_load_dwordx4 v[144:147], v10, s[8:11], s39 offen offset:0 sc1
    s_waitcnt vmcnt(19) lgkmcnt(4)
    v_mfma_f32_32x32x16_bf16 v[32:47], v[72:75], v[196:199], v[32:47]
    ds_read_b64_tr_b16 v[88:89], v16 offset:6144
    ds_read_b64_tr_b16 v[90:91], v16 offset:7168
    v_mfma_f32_32x32x16_bf16 v[48:63], v[76:79], v[196:199], v[48:63]
    ds_read_b64_tr_b16 v[92:93], v17 offset:6144
    ds_read_b64_tr_b16 v[94:95], v17 offset:7168
    buffer_load_dwordx4 v[148:151], v10, s[8:11], s39 offen offset:1024 sc1
    s_waitcnt vmcnt(19) lgkmcnt(4)
    v_mfma_f32_32x32x16_bf16 v[32:47], v[80:83], v[200:203], v[32:47]
    ds_read_b64_tr_b16 v[64:65], v16 offset:8192
    ds_read_b64_tr_b16 v[66:67], v16 offset:9216
    v_mfma_f32_32x32x16_bf16 v[48:63], v[84:87], v[200:203], v[48:63]
    ds_read_b64_tr_b16 v[68:69], v17 offset:8192
    ds_read_b64_tr_b16 v[70:71], v17 offset:9216
    buffer_load_dwordx4 v[152:155], v10, s[8:11], s39 offen offset:2048 sc1
    s_waitcnt vmcnt(19) lgkmcnt(4)
    v_mfma_f32_32x32x16_bf16 v[32:47], v[88:91], v[204:207], v[32:47]
    ds_read_b64_tr_b16 v[72:73], v16 offset:10240
    ds_read_b64_tr_b16 v[74:75], v16 offset:11264
    v_mfma_f32_32x32x16_bf16 v[48:63], v[92:95], v[204:207], v[48:63]
    ds_read_b64_tr_b16 v[76:77], v17 offset:10240
    ds_read_b64_tr_b16 v[78:79], v17 offset:11264
    buffer_load_dwordx4 v[156:159], v10, s[8:11], s39 offen offset:3072 sc1
    s_add_u32 s39, s39, 4096
    s_waitcnt vmcnt(19) lgkmcnt(4)
    v_mfma_f32_32x32x16_bf16 v[32:47], v[64:67], v[208:211], v[32:47]
    ds_read_b64_tr_b16 v[80:81], v16 offset:12288
    ds_read_b64_tr_b16 v[82:83], v16 offset:13312
    v_mfma_f32_32x32x16_bf16 v[48:63], v[68:71], v[208:211], v[48:63]
    ds_read_b64_tr_b16 v[84:85], v17 offset:12288
    ds_read_b64_tr_b16 v[86:87], v17 offset:13312
    s_cmp_gt_u32 s63, 12
    s_cbranch_scc1 L_lp_240_ok
L_lp_240:
    ds_read_b32 v5, v4
    s_waitcnt lgkmcnt(0)
    v_readfirstlane_b32 s63, v5
    s_nop 0
    s_cmp_gt_u32 s63, 12
    s_cbranch_scc0 L_lp_240
L_lp_240_ok:
    buffer_load_dwordx4 v[160:163], v10, s[8:11], s39 offen offset:0 sc1
    s_waitcnt vmcnt(19) lgkmcnt(4)
    v_mfma_f32_32x32x16_bf16 v[32:47], v[72:75], v[212:215], v[32:47]
    ds_read_b64_tr_b16 v[88:89], v16 offset:14336
    ds_read_b64_tr_b16 v[90:91], v16 offset:15360
    v_mfma_f32_32x32x16_bf16 v[48:63], v[76:79], v[212:215], v[48:63]
    ds_read_b64_tr_b16 v[92:93], v17 offset:14336
    ds_read_b64_tr_b16 v[94:95], v17 offset:15360
    buffer_load_dwordx4 v[164:167], v10, s[8:11], s39 offen offset:1024 sc1
    s_waitcnt vmcnt(19) lgkmcnt(4)
    v_mfma_f32_32x32x16_bf16 v[32:47], v[80:83], v[216:219], v[32:47]
    ds_read_b64_tr_b16 v[64:65], v16 offset:16384
    ds_read_b64_tr_b16 v[66:67], v16 offset:17408
    v_mfma_f32_32x32x16_bf16 v[48:63], v[84:87], v[216:219], v[48:63]
    ds_read_b64_tr_b16 v[68:69], v17 offset:16384
    ds_read_b64_tr_b16 v[70:71], v17 offset:17408
    buffer_load_dwordx4 v[168:171], v10, s[8:11], s39 offen offset:2048 sc1
    s_waitcnt vmcnt(19) lgkmcnt(4)
    v_mfma_f32_32x32x16_bf16 v[32:47], v[88:91], v[220:223], v[32:47]
    ds_read_b64_tr_b16 v[72:73], v16 offset:18432
    ds_read_b64_tr_b16 v[74:75], v16 offset:19456
    v_mfma_f32_32x32x16_bf16 v[48:63], v[92:95], v[220:223], v[48:63]
    ds_read_b64_tr_b16 v[76:77], v17 offset:18432
    ds_read_b64_tr_b16 v[78:79], v17 offset:19456
    buffer_load_dwordx4 v[172:175], v10, s[8:11], s39 offen offset:3072 sc1
    s_add_u32 s39, s39, 4096
    s_waitcnt vmcnt(19) lgkmcnt(4)
    v_mfma_f32_32x32x16_bf16 v[32:47], v[64:67], v[96:99], v[32:47]
    ds_read_b64_tr_b16 v[80:81], v16 offset:20480
    ds_read_b64_tr_b16 v[82:83], v16 offset:21504
    v_mfma_f32_32x32x16_bf16 v[48:63], v[68:71], v[96:99], v[48:63]
    ds_read_b64_tr_b16 v[84:85], v17 offset:20480
    ds_read_b64_tr_b16 v[86:87], v17 offset:21504
    s_cmp_gt_u32 s63, 13
    s_cbranch_scc1 L_lp_241_ok
L_lp_241:
    ds_read_b32 v5, v4
    s_waitcnt lgkmcnt(0)
    v_readfirstlane_b32 s63, v5
    s_nop 0
    s_cmp_gt_u32 s63, 13
    s_cbranch_scc0 L_lp_241
L_lp_241_ok:
    buffer_load_dwordx4 v[176:179], v10, s[8:11], s39 offen offset:0 sc1
    s_waitcnt vmcnt(19) lgkmcnt(4)
    v_mfma_f32_32x32x16_bf16 v[32:47], v[72:75], v[100:103], v[32:47]
    ds_read_b64_tr_b16 v[88:89], v16 offset:22528
    ds_read_b64_tr_b16 v[90:91], v16 offset:23552
    v_mfma_f32_32x32x16_bf16 v[48:63], v[76:79], v[100:103], v[48:63]
    ds_read_b64_tr_b16 v[92:93], v17 offset:22528
    ds_read_b64_tr_b16 v[94:95], v17 offset:23552
    buffer_load_dwordx4 v[180:183], v10, s[8:11], s39 offen offset:1024 sc1
    s_waitcnt vmcnt(19) lgkmcnt(4)
    v_mfma_f32_32x32x16_bf16 v[32:47], v[80:83], v[104:107], v[32:47]
    s_barrier
    ds_read_b64_tr_b16 v[64:65], v12 offset:0
    ds_read_b64_tr_b16 v[66:67], v12 offset:1024
    v_mfma_f32_32x32x16_bf16 v[48:63], v[84:87], v[104:107], v[48:63]
    ds_read_b64_tr_b16 v[68:69], v13 offset:0
    ds_read_b64_tr_b16 v[70:71], v13 offset:1024
    buffer_load_dwordx4 v[184:187], v10, s[8:11], s39 offen offset:2048 sc1
    s_waitcnt vmcnt(19) lgkmcnt(4)
    v_mfma_f32_32x32x16_bf16 v[32:47], v[88:91], v[108:111], v[32:47]
    ds_read_b64_tr_b16 v[72:73], v12 offset:2048
    ds_read_b64_tr_b16 v[74:75], v12 offset:3072
    v_mfma_f32_32x32x16_bf16 v[48:63], v[92:95], v[108:111], v[48:63]
    ds_read_b64_tr_b16 v[76:77], v13 offset:2048
    ds_read_b64_tr_b16 v[78:79], v13 offset:3072
    buffer_load_dwordx4 v[188:191], v10, s[8:11], s39 offen offset:3072 sc1
    s_sub_u32 s39, s39, 49152
    s_waitcnt vmcnt(19) lgkmcnt(4)
    v_mfma_f32_32x32x16_bf16 v[32:47], v[64:67], v[112:115], v[32:47]
    ds_read_b64_tr_b16 v[80:81], v12 offset:4096
    ds_read_b64_tr_b16 v[82:83], v12 offset:5120
    v_mfma_f32_32x32x16_bf16 v[48:63], v[68:71], v[112:115], v[48:63]
    ds_read_b64_tr_b16 v[84:85], v13 offset:4096
    ds_read_b64_tr_b16 v[86:87], v13 offset:5120
    s_cmp_gt_u32 s63, 14
    s_cbranch_scc1 L_lp_242_ok
L_lp_242:
    ds_read_b32 v5, v4
    s_waitcnt lgkmcnt(0)
    v_readfirstlane_b32 s63, v5
    s_nop 0
    s_cmp_gt_u32 s63, 14
    s_cbranch_scc0 L_lp_242
L_lp_242_ok:
    buffer_load_dwordx4 v[192:195], v10, s[8:11], s39 offen offset:0 sc1
    s_waitcnt vmcnt(19) lgkmcnt(4)
    v_mfma_f32_32x32x16_bf16 v[32:47], v[72:75], v[116:119], v[32:47]
    ds_read_b64_tr_b16 v[88:89], v12 offset:6144
    ds_read_b64_tr_b16 v[90:91], v12 offset:7168
    v_mfma_f32_32x32x16_bf16 v[48:63], v[76:79], v[116:119], v[48:63]
    ds_read_b64_tr_b16 v[92:93], v13 offset:6144
    ds_read_b64_tr_b16 v[94:95], v13 offset:7168
    buffer_load_dwordx4 v[196:199], v10, s[8:11], s39 offen offset:1024 sc1
    s_waitcnt vmcnt(19) lgkmcnt(4)
    v_mfma_f32_32x32x16_bf16 v[32:47], v[80:83], v[120:123], v[32:47]
    ds_read_b64_tr_b16 v[64:65], v12 offset:8192
    ds_read_b64_tr_b16 v[66:67], v12 offset:9216
    v_mfma_f32_32x32x16_bf16 v[48:63], v[84:87], v[120:123], v[48:63]
    ds_read_b64_tr_b16 v[68:69], v13 offset:8192
    ds_read_b64_tr_b16 v[70:71], v13 offset:9216
    buffer_load_dwordx4 v[200:203], v10, s[8:11], s39 offen offset:2048 sc1
    s_waitcnt vmcnt(19) lgkmcnt(4)
    v_mfma_f32_32x32x16_bf16 v[32:47], v[88:91], v[124:127], v[32:47]
    ds_read_b64_tr_b16 v[72:73], v12 offset:10240
    ds_read_b64_tr_b16 v[74:75], v12 offset:11264
    v_mfma_f32_32x32x16_bf16 v[48:63], v[92:95], v[124:127], v[48:63]
    ds_read_b64_tr_b16 v[76:77], v13 offset:10240
    ds_read_b64_tr_b16 v[78:79], v13 offset:11264
    buffer_load_dwordx4 v[204:207], v10, s[8:11], s39 offen offset:3072 sc1
    s_add_u32 s39, s39, 32768
    s_waitcnt vmcnt(19) lgkmcnt(4)
    v_mfma_f32_32x32x16_bf16 v[32:47], v[64:67], v[128:131], v[32:47]
    ds_read_b64_tr_b16 v[80:81], v12 offset:12288
    ds_read_b64_tr_b16 v[82:83], v12 offset:13312
    v_mfma_f32_32x32x16_bf16 v[48:63], v[68:71], v[128:131], v[48:63]
    ds_read_b64_tr_b16 v[84:85], v13 offset:12288
    ds_read_b64_tr_b16 v[86:87], v13 offset:13312
    s_cmp_gt_u32 s63, 15
    s_cbranch_scc1 L_lp_243_ok
L_lp_243:
    ds_read_b32 v5, v4
    s_waitcnt lgkmcnt(0)
    v_readfirstlane_b32 s63, v5
    s_nop 0
    s_cmp_gt_u32 s63, 15
    s_cbranch_scc0 L_lp_243
L_lp_243_ok:
    buffer_load_dwordx4 v[208:211], v10, s[8:11], s39 offen offset:0 sc1
    s_waitcnt vmcnt(19) lgkmcnt(4)
    v_mfma_f32_32x32x16_bf16 v[32:47], v[72:75], v[132:135], v[32:47]
    ds_read_b64_tr_b16 v[88:89], v12 offset:14336
    ds_read_b64_tr_b16 v[90:91], v12 offset:15360
    v_mfma_f32_32x32x16_bf16 v[48:63], v[76:79], v[132:135], v[48:63]
    ds_read_b64_tr_b16 v[92:93], v13 offset:14336
    ds_read_b64_tr_b16 v[94:95], v13 offset:15360
    buffer_load_dwordx4 v[212:215], v10, s[8:11], s39 offen offset:1024 sc1
    s_waitcnt vmcnt(19) lgkmcnt(4)
    v_mfma_f32_32x32x16_bf16 v[32:47], v[80:83], v[136:139], v[32:47]
    ds_read_b64_tr_b16 v[64:65], v12 offset:16384
    ds_read_b64_tr_b16 v[66:67], v12 offset:17408
    v_mfma_f32_32x32x16_bf16 v[48:63], v[84:87], v[136:139], v[48:63]
    ds_read_b64_tr_b16 v[68:69], v13 offset:16384
    ds_read_b64_tr_b16 v[70:71], v13 offset:17408
    buffer_load_dwordx4 v[216:219], v10, s[8:11], s39 offen offset:2048 sc1
    s_waitcnt vmcnt(19) lgkmcnt(4)
    v_mfma_f32_32x32x16_bf16 v[32:47], v[88:91], v[140:143], v[32:47]
    ds_read_b64_tr_b16 v[72:73], v12 offset:18432
    ds_read_b64_tr_b16 v[74:75], v12 offset:19456
    v_mfma_f32_32x32x16_bf16 v[48:63], v[92:95], v[140:143], v[48:63]
    ds_read_b64_tr_b16 v[76:77], v13 offset:18432
    ds_read_b64_tr_b16 v[78:79], v13 offset:19456
    buffer_load_dwordx4 v[220:223], v10, s[8:11], s39 offen offset:3072 sc1
    s_waitcnt vmcnt(19) lgkmcnt(4)
    v_mfma_f32_32x32x16_bf16 v[32:47], v[64:67], v[144:147], v[32:47]
    ds_read_b64_tr_b16 v[80:81], v12 offset:20480
    ds_read_b64_tr_b16 v[82:83], v12 offset:21504
    v_mfma_f32_32x32x16_bf16 v[48:63], v[68:71], v[144:147], v[48:63]
    ds_read_b64_tr_b16 v[84:85], v13 offset:20480
    ds_read_b64_tr_b16 v[86:87], v13 offset:21504
    s_waitcnt vmcnt(18) lgkmcnt(4)
    v_mfma_f32_32x32x16_bf16 v[32:47], v[72:75], v[148:151], v[32:47]
    ds_read_b64_tr_b16 v[88:89], v12 offset:22528
    ds_read_b64_tr_b16 v[90:91], v12 offset:23552
    v_mfma_f32_32x32x16_bf16 v[48:63], v[76:79], v[148:151], v[48:63]
    ds_read_b64_tr_b16 v[92:93], v13 offset:22528
    ds_read_b64_tr_b16 v[94:95], v13 offset:23552
    s_waitcnt vmcnt(17) lgkmcnt(4)
    v_mfma_f32_32x32x16_bf16 v[32:47], v[80:83], v[152:155], v[32:47]
    ds_read_b64_tr_b16 v[64:65], v12 offset:24576
    ds_read_b64_tr_b16 v[66:67], v12 offset:25600
    v_mfma_f32_32x32x16_bf16 v[48:63], v[84:87], v[152:155], v[48:63]
    ds_read_b64_tr_b16 v[68:69], v13 offset:24576
    ds_read_b64_tr_b16 v[70:71], v13 offset:25600
    s_waitcnt vmcnt(16) lgkmcnt(4)
    v_mfma_f32_32x32x16_bf16 v[32:47], v[88:91], v[156:159], v[32:47]
    ds_read_b64_tr_b16 v[72:73], v12 offset:26624
    ds_read_b64_tr_b16 v[74:75], v12 offset:27648
    v_mfma_f32_32x32x16_bf16 v[48:63], v[92:95], v[156:159], v[48:63]
    ds_read_b64_tr_b16 v[76:77], v13 offset:26624
    ds_read_b64_tr_b16 v[78:79], v13 offset:27648
    s_waitcnt vmcnt(15) lgkmcnt(4)
    v_mfma_f32_32x32x16_bf16 v[32:47], v[64:67], v[160:163], v[32:47]
    ds_read_b64_tr_b16 v[80:81], v12 offset:28672
    ds_read_b64_tr_b16 v[82:83], v12 offset:29696
    s_add_u32 s37, s36, 0x800000
    s_mov_b32 s35, 0x3f803f80
    v_mfma_f32_32x32x16_bf16 v[48:63], v[68:71], v[160:163], v[48:63]
    ds_read_b64_tr_b16 v[84:85], v13 offset:28672
    ds_read_b64_tr_b16 v[86:87], v13 offset:29696
    v_mov_b32 v24, 0
    v_mov_b32 v25, 0
    s_waitcnt vmcnt(14) lgkmcnt(4)
    v_mfma_f32_32x32x16_bf16 v[32:47], v[72:75], v[164:167], v[32:47]
    ds_read_b64_tr_b16 v[88:89], v12 offset:30720
    ds_read_b64_tr_b16 v[90:91], v12 offset:31744
    s_lshl_b32 s38, s4, 14
    s_lshl_b32 s31, s5, 10
    v_mfma_f32_32x32x16_bf16 v[48:63], v[76:79], v[164:167], v[48:63]
    ds_read_b64_tr_b16 v[92:93], v13 offset:30720
    ds_read_b64_tr_b16 v[94:95], v13 offset:31744
    s_add_u32 s38, s38, s31
    s_lshl_b32 s31, s3, 8
    s_waitcnt vmcnt(13) lgkmcnt(4)
    v_mfma_f32_32x32x16_bf16 v[32:47], v[80:83], v[168:171], v[32:47]
    ds_read_b64_tr_b16 v[64:65], v12 offset:32768
    ds_read_b64_tr_b16 v[66:67], v12 offset:33792
    s_add_u32 s38, s38, s31
    s_add_u32 s38, s38, 0x26c0000
    v_mfma_f32_32x32x16_bf16 v[48:63], v[84:87], v[168:171], v[48:63]
    ds_read_b64_tr_b16 v[68:69], v13 offset:32768
    ds_read_b64_tr_b16 v[70:71], v13 offset:33792
    v_lshlrev_b32 v9, 2, v1
    s_waitcnt vmcnt(12) lgkmcnt(4)
    v_mfma_f32_32x32x16_bf16 v[32:47], v[88:91], v[172:175], v[32:47]
    ds_read_b64_tr_b16 v[72:73], v12 offset:34816
    ds_read_b64_tr_b16 v[74:75], v12 offset:35840
    v_mfma_f32_32x32x16_bf16 v[48:63], v[92:95], v[172:175], v[48:63]
    ds_read_b64_tr_b16 v[76:77], v13 offset:34816
    ds_read_b64_tr_b16 v[78:79], v13 offset:35840
    s_waitcnt vmcnt(11) lgkmcnt(4)
    v_mfma_f32_32x32x16_bf16 v[32:47], v[64:67], v[176:179], v[32:47]
    ds_read_b64_tr_b16 v[80:81], v12 offset:36864
    ds_read_b64_tr_b16 v[82:83], v12 offset:37888
    v_mfma_f32_32x32x16_bf16 v[48:63], v[68:71], v[176:179], v[48:63]
    ds_read_b64_tr_b16 v[84:85], v13 offset:36864
    ds_read_b64_tr_b16 v[86:87], v13 offset:37888
    s_waitcnt vmcnt(10) lgkmcnt(4)
    v_mfma_f32_32x32x16_bf16 v[32:47], v[72:75], v[180:183], v[32:47]
    ds_read_b64_tr_b16 v[88:89], v12 offset:38912
    ds_read_b64_tr_b16 v[90:91], v12 offset:39936
    v_mfma_f32_32x32x16_bf16 v[48:63], v[76:79], v[180:183], v[48:63]
    ds_read_b64_tr_b16 v[92:93], v13 offset:38912
    ds_read_b64_tr_b16 v[94:95], v13 offset:39936
    s_waitcnt vmcnt(9) lgkmcnt(4)
    v_mfma_f32_32x32x16_bf16 v[32:47], v[80:83], v[184:187], v[32:47]
    ds_read_b64_tr_b16 v[64:65], v12 offset:40960
    ds_read_b64_tr_b16 v[66:67], v12 offset:41984
    v_mfma_f32_32x32x16_bf16 v[48:63], v[84:87], v[184:187], v[48:63]
    ds_read_b64_tr_b16 v[68:69], v13 offset:40960
    ds_read_b64_tr_b16 v[70:71], v13 offset:41984
    s_waitcnt vmcnt(8) lgkmcnt(4)
    v_mfma_f32_32x32x16_bf16 v[32:47], v[88:91], v[188:191], v[32:47]
    ds_read_b64_tr_b16 v[72:73], v12 offset:43008
    ds_read_b64_tr_b16 v[74:75], v12 offset:44032
    v_mfma_f32_32x32x16_bf16 v[48:63], v[92:95], v[188:191], v[48:63]
    ds_read_b64_tr_b16 v[76:77], v13 offset:43008
    ds_read_b64_tr_b16 v[78:79], v13 offset:44032
    s_waitcnt vmcnt(7) lgkmcnt(4)
    v_mfma_f32_32x32x16_bf16 v[32:47], v[64:67], v[192:195], v[32:47]
    ds_read_b64_tr_b16 v[80:81], v12 offset:45056
    ds_read_b64_tr_b16 v[82:83], v12 offset:46080
    v_mfma_f32_32x32x16_bf16 v[48:63], v[68:71], v[192:195], v[48:63]
    ds_read_b64_tr_b16 v[84:85], v13 offset:45056
    ds_read_b64_tr_b16 v[86:87], v13 offset:46080
    s_waitcnt vmcnt(6) lgkmcnt(4)
    v_mfma_f32_32x32x16_bf16 v[32:47], v[72:75], v[196:199], v[32:47]
    ds_read_b64_tr_b16 v[88:89], v12 offset:47104
    ds_read_b64_tr_b16 v[90:91], v12 offset:48128
    v_mfma_f32_32x32x16_bf16 v[48:63], v[76:79], v[196:199], v[48:63]
    ds_read_b64_tr_b16 v[92:93], v13 offset:47104
    ds_read_b64_tr_b16 v[94:95], v13 offset:48128
    s_waitcnt vmcnt(5) lgkmcnt(4)
    v_mfma_f32_32x32x16_bf16 v[32:47], v[80:83], v[200:203], v[32:47]
    ds_read_b64_tr_b16 v[64:65], v12 offset:49152
    ds_read_b64_tr_b16 v[66:67], v12 offset:50176
    v_mfma_f32_32x32x16_bf16 v[48:63], v[84:87], v[200:203], v[48:63]
    ds_read_b64_tr_b16 v[68:69], v13 offset:49152
    ds_read_b64_tr_b16 v[70:71], v13 offset:50176
    s_waitcnt vmcnt(4) lgkmcnt(4)
    v_mfma_f32_32x32x16_bf16 v[32:47], v[88:91], v[204:207], v[32:47]
    ds_read_b64_tr_b16 v[72:73], v12 offset:51200
    ds_read_b64_tr_b16 v[74:75], v12 offset:52224
    v_mfma_f32_32x32x16_bf16 v[48:63], v[92:95], v[204:207], v[48:63]
    ds_read_b64_tr_b16 v[76:77], v13 offset:51200
    ds_read_b64_tr_b16 v[78:79], v13 offset:52224
    s_waitcnt vmcnt(3) lgkmcnt(4)
    v_mfma_f32_32x32x16_bf16 v[32:47], v[64:67], v[208:211], v[32:47]
    ds_read_b64_tr_b16 v[80:81], v12 offset:53248
    ds_read_b64_tr_b16 v[82:83], v12 offset:54272
    v_mfma_f32_32x32x16_bf16 v[48:63], v[68:71], v[208:211], v[48:63]
    ds_read_b64_tr_b16 v[84:85], v13 offset:53248
    ds_read_b64_tr_b16 v[86:87], v13 offset:54272
    s_waitcnt vmcnt(2) lgkmcnt(4)
    v_mfma_f32_32x32x16_bf16 v[32:47], v[72:75], v[212:215], v[32:47]
    ds_read_b64_tr_b16 v[88:89], v12 offset:55296
    ds_read_b64_tr_b16 v[90:91], v12 offset:56320
    v_mfma_f32_32x32x16_bf16 v[48:63], v[76:79], v[212:215], v[48:63]
    ds_read_b64_tr_b16 v[92:93], v13 offset:55296
    ds_read_b64_tr_b16 v[94:95], v13 offset:56320
    s_waitcnt vmcnt(1) lgkmcnt(4)
    v_mfma_f32_32x32x16_bf16 v[32:47], v[80:83], v[216:219], v[32:47]
    v_mfma_f32_32x32x16_bf16 v[48:63], v[84:87], v[216:219], v[48:63]
    s_waitcnt vmcnt(0) lgkmcnt(0)
    v_mfma_f32_32x32x16_bf16 v[32:47], v[88:91], v[220:223], v[32:47]
    s_barrier
    v_mfma_f32_32x32x16_bf16 v[48:63], v[92:95], v[220:223], v[48:63]
    s_nop 9
    v_cvt_pk_bf16_f32 v96, v32, v33
    v_cvt_pk_bf16_f32 v97, v34, v35
    v_cvt_pk_bf16_f32 v98, v36, v37
    v_cvt_pk_bf16_f32 v99, v38, v39
    buffer_store_dwordx4 v[96:99], v10, s[16:19], s37 offen offset:0 sc1
    v_cvt_pk_bf16_f32 v100, v40, v41
    v_cvt_pk_bf16_f32 v101, v42, v43
    v_cvt_pk_bf16_f32 v102, v44, v45
    v_cvt_pk_bf16_f32 v103, v46, v47
    buffer_store_dwordx4 v[100:103], v10, s[16:19], s37 offen offset:1024 sc1
    v_cvt_pk_bf16_f32 v104, v48, v49
    v_cvt_pk_bf16_f32 v105, v50, v51
    v_cvt_pk_bf16_f32 v106, v52, v53
    v_cvt_pk_bf16_f32 v107, v54, v55
    buffer_store_dwordx4 v[104:107], v10, s[16:19], s37 offen offset:2048 sc1
    v_cvt_pk_bf16_f32 v108, v56, v57
    v_cvt_pk_bf16_f32 v109, v58, v59
    v_cvt_pk_bf16_f32 v110, v60, v61
    v_cvt_pk_bf16_f32 v111, v62, v63
    buffer_store_dwordx4 v[108:111], v10, s[16:19], s37 offen offset:3072 sc1
    v_dot2_f32_bf16 v24, v96, s35, v24
    v_dot2_f32_bf16 v25, v96, v96, v25
    v_dot2_f32_bf16 v24, v97, s35, v24
    v_dot2_f32_bf16 v25, v97, v97, v25
    v_dot2_f32_bf16 v24, v98, s35, v24
    v_dot2_f32_bf16 v25, v98, v98, v25
    v_dot2_f32_bf16 v24, v99, s35, v24
    v_dot2_f32_bf16 v25, v99, v99, v25
    v_dot2_f32_bf16 v24, v100, s35, v24
    v_dot2_f32_bf16 v25, v100, v100, v25
    v_dot2_f32_bf16 v24, v101, s35, v24
    v_dot2_f32_bf16 v25, v101, v101, v25
    v_dot2_f32_bf16 v24, v102, s35, v24
    v_dot2_f32_bf16 v25, v102, v102, v25
    v_dot2_f32_bf16 v24, v103, s35, v24
    v_dot2_f32_bf16 v25, v103, v103, v25
    v_dot2_f32_bf16 v24, v104, s35, v24
    v_dot2_f32_bf16 v25, v104, v104, v25
    v_dot2_f32_bf16 v24, v105, s35, v24
    v_dot2_f32_bf16 v25, v105, v105, v25
    v_dot2_f32_bf16 v24, v106, s35, v24
    v_dot2_f32_bf16 v25, v106, v106, v25
    v_dot2_f32_bf16 v24, v107, s35, v24
    v_dot2_f32_bf16 v25, v107, v107, v25
    v_dot2_f32_bf16 v24, v108, s35, v24
    v_dot2_f32_bf16 v25, v108, v108, v25
    v_dot2_f32_bf16 v24, v109, s35, v24
    v_dot2_f32_bf16 v25, v109, v109, v25
    v_dot2_f32_bf16 v24, v110, s35, v24
    v_dot2_f32_bf16 v25, v110, v110, v25
    v_dot2_f32_bf16 v24, v111, s35, v24
    v_dot2_f32_bf16 v25, v111, v111, v25
    s_nop 2
    v_permlane32_swap_b32 v24, v25
    v_add_f32 v24, v24, v25
    buffer_store_dword v24, v9, s[16:19], s38 offen sc1
    s_waitcnt vmcnt(0)
    s_lshl_b32 s34, s4, 8
    s_add_u32 s34, s34, 0x2808000
    v_mov_b32 v4, 1
    v_mov_b32 v5, 0
    s_mov_b64 exec, 1
    v_mov_b32 v6, 163828
    ds_add_rtn_u32 v7, v6, v4
    s_waitcnt lgkmcnt(0)
    v_readfirstlane_b32 s35, v7
    s_nop 0
    s_cmp_eq_u32 s35, 3
    s_cbranch_scc0 L_sig_244
    s_lshl_b32 s35, s5, 2
    s_add_u32 s34, s34, s35
    buffer_store_dword v4, v5, s[16:19], s34 offen sc1
L_sig_244:
    s_mov_b64 exec, -1
    s_branch L_wa1_end_227
L_wa1_ld_226:
    s_sub_u32 s30, s3, 4
    v_lshrrev_b32 v6, 3, v1
    v_and_b32 v7, 7, v1
    s_lshl_b32 s31, s30, 4
    v_lshrrev_b32 v5, 1, v6
    v_and_b32 v5, 1, v5
    v_lshlrev_b32 v5, 2, v5
    v_xor_b32 v5, v5, v7
    v_lshlrev_b32 v5, 4, v5
    s_lshl_b32 s32, s5, 7
    v_add_u32 v5, s32, v5
    v_add_u32 v4, s31, v6
    v_lshl_add_u32 v12, v4, 11, v5
    v_add_u32 v13, 15360, v12
    v_lshlrev_b32 v8, 4, v1
    s_lshl_b32 s35, s30, 11
    s_add_u32 m0, s35, 0
    s_mov_b32 s38, 1310720
    buffer_load_dwordx4 v12, s[12:15], s38 offen offset:0 lds
    buffer_load_dwordx4 v13, s[12:15], s38 offen offset:1024 lds
    s_add_u32 m0, s35, 8192
    s_mov_b32 s38, 1572864
    buffer_load_dwordx4 v12, s[12:15], s38 offen offset:0 lds
    buffer_load_dwordx4 v13, s[12:15], s38 offen offset:1024 lds
    s_add_u32 m0, s35, 16384
    s_mov_b32 s38, 1703936
    buffer_load_dwordx4 v12, s[12:15], s38 offen offset:0 lds
    buffer_load_dwordx4 v13, s[12:15], s38 offen offset:1024 lds
    s_add_u32 m0, s35, 24576
    s_mov_b32 s38, 1835008
    buffer_load_dwordx4 v12, s[12:15], s38 offen offset:0 lds
    buffer_load_dwordx4 v13, s[12:15], s38 offen offset:1024 lds
    s_add_u32 m0, s35, 32768
    s_mov_b32 s38, 1966080
    buffer_load_dwordx4 v12, s[12:15], s38 offen offset:0 lds
    buffer_load_dwordx4 v13, s[12:15], s38 offen offset:1024 lds
    s_add_u32 m0, s35, 40960
    s_mov_b32 s38, 393216
    buffer_load_dwordx4 v12, s[12:15], s38 offen offset:0 lds
    buffer_load_dwordx4 v13, s[12:15], s38 offen offset:1024 lds
    s_add_u32 m0, s35, 49152
    s_mov_b32 s38, 1441792
    buffer_load_dwordx4 v12, s[12:15], s38 offen offset:0 lds
    buffer_load_dwordx4 v13, s[12:15], s38 offen offset:1024 lds
    s_barrier
    s_cmp_lg_u32 s3, 7
    s_cbranch_scc1 L_rp_245_ok
    v_and_b32 v4, 15, v1
    v_mov_b32 v5, 0x87654210
    v_mov_b32 v6, 0xb3fedca9
    v_cmp_lt_u32 vcc, 7, v4
    s_nop 1
    v_cndmask_b32 v5, v5, v6, vcc
    v_and_b32 v4, 7, v4
    v_lshlrev_b32 v4, 2, v4
    v_bfe_u32 v4, v5, v4, 4
    v_lshlrev_b32 v4, 2, v4
    s_lshl_b32 s52, s4, 8
    s_add_u32 s52, s52, 0x2807000
    s_mov_b32 s53, 0
    v_mov_b32 v6, 163832
L_rp_245:
    buffer_load_dword v5, v4, s[16:19], s52 offen sc1
    s_waitcnt vmcnt(0)
    v_cmp_ne_u32 vcc, 1, v5
    s_nop 0
    s_or_b32 s63, vcc_lo, 0x10000
    s_ff1_i32_b32 s63, s63
    s_add_u32 s53, s53, 1
    s_cmp_lt_u32 s53, 0x40000
    s_cselect_b32 s63, s63, 16
    v_mov_b32 v7, s63
    ds_write_b32 v6, v7
    s_cmp_lt_u32 s63, 14
    s_cbranch_scc1 L_rp_245
L_rp_245_ok:
    s_waitcnt vmcnt(0)
    s_barrier
    s_cmp_lg_u32 s3, 7
    s_cbranch_scc1 L_rp_246_ok
    v_and_b32 v4, 15, v1
    v_mov_b32 v5, 0x87654210
    v_mov_b32 v6, 0xb3fedca9
    v_cmp_lt_u32 vcc, 7, v4
    s_nop 1
    v_cndmask_b32 v5, v5, v6, vcc
    v_and_b32 v4, 7, v4
    v_lshlrev_b32 v4, 2, v4
    v_bfe_u32 v4, v5, v4, 4
    v_lshlrev_b32 v4, 2, v4
    s_lshl_b32 s52, s4, 8
    s_add_u32 s52, s52, 0x2807000
    s_mov_b32 s53, 0
    v_mov_b32 v6, 163832
L_rp_246:
    buffer_load_dword v5, v4, s[16:19], s52 offen sc1
    s_waitcnt vmcnt(0)
    v_cmp_ne_u32 vcc, 1, v5
    s_nop 0
    s_or_b32 s63, vcc_lo, 0x10000
    s_ff1_i32_b32 s63, s63
    s_add_u32 s53, s53, 1
    s_cmp_lt_u32 s53, 0x40000
    s_cselect_b32 s63, s63, 16
    v_mov_b32 v7, s63
    ds_write_b32 v6, v7
    s_cmp_lt_u32 s63, 16
    s_cbranch_scc1 L_rp_246
L_rp_246_ok:
    s_mov_b32 s24, s74
    s_and_b32 s25, s75, 0xffff
    s_mov_b32 s26, 0x200000
    s_mov_b32 s27, 0x20000
    s_and_b32 s57, s2, 1
    s_lshl_b32 s57, s57, 3
    s_bfe_u32 s58, s2, 0x30003
    s_add_u32 s57, s57, s58
    s_lshl_b32 s57, s57, 7
    v_lshrrev_b32 v241, 3, v1
    v_bfe_u32 v242, v241, 1, 1
    v_lshlrev_b32 v242, 2, v242
    v_and_b32 v243, 7, v1
    v_xor_b32 v242, v242, v243
    v_lshlrev_b32 v242, 4, v242
    s_lshl_b32 s58, s30, 4
    v_add_u32 v241, s58, v241
    v_lshl_add_u32 v241, v241, 11, v242
    v_add_u32 v241, s57, v241
    v_add_u32 v242, 15360, v241
    s_lshl_b32 s60, s30, 11
    s_add_u32 m0, s60, 57344
    s_mov_b32 s59, 0
    buffer_load_dwordx4 v241, s[24:27], s59 offen lds
    buffer_load_dwordx4 v242, s[24:27], s59 offen offset:1024 lds
    s_add_u32 m0, s60, 65536
    s_mov_b32 s59, 131072
    buffer_load_dwordx4 v241, s[24:27], s59 offen lds
    buffer_load_dwordx4 v242, s[24:27], s59 offen offset:1024 lds
    s_add_u32 m0, s60, 73728
    s_mov_b32 s59, 262144
    buffer_load_dwordx4 v241, s[24:27], s59 offen lds
    buffer_load_dwordx4 v242, s[24:27], s59 offen offset:1024 lds
    s_cmp_ge_u32 s5, 8
    s_cbranch_scc1 L_qe_247
    s_bitcmp1_b32 s5, 0
    s_cselect_b32 s46, s78, s76
    s_cselect_b32 s47, s79, s77
    s_mov_b32 s20, s46
    s_and_b32 s21, s47, 0xffff
    s_mov_b32 s22, 0x10000
    s_mov_b32 s23, 0x20000
    s_lshl_b32 s39, s30, 14
    s_add_u32 s31, s39, 81920
    s_add_u32 m0, s31, 0
    s_nop 0
    buffer_load_dwordx4 v8, s[20:23], s39 offen offset:0 lds
    buffer_load_dwordx4 v8, s[20:23], s39 offen offset:1024 lds
    buffer_load_dwordx4 v8, s[20:23], s39 offen offset:2048 lds
    buffer_load_dwordx4 v8, s[20:23], s39 offen offset:3072 lds
    s_add_u32 s39, s39, 4096
    s_add_u32 m0, s31, 4096
    s_nop 0
    buffer_load_dwordx4 v8, s[20:23], s39 offen offset:0 lds
    buffer_load_dwordx4 v8, s[20:23], s39 offen offset:1024 lds
    buffer_load_dwordx4 v8, s[20:23], s39 offen offset:2048 lds
    buffer_load_dwordx4 v8, s[20:23], s39 offen offset:3072 lds
    s_add_u32 s39, s39, 4096
    s_add_u32 m0, s31, 8192
    s_nop 0
    buffer_load_dwordx4 v8, s[20:23], s39 offen offset:0 lds
    buffer_load_dwordx4 v8, s[20:23], s39 offen offset:1024 lds
    buffer_load_dwordx4 v8, s[20:23], s39 offen offset:2048 lds
    buffer_load_dwordx4 v8, s[20:23], s39 offen offset:3072 lds
    s_add_u32 s39, s39, 4096
    s_add_u32 m0, s31, 12288
    s_nop 0
    buffer_load_dwordx4 v8, s[20:23], s39 offen offset:0 lds
    buffer_load_dwordx4 v8, s[20:23], s39 offen offset:1024 lds
    buffer_load_dwordx4 v8, s[20:23], s39 offen offset:2048 lds
    buffer_load_dwordx4 v8, s[20:23], s39 offen offset:3072 lds
    s_add_u32 s39, s39, 4096
    s_branch L_qe_248
L_qe_247:
    s_add_u32 m0, s60, 90112
    s_mov_b32 s59, 1441792
    buffer_load_dwordx4 v241, s[24:27], s59 offen lds
    buffer_load_dwordx4 v242, s[24:27], s59 offen offset:1024 lds
    s_add_u32 m0, s60, 106496
    s_mov_b32 s59, 1572864
    buffer_load_dwordx4 v241, s[24:27], s59 offen lds
    buffer_load_dwordx4 v242, s[24:27], s59 offen offset:1024 lds
    s_add_u32 m0, s60, 122880
    s_mov_b32 s59, 1703936
    buffer_load_dwordx4 v241, s[24:27], s59 offen lds
    buffer_load_dwordx4 v242, s[24:27], s59 offen offset:1024 lds
    s_add_u32 m0, s60, 139264
    s_mov_b32 s59, 1835008
    buffer_load_dwordx4 v241, s[24:27], s59 offen lds
    buffer_load_dwordx4 v242, s[24:27], s59 offen offset:1024 lds
    s_add_u32 m0, s60, 81920
    s_mov_b32 s59, 1966080
    buffer_load_dwordx4 v241, s[24:27], s59 offen lds
    buffer_load_dwordx4 v242, s[24:27], s59 offen offset:1024 lds
L_qe_248:
    s_barrier
L_wa1_end_227:
    s_and_b32 s6, s2, 7
    s_lshr_b32 s7, s2, 3
    s_lshr_b32 s4, s6, 1
    s_lshl_b32 s4, s4, 2
    s_lshr_b32 s5, s7, 3
    s_add_u32 s4, s4, s5
    s_and_b32 s5, s6, 1
    s_lshl_b32 s5, s5, 3
    s_and_b32 s7, s7, 7
    s_add_u32 s5, s5, s7
    s_add_u32 s8, s86, 0x800000
    s_addc_u32 s9, s87, 0
    s_and_b32 s9, s9, 0xffff
    s_mov_b32 s10, 0x400000
    s_mov_b32 s11, 0x20000
    s_mov_b32 s12, s74
    s_and_b32 s13, s75, 0xffff
    s_mov_b32 s14, 0x200000
    s_mov_b32 s15, 0x20000
    s_lshr_b32 s48, s5, 1
    s_cmp_ge_u32 s3, 4
    s_cbranch_scc1 L_qb1_ld_249
    v_lshlrev_b32 v10, 4, v1
    s_lshl_b32 s39, s4, 2
    s_add_u32 s36, s39, s48
    s_add_u32 s39, s39, s3
    s_lshl_b32 s39, s39, 16
    s_lshl_b32 s36, s36, 16
    s_lshl_b32 s31, s3, 14
    s_add_u32 s36, s36, s31
    v_and_b32 v4, 15, v1
    v_lshrrev_b32 v5, 2, v4
    v_lshl_add_u32 v5, v3, 2, v5
    v_mul_u32_u24 v5, 128, v5
    v_and_b32 v6, 3, v4
    v_lshlrev_b32 v6, 3, v6
    v_bfe_u32 v7, v1, 4, 1
    v_lshl_add_u32 v6, v7, 5, v6
    v_add_u32 v6, 0, v6
    v_bfe_u32 v7, v1, 3, 1
    v_lshlrev_b32 v7, 6, v7
    v_xor_b32 v6, v6, v7
    v_add_u32 v12, v5, v6
    v_xor_b32 v13, 64, v12
    v_and_b32 v4, 15, v1
    v_lshrrev_b32 v5, 2, v4
    v_lshl_add_u32 v5, v3, 2, v5
    v_mul_u32_u24 v5, 64, v5
    v_and_b32 v6, 3, v4
    v_lshlrev_b32 v6, 3, v6
    v_bfe_u32 v7, v1, 4, 1
    v_lshl_add_u32 v6, v7, 5, v6
    v_add_u32 v6, 0, v6
    v_add_u32 v30, v5, v6
    s_lshl_b32 s31, s3, 14
    s_add_u32 s31, s31, 81920
    v_add_u32 v30, s31, v30
    v_add_u32 v31, s31, v10
    v_mov_b32 v4, 163836
    v_mov_b32 v5, 0
    ds_write_b32 v4, v5
    v_mov_b32 v32, 0
    v_mov_b32 v33, 0
    v_mov_b32 v34, 0
    v_mov_b32 v35, 0
    v_mov_b32 v36, 0
    v_mov_b32 v37, 0
    v_mov_b32 v38, 0
    v_mov_b32 v39, 0
    v_mov_b32 v40, 0
    v_mov_b32 v41, 0
    v_mov_b32 v42, 0
    v_mov_b32 v43, 0
    v_mov_b32 v44, 0
    v_mov_b32 v45, 0
    v_mov_b32 v46, 0
    v_mov_b32 v47, 0
    v_mov_b32 v48, 0
    v_mov_b32 v49, 0
    v_mov_b32 v50, 0
    v_mov_b32 v51, 0
    v_mov_b32 v52, 0
    v_mov_b32 v53, 0
    v_mov_b32 v54, 0
    v_mov_b32 v55, 0
    v_mov_b32 v56, 0
    v_mov_b32 v57, 0
    v_mov_b32 v58, 0
    v_mov_b32 v59, 0
    v_mov_b32 v60, 0
    v_mov_b32 v61, 0
    v_mov_b32 v62, 0
    v_mov_b32 v63, 0
    s_waitcnt lgkmcnt(0)
    v_add_u32 v14, 0x10000, v12
    v_add_u32 v15, 0x10000, v13
    v_add_u32 v16, 0x20000, v12
    v_add_u32 v17, 0x20000, v13
    v_mov_b32 v4, 163836
    s_mov_b32 s63, 0
    s_barrier
    s_cmp_ge_u32 s5, 8
    s_cbranch_scc1 L_qb1_nokv_251_a
    s_lshl_b32 s31, s3, 2
    s_add_u32 s31, s31, 3
L_pp_253:
    ds_read_b32 v5, v4
    s_waitcnt lgkmcnt(0)
    v_readfirstlane_b32 s63, v5
    s_nop 0
    s_cmp_gt_u32 s63, s31
    s_cbranch_scc0 L_pp_253
    buffer_load_dwordx4 v[128:131], v10, s[8:11], s36 offen offset:0 sc1
    buffer_load_dwordx4 v[132:135], v10, s[8:11], s36 offen offset:1024 sc1
    buffer_load_dwordx4 v[136:139], v10, s[8:11], s36 offen offset:2048 sc1
    buffer_load_dwordx4 v[140:143], v10, s[8:11], s36 offen offset:3072 sc1
    s_add_u32 s36, s36, 4096
    buffer_load_dwordx4 v[144:147], v10, s[8:11], s36 offen offset:0 sc1
    buffer_load_dwordx4 v[148:151], v10, s[8:11], s36 offen offset:1024 sc1
    buffer_load_dwordx4 v[152:155], v10, s[8:11], s36 offen offset:2048 sc1
    buffer_load_dwordx4 v[156:159], v10, s[8:11], s36 offen offset:3072 sc1
    s_add_u32 s36, s36, 4096
    buffer_load_dwordx4 v[160:163], v10, s[8:11], s36 offen offset:0 sc1
    buffer_load_dwordx4 v[164:167], v10, s[8:11], s36 offen offset:1024 sc1
    buffer_load_dwordx4 v[168:171], v10, s[8:11], s36 offen offset:2048 sc1
    buffer_load_dwordx4 v[172:175], v10, s[8:11], s36 offen offset:3072 sc1
    s_add_u32 s36, s36, 4096
    buffer_load_dwordx4 v[176:179], v10, s[8:11], s36 offen offset:0 sc1
    buffer_load_dwordx4 v[180:183], v10, s[8:11], s36 offen offset:1024 sc1
    buffer_load_dwordx4 v[184:187], v10, s[8:11], s36 offen offset:2048 sc1
    buffer_load_dwordx4 v[188:191], v10, s[8:11], s36 offen offset:3072 sc1
    s_add_u32 s36, s36, 4096
L_qb1_nokv_251_a:
    s_cmp_gt_u32 s63, 0
    s_cbranch_scc1 L_lp_254_ok
L_lp_254:
    ds_read_b32 v5, v4
    s_waitcnt lgkmcnt(0)
    v_readfirstlane_b32 s63, v5
    s_nop 0
    s_cmp_gt_u32 s63, 0
    s_cbranch_scc0 L_lp_254
L_lp_254_ok:
    buffer_load_dwordx4 v[96:99], v10, s[8:11], s39 offen offset:0 sc1
    buffer_load_dwordx4 v[100:103], v10, s[8:11], s39 offen offset:1024 sc1
    buffer_load_dwordx4 v[104:107], v10, s[8:11], s39 offen offset:2048 sc1
    buffer_load_dwordx4 v[108:111], v10, s[8:11], s39 offen offset:3072 sc1
    s_add_u32 s39, s39, 4096
    s_cmp_gt_u32 s63, 1
    s_cbranch_scc1 L_lp_255_ok
L_lp_255:
    ds_read_b32 v5, v4
    s_waitcnt lgkmcnt(0)
    v_readfirstlane_b32 s63, v5
    s_nop 0
    s_cmp_gt_u32 s63, 1
    s_cbranch_scc0 L_lp_255
L_lp_255_ok:
    buffer_load_dwordx4 v[112:115], v10, s[8:11], s39 offen offset:0 sc1
    buffer_load_dwordx4 v[116:119], v10, s[8:11], s39 offen offset:1024 sc1
    buffer_load_dwordx4 v[120:123], v10, s[8:11], s39 offen offset:2048 sc1
    buffer_load_dwordx4 v[124:127], v10, s[8:11], s39 offen offset:3072 sc1
    s_add_u32 s39, s39, 4096
    s_cmp_ge_u32 s5, 8
    s_cbranch_scc1 L_qb1_nokv_251
    ds_read_b64_tr_b16 v[64:65], v30 offset:0
    ds_read_b64_tr_b16 v[66:67], v30 offset:512
    ds_read_b64_tr_b16 v[68:69], v30 offset:1024
    ds_read_b64_tr_b16 v[70:71], v30 offset:1536
    ds_read_b64_tr_b16 v[72:73], v30 offset:2048
    ds_read_b64_tr_b16 v[74:75], v30 offset:2560
    ds_read_b64_tr_b16 v[76:77], v30 offset:3072
    ds_read_b64_tr_b16 v[78:79], v30 offset:3584
    ds_read_b64_tr_b16 v[80:81], v30 offset:4096
    ds_read_b64_tr_b16 v[82:83], v30 offset:4608
    ds_read_b64_tr_b16 v[84:85], v30 offset:5120
    ds_read_b64_tr_b16 v[86:87], v30 offset:5632
    ds_read_b64_tr_b16 v[88:89], v30 offset:6144
    ds_read_b64_tr_b16 v[90:91], v30 offset:6656
    s_waitcnt vmcnt(23) lgkmcnt(12)
    v_mfma_f32_32x32x16_bf16 v[192:207], v[64:67], v[128:131], 0
    ds_read_b64_tr_b16 v[92:93], v30 offset:7168
    ds_read_b64_tr_b16 v[94:95], v30 offset:7680
    s_waitcnt vmcnt(22) lgkmcnt(12)
    v_mfma_f32_32x32x16_bf16 v[192:207], v[68:71], v[132:135], v[192:207]
    ds_read_b64_tr_b16 v[64:65], v30 offset:8192
    ds_read_b64_tr_b16 v[66:67], v30 offset:8704
    s_waitcnt vmcnt(21) lgkmcnt(12)
    v_mfma_f32_32x32x16_bf16 v[192:207], v[72:75], v[136:139], v[192:207]
    ds_read_b64_tr_b16 v[68:69], v30 offset:9216
    ds_read_b64_tr_b16 v[70:71], v30 offset:9728
    s_waitcnt vmcnt(20) lgkmcnt(12)
    v_mfma_f32_32x32x16_bf16 v[192:207], v[76:79], v[140:143], v[192:207]
    ds_read_b64_tr_b16 v[72:73], v30 offset:10240
    ds_read_b64_tr_b16 v[74:75], v30 offset:10752
    s_waitcnt vmcnt(19) lgkmcnt(12)
    v_mfma_f32_32x32x16_bf16 v[192:207], v[80:83], v[144:147], v[192:207]
    ds_read_b64_tr_b16 v[76:77], v30 offset:11264
    ds_read_b64_tr_b16 v[78:79], v30 offset:11776
    s_waitcnt vmcnt(18) lgkmcnt(12)
    v_mfma_f32_32x32x16_bf16 v[192:207], v[84:87], v[148:151], v[192:207]
    ds_read_b64_tr_b16 v[80:81], v30 offset:12288
    ds_read_b64_tr_b16 v[82:83], v30 offset:12800
    s_waitcnt vmcnt(17) lgkmcnt(12)
    v_mfma_f32_32x32x16_bf16 v[192:207], v[88:91], v[152:155], v[192:207]
    ds_read_b64_tr_b16 v[84:85], v30 offset:13312
    ds_read_b64_tr_b16 v[86:87], v30 offset:13824
    s_waitcnt vmcnt(16) lgkmcnt(12)
    v_mfma_f32_32x32x16_bf16 v[192:207], v[92:95], v[156:159], v[192:207]
    ds_read_b64_tr_b16 v[88:89], v30 offset:14336
    ds_read_b64_tr_b16 v[90:91], v30 offset:14848
    s_waitcnt vmcnt(15) lgkmcnt(12)
    v_mfma_f32_32x32x16_bf16 v[192:207], v[64:67], v[160:163], v[192:207]
    ds_read_b64_tr_b16 v[92:93], v30 offset:15360
    ds_read_b64_tr_b16 v[94:95], v30 offset:15872
    s_waitcnt vmcnt(14) lgkmcnt(12)
    v_mfma_f32_32x32x16_bf16 v[192:207], v[68:71], v[164:167], v[192:207]
    s_waitcnt vmcnt(13) lgkmcnt(10)
    v_mfma_f32_32x32x16_bf16 v[192:207], v[72:75], v[168:171], v[192:207]
    s_waitcnt vmcnt(12) lgkmcnt(8)
    v_mfma_f32_32x32x16_bf16 v[192:207], v[76:79], v[172:175], v[192:207]
    s_waitcnt vmcnt(11) lgkmcnt(6)
    v_mfma_f32_32x32x16_bf16 v[192:207], v[80:83], v[176:179], v[192:207]
    s_waitcnt vmcnt(10) lgkmcnt(4)
    v_mfma_f32_32x32x16_bf16 v[192:207], v[84:87], v[180:183], v[192:207]
    s_waitcnt vmcnt(9) lgkmcnt(2)
    v_mfma_f32_32x32x16_bf16 v[192:207], v[88:91], v[184:187], v[192:207]
    s_waitcnt vmcnt(8) lgkmcnt(0)
    v_mfma_f32_32x32x16_bf16 v[192:207], v[92:95], v[188:191], v[192:207]
    s_nop 11
    ds_write_b128 v31, v[192:195] offset:0
    ds_write_b128 v31, v[196:199] offset:1024
    ds_write_b128 v31, v[200:203] offset:2048
    ds_write_b128 v31, v[204:207] offset:3072
    s_waitcnt lgkmcnt(0)
L_qb1_nokv_251:
    s_barrier
    ds_read_b64_tr_b16 v[64:65], v12 offset:57344
    ds_read_b64_tr_b16 v[66:67], v12 offset:58368
    ds_read_b64_tr_b16 v[68:69], v13 offset:57344
    ds_read_b64_tr_b16 v[70:71], v13 offset:58368
    ds_read_b64_tr_b16 v[72:73], v12 offset:59392
    ds_read_b64_tr_b16 v[74:75], v12 offset:60416
    ds_read_b64_tr_b16 v[76:77], v13 offset:59392
    ds_read_b64_tr_b16 v[78:79], v13 offset:60416
    s_waitcnt vmcnt(7) lgkmcnt(4)
    v_mfma_f32_32x32x16_bf16 v[32:47], v[64:67], v[96:99], v[32:47]
    ds_read_b64_tr_b16 v[80:81], v12 offset:61440
    ds_read_b64_tr_b16 v[82:83], v12 offset:62464
    v_mfma_f32_32x32x16_bf16 v[48:63], v[68:71], v[96:99], v[48:63]
    ds_read_b64_tr_b16 v[84:85], v13 offset:61440
    ds_read_b64_tr_b16 v[86:87], v13 offset:62464
    s_cmp_gt_u32 s63, 2
    s_cbranch_scc1 L_lp_256_ok
L_lp_256:
    ds_read_b32 v5, v4
    s_waitcnt lgkmcnt(0)
    v_readfirstlane_b32 s63, v5
    s_nop 0
    s_cmp_gt_u32 s63, 2
    s_cbranch_scc0 L_lp_256
L_lp_256_ok:
    buffer_load_dwordx4 v[128:131], v10, s[8:11], s39 offen offset:0 sc1
    buffer_load_dwordx4 v[132:135], v10, s[8:11], s39 offen offset:1024 sc1
    s_waitcnt vmcnt(8) lgkmcnt(4)
    v_mfma_f32_32x32x16_bf16 v[32:47], v[72:75], v[100:103], v[32:47]
    ds_read_b64_tr_b16 v[88:89], v12 offset:63488
    ds_read_b64_tr_b16 v[90:91], v12 offset:64512
    v_mfma_f32_32x32x16_bf16 v[48:63], v[76:79], v[100:103], v[48:63]
    ds_read_b64_tr_b16 v[92:93], v13 offset:63488
    ds_read_b64_tr_b16 v[94:95], v13 offset:64512
    buffer_load_dwordx4 v[136:139], v10, s[8:11], s39 offen offset:2048 sc1
    buffer_load_dwordx4 v[140:143], v10, s[8:11], s39 offen offset:3072 sc1
    s_add_u32 s39, s39, 4096
    s_waitcnt vmcnt(9) lgkmcnt(4)
    v_mfma_f32_32x32x16_bf16 v[32:47], v[80:83], v[104:107], v[32:47]
    ds_read_b64_tr_b16 v[64:65], v14 offset:0
    ds_read_b64_tr_b16 v[66:67], v14 offset:1024
    v_mfma_f32_32x32x16_bf16 v[48:63], v[84:87], v[104:107], v[48:63]
    ds_read_b64_tr_b16 v[68:69], v15 offset:0
    ds_read_b64_tr_b16 v[70:71], v15 offset:1024
    s_cmp_gt_u32 s63, 3
    s_cbranch_scc1 L_lp_257_ok
L_lp_257:
    ds_read_b32 v5, v4
    s_waitcnt lgkmcnt(0)
    v_readfirstlane_b32 s63, v5
    s_nop 0
    s_cmp_gt_u32 s63, 3
    s_cbranch_scc0 L_lp_257
L_lp_257_ok:
    buffer_load_dwordx4 v[144:147], v10, s[8:11], s39 offen offset:0 sc1
    buffer_load_dwordx4 v[148:151], v10, s[8:11], s39 offen offset:1024 sc1
    s_waitcnt vmcnt(10) lgkmcnt(4)
    v_mfma_f32_32x32x16_bf16 v[32:47], v[88:91], v[108:111], v[32:47]
    ds_read_b64_tr_b16 v[72:73], v14 offset:2048
    ds_read_b64_tr_b16 v[74:75], v14 offset:3072
    v_mfma_f32_32x32x16_bf16 v[48:63], v[92:95], v[108:111], v[48:63]
    ds_read_b64_tr_b16 v[76:77], v15 offset:2048
    ds_read_b64_tr_b16 v[78:79], v15 offset:3072
    buffer_load_dwordx4 v[152:155], v10, s[8:11], s39 offen offset:2048 sc1
    buffer_load_dwordx4 v[156:159], v10, s[8:11], s39 offen offset:3072 sc1
    s_add_u32 s39, s39, 4096
    s_waitcnt vmcnt(11) lgkmcnt(4)
    v_mfma_f32_32x32x16_bf16 v[32:47], v[64:67], v[112:115], v[32:47]
    ds_read_b64_tr_b16 v[80:81], v14 offset:4096
    ds_read_b64_tr_b16 v[82:83], v14 offset:5120
    v_mfma_f32_32x32x16_bf16 v[48:63], v[68:71], v[112:115], v[48:63]
    ds_read_b64_tr_b16 v[84:85], v15 offset:4096
    ds_read_b64_tr_b16 v[86:87], v15 offset:5120
    s_cmp_gt_u32 s63, 4
    s_cbranch_scc1 L_lp_258_ok
L_lp_258:
    ds_read_b32 v5, v4
    s_waitcnt lgkmcnt(0)
    v_readfirstlane_b32 s63, v5
    s_nop 0
    s_cmp_gt_u32 s63, 4
    s_cbranch_scc0 L_lp_258
L_lp_258_ok:
    buffer_load_dwordx4 v[160:163], v10, s[8:11], s39 offen offset:0 sc1
    buffer_load_dwordx4 v[164:167], v10, s[8:11], s39 offen offset:1024 sc1
    s_waitcnt vmcnt(12) lgkmcnt(4)
    v_mfma_f32_32x32x16_bf16 v[32:47], v[72:75], v[116:119], v[32:47]
    ds_read_b64_tr_b16 v[88:89], v14 offset:6144
    ds_read_b64_tr_b16 v[90:91], v14 offset:7168
    v_mfma_f32_32x32x16_bf16 v[48:63], v[76:79], v[116:119], v[48:63]
    ds_read_b64_tr_b16 v[92:93], v15 offset:6144
    ds_read_b64_tr_b16 v[94:95], v15 offset:7168
    buffer_load_dwordx4 v[168:171], v10, s[8:11], s39 offen offset:2048 sc1
    buffer_load_dwordx4 v[172:175], v10, s[8:11], s39 offen offset:3072 sc1
    s_add_u32 s39, s39, 4096
    s_waitcnt vmcnt(13) lgkmcnt(4)
    v_mfma_f32_32x32x16_bf16 v[32:47], v[80:83], v[120:123], v[32:47]
    ds_read_b64_tr_b16 v[64:65], v14 offset:8192
    ds_read_b64_tr_b16 v[66:67], v14 offset:9216
    v_mfma_f32_32x32x16_bf16 v[48:63], v[84:87], v[120:123], v[48:63]
    ds_read_b64_tr_b16 v[68:69], v15 offset:8192
    ds_read_b64_tr_b16 v[70:71], v15 offset:9216
    s_cmp_gt_u32 s63, 5
    s_cbranch_scc1 L_lp_259_ok
L_lp_259:
    ds_read_b32 v5, v4
    s_waitcnt lgkmcnt(0)
    v_readfirstlane_b32 s63, v5
    s_nop 0
    s_cmp_gt_u32 s63, 5
    s_cbranch_scc0 L_lp_259
L_lp_259_ok:
    buffer_load_dwordx4 v[176:179], v10, s[8:11], s39 offen offset:0 sc1
    buffer_load_dwordx4 v[180:183], v10, s[8:11], s39 offen offset:1024 sc1
    s_waitcnt vmcnt(14) lgkmcnt(4)
    v_mfma_f32_32x32x16_bf16 v[32:47], v[88:91], v[124:127], v[32:47]
    ds_read_b64_tr_b16 v[72:73], v14 offset:10240
    ds_read_b64_tr_b16 v[74:75], v14 offset:11264
    v_mfma_f32_32x32x16_bf16 v[48:63], v[92:95], v[124:127], v[48:63]
    ds_read_b64_tr_b16 v[76:77], v15 offset:10240
    ds_read_b64_tr_b16 v[78:79], v15 offset:11264
    buffer_load_dwordx4 v[184:187], v10, s[8:11], s39 offen offset:2048 sc1
    buffer_load_dwordx4 v[188:191], v10, s[8:11], s39 offen offset:3072 sc1
    s_add_u32 s39, s39, 4096
    s_waitcnt vmcnt(15) lgkmcnt(4)
    v_mfma_f32_32x32x16_bf16 v[32:47], v[64:67], v[128:131], v[32:47]
    ds_read_b64_tr_b16 v[80:81], v14 offset:12288
    ds_read_b64_tr_b16 v[82:83], v14 offset:13312
    v_mfma_f32_32x32x16_bf16 v[48:63], v[68:71], v[128:131], v[48:63]
    ds_read_b64_tr_b16 v[84:85], v15 offset:12288
    ds_read_b64_tr_b16 v[86:87], v15 offset:13312
    s_cmp_gt_u32 s63, 6
    s_cbranch_scc1 L_lp_260_ok
L_lp_260:
    ds_read_b32 v5, v4
    s_waitcnt lgkmcnt(0)
    v_readfirstlane_b32 s63, v5
    s_nop 0
    s_cmp_gt_u32 s63, 6
    s_cbranch_scc0 L_lp_260
L_lp_260_ok:
    buffer_load_dwordx4 v[192:195], v10, s[8:11], s39 offen offset:0 sc1
    buffer_load_dwordx4 v[196:199], v10, s[8:11], s39 offen offset:1024 sc1
    s_waitcnt vmcnt(16) lgkmcnt(4)
    v_mfma_f32_32x32x16_bf16 v[32:47], v[72:75], v[132:135], v[32:47]
    ds_read_b64_tr_b16 v[88:89], v14 offset:14336
    ds_read_b64_tr_b16 v[90:91], v14 offset:15360
    v_mfma_f32_32x32x16_bf16 v[48:63], v[76:79], v[132:135], v[48:63]
    ds_read_b64_tr_b16 v[92:93], v15 offset:14336
    ds_read_b64_tr_b16 v[94:95], v15 offset:15360
    buffer_load_dwordx4 v[200:203], v10, s[8:11], s39 offen offset:2048 sc1
    buffer_load_dwordx4 v[204:207], v10, s[8:11], s39 offen offset:3072 sc1
    s_add_u32 s39, s39, 4096
    s_waitcnt vmcnt(17) lgkmcnt(4)
    v_mfma_f32_32x32x16_bf16 v[32:47], v[80:83], v[136:139], v[32:47]
    ds_read_b64_tr_b16 v[64:65], v12 offset:0
    ds_read_b64_tr_b16 v[66:67], v12 offset:1024
    v_mfma_f32_32x32x16_bf16 v[48:63], v[84:87], v[136:139], v[48:63]
    ds_read_b64_tr_b16 v[68:69], v13 offset:0
    ds_read_b64_tr_b16 v[70:71], v13 offset:1024
    s_cmp_gt_u32 s63, 7
    s_cbranch_scc1 L_lp_261_ok
L_lp_261:
    ds_read_b32 v5, v4
    s_waitcnt lgkmcnt(0)
    v_readfirstlane_b32 s63, v5
    s_nop 0
    s_cmp_gt_u32 s63, 7
    s_cbranch_scc0 L_lp_261
L_lp_261_ok:
    buffer_load_dwordx4 v[96:99], v10, s[8:11], s39 offen offset:0 sc1
    buffer_load_dwordx4 v[100:103], v10, s[8:11], s39 offen offset:1024 sc1
    s_waitcnt vmcnt(18) lgkmcnt(4)
    v_mfma_f32_32x32x16_bf16 v[32:47], v[88:91], v[140:143], v[32:47]
    ds_read_b64_tr_b16 v[72:73], v12 offset:2048
    ds_read_b64_tr_b16 v[74:75], v12 offset:3072
    v_mfma_f32_32x32x16_bf16 v[48:63], v[92:95], v[140:143], v[48:63]
    ds_read_b64_tr_b16 v[76:77], v13 offset:2048
    ds_read_b64_tr_b16 v[78:79], v13 offset:3072
    buffer_load_dwordx4 v[104:107], v10, s[8:11], s39 offen offset:2048 sc1
    buffer_load_dwordx4 v[108:111], v10, s[8:11], s39 offen offset:3072 sc1
    s_add_u32 s39, s39, 4096
    s_waitcnt vmcnt(19) lgkmcnt(4)
    v_mfma_f32_32x32x16_bf16 v[32:47], v[64:67], v[144:147], v[32:47]
    ds_read_b64_tr_b16 v[80:81], v12 offset:4096
    ds_read_b64_tr_b16 v[82:83], v12 offset:5120
    v_mfma_f32_32x32x16_bf16 v[48:63], v[68:71], v[144:147], v[48:63]
    ds_read_b64_tr_b16 v[84:85], v13 offset:4096
    ds_read_b64_tr_b16 v[86:87], v13 offset:5120
    s_cmp_gt_u32 s63, 8
    s_cbranch_scc1 L_lp_262_ok
L_lp_262:
    ds_read_b32 v5, v4
    s_waitcnt lgkmcnt(0)
    v_readfirstlane_b32 s63, v5
    s_nop 0
    s_cmp_gt_u32 s63, 8
    s_cbranch_scc0 L_lp_262
L_lp_262_ok:
    buffer_load_dwordx4 v[112:115], v10, s[8:11], s39 offen offset:0 sc1
    s_waitcnt vmcnt(19) lgkmcnt(4)
    v_mfma_f32_32x32x16_bf16 v[32:47], v[72:75], v[148:151], v[32:47]
    ds_read_b64_tr_b16 v[88:89], v12 offset:6144
    ds_read_b64_tr_b16 v[90:91], v12 offset:7168
    v_mfma_f32_32x32x16_bf16 v[48:63], v[76:79], v[148:151], v[48:63]
    ds_read_b64_tr_b16 v[92:93], v13 offset:6144
    ds_read_b64_tr_b16 v[94:95], v13 offset:7168
    buffer_load_dwordx4 v[116:119], v10, s[8:11], s39 offen offset:1024 sc1
    s_waitcnt vmcnt(19) lgkmcnt(4)
    v_mfma_f32_32x32x16_bf16 v[32:47], v[80:83], v[152:155], v[32:47]
    ds_read_b64_tr_b16 v[64:65], v12 offset:8192
    ds_read_b64_tr_b16 v[66:67], v12 offset:9216
    v_mfma_f32_32x32x16_bf16 v[48:63], v[84:87], v[152:155], v[48:63]
    ds_read_b64_tr_b16 v[68:69], v13 offset:8192
    ds_read_b64_tr_b16 v[70:71], v13 offset:9216
    buffer_load_dwordx4 v[120:123], v10, s[8:11], s39 offen offset:2048 sc1
    s_waitcnt vmcnt(19) lgkmcnt(4)
    v_mfma_f32_32x32x16_bf16 v[32:47], v[88:91], v[156:159], v[32:47]
    ds_read_b64_tr_b16 v[72:73], v12 offset:10240
    ds_read_b64_tr_b16 v[74:75], v12 offset:11264
    v_mfma_f32_32x32x16_bf16 v[48:63], v[92:95], v[156:159], v[48:63]
    ds_read_b64_tr_b16 v[76:77], v13 offset:10240
    ds_read_b64_tr_b16 v[78:79], v13 offset:11264
    buffer_load_dwordx4 v[124:127], v10, s[8:11], s39 offen offset:3072 sc1
    s_add_u32 s39, s39, 4096
    s_waitcnt vmcnt(19) lgkmcnt(4)
    v_mfma_f32_32x32x16_bf16 v[32:47], v[64:67], v[160:163], v[32:47]
    ds_read_b64_tr_b16 v[80:81], v12 offset:12288
    ds_read_b64_tr_b16 v[82:83], v12 offset:13312
    v_mfma_f32_32x32x16_bf16 v[48:63], v[68:71], v[160:163], v[48:63]
    ds_read_b64_tr_b16 v[84:85], v13 offset:12288
    ds_read_b64_tr_b16 v[86:87], v13 offset:13312
    s_cmp_gt_u32 s63, 9
    s_cbranch_scc1 L_lp_263_ok
L_lp_263:
    ds_read_b32 v5, v4
    s_waitcnt lgkmcnt(0)
    v_readfirstlane_b32 s63, v5
    s_nop 0
    s_cmp_gt_u32 s63, 9
    s_cbranch_scc0 L_lp_263
L_lp_263_ok:
    buffer_load_dwordx4 v[128:131], v10, s[8:11], s39 offen offset:0 sc1
    s_waitcnt vmcnt(19) lgkmcnt(4)
    v_mfma_f32_32x32x16_bf16 v[32:47], v[72:75], v[164:167], v[32:47]
    ds_read_b64_tr_b16 v[88:89], v12 offset:14336
    ds_read_b64_tr_b16 v[90:91], v12 offset:15360
    v_mfma_f32_32x32x16_bf16 v[48:63], v[76:79], v[164:167], v[48:63]
    ds_read_b64_tr_b16 v[92:93], v13 offset:14336
    ds_read_b64_tr_b16 v[94:95], v13 offset:15360
    buffer_load_dwordx4 v[132:135], v10, s[8:11], s39 offen offset:1024 sc1
    s_waitcnt vmcnt(19) lgkmcnt(4)
    v_mfma_f32_32x32x16_bf16 v[32:47], v[80:83], v[168:171], v[32:47]
    ds_read_b64_tr_b16 v[64:65], v12 offset:16384
    ds_read_b64_tr_b16 v[66:67], v12 offset:17408
    v_mfma_f32_32x32x16_bf16 v[48:63], v[84:87], v[168:171], v[48:63]
    ds_read_b64_tr_b16 v[68:69], v13 offset:16384
    ds_read_b64_tr_b16 v[70:71], v13 offset:17408
    buffer_load_dwordx4 v[136:139], v10, s[8:11], s39 offen offset:2048 sc1
    s_waitcnt vmcnt(19) lgkmcnt(4)
    v_mfma_f32_32x32x16_bf16 v[32:47], v[88:91], v[172:175], v[32:47]
    ds_read_b64_tr_b16 v[72:73], v12 offset:18432
    ds_read_b64_tr_b16 v[74:75], v12 offset:19456
    v_mfma_f32_32x32x16_bf16 v[48:63], v[92:95], v[172:175], v[48:63]
    ds_read_b64_tr_b16 v[76:77], v13 offset:18432
    ds_read_b64_tr_b16 v[78:79], v13 offset:19456
    buffer_load_dwordx4 v[140:143], v10, s[8:11], s39 offen offset:3072 sc1
    s_add_u32 s39, s39, 4096
    s_waitcnt vmcnt(19) lgkmcnt(4)
    v_mfma_f32_32x32x16_bf16 v[32:47], v[64:67], v[176:179], v[32:47]
    ds_read_b64_tr_b16 v[80:81], v12 offset:20480
    ds_read_b64_tr_b16 v[82:83], v12 offset:21504
    v_mfma_f32_32x32x16_bf16 v[48:63], v[68:71], v[176:179], v[48:63]
    ds_read_b64_tr_b16 v[84:85], v13 offset:20480
    ds_read_b64_tr_b16 v[86:87], v13 offset:21504
    s_cmp_gt_u32 s63, 10
    s_cbranch_scc1 L_lp_264_ok
L_lp_264:
    ds_read_b32 v5, v4
    s_waitcnt lgkmcnt(0)
    v_readfirstlane_b32 s63, v5
    s_nop 0
    s_cmp_gt_u32 s63, 10
    s_cbranch_scc0 L_lp_264
L_lp_264_ok:
    buffer_load_dwordx4 v[144:147], v10, s[8:11], s39 offen offset:0 sc1
    s_waitcnt vmcnt(19) lgkmcnt(4)
    v_mfma_f32_32x32x16_bf16 v[32:47], v[72:75], v[180:183], v[32:47]
    ds_read_b64_tr_b16 v[88:89], v12 offset:22528
    ds_read_b64_tr_b16 v[90:91], v12 offset:23552
    v_mfma_f32_32x32x16_bf16 v[48:63], v[76:79], v[180:183], v[48:63]
    ds_read_b64_tr_b16 v[92:93], v13 offset:22528
    ds_read_b64_tr_b16 v[94:95], v13 offset:23552
    buffer_load_dwordx4 v[148:151], v10, s[8:11], s39 offen offset:1024 sc1
    s_waitcnt vmcnt(19) lgkmcnt(4)
    v_mfma_f32_32x32x16_bf16 v[32:47], v[80:83], v[184:187], v[32:47]
    ds_read_b64_tr_b16 v[64:65], v12 offset:24576
    ds_read_b64_tr_b16 v[66:67], v12 offset:25600
    v_mfma_f32_32x32x16_bf16 v[48:63], v[84:87], v[184:187], v[48:63]
    ds_read_b64_tr_b16 v[68:69], v13 offset:24576
    ds_read_b64_tr_b16 v[70:71], v13 offset:25600
    buffer_load_dwordx4 v[152:155], v10, s[8:11], s39 offen offset:2048 sc1
    s_waitcnt vmcnt(19) lgkmcnt(4)
    v_mfma_f32_32x32x16_bf16 v[32:47], v[88:91], v[188:191], v[32:47]
    ds_read_b64_tr_b16 v[72:73], v12 offset:26624
    ds_read_b64_tr_b16 v[74:75], v12 offset:27648
    v_mfma_f32_32x32x16_bf16 v[48:63], v[92:95], v[188:191], v[48:63]
    ds_read_b64_tr_b16 v[76:77], v13 offset:26624
    ds_read_b64_tr_b16 v[78:79], v13 offset:27648
    buffer_load_dwordx4 v[156:159], v10, s[8:11], s39 offen offset:3072 sc1
    s_add_u32 s39, s39, 4096
    s_waitcnt vmcnt(19) lgkmcnt(4)
    v_mfma_f32_32x32x16_bf16 v[32:47], v[64:67], v[192:195], v[32:47]
    ds_read_b64_tr_b16 v[80:81], v12 offset:28672
    ds_read_b64_tr_b16 v[82:83], v12 offset:29696
    v_mfma_f32_32x32x16_bf16 v[48:63], v[68:71], v[192:195], v[48:63]
    ds_read_b64_tr_b16 v[84:85], v13 offset:28672
    ds_read_b64_tr_b16 v[86:87], v13 offset:29696
    s_cmp_gt_u32 s63, 11
    s_cbranch_scc1 L_lp_265_ok
L_lp_265:
    ds_read_b32 v5, v4
    s_waitcnt lgkmcnt(0)
    v_readfirstlane_b32 s63, v5
    s_nop 0
    s_cmp_gt_u32 s63, 11
    s_cbranch_scc0 L_lp_265
L_lp_265_ok:
    buffer_load_dwordx4 v[160:163], v10, s[8:11], s39 offen offset:0 sc1
    s_waitcnt vmcnt(19) lgkmcnt(4)
    v_mfma_f32_32x32x16_bf16 v[32:47], v[72:75], v[196:199], v[32:47]
    ds_read_b64_tr_b16 v[88:89], v12 offset:30720
    ds_read_b64_tr_b16 v[90:91], v12 offset:31744
    v_mfma_f32_32x32x16_bf16 v[48:63], v[76:79], v[196:199], v[48:63]
    ds_read_b64_tr_b16 v[92:93], v13 offset:30720
    ds_read_b64_tr_b16 v[94:95], v13 offset:31744
    buffer_load_dwordx4 v[164:167], v10, s[8:11], s39 offen offset:1024 sc1
    s_waitcnt vmcnt(19) lgkmcnt(4)
    v_mfma_f32_32x32x16_bf16 v[32:47], v[80:83], v[200:203], v[32:47]
    ds_read_b64_tr_b16 v[64:65], v12 offset:32768
    ds_read_b64_tr_b16 v[66:67], v12 offset:33792
    v_mfma_f32_32x32x16_bf16 v[48:63], v[84:87], v[200:203], v[48:63]
    ds_read_b64_tr_b16 v[68:69], v13 offset:32768
    ds_read_b64_tr_b16 v[70:71], v13 offset:33792
    buffer_load_dwordx4 v[168:171], v10, s[8:11], s39 offen offset:2048 sc1
    s_waitcnt vmcnt(19) lgkmcnt(4)
    v_mfma_f32_32x32x16_bf16 v[32:47], v[88:91], v[204:207], v[32:47]
    ds_read_b64_tr_b16 v[72:73], v12 offset:34816
    ds_read_b64_tr_b16 v[74:75], v12 offset:35840
    v_mfma_f32_32x32x16_bf16 v[48:63], v[92:95], v[204:207], v[48:63]
    ds_read_b64_tr_b16 v[76:77], v13 offset:34816
    ds_read_b64_tr_b16 v[78:79], v13 offset:35840
    buffer_load_dwordx4 v[172:175], v10, s[8:11], s39 offen offset:3072 sc1
    s_add_u32 s39, s39, 4096
    s_waitcnt vmcnt(19) lgkmcnt(4)
    v_mfma_f32_32x32x16_bf16 v[32:47], v[64:67], v[96:99], v[32:47]
    ds_read_b64_tr_b16 v[80:81], v12 offset:36864
    ds_read_b64_tr_b16 v[82:83], v12 offset:37888
    v_mfma_f32_32x32x16_bf16 v[48:63], v[68:71], v[96:99], v[48:63]
    ds_read_b64_tr_b16 v[84:85], v13 offset:36864
    ds_read_b64_tr_b16 v[86:87], v13 offset:37888
    s_cmp_gt_u32 s63, 12
    s_cbranch_scc1 L_lp_266_ok
L_lp_266:
    ds_read_b32 v5, v4
    s_waitcnt lgkmcnt(0)
    v_readfirstlane_b32 s63, v5
    s_nop 0
    s_cmp_gt_u32 s63, 12
    s_cbranch_scc0 L_lp_266
L_lp_266_ok:
    buffer_load_dwordx4 v[176:179], v10, s[8:11], s39 offen offset:0 sc1
    s_waitcnt vmcnt(19) lgkmcnt(4)
    v_mfma_f32_32x32x16_bf16 v[32:47], v[72:75], v[100:103], v[32:47]
    ds_read_b64_tr_b16 v[88:89], v12 offset:38912
    ds_read_b64_tr_b16 v[90:91], v12 offset:39936
    v_mfma_f32_32x32x16_bf16 v[48:63], v[76:79], v[100:103], v[48:63]
    ds_read_b64_tr_b16 v[92:93], v13 offset:38912
    ds_read_b64_tr_b16 v[94:95], v13 offset:39936
    buffer_load_dwordx4 v[180:183], v10, s[8:11], s39 offen offset:1024 sc1
    s_waitcnt vmcnt(19) lgkmcnt(4)
    v_mfma_f32_32x32x16_bf16 v[32:47], v[80:83], v[104:107], v[32:47]
    ds_read_b64_tr_b16 v[64:65], v12 offset:40960
    ds_read_b64_tr_b16 v[66:67], v12 offset:41984
    v_mfma_f32_32x32x16_bf16 v[48:63], v[84:87], v[104:107], v[48:63]
    ds_read_b64_tr_b16 v[68:69], v13 offset:40960
    ds_read_b64_tr_b16 v[70:71], v13 offset:41984
    buffer_load_dwordx4 v[184:187], v10, s[8:11], s39 offen offset:2048 sc1
    s_waitcnt vmcnt(19) lgkmcnt(4)
    v_mfma_f32_32x32x16_bf16 v[32:47], v[88:91], v[108:111], v[32:47]
    ds_read_b64_tr_b16 v[72:73], v12 offset:43008
    ds_read_b64_tr_b16 v[74:75], v12 offset:44032
    v_mfma_f32_32x32x16_bf16 v[48:63], v[92:95], v[108:111], v[48:63]
    ds_read_b64_tr_b16 v[76:77], v13 offset:43008
    ds_read_b64_tr_b16 v[78:79], v13 offset:44032
    buffer_load_dwordx4 v[188:191], v10, s[8:11], s39 offen offset:3072 sc1
    s_add_u32 s39, s39, 4096
    s_waitcnt vmcnt(19) lgkmcnt(4)
    v_mfma_f32_32x32x16_bf16 v[32:47], v[64:67], v[112:115], v[32:47]
    ds_read_b64_tr_b16 v[80:81], v12 offset:45056
    ds_read_b64_tr_b16 v[82:83], v12 offset:46080
    v_mfma_f32_32x32x16_bf16 v[48:63], v[68:71], v[112:115], v[48:63]
    ds_read_b64_tr_b16 v[84:85], v13 offset:45056
    ds_read_b64_tr_b16 v[86:87], v13 offset:46080
    s_cmp_gt_u32 s63, 13
    s_cbranch_scc1 L_lp_267_ok
L_lp_267:
    ds_read_b32 v5, v4
    s_waitcnt lgkmcnt(0)
    v_readfirstlane_b32 s63, v5
    s_nop 0
    s_cmp_gt_u32 s63, 13
    s_cbranch_scc0 L_lp_267
L_lp_267_ok:
    buffer_load_dwordx4 v[192:195], v10, s[8:11], s39 offen offset:0 sc1
    s_waitcnt vmcnt(19) lgkmcnt(4)
    v_mfma_f32_32x32x16_bf16 v[32:47], v[72:75], v[116:119], v[32:47]
    ds_read_b64_tr_b16 v[88:89], v12 offset:47104
    ds_read_b64_tr_b16 v[90:91], v12 offset:48128
    v_mfma_f32_32x32x16_bf16 v[48:63], v[76:79], v[116:119], v[48:63]
    ds_read_b64_tr_b16 v[92:93], v13 offset:47104
    ds_read_b64_tr_b16 v[94:95], v13 offset:48128
    buffer_load_dwordx4 v[196:199], v10, s[8:11], s39 offen offset:1024 sc1
    s_waitcnt vmcnt(19) lgkmcnt(4)
    v_mfma_f32_32x32x16_bf16 v[32:47], v[80:83], v[120:123], v[32:47]
    ds_read_b64_tr_b16 v[64:65], v12 offset:49152
    ds_read_b64_tr_b16 v[66:67], v12 offset:50176
    v_mfma_f32_32x32x16_bf16 v[48:63], v[84:87], v[120:123], v[48:63]
    ds_read_b64_tr_b16 v[68:69], v13 offset:49152
    ds_read_b64_tr_b16 v[70:71], v13 offset:50176
    buffer_load_dwordx4 v[200:203], v10, s[8:11], s39 offen offset:2048 sc1
    s_waitcnt vmcnt(19) lgkmcnt(4)
    v_mfma_f32_32x32x16_bf16 v[32:47], v[88:91], v[124:127], v[32:47]
    ds_read_b64_tr_b16 v[72:73], v12 offset:51200
    ds_read_b64_tr_b16 v[74:75], v12 offset:52224
    v_mfma_f32_32x32x16_bf16 v[48:63], v[92:95], v[124:127], v[48:63]
    ds_read_b64_tr_b16 v[76:77], v13 offset:51200
    ds_read_b64_tr_b16 v[78:79], v13 offset:52224
    buffer_load_dwordx4 v[204:207], v10, s[8:11], s39 offen offset:3072 sc1
    s_add_u32 s39, s39, 4096
    s_waitcnt vmcnt(19) lgkmcnt(4)
    v_mfma_f32_32x32x16_bf16 v[32:47], v[64:67], v[128:131], v[32:47]
    ds_read_b64_tr_b16 v[80:81], v12 offset:53248
    ds_read_b64_tr_b16 v[82:83], v12 offset:54272
    v_mfma_f32_32x32x16_bf16 v[48:63], v[68:71], v[128:131], v[48:63]
    ds_read_b64_tr_b16 v[84:85], v13 offset:53248
    ds_read_b64_tr_b16 v[86:87], v13 offset:54272
    s_cmp_gt_u32 s63, 14
    s_cbranch_scc1 L_lp_268_ok
L_lp_268:
    ds_read_b32 v5, v4
    s_waitcnt lgkmcnt(0)
    v_readfirstlane_b32 s63, v5
    s_nop 0
    s_cmp_gt_u32 s63, 14
    s_cbranch_scc0 L_lp_268
L_lp_268_ok:
    buffer_load_dwordx4 v[96:99], v10, s[8:11], s39 offen offset:0 sc1
    s_waitcnt vmcnt(19) lgkmcnt(4)
    v_mfma_f32_32x32x16_bf16 v[32:47], v[72:75], v[132:135], v[32:47]
    ds_read_b64_tr_b16 v[88:89], v12 offset:55296
    ds_read_b64_tr_b16 v[90:91], v12 offset:56320
    v_mfma_f32_32x32x16_bf16 v[48:63], v[76:79], v[132:135], v[48:63]
    ds_read_b64_tr_b16 v[92:93], v13 offset:55296
    ds_read_b64_tr_b16 v[94:95], v13 offset:56320
    buffer_load_dwordx4 v[100:103], v10, s[8:11], s39 offen offset:1024 sc1
    s_waitcnt vmcnt(19) lgkmcnt(4)
    v_mfma_f32_32x32x16_bf16 v[32:47], v[80:83], v[136:139], v[32:47]
    ds_read_b64_tr_b16 v[64:65], v16 offset:16384
    ds_read_b64_tr_b16 v[66:67], v16 offset:17408
    v_mfma_f32_32x32x16_bf16 v[48:63], v[84:87], v[136:139], v[48:63]
    ds_read_b64_tr_b16 v[68:69], v17 offset:16384
    ds_read_b64_tr_b16 v[70:71], v17 offset:17408
    buffer_load_dwordx4 v[104:107], v10, s[8:11], s39 offen offset:2048 sc1
    s_waitcnt vmcnt(19) lgkmcnt(4)
    v_mfma_f32_32x32x16_bf16 v[32:47], v[88:91], v[140:143], v[32:47]
    ds_read_b64_tr_b16 v[72:73], v16 offset:18432
    ds_read_b64_tr_b16 v[74:75], v16 offset:19456
    v_mfma_f32_32x32x16_bf16 v[48:63], v[92:95], v[140:143], v[48:63]
    ds_read_b64_tr_b16 v[76:77], v17 offset:18432
    ds_read_b64_tr_b16 v[78:79], v17 offset:19456
    buffer_load_dwordx4 v[108:111], v10, s[8:11], s39 offen offset:3072 sc1
    s_add_u32 s39, s39, 4096
    s_waitcnt vmcnt(19) lgkmcnt(4)
    v_mfma_f32_32x32x16_bf16 v[32:47], v[64:67], v[144:147], v[32:47]
    ds_read_b64_tr_b16 v[80:81], v16 offset:20480
    ds_read_b64_tr_b16 v[82:83], v16 offset:21504
    v_mfma_f32_32x32x16_bf16 v[48:63], v[68:71], v[144:147], v[48:63]
    ds_read_b64_tr_b16 v[84:85], v17 offset:20480
    ds_read_b64_tr_b16 v[86:87], v17 offset:21504
    s_cmp_gt_u32 s63, 15
    s_cbranch_scc1 L_lp_269_ok
L_lp_269:
    ds_read_b32 v5, v4
    s_waitcnt lgkmcnt(0)
    v_readfirstlane_b32 s63, v5
    s_nop 0
    s_cmp_gt_u32 s63, 15
    s_cbranch_scc0 L_lp_269
L_lp_269_ok:
    buffer_load_dwordx4 v[112:115], v10, s[8:11], s39 offen offset:0 sc1
    s_waitcnt vmcnt(19) lgkmcnt(4)
    v_mfma_f32_32x32x16_bf16 v[32:47], v[72:75], v[148:151], v[32:47]
    ds_read_b64_tr_b16 v[88:89], v16 offset:22528
    ds_read_b64_tr_b16 v[90:91], v16 offset:23552
    v_mfma_f32_32x32x16_bf16 v[48:63], v[76:79], v[148:151], v[48:63]
    ds_read_b64_tr_b16 v[92:93], v17 offset:22528
    ds_read_b64_tr_b16 v[94:95], v17 offset:23552
    buffer_load_dwordx4 v[116:119], v10, s[8:11], s39 offen offset:1024 sc1
    s_waitcnt vmcnt(19) lgkmcnt(4)
    v_mfma_f32_32x32x16_bf16 v[32:47], v[80:83], v[152:155], v[32:47]
    s_barrier
    ds_read_b64_tr_b16 v[64:65], v14 offset:24576
    ds_read_b64_tr_b16 v[66:67], v14 offset:25600
    v_mfma_f32_32x32x16_bf16 v[48:63], v[84:87], v[152:155], v[48:63]
    ds_read_b64_tr_b16 v[68:69], v15 offset:24576
    ds_read_b64_tr_b16 v[70:71], v15 offset:25600
    buffer_load_dwordx4 v[120:123], v10, s[8:11], s39 offen offset:2048 sc1
    s_waitcnt vmcnt(19) lgkmcnt(4)
    v_mfma_f32_32x32x16_bf16 v[32:47], v[88:91], v[156:159], v[32:47]
    ds_read_b64_tr_b16 v[72:73], v14 offset:26624
    ds_read_b64_tr_b16 v[74:75], v14 offset:27648
    v_mfma_f32_32x32x16_bf16 v[48:63], v[92:95], v[156:159], v[48:63]
    ds_read_b64_tr_b16 v[76:77], v15 offset:26624
    ds_read_b64_tr_b16 v[78:79], v15 offset:27648
    buffer_load_dwordx4 v[124:127], v10, s[8:11], s39 offen offset:3072 sc1
    s_waitcnt vmcnt(19) lgkmcnt(4)
    v_mfma_f32_32x32x16_bf16 v[32:47], v[64:67], v[160:163], v[32:47]
    ds_read_b64_tr_b16 v[80:81], v14 offset:28672
    ds_read_b64_tr_b16 v[82:83], v14 offset:29696
    v_mfma_f32_32x32x16_bf16 v[48:63], v[68:71], v[160:163], v[48:63]
    ds_read_b64_tr_b16 v[84:85], v15 offset:28672
    ds_read_b64_tr_b16 v[86:87], v15 offset:29696
    s_waitcnt vmcnt(18) lgkmcnt(4)
    v_mfma_f32_32x32x16_bf16 v[32:47], v[72:75], v[164:167], v[32:47]
    ds_read_b64_tr_b16 v[88:89], v14 offset:30720
    ds_read_b64_tr_b16 v[90:91], v14 offset:31744
    v_mfma_f32_32x32x16_bf16 v[48:63], v[76:79], v[164:167], v[48:63]
    ds_read_b64_tr_b16 v[92:93], v15 offset:30720
    ds_read_b64_tr_b16 v[94:95], v15 offset:31744
    v_lshlrev_b32 v9, 2, v1
    s_lshl_b32 s54, s4, 14
    s_lshl_b32 s55, s3, 8
    s_add_u32 s54, s54, s55
    s_add_u32 s54, s54, 0x26c0000
    buffer_load_dword v224, v9, s[16:19], s54 offen offset:0 sc1
    buffer_load_dword v225, v9, s[16:19], s54 offen offset:1024 sc1
    buffer_load_dword v226, v9, s[16:19], s54 offen offset:2048 sc1
    buffer_load_dword v227, v9, s[16:19], s54 offen offset:3072 sc1
    s_add_u32 s54, s54, 4096
    buffer_load_dword v228, v9, s[16:19], s54 offen offset:0 sc1
    buffer_load_dword v229, v9, s[16:19], s54 offen offset:1024 sc1
    buffer_load_dword v230, v9, s[16:19], s54 offen offset:2048 sc1
    buffer_load_dword v231, v9, s[16:19], s54 offen offset:3072 sc1
    s_add_u32 s54, s54, 4096
    buffer_load_dword v232, v9, s[16:19], s54 offen offset:0 sc1
    buffer_load_dword v233, v9, s[16:19], s54 offen offset:1024 sc1
    buffer_load_dword v234, v9, s[16:19], s54 offen offset:2048 sc1
    buffer_load_dword v235, v9, s[16:19], s54 offen offset:3072 sc1
    s_add_u32 s54, s54, 4096
    buffer_load_dword v236, v9, s[16:19], s54 offen offset:0 sc1
    buffer_load_dword v237, v9, s[16:19], s54 offen offset:1024 sc1
    buffer_load_dword v238, v9, s[16:19], s54 offen offset:2048 sc1
    buffer_load_dword v239, v9, s[16:19], s54 offen offset:3072 sc1
    s_waitcnt vmcnt(33) lgkmcnt(4)
    v_mfma_f32_32x32x16_bf16 v[32:47], v[80:83], v[168:171], v[32:47]
    ds_read_b64_tr_b16 v[64:65], v14 offset:40960
    ds_read_b64_tr_b16 v[66:67], v14 offset:41984
    v_mfma_f32_32x32x16_bf16 v[48:63], v[84:87], v[168:171], v[48:63]
    ds_read_b64_tr_b16 v[68:69], v15 offset:40960
    ds_read_b64_tr_b16 v[70:71], v15 offset:41984
    s_waitcnt vmcnt(32) lgkmcnt(4)
    v_mfma_f32_32x32x16_bf16 v[32:47], v[88:91], v[172:175], v[32:47]
    ds_read_b64_tr_b16 v[72:73], v14 offset:43008
    ds_read_b64_tr_b16 v[74:75], v14 offset:44032
    v_mfma_f32_32x32x16_bf16 v[48:63], v[92:95], v[172:175], v[48:63]
    ds_read_b64_tr_b16 v[76:77], v15 offset:43008
    ds_read_b64_tr_b16 v[78:79], v15 offset:44032
    s_waitcnt vmcnt(31) lgkmcnt(4)
    v_mfma_f32_32x32x16_bf16 v[32:47], v[64:67], v[176:179], v[32:47]
    ds_read_b64_tr_b16 v[80:81], v14 offset:45056
    ds_read_b64_tr_b16 v[82:83], v14 offset:46080
    v_mfma_f32_32x32x16_bf16 v[48:63], v[68:71], v[176:179], v[48:63]
    ds_read_b64_tr_b16 v[84:85], v15 offset:45056
    ds_read_b64_tr_b16 v[86:87], v15 offset:46080
    s_waitcnt vmcnt(30) lgkmcnt(4)
    v_mfma_f32_32x32x16_bf16 v[32:47], v[72:75], v[180:183], v[32:47]
    ds_read_b64_tr_b16 v[88:89], v14 offset:47104
    ds_read_b64_tr_b16 v[90:91], v14 offset:48128
    v_mfma_f32_32x32x16_bf16 v[48:63], v[76:79], v[180:183], v[48:63]
    ds_read_b64_tr_b16 v[92:93], v15 offset:47104
    ds_read_b64_tr_b16 v[94:95], v15 offset:48128
    s_waitcnt vmcnt(29) lgkmcnt(4)
    v_mfma_f32_32x32x16_bf16 v[32:47], v[80:83], v[184:187], v[32:47]
    ds_read_b64_tr_b16 v[64:65], v14 offset:57344
    ds_read_b64_tr_b16 v[66:67], v14 offset:58368
    v_mfma_f32_32x32x16_bf16 v[48:63], v[84:87], v[184:187], v[48:63]
    ds_read_b64_tr_b16 v[68:69], v15 offset:57344
    ds_read_b64_tr_b16 v[70:71], v15 offset:58368
    s_waitcnt vmcnt(28) lgkmcnt(4)
    v_mfma_f32_32x32x16_bf16 v[32:47], v[88:91], v[188:191], v[32:47]
    ds_read_b64_tr_b16 v[72:73], v14 offset:59392
    ds_read_b64_tr_b16 v[74:75], v14 offset:60416
    v_mfma_f32_32x32x16_bf16 v[48:63], v[92:95], v[188:191], v[48:63]
    ds_read_b64_tr_b16 v[76:77], v15 offset:59392
    ds_read_b64_tr_b16 v[78:79], v15 offset:60416
    s_waitcnt vmcnt(27) lgkmcnt(4)
    v_mfma_f32_32x32x16_bf16 v[32:47], v[64:67], v[192:195], v[32:47]
    ds_read_b64_tr_b16 v[80:81], v14 offset:61440
    ds_read_b64_tr_b16 v[82:83], v14 offset:62464
    v_mfma_f32_32x32x16_bf16 v[48:63], v[68:71], v[192:195], v[48:63]
    ds_read_b64_tr_b16 v[84:85], v15 offset:61440
    ds_read_b64_tr_b16 v[86:87], v15 offset:62464
    s_waitcnt vmcnt(26) lgkmcnt(4)
    v_mfma_f32_32x32x16_bf16 v[32:47], v[72:75], v[196:199], v[32:47]
    ds_read_b64_tr_b16 v[88:89], v14 offset:63488
    ds_read_b64_tr_b16 v[90:91], v14 offset:64512
    v_mfma_f32_32x32x16_bf16 v[48:63], v[76:79], v[196:199], v[48:63]
    ds_read_b64_tr_b16 v[92:93], v15 offset:63488
    ds_read_b64_tr_b16 v[94:95], v15 offset:64512
    s_waitcnt vmcnt(25) lgkmcnt(4)
    v_mfma_f32_32x32x16_bf16 v[32:47], v[80:83], v[200:203], v[32:47]
    ds_read_b64_tr_b16 v[64:65], v16 offset:8192
    ds_read_b64_tr_b16 v[66:67], v16 offset:9216
    v_mfma_f32_32x32x16_bf16 v[48:63], v[84:87], v[200:203], v[48:63]
    ds_read_b64_tr_b16 v[68:69], v17 offset:8192
    ds_read_b64_tr_b16 v[70:71], v17 offset:9216
    s_waitcnt vmcnt(24) lgkmcnt(4)
    v_mfma_f32_32x32x16_bf16 v[32:47], v[88:91], v[204:207], v[32:47]
    ds_read_b64_tr_b16 v[72:73], v16 offset:10240
    ds_read_b64_tr_b16 v[74:75], v16 offset:11264
    v_mfma_f32_32x32x16_bf16 v[48:63], v[92:95], v[204:207], v[48:63]
    ds_read_b64_tr_b16 v[76:77], v17 offset:10240
    ds_read_b64_tr_b16 v[78:79], v17 offset:11264
    s_waitcnt vmcnt(23) lgkmcnt(4)
    v_mfma_f32_32x32x16_bf16 v[32:47], v[64:67], v[96:99], v[32:47]
    ds_read_b64_tr_b16 v[80:81], v16 offset:12288
    ds_read_b64_tr_b16 v[82:83], v16 offset:13312
    v_mfma_f32_32x32x16_bf16 v[48:63], v[68:71], v[96:99], v[48:63]
    ds_read_b64_tr_b16 v[84:85], v17 offset:12288
    ds_read_b64_tr_b16 v[86:87], v17 offset:13312
    s_waitcnt vmcnt(22) lgkmcnt(4)
    v_mfma_f32_32x32x16_bf16 v[32:47], v[72:75], v[100:103], v[32:47]
    ds_read_b64_tr_b16 v[88:89], v16 offset:14336
    ds_read_b64_tr_b16 v[90:91], v16 offset:15360
    v_mfma_f32_32x32x16_bf16 v[48:63], v[76:79], v[100:103], v[48:63]
    ds_read_b64_tr_b16 v[92:93], v17 offset:14336
    ds_read_b64_tr_b16 v[94:95], v17 offset:15360
    s_waitcnt vmcnt(21) lgkmcnt(4)
    v_mfma_f32_32x32x16_bf16 v[32:47], v[80:83], v[104:107], v[32:47]
    s_barrier
    ds_read_b64_tr_b16 v[64:65], v14 offset:16384
    ds_read_b64_tr_b16 v[66:67], v14 offset:17408
    s_waitcnt vmcnt(0)
    v_pk_add_f32 v[224:225], v[224:225], v[232:233]
    v_mfma_f32_32x32x16_bf16 v[48:63], v[84:87], v[104:107], v[48:63]
    ds_read_b64_tr_b16 v[68:69], v15 offset:16384
    ds_read_b64_tr_b16 v[70:71], v15 offset:17408
    v_pk_add_f32 v[226:227], v[226:227], v[234:235]
    v_pk_add_f32 v[228:229], v[228:229], v[236:237]
    s_waitcnt vmcnt(20) lgkmcnt(4)
    v_mfma_f32_32x32x16_bf16 v[32:47], v[88:91], v[108:111], v[32:47]
    ds_read_b64_tr_b16 v[72:73], v14 offset:18432
    ds_read_b64_tr_b16 v[74:75], v14 offset:19456
    v_pk_add_f32 v[230:231], v[230:231], v[238:239]
    v_pk_add_f32 v[224:225], v[224:225], v[228:229]
    v_mfma_f32_32x32x16_bf16 v[48:63], v[92:95], v[108:111], v[48:63]
    ds_read_b64_tr_b16 v[76:77], v15 offset:18432
    ds_read_b64_tr_b16 v[78:79], v15 offset:19456
    v_pk_add_f32 v[226:227], v[226:227], v[230:231]
    v_pk_add_f32 v[224:225], v[224:225], v[226:227]
    s_waitcnt vmcnt(19) lgkmcnt(4)
    v_mfma_f32_32x32x16_bf16 v[32:47], v[64:67], v[112:115], v[32:47]
    ds_read_b64_tr_b16 v[80:81], v14 offset:20480
    ds_read_b64_tr_b16 v[82:83], v14 offset:21504
    v_add_f32 v224, v224, v225
    v_mul_f32 v224, 0x3a800000, v224
    v_mfma_f32_32x32x16_bf16 v[48:63], v[68:71], v[112:115], v[48:63]
    ds_read_b64_tr_b16 v[84:85], v15 offset:20480
    ds_read_b64_tr_b16 v[86:87], v15 offset:21504
    v_mov_b32 v225, v224
    s_nop 1
    v_permlane32_swap_b32 v224, v225
    s_waitcnt vmcnt(18) lgkmcnt(4)
    v_mfma_f32_32x32x16_bf16 v[32:47], v[72:75], v[116:119], v[32:47]
    ds_read_b64_tr_b16 v[88:89], v14 offset:22528
    ds_read_b64_tr_b16 v[90:91], v14 offset:23552
    v_fma_f32 v225, -v224, v224, v225
    v_max_f32 v225, 0, v225
    v_mfma_f32_32x32x16_bf16 v[48:63], v[76:79], v[116:119], v[48:63]
    ds_read_b64_tr_b16 v[92:93], v15 offset:22528
    ds_read_b64_tr_b16 v[94:95], v15 offset:23552
    v_add_f32 v225, 0x3727c5ac, v225
    v_rsq_f32 v18, v225
    s_waitcnt vmcnt(17) lgkmcnt(4)
    v_mfma_f32_32x32x16_bf16 v[32:47], v[80:83], v[120:123], v[32:47]
    v_sub_f32 v224, 0, v224
    v_cvt_pk_bf16_f32 v226, v224, v224
    v_mfma_f32_32x32x16_bf16 v[48:63], v[84:87], v[120:123], v[48:63]
    v_lshlrev_b32 v227, 16, v226
    v_sub_f32 v227, v224, v227
    s_waitcnt vmcnt(16) lgkmcnt(0)
    v_mfma_f32_32x32x16_bf16 v[32:47], v[88:91], v[124:127], v[32:47]
    s_barrier
    v_cvt_pk_bf16_f32 v227, v227, v227
    v_cndmask_b32 v240, v226, v227, s[40:41]
    v_mfma_f32_32x32x16_bf16 v[48:63], v[92:95], v[124:127], v[48:63]
    v_mov_b32 v241, v240
    v_mov_b32 v242, v240
    v_mov_b32 v243, v240
    v_mul_f32 v28, 0x3e8293ee, v18
    v_mov_b32 v29, v28
    s_lshl_b32 s34, s3, 11
    s_add_u32 s34, s34, 147456
    v_add_u32 v11, s34, v10
    v_mov_b32 v20, v251
    v_mov_b32 v21, 0
    v_mov_b32 v22, 0
    v_mov_b32 v23, 0
    v_mov_b32 v24, v252
    v_mov_b32 v25, 0
    v_mov_b32 v26, 0
    v_mov_b32 v27, 0
    s_nop 1
    v_mfma_f32_32x32x16_bf16 v[48:63], v[24:27], v[240:243], v[48:63]
    v_mfma_f32_32x32x16_bf16 v[32:47], v[20:23], v[240:243], v[32:47]
    s_nop 10
    v_pk_mul_f32 v[48:49], v[48:49], v[28:29]
    v_pk_mul_f32 v[50:51], v[50:51], v[28:29]
    v_pk_mul_f32 v[52:53], v[52:53], v[28:29]
    v_pk_mul_f32 v[54:55], v[54:55], v[28:29]
    v_pk_mul_f32 v[56:57], v[56:57], v[28:29]
    v_pk_mul_f32 v[58:59], v[58:59], v[28:29]
    v_pk_mul_f32 v[60:61], v[60:61], v[28:29]
    v_pk_mul_f32 v[62:63], v[62:63], v[28:29]
    v_cvt_pk_bf16_f32 v88, v48, v49
    v_cvt_pk_bf16_f32 v89, v50, v51
    v_cvt_pk_bf16_f32 v90, v52, v53
    v_cvt_pk_bf16_f32 v91, v54, v55
    v_cvt_pk_bf16_f32 v92, v56, v57
    v_cvt_pk_bf16_f32 v93, v58, v59
    v_cvt_pk_bf16_f32 v94, v60, v61
    v_cvt_pk_bf16_f32 v95, v62, v63
    ds_write_b128 v11, v[88:91] offset:0
    ds_write_b128 v11, v[92:95] offset:1024
    v_pk_mul_f32 v[32:33], v[32:33], v[28:29]
    v_pk_mul_f32 v[34:35], v[34:35], v[28:29]
    v_pk_mul_f32 v[36:37], v[36:37], v[28:29]
    v_pk_mul_f32 v[38:39], v[38:39], v[28:29]
    v_pk_mul_f32 v[40:41], v[40:41], v[28:29]
    v_pk_mul_f32 v[42:43], v[42:43], v[28:29]
    v_pk_mul_f32 v[44:45], v[44:45], v[28:29]
    v_pk_mul_f32 v[46:47], v[46:47], v[28:29]
    v_cvt_pk_bf16_f32 v180, v32, v33
    v_cvt_pk_bf16_f32 v181, v34, v35
    v_cvt_pk_bf16_f32 v182, v36, v37
    v_cvt_pk_bf16_f32 v183, v38, v39
    v_cvt_pk_bf16_f32 v184, v40, v41
    v_cvt_pk_bf16_f32 v185, v42, v43
    v_cvt_pk_bf16_f32 v186, v44, v45
    v_cvt_pk_bf16_f32 v187, v46, v47
    s_branch L_qb1_end_250
L_qb1_ld_249:
    s_sub_u32 s30, s3, 4
    v_lshrrev_b32 v6, 3, v1
    v_and_b32 v7, 7, v1
    s_lshl_b32 s31, s30, 4
    v_lshrrev_b32 v5, 1, v6
    v_and_b32 v5, 1, v5
    v_lshlrev_b32 v5, 2, v5
    v_xor_b32 v5, v5, v7
    v_lshlrev_b32 v5, 4, v5
    s_lshl_b32 s32, s5, 7
    v_add_u32 v5, s32, v5
    v_add_u32 v4, s31, v6
    v_lshl_add_u32 v12, v4, 11, v5
    v_add_u32 v13, 15360, v12
    v_lshlrev_b32 v8, 4, v1
    s_lshl_b32 s35, s30, 11
    s_add_u32 m0, s35, 0
    s_mov_b32 s38, 393216
    buffer_load_dwordx4 v12, s[12:15], s38 offen offset:0 lds
    buffer_load_dwordx4 v13, s[12:15], s38 offen offset:1024 lds
    s_add_u32 m0, s35, 8192
    s_mov_b32 s38, 524288
    buffer_load_dwordx4 v12, s[12:15], s38 offen offset:0 lds
    buffer_load_dwordx4 v13, s[12:15], s38 offen offset:1024 lds
    s_add_u32 m0, s35, 16384
    s_mov_b32 s38, 655360
    buffer_load_dwordx4 v12, s[12:15], s38 offen offset:0 lds
    buffer_load_dwordx4 v13, s[12:15], s38 offen offset:1024 lds
    s_add_u32 m0, s35, 24576
    s_mov_b32 s38, 786432
    buffer_load_dwordx4 v12, s[12:15], s38 offen offset:0 lds
    buffer_load_dwordx4 v13, s[12:15], s38 offen offset:1024 lds
    s_add_u32 m0, s35, 32768
    s_mov_b32 s38, 917504
    buffer_load_dwordx4 v12, s[12:15], s38 offen offset:0 lds
    buffer_load_dwordx4 v13, s[12:15], s38 offen offset:1024 lds
    s_add_u32 m0, s35, 40960
    s_mov_b32 s38, 1048576
    buffer_load_dwordx4 v12, s[12:15], s38 offen offset:0 lds
    buffer_load_dwordx4 v13, s[12:15], s38 offen offset:1024 lds
    s_add_u32 m0, s35, 49152
    s_mov_b32 s38, 1179648
    buffer_load_dwordx4 v12, s[12:15], s38 offen offset:0 lds
    buffer_load_dwordx4 v13, s[12:15], s38 offen offset:1024 lds
    s_add_u32 m0, s35, 147456
    s_mov_b32 s38, 1310720
    buffer_load_dwordx4 v12, s[12:15], s38 offen offset:0 lds
    buffer_load_dwordx4 v13, s[12:15], s38 offen offset:1024 lds
    s_waitcnt vmcnt(16)
    s_barrier
    s_cmp_lg_u32 s3, 7
    s_cbranch_scc1 L_rp_270_ok
    v_and_b32 v4, 15, v1
    v_lshlrev_b32 v4, 2, v4
    s_lshl_b32 s52, s4, 8
    s_add_u32 s52, s52, 0x2808000
    s_mov_b32 s53, 0
    v_mov_b32 v6, 163836
L_rp_270:
    buffer_load_dword v5, v4, s[16:19], s52 offen sc1
    s_waitcnt vmcnt(0)
    v_cmp_ne_u32 vcc, 1, v5
    s_nop 0
    s_or_b32 s63, vcc_lo, 0x10000
    s_ff1_i32_b32 s63, s63
    s_add_u32 s53, s53, 1
    s_cmp_lt_u32 s53, 0x40000
    s_cselect_b32 s63, s63, 16
    v_mov_b32 v7, s63
    ds_write_b32 v6, v7
    s_cmp_lt_u32 s63, 16
    s_cbranch_scc1 L_rp_270
L_rp_270_ok:
    s_cmp_lg_u32 s3, 6
    s_cbranch_scc1 L_s6_271
    s_setprio 3
    v_mov_b32 v4, 163836
L_l6_272:
    ds_read_b32 v5, v4
    s_waitcnt lgkmcnt(0)
    v_readfirstlane_b32 s63, v5
    s_nop 0
    s_cmp_gt_u32 s63, 15
    s_cbranch_scc0 L_l6_272
    s_and_b32 s49, s48, 3
    v_lshlrev_b32 v9, 2, v1
    s_lshl_b32 s54, s4, 14
    s_lshl_b32 s55, s49, 8
    s_add_u32 s54, s54, s55
    s_add_u32 s54, s54, 0x26c0000
    buffer_load_dword v224, v9, s[16:19], s54 offen offset:0 sc1
    buffer_load_dword v225, v9, s[16:19], s54 offen offset:1024 sc1
    buffer_load_dword v226, v9, s[16:19], s54 offen offset:2048 sc1
    buffer_load_dword v227, v9, s[16:19], s54 offen offset:3072 sc1
    s_add_u32 s54, s54, 4096
    buffer_load_dword v228, v9, s[16:19], s54 offen offset:0 sc1
    buffer_load_dword v229, v9, s[16:19], s54 offen offset:1024 sc1
    buffer_load_dword v230, v9, s[16:19], s54 offen offset:2048 sc1
    buffer_load_dword v231, v9, s[16:19], s54 offen offset:3072 sc1
    s_add_u32 s54, s54, 4096
    buffer_load_dword v232, v9, s[16:19], s54 offen offset:0 sc1
    buffer_load_dword v233, v9, s[16:19], s54 offen offset:1024 sc1
    buffer_load_dword v234, v9, s[16:19], s54 offen offset:2048 sc1
    buffer_load_dword v235, v9, s[16:19], s54 offen offset:3072 sc1
    s_add_u32 s54, s54, 4096
    buffer_load_dword v236, v9, s[16:19], s54 offen offset:0 sc1
    buffer_load_dword v237, v9, s[16:19], s54 offen offset:1024 sc1
    buffer_load_dword v238, v9, s[16:19], s54 offen offset:2048 sc1
    buffer_load_dword v239, v9, s[16:19], s54 offen offset:3072 sc1
    s_lshl_b32 s54, s4, 2
    s_add_u32 s54, s54, s48
    s_lshl_b32 s54, s54, 12
    s_add_u32 s54, s54, 0x2440000
    v_mul_u32_u24 v26, 72, v2
    v_lshl_add_u32 v26, v3, 3, v26
    v_add_u32 v26, 155648, v26
    v_and_b32 v24, 15, v1
    v_lshrrev_b32 v25, 2, v24
    v_lshl_add_u32 v25, v3, 2, v25
    v_mul_u32_u24 v25, 72, v25
    v_and_b32 v24, 3, v24
    v_lshl_add_u32 v25, v24, 3, v25
    v_bfe_u32 v24, v1, 4, 1
    v_lshl_add_u32 v25, v24, 5, v25
    v_add_u32 v25, 155648, v25
    s_waitcnt vmcnt(0)
    v_pk_add_f32 v[224:225], v[224:225], v[232:233]
    v_pk_add_f32 v[226:227], v[226:227], v[234:235]
    v_pk_add_f32 v[228:229], v[228:229], v[236:237]
    v_pk_add_f32 v[230:231], v[230:231], v[238:239]
    v_pk_add_f32 v[224:225], v[224:225], v[228:229]
    v_pk_add_f32 v[226:227], v[226:227], v[230:231]
    v_pk_add_f32 v[224:225], v[224:225], v[226:227]
    v_add_f32 v224, v224, v225
    v_mul_f32 v224, 0x3a800000, v224
    v_mov_b32 v225, v224
    s_nop 1
    v_permlane32_swap_b32 v224, v225
    v_fma_f32 v225, -v224, v224, v225
    v_max_f32 v225, 0, v225
    v_add_f32 v225, 0x3727c5ac, v225
    v_rsq_f32 v18, v225
    v_sub_f32 v224, 0, v224
    v_cvt_pk_bf16_f32 v226, v224, v224
    v_lshlrev_b32 v227, 16, v226
    v_sub_f32 v227, v224, v227
    v_cvt_pk_bf16_f32 v227, v227, v227
    v_cndmask_b32 v240, v226, v227, s[40:41]
    v_mov_b32 v241, v240
    v_mov_b32 v242, v240
    v_mov_b32 v243, v240
    v_mov_b32 v19, v18
    v_mov_b32 v20, v248
    v_mov_b32 v21, 0
    v_mov_b32 v22, 0
    v_mov_b32 v23, 0
L_s6_271:
    s_waitcnt vmcnt(0)
    s_barrier
    s_cmp_ge_u32 s5, 8
    s_cbranch_scc1 L_kvs_273
    s_cmp_eq_u32 s3, 6
    s_cbranch_scc1 L_kvs_275
    s_add_u32 m0, s35, 90112
    s_mov_b32 s38, 1441792
    buffer_load_dwordx4 v12, s[12:15], s38 offen offset:0 lds
    buffer_load_dwordx4 v13, s[12:15], s38 offen offset:1024 lds
    s_add_u32 m0, s35, 106496
    s_mov_b32 s38, 1572864
    buffer_load_dwordx4 v12, s[12:15], s38 offen offset:0 lds
    buffer_load_dwordx4 v13, s[12:15], s38 offen offset:1024 lds
    s_add_u32 m0, s35, 122880
    s_mov_b32 s38, 1703936
    buffer_load_dwordx4 v12, s[12:15], s38 offen offset:0 lds
    buffer_load_dwordx4 v13, s[12:15], s38 offen offset:1024 lds
    s_add_u32 m0, s35, 139264
    s_mov_b32 s38, 1835008
    buffer_load_dwordx4 v12, s[12:15], s38 offen offset:0 lds
    buffer_load_dwordx4 v13, s[12:15], s38 offen offset:1024 lds
    s_branch L_kvs_273
L_kvs_275:
    v_add_u32 v9, 81920, v8
    ds_read_b128 v[32:35], v9 offset:0
    ds_read_b128 v[36:39], v9 offset:1024
    ds_read_b128 v[40:43], v9 offset:2048
    ds_read_b128 v[44:47], v9 offset:3072
    ds_read_b128 v[48:51], v9 offset:16384
    ds_read_b128 v[52:55], v9 offset:17408
    ds_read_b128 v[56:59], v9 offset:18432
    ds_read_b128 v[60:63], v9 offset:19456
    ds_read_b128 v[64:67], v9 offset:32768
    ds_read_b128 v[68:71], v9 offset:33792
    ds_read_b128 v[72:75], v9 offset:34816
    ds_read_b128 v[76:79], v9 offset:35840
    ds_read_b128 v[80:83], v9 offset:49152
    ds_read_b128 v[84:87], v9 offset:50176
    ds_read_b128 v[88:91], v9 offset:51200
    ds_read_b128 v[92:95], v9 offset:52224
    s_waitcnt lgkmcnt(0)
    v_pk_add_f32 v[32:33], v[32:33], v[48:49]
    v_pk_add_f32 v[64:65], v[64:65], v[80:81]
    v_pk_add_f32 v[32:33], v[32:33], v[64:65]
    v_pk_add_f32 v[34:35], v[34:35], v[50:51]
    v_pk_add_f32 v[66:67], v[66:67], v[82:83]
    v_pk_add_f32 v[34:35], v[34:35], v[66:67]
    v_pk_add_f32 v[36:37], v[36:37], v[52:53]
    v_pk_add_f32 v[68:69], v[68:69], v[84:85]
    v_pk_add_f32 v[36:37], v[36:37], v[68:69]
    v_pk_add_f32 v[38:39], v[38:39], v[54:55]
    v_pk_add_f32 v[70:71], v[70:71], v[86:87]
    v_pk_add_f32 v[38:39], v[38:39], v[70:71]
    v_pk_add_f32 v[40:41], v[40:41], v[56:57]
    v_pk_add_f32 v[72:73], v[72:73], v[88:89]
    v_pk_add_f32 v[40:41], v[40:41], v[72:73]
    v_pk_add_f32 v[42:43], v[42:43], v[58:59]
    v_pk_add_f32 v[74:75], v[74:75], v[90:91]
    v_pk_add_f32 v[42:43], v[42:43], v[74:75]
    v_pk_add_f32 v[44:45], v[44:45], v[60:61]
    v_pk_add_f32 v[76:77], v[76:77], v[92:93]
    v_pk_add_f32 v[44:45], v[44:45], v[76:77]
    v_pk_add_f32 v[46:47], v[46:47], v[62:63]
    v_pk_add_f32 v[78:79], v[78:79], v[94:95]
    v_pk_add_f32 v[46:47], v[46:47], v[78:79]
    s_nop 1
    v_mfma_f32_32x32x16_bf16 v[32:47], v[20:23], v[240:243], v[32:47]
    s_nop 11
    v_pk_mul_f32 v[32:33], v[32:33], v[18:19]
    v_pk_mul_f32 v[34:35], v[34:35], v[18:19]
    v_pk_mul_f32 v[36:37], v[36:37], v[18:19]
    v_pk_mul_f32 v[38:39], v[38:39], v[18:19]
    v_pk_mul_f32 v[40:41], v[40:41], v[18:19]
    v_pk_mul_f32 v[42:43], v[42:43], v[18:19]
    v_pk_mul_f32 v[44:45], v[44:45], v[18:19]
    v_pk_mul_f32 v[46:47], v[46:47], v[18:19]
    v_cvt_pk_bf16_f32 v96, v32, v33
    v_cvt_pk_bf16_f32 v97, v34, v35
    v_cvt_pk_bf16_f32 v98, v36, v37
    v_cvt_pk_bf16_f32 v99, v38, v39
    v_cvt_pk_bf16_f32 v100, v40, v41
    v_cvt_pk_bf16_f32 v101, v42, v43
    v_cvt_pk_bf16_f32 v102, v44, v45
    v_cvt_pk_bf16_f32 v103, v46, v47
    s_bitcmp1_b32 s5, 0
    s_cbranch_scc0 L_qb1_sg_252
    ds_write_b64 v26, v[96:97] offset:0
    ds_write_b64 v26, v[98:99] offset:16
    ds_write_b64 v26, v[100:101] offset:32
    ds_write_b64 v26, v[102:103] offset:48
    s_waitcnt lgkmcnt(0)
    ds_read_b64_tr_b16 v[96:97], v25 offset:0
    ds_read_b64_tr_b16 v[98:99], v25 offset:576
    ds_read_b64_tr_b16 v[100:101], v25 offset:1152
    ds_read_b64_tr_b16 v[102:103], v25 offset:1728
    s_waitcnt lgkmcnt(0)
    s_add_u32 s54, s54, 2048
L_qb1_sg_252:
    buffer_store_dwordx4 v[96:99], v8, s[16:19], s54 offen offset:0 sc1
    buffer_store_dwordx4 v[100:103], v8, s[16:19], s54 offen offset:1024 sc1
    s_waitcnt vmcnt(0)
    s_mov_b32 s61, s35
    s_lshl_b32 s34, s4, 8
    s_add_u32 s34, s34, 0x2809000
    v_mov_b32 v4, 1
    v_mov_b32 v5, 0
    s_mov_b64 exec, 1
    buffer_atomic_add v4, v5, s[16:19], s34 offen sc1
L_sig_276:
    s_mov_b64 exec, -1
    s_mov_b32 s35, s61
    s_add_u32 m0, s35, 90112
    s_mov_b32 s38, 1441792
    buffer_load_dwordx4 v12, s[12:15], s38 offen offset:0 lds
    buffer_load_dwordx4 v13, s[12:15], s38 offen offset:1024 lds
    s_add_u32 m0, s35, 106496
    s_mov_b32 s38, 1572864
    buffer_load_dwordx4 v12, s[12:15], s38 offen offset:0 lds
    buffer_load_dwordx4 v13, s[12:15], s38 offen offset:1024 lds
    s_add_u32 m0, s35, 122880
    s_mov_b32 s38, 1703936
    buffer_load_dwordx4 v12, s[12:15], s38 offen offset:0 lds
    buffer_load_dwordx4 v13, s[12:15], s38 offen offset:1024 lds
    s_add_u32 m0, s35, 139264
    s_mov_b32 s38, 1835008
    buffer_load_dwordx4 v12, s[12:15], s38 offen offset:0 lds
    buffer_load_dwordx4 v13, s[12:15], s38 offen offset:1024 lds
L_kvs_273:
    s_setprio 0
    s_waitcnt vmcnt(0)
    s_barrier
    s_cmp_ge_u32 s5, 8
    s_cbranch_scc1 L_kvs_274
    s_add_u32 m0, s35, 81920
    s_mov_b32 s38, 1966080
    buffer_load_dwordx4 v12, s[12:15], s38 offen offset:0 lds
    buffer_load_dwordx4 v13, s[12:15], s38 offen offset:1024 lds
L_kvs_274:
    s_cmp_lg_u32 s3, 7
    s_cbranch_scc1 L_npk_277
    v_and_b32 v4, 15, v1
    v_lshlrev_b32 v4, 8, v4
    s_mov_b32 s52, 0x2809000
    s_mov_b32 s53, 0
L_poll_278:
    buffer_load_dword v5, v4, s[16:19], s52 offen sc1
    s_waitcnt vmcnt(0)
    v_cmp_gt_u32 vcc, 8, v5
    s_cbranch_vccz L_poll_278_ok
    s_add_u32 s53, s53, 1
    s_cmp_lt_u32 s53, 0x40000
    s_cbranch_scc1 L_poll_278
L_poll_278_ok:
L_npk_277:
    s_waitcnt vmcnt(0)
    s_barrier
    s_lshl_b32 s31, s30, 13
    s_add_u32 s39, s31, 0x2440000
    s_add_u32 m0, s31, 0
    s_nop 0
    buffer_load_dwordx4 v8, s[16:19], s39 offen offset:0 sc1 lds
    buffer_load_dwordx4 v8, s[16:19], s39 offen offset:1024 sc1 lds
    buffer_load_dwordx4 v8, s[16:19], s39 offen offset:2048 sc1 lds
    buffer_load_dwordx4 v8, s[16:19], s39 offen offset:3072 sc1 lds
    s_add_u32 s39, s39, 4096
    s_add_u32 m0, s31, 4096
    s_nop 0
    buffer_load_dwordx4 v8, s[16:19], s39 offen offset:0 sc1 lds
    buffer_load_dwordx4 v8, s[16:19], s39 offen offset:1024 sc1 lds
    buffer_load_dwordx4 v8, s[16:19], s39 offen offset:2048 sc1 lds
    buffer_load_dwordx4 v8, s[16:19], s39 offen offset:3072 sc1 lds
    s_add_u32 s39, s39, 4096
    s_barrier
L_qb1_end_250:
    s_lshr_b32 s36, s3, 2
    s_and_b32 s37, s3, 3
    s_lshl_b32 s38, s5, 1
    s_add_u32 s38, s38, s36
    s_lshl_b32 s39, s4, 2
    s_add_u32 s39, s39, s37
    v_lshlrev_b32 v128, 4, v1
    v_mov_b32 v4, 163776
    v_mov_b32 v5, 0
    ds_write_b32 v4, v5
    v_mov_b32 v4, v128
    s_lshl_b32 s30, s3, 12
    s_add_u32 s31, s30, 0x2448000
    s_add_u32 m0, s30, 32768
    s_nop 0
    buffer_load_dwordx4 v4, s[16:19], s31 offen offset:0 sc1 lds
    buffer_load_dwordx4 v4, s[16:19], s31 offen offset:1024 sc1 lds
    buffer_load_dwordx4 v4, s[16:19], s31 offen offset:2048 sc1 lds
    buffer_load_dwordx4 v4, s[16:19], s31 offen offset:3072 sc1 lds
    s_add_u32 s31, s31, 32768
    s_add_u32 m0, s30, 65536
    s_nop 0
    buffer_load_dwordx4 v4, s[16:19], s31 offen offset:0 sc1 lds
    buffer_load_dwordx4 v4, s[16:19], s31 offen offset:1024 sc1 lds
    buffer_load_dwordx4 v4, s[16:19], s31 offen offset:2048 sc1 lds
    buffer_load_dwordx4 v4, s[16:19], s31 offen offset:3072 sc1 lds
    s_add_u32 s31, s31, 32768
    v_bfe_u32 v5, v1, 2, 1
    v_bfe_u32 v6, v1, 4, 1
    v_cmp_eq_u32 vcc, v5, v6
    v_mov_b32 v5, 0x3f803f80
    s_nop 0
    v_cndmask_b32 v100, 0, v5, vcc
    v_mov_b32 v101, v100
    v_mov_b32 v102, v100
    v_mov_b32 v103, v100
    v_mov_b32 v80, 0
    v_mov_b32 v81, 0
    v_mov_b32 v82, 0
    v_mov_b32 v83, 0
    v_mov_b32 v84, 0
    v_mov_b32 v85, 0
    v_mov_b32 v86, 0
    v_mov_b32 v87, 0
    v_mov_b32 v88, 0
    v_mov_b32 v89, 0
    v_mov_b32 v90, 0
    v_mov_b32 v91, 0
    v_mov_b32 v92, 0
    v_mov_b32 v93, 0
    v_mov_b32 v94, 0
    v_mov_b32 v95, 0
    v_mov_b32 v96, 0
    v_mov_b32 v97, 0
    v_mov_b32 v98, 0
    v_mov_b32 v99, 0
    v_mov_b32 v64, 0
    v_mov_b32 v65, 0
    v_mov_b32 v66, 0
    v_mov_b32 v67, 0
    v_mov_b32 v68, 0
    v_mov_b32 v69, 0
    v_mov_b32 v70, 0
    v_mov_b32 v71, 0
    v_mov_b32 v129, v4
    s_waitcnt vmcnt(8) lgkmcnt(0)
    s_barrier
    s_cmp_ge_u32 s3, 4
    s_cbranch_scc1 L_at1_279_qld
    v_mov_b32 v8, v180
    v_mov_b32 v9, v181
    v_mov_b32 v10, v182
    v_mov_b32 v11, v183
    v_mov_b32 v12, v184
    v_mov_b32 v13, v185
    v_mov_b32 v14, v186
    v_mov_b32 v15, v187
    s_branch L_at1_279_go
L_at1_279_qld:
    s_lshl_b32 s34, s37, 11
    s_add_u32 s34, s34, 147456
    v_add_u32 v5, s34, v128
    ds_read_b128 v[8:11], v5
    ds_read_b128 v[12:15], v5 offset:1024
L_at1_279_go:
    ds_read_b128 v[104:107], v129
    ds_read_b128 v[108:111], v129 offset:1024
    s_waitcnt lgkmcnt(0)
    v_mfma_f32_32x32x16_bf16 v[32:47], v[104:107], v[8:11], 0
    v_mfma_f32_32x32x16_bf16 v[32:47], v[108:111], v[12:15], v[32:47]
    s_nop 11
    v_max3_f32 v5, v32, v33, v34
    v_max3_f32 v5, v5, v35, v36
    v_max3_f32 v5, v5, v37, v38
    v_max3_f32 v5, v5, v39, v40
    v_max3_f32 v5, v5, v41, v42
    v_max3_f32 v5, v5, v43, v44
    v_max3_f32 v5, v5, v45, v46
    v_max_f32 v5, v5, v47
    v_mov_b32 v6, v5
    s_nop 1
    v_permlane32_swap_b32 v5, v6
    v_max_f32 v5, v5, v6
    v_sub_f32 v16, 0, v5
    v_sub_f32 v17, 0, v5
    v_sub_f32 v18, 0, v5
    v_sub_f32 v19, 0, v5
    v_sub_f32 v20, 0, v5
    v_sub_f32 v21, 0, v5
    v_sub_f32 v22, 0, v5
    v_sub_f32 v23, 0, v5
    v_sub_f32 v24, 0, v5
    v_sub_f32 v25, 0, v5
    v_sub_f32 v26, 0, v5
    v_sub_f32 v27, 0, v5
    v_sub_f32 v28, 0, v5
    v_sub_f32 v29, 0, v5
    v_sub_f32 v30, 0, v5
    v_sub_f32 v31, 0, v5
    v_sub_f32 v32, v32, v5
    v_sub_f32 v33, v33, v5
    v_sub_f32 v34, v34, v5
    v_sub_f32 v35, v35, v5
    v_sub_f32 v36, v36, v5
    v_sub_f32 v37, v37, v5
    v_sub_f32 v38, v38, v5
    v_sub_f32 v39, v39, v5
    v_sub_f32 v40, v40, v5
    v_sub_f32 v41, v41, v5
    v_sub_f32 v42, v42, v5
    v_sub_f32 v43, v43, v5
    v_sub_f32 v44, v44, v5
    v_sub_f32 v45, v45, v5
    v_sub_f32 v46, v46, v5
    v_sub_f32 v47, v47, v5
    s_mov_b32 s24, s80
    s_and_b32 s25, s81, 0xffff
    s_mov_b32 s26, 0x200000
    s_mov_b32 s27, 0x20000
    s_and_b32 s57, s2, 1
    s_lshl_b32 s57, s57, 3
    s_bfe_u32 s58, s2, 0x30003
    s_add_u32 s57, s57, s58
    s_lshl_b32 s57, s57, 7
    v_lshrrev_b32 v241, 3, v1
    v_bfe_u32 v242, v241, 1, 1
    v_lshlrev_b32 v242, 2, v242
    v_and_b32 v243, 7, v1
    v_xor_b32 v242, v242, v243
    v_lshlrev_b32 v242, 4, v242
    s_lshl_b32 s58, s3, 3
    v_add_u32 v241, s58, v241
    v_lshl_add_u32 v241, v241, 11, v242
    v_add_u32 v241, s57, v241
    v_add_u32 v242, 15360, v241
    s_lshl_b32 s60, s3, 10
    s_mov_b32 s92, s24
    s_mov_b32 s93, s25
    s_mov_b32 s94, s26
    s_mov_b32 s95, 0x20000
    v_mov_b32 v130, v241
    s_add_u32 s96, s60, 131072
    s_mov_b32 s97, 1572864
    s_movk_i32 s98, 8192
    s_mov_b32 s99, 0x20000
    ds_read_b128 v[124:127], v129 offset:3072
    ds_read_b128 v[104:107], v129 offset:4096
    ds_read_b128 v[108:111], v129 offset:5120
    ds_read_b128 v[120:123], v129 offset:2048
    s_mov_b32 s32, 0
    v_mov_b32 v5, v129
    v_add_u32 v6, 32768, v4
    s_mov_b32 s33, 0x18000
L_at1_279_loop:
    s_waitcnt lgkmcnt(3)
    v_mfma_f32_32x32x16_bf16 v[80:95], v[124:127], v[68:71], v[80:95]
    ds_read_b128 v[124:127], v5 offset:3072
    v_exp_f32 v32, v32
    v_exp_f32 v33, v33
    v_exp_f32 v34, v34
    v_exp_f32 v35, v35
    v_mfma_f32_16x16x32_bf16 v[96:99], v[100:103], v[68:71], v[96:99]
    v_exp_f32 v36, v36
    v_exp_f32 v37, v37
    s_setprio 2
    s_waitcnt lgkmcnt(3)
    v_mfma_f32_32x32x16_bf16 v[48:63], v[104:107], v[8:11], v[16:31]
    ds_read_b128 v[104:107], v5 offset:8192
    v_exp_f32 v38, v38
    v_exp_f32 v39, v39
    v_cvt_pk_bf16_f32 v64, v32, v33
    v_cvt_pk_bf16_f32 v65, v34, v35
    v_cvt_pk_bf16_f32 v66, v36, v37
    v_cvt_pk_bf16_f32 v67, v38, v39
    s_waitcnt lgkmcnt(3)
    v_mfma_f32_32x32x16_bf16 v[48:63], v[108:111], v[12:15], v[48:63]
    ds_read_b128 v[108:111], v5 offset:9216
    v_exp_f32 v40, v40
    v_exp_f32 v41, v41
    v_exp_f32 v42, v42
    v_exp_f32 v43, v43
    s_mov_b32 m0, s96
    s_add_u32 s96, s96, s98
    buffer_load_dwordx4 v130, s[92:95], s97 offen sc1 lds
    s_add_u32 s97, s97, s99
    s_waitcnt lgkmcnt(3)
    v_mfma_f32_32x32x16_bf16 v[80:95], v[120:123], v[64:67], v[80:95]
    ds_read_b128 v[120:123], v5 offset:6144
    v_exp_f32 v44, v44
    v_exp_f32 v45, v45
    v_exp_f32 v46, v46
    v_exp_f32 v47, v47
    v_mfma_f32_16x16x32_bf16 v[96:99], v[100:103], v[64:67], v[96:99]
    v_cvt_pk_bf16_f32 v68, v40, v41
    v_cvt_pk_bf16_f32 v69, v42, v43
    v_cvt_pk_bf16_f32 v70, v44, v45
    v_cvt_pk_bf16_f32 v71, v46, v47
    s_waitcnt lgkmcnt(3)
    s_nop 0
    v_mfma_f32_32x32x16_bf16 v[80:95], v[124:127], v[68:71], v[80:95]
    ds_read_b128 v[124:127], v5 offset:7168
    v_exp_f32 v48, v48
    v_exp_f32 v49, v49
    v_exp_f32 v50, v50
    v_exp_f32 v51, v51
    v_mfma_f32_16x16x32_bf16 v[96:99], v[100:103], v[68:71], v[96:99]
    v_exp_f32 v52, v52
    v_exp_f32 v53, v53
    s_waitcnt lgkmcnt(3)
    v_mfma_f32_32x32x16_bf16 v[32:47], v[104:107], v[8:11], v[16:31]
    ds_read_b128 v[104:107], v5 offset:12288
    v_exp_f32 v54, v54
    v_exp_f32 v55, v55
    v_cvt_pk_bf16_f32 v64, v48, v49
    v_cvt_pk_bf16_f32 v65, v50, v51
    v_cvt_pk_bf16_f32 v66, v52, v53
    v_cvt_pk_bf16_f32 v67, v54, v55
    s_waitcnt lgkmcnt(3)
    v_mfma_f32_32x32x16_bf16 v[32:47], v[108:111], v[12:15], v[32:47]
    ds_read_b128 v[108:111], v5 offset:13312
    v_exp_f32 v56, v56
    v_exp_f32 v57, v57
    v_exp_f32 v58, v58
    v_exp_f32 v59, v59
    s_mov_b32 m0, s96
    s_add_u32 s96, s96, s98
    buffer_load_dwordx4 v130, s[92:95], s97 offen sc1 lds
    s_add_u32 s97, s97, s99
    s_waitcnt lgkmcnt(3)
    v_mfma_f32_32x32x16_bf16 v[80:95], v[120:123], v[64:67], v[80:95]
    ds_read_b128 v[120:123], v5 offset:10240
    v_exp_f32 v60, v60
    v_exp_f32 v61, v61
    v_exp_f32 v62, v62
    v_exp_f32 v63, v63
    v_mfma_f32_16x16x32_bf16 v[96:99], v[100:103], v[64:67], v[96:99]
    v_cvt_pk_bf16_f32 v68, v56, v57
    v_cvt_pk_bf16_f32 v69, v58, v59
    v_cvt_pk_bf16_f32 v70, v60, v61
    v_cvt_pk_bf16_f32 v71, v62, v63
    s_waitcnt lgkmcnt(3)
    s_nop 0
    v_mfma_f32_32x32x16_bf16 v[80:95], v[124:127], v[68:71], v[80:95]
    ds_read_b128 v[124:127], v5 offset:11264
    v_exp_f32 v32, v32
    v_exp_f32 v33, v33
    v_exp_f32 v34, v34
    v_exp_f32 v35, v35
    v_mfma_f32_16x16x32_bf16 v[96:99], v[100:103], v[68:71], v[96:99]
    v_exp_f32 v36, v36
    v_exp_f32 v37, v37
    s_setprio 1
    s_waitcnt lgkmcnt(3)
    v_mfma_f32_32x32x16_bf16 v[48:63], v[104:107], v[8:11], v[16:31]
    ds_read_b128 v[104:107], v5 offset:16384
    v_exp_f32 v38, v38
    v_exp_f32 v39, v39
    v_cvt_pk_bf16_f32 v64, v32, v33
    v_cvt_pk_bf16_f32 v65, v34, v35
    v_cvt_pk_bf16_f32 v66, v36, v37
    v_cvt_pk_bf16_f32 v67, v38, v39
    s_waitcnt lgkmcnt(3)
    v_mfma_f32_32x32x16_bf16 v[48:63], v[108:111], v[12:15], v[48:63]
    ds_read_b128 v[108:111], v5 offset:17408
    v_exp_f32 v40, v40
    v_exp_f32 v41, v41
    v_exp_f32 v42, v42
    v_exp_f32 v43, v43
    s_waitcnt lgkmcnt(3)
    v_mfma_f32_32x32x16_bf16 v[80:95], v[120:123], v[64:67], v[80:95]
    ds_read_b128 v[120:123], v5 offset:14336
    v_exp_f32 v44, v44
    v_exp_f32 v45, v45
    v_exp_f32 v46, v46
    v_exp_f32 v47, v47
    v_mfma_f32_16x16x32_bf16 v[96:99], v[100:103], v[64:67], v[96:99]
    v_cvt_pk_bf16_f32 v68, v40, v41
    v_cvt_pk_bf16_f32 v69, v42, v43
    v_cvt_pk_bf16_f32 v70, v44, v45
    v_cvt_pk_bf16_f32 v71, v46, v47
    s_waitcnt lgkmcnt(3)
    s_nop 0
    v_mfma_f32_32x32x16_bf16 v[80:95], v[124:127], v[68:71], v[80:95]
    ds_read_b128 v[124:127], v5 offset:15360
    v_exp_f32 v48, v48
    v_exp_f32 v49, v49
    v_exp_f32 v50, v50
    v_exp_f32 v51, v51
    v_mfma_f32_16x16x32_bf16 v[96:99], v[100:103], v[68:71], v[96:99]
    v_exp_f32 v52, v52
    v_exp_f32 v53, v53
    s_waitcnt lgkmcnt(3)
    v_mfma_f32_32x32x16_bf16 v[32:47], v[104:107], v[8:11], v[16:31]
    ds_read_b128 v[104:107], v5 offset:20480
    v_exp_f32 v54, v54
    v_exp_f32 v55, v55
    v_cvt_pk_bf16_f32 v64, v48, v49
    v_cvt_pk_bf16_f32 v65, v50, v51
    v_cvt_pk_bf16_f32 v66, v52, v53
    v_cvt_pk_bf16_f32 v67, v54, v55
    s_waitcnt lgkmcnt(3)
    v_mfma_f32_32x32x16_bf16 v[32:47], v[108:111], v[12:15], v[32:47]
    ds_read_b128 v[108:111], v5 offset:21504
    v_exp_f32 v56, v56
    v_exp_f32 v57, v57
    v_exp_f32 v58, v58
    v_exp_f32 v59, v59
    s_waitcnt lgkmcnt(3)
    v_mfma_f32_32x32x16_bf16 v[80:95], v[120:123], v[64:67], v[80:95]
    ds_read_b128 v[120:123], v5 offset:18432
    v_exp_f32 v60, v60
    v_exp_f32 v61, v61
    v_exp_f32 v62, v62
    v_exp_f32 v63, v63
    v_mfma_f32_16x16x32_bf16 v[96:99], v[100:103], v[64:67], v[96:99]
    v_cvt_pk_bf16_f32 v68, v56, v57
    v_cvt_pk_bf16_f32 v69, v58, v59
    v_cvt_pk_bf16_f32 v70, v60, v61
    v_cvt_pk_bf16_f32 v71, v62, v63
    s_waitcnt lgkmcnt(3)
    s_nop 0
    v_mfma_f32_32x32x16_bf16 v[80:95], v[124:127], v[68:71], v[80:95]
    ds_read_b128 v[124:127], v5 offset:19456
    v_exp_f32 v32, v32
    v_exp_f32 v33, v33
    v_exp_f32 v34, v34
    v_exp_f32 v35, v35
    v_mfma_f32_16x16x32_bf16 v[96:99], v[100:103], v[68:71], v[96:99]
    v_exp_f32 v36, v36
    v_exp_f32 v37, v37
    s_setprio 0
    s_waitcnt lgkmcnt(3)
    v_mfma_f32_32x32x16_bf16 v[48:63], v[104:107], v[8:11], v[16:31]
    ds_read_b128 v[104:107], v5 offset:24576
    v_exp_f32 v38, v38
    v_exp_f32 v39, v39
    v_cvt_pk_bf16_f32 v64, v32, v33
    v_cvt_pk_bf16_f32 v65, v34, v35
    v_cvt_pk_bf16_f32 v66, v36, v37
    v_cvt_pk_bf16_f32 v67, v38, v39
    s_waitcnt lgkmcnt(3)
    v_mfma_f32_32x32x16_bf16 v[48:63], v[108:111], v[12:15], v[48:63]
    ds_read_b128 v[108:111], v5 offset:25600
    v_exp_f32 v40, v40
    v_exp_f32 v41, v41
    v_exp_f32 v42, v42
    v_exp_f32 v43, v43
    s_waitcnt lgkmcnt(3)
    v_mfma_f32_32x32x16_bf16 v[80:95], v[120:123], v[64:67], v[80:95]
    ds_read_b128 v[120:123], v5 offset:22528
    v_exp_f32 v44, v44
    v_exp_f32 v45, v45
    v_exp_f32 v46, v46
    v_exp_f32 v47, v47
    v_mfma_f32_16x16x32_bf16 v[96:99], v[100:103], v[64:67], v[96:99]
    v_cvt_pk_bf16_f32 v68, v40, v41
    v_cvt_pk_bf16_f32 v69, v42, v43
    v_cvt_pk_bf16_f32 v70, v44, v45
    v_cvt_pk_bf16_f32 v71, v46, v47
    s_waitcnt lgkmcnt(3)
    s_nop 0
    v_mfma_f32_32x32x16_bf16 v[80:95], v[124:127], v[68:71], v[80:95]
    ds_read_b128 v[124:127], v5 offset:23552
    v_exp_f32 v48, v48
    v_exp_f32 v49, v49
    v_exp_f32 v50, v50
    v_exp_f32 v51, v51
    v_mfma_f32_16x16x32_bf16 v[96:99], v[100:103], v[68:71], v[96:99]
    v_exp_f32 v52, v52
    v_exp_f32 v53, v53
    s_waitcnt lgkmcnt(3)
    v_mfma_f32_32x32x16_bf16 v[32:47], v[104:107], v[8:11], v[16:31]
    ds_read_b128 v[104:107], v5 offset:28672
    v_exp_f32 v54, v54
    v_exp_f32 v55, v55
    v_cvt_pk_bf16_f32 v64, v48, v49
    v_cvt_pk_bf16_f32 v65, v50, v51
    v_cvt_pk_bf16_f32 v66, v52, v53
    v_cvt_pk_bf16_f32 v67, v54, v55
    s_waitcnt lgkmcnt(3)
    v_mfma_f32_32x32x16_bf16 v[32:47], v[108:111], v[12:15], v[32:47]
    ds_read_b128 v[108:111], v5 offset:29696
    v_exp_f32 v56, v56
    v_exp_f32 v57, v57
    v_exp_f32 v58, v58
    v_exp_f32 v59, v59
    s_waitcnt lgkmcnt(3)
    v_mfma_f32_32x32x16_bf16 v[80:95], v[120:123], v[64:67], v[80:95]
    ds_read_b128 v[120:123], v5 offset:26624
    v_exp_f32 v60, v60
    v_exp_f32 v61, v61
    v_exp_f32 v62, v62
    v_exp_f32 v63, v63
    v_mfma_f32_16x16x32_bf16 v[96:99], v[100:103], v[64:67], v[96:99]
    v_cvt_pk_bf16_f32 v68, v56, v57
    v_cvt_pk_bf16_f32 v69, v58, v59
    v_cvt_pk_bf16_f32 v70, v60, v61
    v_cvt_pk_bf16_f32 v71, v62, v63
    s_waitcnt lgkmcnt(3)
    s_nop 0
    v_mfma_f32_32x32x16_bf16 v[80:95], v[124:127], v[68:71], v[80:95]
    ds_read_b128 v[124:127], v5 offset:27648
    v_exp_f32 v32, v32
    v_exp_f32 v33, v33
    v_exp_f32 v34, v34
    v_exp_f32 v35, v35
    v_mfma_f32_16x16x32_bf16 v[96:99], v[100:103], v[68:71], v[96:99]
    v_exp_f32 v36, v36
    v_exp_f32 v37, v37
    s_waitcnt vmcnt(4)
    s_barrier
    s_cmp_ge_u32 s32, 5
    s_cbranch_scc1 L_at1_279_wm
    s_mov_b32 s92, s16
    s_mov_b32 s93, s17
    s_mov_b32 s94, s18
    v_mov_b32 v130, v4
    s_add_u32 s96, s30, s33
    s_mov_b32 s97, s31
    s_add_u32 s31, s31, 32768
    s_movk_i32 s98, 1024
    s_movk_i32 s99, 1024
    s_branch L_at1_279_dd
L_at1_279_wm:
    s_mov_b32 s92, s24
    s_mov_b32 s93, s25
    s_mov_b32 s94, s26
    v_mov_b32 v130, v241
    s_sub_u32 s97, s32, 5
    s_lshl_b32 s96, s97, 15
    s_add_u32 s96, s96, s60
    s_lshl_b32 s97, s97, 19
    s_movk_i32 s98, 8192
    s_mov_b32 s99, 0x20000
L_at1_279_dd:
    s_setprio 3
    s_waitcnt lgkmcnt(3)
    v_mfma_f32_32x32x16_bf16 v[48:63], v[104:107], v[8:11], v[16:31]
    ds_read_b128 v[104:107], v6 offset:0
    v_exp_f32 v38, v38
    v_exp_f32 v39, v39
    v_cvt_pk_bf16_f32 v64, v32, v33
    v_cvt_pk_bf16_f32 v65, v34, v35
    v_cvt_pk_bf16_f32 v66, v36, v37
    v_cvt_pk_bf16_f32 v67, v38, v39
    s_waitcnt lgkmcnt(3)
    v_mfma_f32_32x32x16_bf16 v[48:63], v[108:111], v[12:15], v[48:63]
    ds_read_b128 v[108:111], v6 offset:1024
    v_exp_f32 v40, v40
    v_exp_f32 v41, v41
    v_exp_f32 v42, v42
    v_exp_f32 v43, v43
    s_mov_b32 m0, s96
    s_add_u32 s96, s96, s98
    buffer_load_dwordx4 v130, s[92:95], s97 offen sc1 lds
    s_add_u32 s97, s97, s99
    s_waitcnt lgkmcnt(3)
    v_mfma_f32_32x32x16_bf16 v[80:95], v[120:123], v[64:67], v[80:95]
    ds_read_b128 v[120:123], v5 offset:30720
    v_exp_f32 v44, v44
    v_exp_f32 v45, v45
    v_exp_f32 v46, v46
    v_exp_f32 v47, v47
    v_mfma_f32_16x16x32_bf16 v[96:99], v[100:103], v[64:67], v[96:99]
    v_cvt_pk_bf16_f32 v68, v40, v41
    v_cvt_pk_bf16_f32 v69, v42, v43
    v_cvt_pk_bf16_f32 v70, v44, v45
    v_cvt_pk_bf16_f32 v71, v46, v47
    s_waitcnt lgkmcnt(3)
    s_nop 0
    v_mfma_f32_32x32x16_bf16 v[80:95], v[124:127], v[68:71], v[80:95]
    ds_read_b128 v[124:127], v5 offset:31744
    v_exp_f32 v48, v48
    v_exp_f32 v49, v49
    v_exp_f32 v50, v50
    v_exp_f32 v51, v51
    v_mfma_f32_16x16x32_bf16 v[96:99], v[100:103], v[68:71], v[96:99]
    v_exp_f32 v52, v52
    v_exp_f32 v53, v53
    s_waitcnt lgkmcnt(3)
    v_mfma_f32_32x32x16_bf16 v[32:47], v[104:107], v[8:11], v[16:31]
    ds_read_b128 v[104:107], v6 offset:4096
    v_exp_f32 v54, v54
    v_exp_f32 v55, v55
    v_cvt_pk_bf16_f32 v64, v48, v49
    v_cvt_pk_bf16_f32 v65, v50, v51
    v_cvt_pk_bf16_f32 v66, v52, v53
    v_cvt_pk_bf16_f32 v67, v54, v55
    s_waitcnt lgkmcnt(3)
    v_mfma_f32_32x32x16_bf16 v[32:47], v[108:111], v[12:15], v[32:47]
    ds_read_b128 v[108:111], v6 offset:5120
    v_exp_f32 v56, v56
    v_exp_f32 v57, v57
    v_exp_f32 v58, v58
    v_exp_f32 v59, v59
    s_mov_b32 m0, s96
    s_add_u32 s96, s96, s98
    buffer_load_dwordx4 v130, s[92:95], s97 offen sc1 lds
    s_add_u32 s97, s97, s99
    s_waitcnt lgkmcnt(3)
    v_mfma_f32_32x32x16_bf16 v[80:95], v[120:123], v[64:67], v[80:95]
    ds_read_b128 v[120:123], v6 offset:2048
    v_exp_f32 v60, v60
    v_exp_f32 v61, v61
    v_exp_f32 v62, v62
    v_exp_f32 v63, v63
    v_mfma_f32_16x16x32_bf16 v[96:99], v[100:103], v[64:67], v[96:99]
    v_cvt_pk_bf16_f32 v68, v56, v57
    v_cvt_pk_bf16_f32 v69, v58, v59
    v_cvt_pk_bf16_f32 v70, v60, v61
    v_cvt_pk_bf16_f32 v71, v62, v63
    v_mov_b32 v5, v6
    s_add_u32 s33, s33, 0x8000
    s_and_b32 s33, s33, 0x1ffff
    s_add_u32 s34, s33, 0x10000
    s_and_b32 s34, s34, 0x1ffff
    v_add_u32 v6, s34, v4
    s_add_u32 s32, s32, 1
    s_cmp_lt_u32 s32, 8
    s_cbranch_scc1 L_at1_279_loop
    s_waitcnt lgkmcnt(0)
    s_barrier
    v_mfma_f32_32x32x16_bf16 v[80:95], v[124:127], v[68:71], v[80:95]
    v_mfma_f32_16x16x32_bf16 v[96:99], v[100:103], v[68:71], v[96:99]
    s_mov_b32 m0, s96
    s_add_u32 s96, s96, s98
    buffer_load_dwordx4 v130, s[92:95], s97 offen sc1 lds
    s_add_u32 s97, s97, s99
    s_mov_b32 m0, s96
    s_add_u32 s96, s96, s98
    buffer_load_dwordx4 v130, s[92:95], s97 offen sc1 lds
    s_add_u32 s97, s97, s99
    s_add_u32 m0, s60, 147456
    s_mov_b32 s59, 1835008
    buffer_load_dwordx4 v241, s[24:27], s59 offen lds
    s_setprio 0
    v_max3_f32 v5, abs(v80), abs(v81), abs(v82)
    v_max3_f32 v5, v5, abs(v83), abs(v84)
    v_max3_f32 v5, v5, abs(v85), abs(v86)
    v_max3_f32 v5, v5, abs(v87), abs(v88)
    v_max3_f32 v5, v5, abs(v89), abs(v90)
    v_max3_f32 v5, v5, abs(v91), abs(v92)
    v_max3_f32 v5, v5, abs(v93), abs(v94)
    v_max3_f32 v5, v5, abs(v95), v96
    v_mov_b32 v6, 0
    v_fma_f32 v6, v80, 0, v6
    v_fma_f32 v6, v81, 0, v6
    v_fma_f32 v6, v82, 0, v6
    v_fma_f32 v6, v83, 0, v6
    v_fma_f32 v6, v84, 0, v6
    v_fma_f32 v6, v85, 0, v6
    v_fma_f32 v6, v86, 0, v6
    v_fma_f32 v6, v87, 0, v6
    v_fma_f32 v6, v88, 0, v6
    v_fma_f32 v6, v89, 0, v6
    v_fma_f32 v6, v90, 0, v6
    v_fma_f32 v6, v91, 0, v6
    v_fma_f32 v6, v92, 0, v6
    v_fma_f32 v6, v93, 0, v6
    v_fma_f32 v6, v94, 0, v6
    v_fma_f32 v6, v95, 0, v6
    v_fma_f32 v6, v96, 0, v6
    v_add_f32 v5, v5, v6
    s_mov_b32 s34, 0x71800000
    v_cmp_nlt_f32 vcc, v5, s34
    s_cbranch_vccz L_at1_279_fin
    v_mov_b32 v80, 0
    v_mov_b32 v81, 0
    v_mov_b32 v82, 0
    v_mov_b32 v83, 0
    v_mov_b32 v84, 0
    v_mov_b32 v85, 0
    v_mov_b32 v86, 0
    v_mov_b32 v87, 0
    v_mov_b32 v88, 0
    v_mov_b32 v89, 0
    v_mov_b32 v90, 0
    v_mov_b32 v91, 0
    v_mov_b32 v92, 0
    v_mov_b32 v93, 0
    v_mov_b32 v94, 0
    v_mov_b32 v95, 0
    v_mov_b32 v96, 0
    v_mov_b32 v97, 0
    v_mov_b32 v98, 0
    v_mov_b32 v99, 0
    v_mov_b32 v7, 0xff800000
    s_mov_b32 s31, 0x2440000
    s_mov_b32 s32, 0
L_at1_279_sloop:
    buffer_load_dwordx4 v[104:107], v4, s[16:19], s31 offen sc1
    buffer_load_dwordx4 v[108:111], v4, s[16:19], s31 offen offset:1024 sc1
    buffer_load_dwordx4 v[120:123], v4, s[16:19], s31 offen offset:2048 sc1
    buffer_load_dwordx4 v[124:127], v4, s[16:19], s31 offen offset:3072 sc1
    s_waitcnt vmcnt(0)
    v_mfma_f32_32x32x16_bf16 v[32:47], v[104:107], v[8:11], 0
    v_mfma_f32_32x32x16_bf16 v[32:47], v[108:111], v[12:15], v[32:47]
    s_nop 11
    v_max3_f32 v5, v32, v33, v34
    v_max3_f32 v5, v5, v35, v36
    v_max3_f32 v5, v5, v37, v38
    v_max3_f32 v5, v5, v39, v40
    v_max3_f32 v5, v5, v41, v42
    v_max3_f32 v5, v5, v43, v44
    v_max3_f32 v5, v5, v45, v46
    v_max_f32 v5, v5, v47
    v_mov_b32 v6, v5
    s_nop 1
    v_permlane32_swap_b32 v5, v6
    v_max3_f32 v5, v5, v6, v7
    v_sub_f32 v6, v7, v5
    v_exp_f32 v6, v6
    v_mov_b32 v7, v5
    v_sub_f32 v32, v32, v5
    v_sub_f32 v33, v33, v5
    v_sub_f32 v34, v34, v5
    v_sub_f32 v35, v35, v5
    v_sub_f32 v36, v36, v5
    v_sub_f32 v37, v37, v5
    v_sub_f32 v38, v38, v5
    v_sub_f32 v39, v39, v5
    v_sub_f32 v40, v40, v5
    v_sub_f32 v41, v41, v5
    v_sub_f32 v42, v42, v5
    v_sub_f32 v43, v43, v5
    v_sub_f32 v44, v44, v5
    v_sub_f32 v45, v45, v5
    v_sub_f32 v46, v46, v5
    v_sub_f32 v47, v47, v5
    v_exp_f32 v32, v32
    v_exp_f32 v33, v33
    v_exp_f32 v34, v34
    v_exp_f32 v35, v35
    v_exp_f32 v36, v36
    v_exp_f32 v37, v37
    v_exp_f32 v38, v38
    v_exp_f32 v39, v39
    v_exp_f32 v40, v40
    v_exp_f32 v41, v41
    v_exp_f32 v42, v42
    v_exp_f32 v43, v43
    v_exp_f32 v44, v44
    v_exp_f32 v45, v45
    v_exp_f32 v46, v46
    v_exp_f32 v47, v47
    v_mul_f32 v80, v80, v6
    v_mul_f32 v81, v81, v6
    v_mul_f32 v82, v82, v6
    v_mul_f32 v83, v83, v6
    v_mul_f32 v84, v84, v6
    v_mul_f32 v85, v85, v6
    v_mul_f32 v86, v86, v6
    v_mul_f32 v87, v87, v6
    v_mul_f32 v88, v88, v6
    v_mul_f32 v89, v89, v6
    v_mul_f32 v90, v90, v6
    v_mul_f32 v91, v91, v6
    v_mul_f32 v92, v92, v6
    v_mul_f32 v93, v93, v6
    v_mul_f32 v94, v94, v6
    v_mul_f32 v95, v95, v6
    v_mul_f32 v96, v96, v6
    v_mul_f32 v97, v97, v6
    v_mul_f32 v98, v98, v6
    v_mul_f32 v99, v99, v6
    v_cvt_pk_bf16_f32 v64, v32, v33
    v_cvt_pk_bf16_f32 v65, v34, v35
    v_cvt_pk_bf16_f32 v66, v36, v37
    v_cvt_pk_bf16_f32 v67, v38, v39
    v_cvt_pk_bf16_f32 v68, v40, v41
    v_cvt_pk_bf16_f32 v69, v42, v43
    v_cvt_pk_bf16_f32 v70, v44, v45
    v_cvt_pk_bf16_f32 v71, v46, v47
    v_mfma_f32_32x32x16_bf16 v[80:95], v[120:123], v[64:67], v[80:95]
    v_mfma_f32_16x16x32_bf16 v[96:99], v[100:103], v[64:67], v[96:99]
    v_mfma_f32_32x32x16_bf16 v[80:95], v[124:127], v[68:71], v[80:95]
    v_mfma_f32_16x16x32_bf16 v[96:99], v[100:103], v[68:71], v[96:99]
    s_add_u32 s31, s31, 4096
    s_add_u32 s32, s32, 1
    s_cmp_lt_u32 s32, 64
    s_cbranch_scc1 L_at1_279_sloop
L_at1_279_fin:
    s_nop 3
    v_rcp_f32 v6, v96
    s_lshl_b32 s34, s39, 16
    s_lshl_b32 s35, s38, 11
    s_add_u32 s34, s34, s35
    s_add_u32 s34, s34, 0x1800000
    v_mov_b32 v7, v6
    v_pk_mul_f32 v[80:81], v[80:81], v[6:7]
    v_pk_mul_f32 v[82:83], v[82:83], v[6:7]
    v_pk_mul_f32 v[84:85], v[84:85], v[6:7]
    v_pk_mul_f32 v[86:87], v[86:87], v[6:7]
    v_pk_mul_f32 v[88:89], v[88:89], v[6:7]
    v_pk_mul_f32 v[90:91], v[90:91], v[6:7]
    v_pk_mul_f32 v[92:93], v[92:93], v[6:7]
    v_pk_mul_f32 v[94:95], v[94:95], v[6:7]
    v_cvt_pk_bf16_f32 v64, v80, v81
    v_cvt_pk_bf16_f32 v65, v82, v83
    v_cvt_pk_bf16_f32 v66, v84, v85
    v_cvt_pk_bf16_f32 v67, v86, v87
    v_cvt_pk_bf16_f32 v68, v88, v89
    v_cvt_pk_bf16_f32 v69, v90, v91
    v_cvt_pk_bf16_f32 v70, v92, v93
    v_cvt_pk_bf16_f32 v71, v94, v95
    buffer_store_dwordx4 v[64:67], v4, s[16:19], s34 offen offset:0 sc1
    buffer_store_dwordx4 v[68:71], v4, s[16:19], s34 offen offset:1024 sc1
    s_waitcnt vmcnt(0)
    s_lshl_b32 s34, s4, 8
    s_add_u32 s34, s34, 0x280a000
    v_mov_b32 v4, 1
    v_mov_b32 v5, 0
    s_mov_b64 exec, 1
    v_mov_b32 v6, 163776
    ds_add_rtn_u32 v7, v6, v4
    s_waitcnt lgkmcnt(0)
    v_readfirstlane_b32 s35, v7
    s_nop 0
    s_cmp_eq_u32 s35, 7
    s_cbranch_scc0 L_sig_280
    s_lshl_b32 s35, s5, 2
    s_add_u32 s34, s34, s35
    buffer_store_dword v4, v5, s[16:19], s34 offen sc1
L_sig_280:
    s_mov_b64 exec, -1
    s_and_b32 s6, s2, 7
    s_lshr_b32 s7, s2, 3
    s_lshr_b32 s4, s6, 1
    s_lshl_b32 s4, s4, 2
    s_lshr_b32 s5, s7, 3
    s_add_u32 s4, s4, s5
    s_and_b32 s5, s6, 1
    s_lshl_b32 s5, s5, 3
    s_and_b32 s7, s7, 7
    s_add_u32 s5, s5, s7
    s_add_u32 s8, s86, 0x1800000
    s_addc_u32 s9, s87, 0
    s_and_b32 s9, s9, 0xffff
    s_mov_b32 s10, 0x400000
    s_mov_b32 s11, 0x20000
    s_mov_b32 s12, s80
    s_and_b32 s13, s81, 0xffff
    s_mov_b32 s14, 0x200000
    s_mov_b32 s15, 0x20000
    s_mov_b32 s24, s82
    s_and_b32 s25, s83, 0xffff
    s_mov_b32 s26, 0x400000
    s_mov_b32 s27, 0x20000
    s_cmp_ge_u32 s3, 4
    s_cbranch_scc1 L_wb1_ld_281
    s_lshl_b32 s30, s4, 2
    s_add_u32 s30, s30, s3
    s_lshl_b32 s39, s30, 16
    s_lshl_b32 s31, s5, 12
    s_add_u32 s36, s39, s31
    s_add_u32 s37, s36, 0x800000
    v_lshlrev_b32 v10, 4, v1
    buffer_load_dwordx4 v[64:67], v10, s[16:19], s37 offen offset:0 sc1
    buffer_load_dwordx4 v[68:71], v10, s[16:19], s37 offen offset:1024 sc1
    buffer_load_dwordx4 v[72:75], v10, s[16:19], s37 offen offset:2048 sc1
    buffer_load_dwordx4 v[76:79], v10, s[16:19], s37 offen offset:3072 sc1
    v_and_b32 v4, 15, v1
    v_lshrrev_b32 v5, 2, v4
    v_lshl_add_u32 v5, v3, 2, v5
    v_mul_u32_u24 v5, 128, v5
    v_and_b32 v6, 3, v4
    v_lshlrev_b32 v6, 3, v6
    v_bfe_u32 v7, v1, 4, 1
    v_lshl_add_u32 v6, v7, 5, v6
    v_add_u32 v6, 0, v6
    v_bfe_u32 v7, v1, 3, 1
    v_lshlrev_b32 v7, 6, v7
    v_xor_b32 v6, v6, v7
    v_add_u32 v12, v5, v6
    v_xor_b32 v13, 64, v12
    v_mov_b32 v4, 163780
    v_mov_b32 v5, 0
    ds_write_b32 v4, v5
    v_mov_b32 v4, 163784
    v_mov_b32 v5, 0
    ds_write_b32 v4, v5
    s_waitcnt lgkmcnt(0)
    v_add_u32 v14, 0x10000, v12
    v_add_u32 v15, 0x10000, v13
    v_add_u32 v16, 0x20000, v12
    v_add_u32 v17, 0x20000, v13
    v_mov_b32 v4, 163784
    s_mov_b32 s63, 0
    s_barrier
    s_waitcnt vmcnt(0)
    v_lshlrev_b32 v32, 16, v64
    v_and_b32 v33, 0xffff0000, v64
    v_lshlrev_b32 v34, 16, v65
    v_and_b32 v35, 0xffff0000, v65
    v_lshlrev_b32 v36, 16, v66
    v_and_b32 v37, 0xffff0000, v66
    v_lshlrev_b32 v38, 16, v67
    v_and_b32 v39, 0xffff0000, v67
    v_lshlrev_b32 v40, 16, v68
    v_and_b32 v41, 0xffff0000, v68
    v_lshlrev_b32 v42, 16, v69
    v_and_b32 v43, 0xffff0000, v69
    v_lshlrev_b32 v44, 16, v70
    v_and_b32 v45, 0xffff0000, v70
    v_lshlrev_b32 v46, 16, v71
    v_and_b32 v47, 0xffff0000, v71
    v_lshlrev_b32 v48, 16, v72
    v_and_b32 v49, 0xffff0000, v72
    v_lshlrev_b32 v50, 16, v73
    v_and_b32 v51, 0xffff0000, v73
    v_lshlrev_b32 v52, 16, v74
    v_and_b32 v53, 0xffff0000, v74
    v_lshlrev_b32 v54, 16, v75
    v_and_b32 v55, 0xffff0000, v75
    v_lshlrev_b32 v56, 16, v76
    v_and_b32 v57, 0xffff0000, v76
    v_lshlrev_b32 v58, 16, v77
    v_and_b32 v59, 0xffff0000, v77
    v_lshlrev_b32 v60, 16, v78
    v_and_b32 v61, 0xffff0000, v78
    v_lshlrev_b32 v62, 16, v79
    v_and_b32 v63, 0xffff0000, v79
    s_cmp_gt_u32 s63, 0
    s_cbranch_scc1 L_lp_283_ok
L_lp_283:
    ds_read_b32 v5, v4
    s_waitcnt lgkmcnt(0)
    v_readfirstlane_b32 s63, v5
    s_nop 0
    s_cmp_gt_u32 s63, 0
    s_cbranch_scc0 L_lp_283
L_lp_283_ok:
    buffer_load_dwordx4 v[96:99], v10, s[8:11], s39 offen offset:0 sc1
    buffer_load_dwordx4 v[100:103], v10, s[8:11], s39 offen offset:1024 sc1
    buffer_load_dwordx4 v[104:107], v10, s[8:11], s39 offen offset:2048 sc1
    buffer_load_dwordx4 v[108:111], v10, s[8:11], s39 offen offset:3072 sc1
    s_add_u32 s39, s39, 4096
    s_cmp_gt_u32 s63, 1
    s_cbranch_scc1 L_lp_284_ok
L_lp_284:
    ds_read_b32 v5, v4
    s_waitcnt lgkmcnt(0)
    v_readfirstlane_b32 s63, v5
    s_nop 0
    s_cmp_gt_u32 s63, 1
    s_cbranch_scc0 L_lp_284
L_lp_284_ok:
    buffer_load_dwordx4 v[112:115], v10, s[8:11], s39 offen offset:0 sc1
    buffer_load_dwordx4 v[116:119], v10, s[8:11], s39 offen offset:1024 sc1
    buffer_load_dwordx4 v[120:123], v10, s[8:11], s39 offen offset:2048 sc1
    buffer_load_dwordx4 v[124:127], v10, s[8:11], s39 offen offset:3072 sc1
    s_add_u32 s39, s39, 4096
    ds_read_b64_tr_b16 v[64:65], v12 offset:0
    ds_read_b64_tr_b16 v[66:67], v12 offset:1024
    ds_read_b64_tr_b16 v[68:69], v13 offset:0
    ds_read_b64_tr_b16 v[70:71], v13 offset:1024
    ds_read_b64_tr_b16 v[72:73], v12 offset:2048
    ds_read_b64_tr_b16 v[74:75], v12 offset:3072
    ds_read_b64_tr_b16 v[76:77], v13 offset:2048
    ds_read_b64_tr_b16 v[78:79], v13 offset:3072
    s_waitcnt vmcnt(7) lgkmcnt(4)
    v_mfma_f32_32x32x16_bf16 v[32:47], v[64:67], v[96:99], v[32:47]
    ds_read_b64_tr_b16 v[80:81], v12 offset:4096
    ds_read_b64_tr_b16 v[82:83], v12 offset:5120
    v_mfma_f32_32x32x16_bf16 v[48:63], v[68:71], v[96:99], v[48:63]
    ds_read_b64_tr_b16 v[84:85], v13 offset:4096
    ds_read_b64_tr_b16 v[86:87], v13 offset:5120
    s_cmp_gt_u32 s63, 2
    s_cbranch_scc1 L_lp_285_ok
L_lp_285:
    ds_read_b32 v5, v4
    s_waitcnt lgkmcnt(0)
    v_readfirstlane_b32 s63, v5
    s_nop 0
    s_cmp_gt_u32 s63, 2
    s_cbranch_scc0 L_lp_285
L_lp_285_ok:
    buffer_load_dwordx4 v[128:131], v10, s[8:11], s39 offen offset:0 sc1
    buffer_load_dwordx4 v[132:135], v10, s[8:11], s39 offen offset:1024 sc1
    s_waitcnt vmcnt(8) lgkmcnt(4)
    v_mfma_f32_32x32x16_bf16 v[32:47], v[72:75], v[100:103], v[32:47]
    ds_read_b64_tr_b16 v[88:89], v12 offset:6144
    ds_read_b64_tr_b16 v[90:91], v12 offset:7168
    v_mfma_f32_32x32x16_bf16 v[48:63], v[76:79], v[100:103], v[48:63]
    ds_read_b64_tr_b16 v[92:93], v13 offset:6144
    ds_read_b64_tr_b16 v[94:95], v13 offset:7168
    buffer_load_dwordx4 v[136:139], v10, s[8:11], s39 offen offset:2048 sc1
    buffer_load_dwordx4 v[140:143], v10, s[8:11], s39 offen offset:3072 sc1
    s_add_u32 s39, s39, 4096
    s_waitcnt vmcnt(9) lgkmcnt(4)
    v_mfma_f32_32x32x16_bf16 v[32:47], v[80:83], v[104:107], v[32:47]
    ds_read_b64_tr_b16 v[64:65], v12 offset:8192
    ds_read_b64_tr_b16 v[66:67], v12 offset:9216
    v_mfma_f32_32x32x16_bf16 v[48:63], v[84:87], v[104:107], v[48:63]
    ds_read_b64_tr_b16 v[68:69], v13 offset:8192
    ds_read_b64_tr_b16 v[70:71], v13 offset:9216
    s_cmp_gt_u32 s63, 3
    s_cbranch_scc1 L_lp_286_ok
L_lp_286:
    ds_read_b32 v5, v4
    s_waitcnt lgkmcnt(0)
    v_readfirstlane_b32 s63, v5
    s_nop 0
    s_cmp_gt_u32 s63, 3
    s_cbranch_scc0 L_lp_286
L_lp_286_ok:
    buffer_load_dwordx4 v[144:147], v10, s[8:11], s39 offen offset:0 sc1
    buffer_load_dwordx4 v[148:151], v10, s[8:11], s39 offen offset:1024 sc1
    s_waitcnt vmcnt(10) lgkmcnt(4)
    v_mfma_f32_32x32x16_bf16 v[32:47], v[88:91], v[108:111], v[32:47]
    ds_read_b64_tr_b16 v[72:73], v12 offset:10240
    ds_read_b64_tr_b16 v[74:75], v12 offset:11264
    v_mfma_f32_32x32x16_bf16 v[48:63], v[92:95], v[108:111], v[48:63]
    ds_read_b64_tr_b16 v[76:77], v13 offset:10240
    ds_read_b64_tr_b16 v[78:79], v13 offset:11264
    buffer_load_dwordx4 v[152:155], v10, s[8:11], s39 offen offset:2048 sc1
    buffer_load_dwordx4 v[156:159], v10, s[8:11], s39 offen offset:3072 sc1
    s_add_u32 s39, s39, 4096
    s_waitcnt vmcnt(11) lgkmcnt(4)
    v_mfma_f32_32x32x16_bf16 v[32:47], v[64:67], v[112:115], v[32:47]
    ds_read_b64_tr_b16 v[80:81], v12 offset:12288
    ds_read_b64_tr_b16 v[82:83], v12 offset:13312
    v_mfma_f32_32x32x16_bf16 v[48:63], v[68:71], v[112:115], v[48:63]
    ds_read_b64_tr_b16 v[84:85], v13 offset:12288
    ds_read_b64_tr_b16 v[86:87], v13 offset:13312
    s_cmp_gt_u32 s63, 4
    s_cbranch_scc1 L_lp_287_ok
L_lp_287:
    ds_read_b32 v5, v4
    s_waitcnt lgkmcnt(0)
    v_readfirstlane_b32 s63, v5
    s_nop 0
    s_cmp_gt_u32 s63, 4
    s_cbranch_scc0 L_lp_287
L_lp_287_ok:
    buffer_load_dwordx4 v[160:163], v10, s[8:11], s39 offen offset:0 sc1
    buffer_load_dwordx4 v[164:167], v10, s[8:11], s39 offen offset:1024 sc1
    s_waitcnt vmcnt(12) lgkmcnt(4)
    v_mfma_f32_32x32x16_bf16 v[32:47], v[72:75], v[116:119], v[32:47]
    ds_read_b64_tr_b16 v[88:89], v12 offset:14336
    ds_read_b64_tr_b16 v[90:91], v12 offset:15360
    v_mfma_f32_32x32x16_bf16 v[48:63], v[76:79], v[116:119], v[48:63]
    ds_read_b64_tr_b16 v[92:93], v13 offset:14336
    ds_read_b64_tr_b16 v[94:95], v13 offset:15360
    buffer_load_dwordx4 v[168:171], v10, s[8:11], s39 offen offset:2048 sc1
    buffer_load_dwordx4 v[172:175], v10, s[8:11], s39 offen offset:3072 sc1
    s_add_u32 s39, s39, 4096
    s_waitcnt vmcnt(13) lgkmcnt(4)
    v_mfma_f32_32x32x16_bf16 v[32:47], v[80:83], v[120:123], v[32:47]
    ds_read_b64_tr_b16 v[64:65], v12 offset:16384
    ds_read_b64_tr_b16 v[66:67], v12 offset:17408
    v_mfma_f32_32x32x16_bf16 v[48:63], v[84:87], v[120:123], v[48:63]
    ds_read_b64_tr_b16 v[68:69], v13 offset:16384
    ds_read_b64_tr_b16 v[70:71], v13 offset:17408
    s_cmp_gt_u32 s63, 5
    s_cbranch_scc1 L_lp_288_ok
L_lp_288:
    ds_read_b32 v5, v4
    s_waitcnt lgkmcnt(0)
    v_readfirstlane_b32 s63, v5
    s_nop 0
    s_cmp_gt_u32 s63, 5
    s_cbranch_scc0 L_lp_288
L_lp_288_ok:
    buffer_load_dwordx4 v[176:179], v10, s[8:11], s39 offen offset:0 sc1
    buffer_load_dwordx4 v[180:183], v10, s[8:11], s39 offen offset:1024 sc1
    s_waitcnt vmcnt(14) lgkmcnt(4)
    v_mfma_f32_32x32x16_bf16 v[32:47], v[88:91], v[124:127], v[32:47]
    ds_read_b64_tr_b16 v[72:73], v12 offset:18432
    ds_read_b64_tr_b16 v[74:75], v12 offset:19456
    v_mfma_f32_32x32x16_bf16 v[48:63], v[92:95], v[124:127], v[48:63]
    ds_read_b64_tr_b16 v[76:77], v13 offset:18432
    ds_read_b64_tr_b16 v[78:79], v13 offset:19456
    buffer_load_dwordx4 v[184:187], v10, s[8:11], s39 offen offset:2048 sc1
    buffer_load_dwordx4 v[188:191], v10, s[8:11], s39 offen offset:3072 sc1
    s_add_u32 s39, s39, 4096
    s_waitcnt vmcnt(15) lgkmcnt(4)
    v_mfma_f32_32x32x16_bf16 v[32:47], v[64:67], v[128:131], v[32:47]
    ds_read_b64_tr_b16 v[80:81], v12 offset:20480
    ds_read_b64_tr_b16 v[82:83], v12 offset:21504
    v_mfma_f32_32x32x16_bf16 v[48:63], v[68:71], v[128:131], v[48:63]
    ds_read_b64_tr_b16 v[84:85], v13 offset:20480
    ds_read_b64_tr_b16 v[86:87], v13 offset:21504
    s_cmp_gt_u32 s63, 6
    s_cbranch_scc1 L_lp_289_ok
L_lp_289:
    ds_read_b32 v5, v4
    s_waitcnt lgkmcnt(0)
    v_readfirstlane_b32 s63, v5
    s_nop 0
    s_cmp_gt_u32 s63, 6
    s_cbranch_scc0 L_lp_289
L_lp_289_ok:
    buffer_load_dwordx4 v[192:195], v10, s[8:11], s39 offen offset:0 sc1
    buffer_load_dwordx4 v[196:199], v10, s[8:11], s39 offen offset:1024 sc1
    s_waitcnt vmcnt(16) lgkmcnt(4)
    v_mfma_f32_32x32x16_bf16 v[32:47], v[72:75], v[132:135], v[32:47]
    ds_read_b64_tr_b16 v[88:89], v12 offset:22528
    ds_read_b64_tr_b16 v[90:91], v12 offset:23552
    v_mfma_f32_32x32x16_bf16 v[48:63], v[76:79], v[132:135], v[48:63]
    ds_read_b64_tr_b16 v[92:93], v13 offset:22528
    ds_read_b64_tr_b16 v[94:95], v13 offset:23552
    buffer_load_dwordx4 v[200:203], v10, s[8:11], s39 offen offset:2048 sc1
    buffer_load_dwordx4 v[204:207], v10, s[8:11], s39 offen offset:3072 sc1
    s_add_u32 s39, s39, 4096
    s_waitcnt vmcnt(17) lgkmcnt(4)
    v_mfma_f32_32x32x16_bf16 v[32:47], v[80:83], v[136:139], v[32:47]
    ds_read_b64_tr_b16 v[64:65], v12 offset:24576
    ds_read_b64_tr_b16 v[66:67], v12 offset:25600
    v_mfma_f32_32x32x16_bf16 v[48:63], v[84:87], v[136:139], v[48:63]
    ds_read_b64_tr_b16 v[68:69], v13 offset:24576
    ds_read_b64_tr_b16 v[70:71], v13 offset:25600
    s_cmp_gt_u32 s63, 7
    s_cbranch_scc1 L_lp_290_ok
L_lp_290:
    ds_read_b32 v5, v4
    s_waitcnt lgkmcnt(0)
    v_readfirstlane_b32 s63, v5
    s_nop 0
    s_cmp_gt_u32 s63, 7
    s_cbranch_scc0 L_lp_290
L_lp_290_ok:
    buffer_load_dwordx4 v[208:211], v10, s[8:11], s39 offen offset:0 sc1
    buffer_load_dwordx4 v[212:215], v10, s[8:11], s39 offen offset:1024 sc1
    s_waitcnt vmcnt(18) lgkmcnt(4)
    v_mfma_f32_32x32x16_bf16 v[32:47], v[88:91], v[140:143], v[32:47]
    ds_read_b64_tr_b16 v[72:73], v12 offset:26624
    ds_read_b64_tr_b16 v[74:75], v12 offset:27648
    v_mfma_f32_32x32x16_bf16 v[48:63], v[92:95], v[140:143], v[48:63]
    ds_read_b64_tr_b16 v[76:77], v13 offset:26624
    ds_read_b64_tr_b16 v[78:79], v13 offset:27648
    buffer_load_dwordx4 v[216:219], v10, s[8:11], s39 offen offset:2048 sc1
    buffer_load_dwordx4 v[220:223], v10, s[8:11], s39 offen offset:3072 sc1
    s_add_u32 s39, s39, 4096
    s_waitcnt vmcnt(19) lgkmcnt(4)
    v_mfma_f32_32x32x16_bf16 v[32:47], v[64:67], v[144:147], v[32:47]
    ds_read_b64_tr_b16 v[80:81], v12 offset:28672
    ds_read_b64_tr_b16 v[82:83], v12 offset:29696
    v_mfma_f32_32x32x16_bf16 v[48:63], v[68:71], v[144:147], v[48:63]
    ds_read_b64_tr_b16 v[84:85], v13 offset:28672
    ds_read_b64_tr_b16 v[86:87], v13 offset:29696
    s_cmp_gt_u32 s63, 8
    s_cbranch_scc1 L_lp_291_ok
L_lp_291:
    ds_read_b32 v5, v4
    s_waitcnt lgkmcnt(0)
    v_readfirstlane_b32 s63, v5
    s_nop 0
    s_cmp_gt_u32 s63, 8
    s_cbranch_scc0 L_lp_291
L_lp_291_ok:
    buffer_load_dwordx4 v[96:99], v10, s[8:11], s39 offen offset:0 sc1
    s_waitcnt vmcnt(19) lgkmcnt(4)
    v_mfma_f32_32x32x16_bf16 v[32:47], v[72:75], v[148:151], v[32:47]
    ds_read_b64_tr_b16 v[88:89], v12 offset:30720
    ds_read_b64_tr_b16 v[90:91], v12 offset:31744
    v_mfma_f32_32x32x16_bf16 v[48:63], v[76:79], v[148:151], v[48:63]
    ds_read_b64_tr_b16 v[92:93], v13 offset:30720
    ds_read_b64_tr_b16 v[94:95], v13 offset:31744
    buffer_load_dwordx4 v[100:103], v10, s[8:11], s39 offen offset:1024 sc1
    s_waitcnt vmcnt(19) lgkmcnt(4)
    v_mfma_f32_32x32x16_bf16 v[32:47], v[80:83], v[152:155], v[32:47]
    ds_read_b64_tr_b16 v[64:65], v12 offset:32768
    ds_read_b64_tr_b16 v[66:67], v12 offset:33792
    v_mfma_f32_32x32x16_bf16 v[48:63], v[84:87], v[152:155], v[48:63]
    ds_read_b64_tr_b16 v[68:69], v13 offset:32768
    ds_read_b64_tr_b16 v[70:71], v13 offset:33792
    buffer_load_dwordx4 v[104:107], v10, s[8:11], s39 offen offset:2048 sc1
    s_waitcnt vmcnt(19) lgkmcnt(4)
    v_mfma_f32_32x32x16_bf16 v[32:47], v[88:91], v[156:159], v[32:47]
    ds_read_b64_tr_b16 v[72:73], v12 offset:34816
    ds_read_b64_tr_b16 v[74:75], v12 offset:35840
    v_mfma_f32_32x32x16_bf16 v[48:63], v[92:95], v[156:159], v[48:63]
    ds_read_b64_tr_b16 v[76:77], v13 offset:34816
    ds_read_b64_tr_b16 v[78:79], v13 offset:35840
    buffer_load_dwordx4 v[108:111], v10, s[8:11], s39 offen offset:3072 sc1
    s_add_u32 s39, s39, 4096
    s_waitcnt vmcnt(19) lgkmcnt(4)
    v_mfma_f32_32x32x16_bf16 v[32:47], v[64:67], v[160:163], v[32:47]
    ds_read_b64_tr_b16 v[80:81], v12 offset:36864
    ds_read_b64_tr_b16 v[82:83], v12 offset:37888
    v_mfma_f32_32x32x16_bf16 v[48:63], v[68:71], v[160:163], v[48:63]
    ds_read_b64_tr_b16 v[84:85], v13 offset:36864
    ds_read_b64_tr_b16 v[86:87], v13 offset:37888
    s_cmp_gt_u32 s63, 9
    s_cbranch_scc1 L_lp_292_ok
L_lp_292:
    ds_read_b32 v5, v4
    s_waitcnt lgkmcnt(0)
    v_readfirstlane_b32 s63, v5
    s_nop 0
    s_cmp_gt_u32 s63, 9
    s_cbranch_scc0 L_lp_292
L_lp_292_ok:
    buffer_load_dwordx4 v[112:115], v10, s[8:11], s39 offen offset:0 sc1
    s_waitcnt vmcnt(19) lgkmcnt(4)
    v_mfma_f32_32x32x16_bf16 v[32:47], v[72:75], v[164:167], v[32:47]
    ds_read_b64_tr_b16 v[88:89], v12 offset:38912
    ds_read_b64_tr_b16 v[90:91], v12 offset:39936
    v_mfma_f32_32x32x16_bf16 v[48:63], v[76:79], v[164:167], v[48:63]
    ds_read_b64_tr_b16 v[92:93], v13 offset:38912
    ds_read_b64_tr_b16 v[94:95], v13 offset:39936
    buffer_load_dwordx4 v[116:119], v10, s[8:11], s39 offen offset:1024 sc1
    s_waitcnt vmcnt(19) lgkmcnt(4)
    v_mfma_f32_32x32x16_bf16 v[32:47], v[80:83], v[168:171], v[32:47]
    ds_read_b64_tr_b16 v[64:65], v12 offset:40960
    ds_read_b64_tr_b16 v[66:67], v12 offset:41984
    v_mfma_f32_32x32x16_bf16 v[48:63], v[84:87], v[168:171], v[48:63]
    ds_read_b64_tr_b16 v[68:69], v13 offset:40960
    ds_read_b64_tr_b16 v[70:71], v13 offset:41984
    buffer_load_dwordx4 v[120:123], v10, s[8:11], s39 offen offset:2048 sc1
    s_waitcnt vmcnt(19) lgkmcnt(4)
    v_mfma_f32_32x32x16_bf16 v[32:47], v[88:91], v[172:175], v[32:47]
    ds_read_b64_tr_b16 v[72:73], v12 offset:43008
    ds_read_b64_tr_b16 v[74:75], v12 offset:44032
    v_mfma_f32_32x32x16_bf16 v[48:63], v[92:95], v[172:175], v[48:63]
    ds_read_b64_tr_b16 v[76:77], v13 offset:43008
    ds_read_b64_tr_b16 v[78:79], v13 offset:44032
    buffer_load_dwordx4 v[124:127], v10, s[8:11], s39 offen offset:3072 sc1
    s_add_u32 s39, s39, 4096
    s_waitcnt vmcnt(19) lgkmcnt(4)
    v_mfma_f32_32x32x16_bf16 v[32:47], v[64:67], v[176:179], v[32:47]
    ds_read_b64_tr_b16 v[80:81], v12 offset:45056
    ds_read_b64_tr_b16 v[82:83], v12 offset:46080
    v_mfma_f32_32x32x16_bf16 v[48:63], v[68:71], v[176:179], v[48:63]
    ds_read_b64_tr_b16 v[84:85], v13 offset:45056
    ds_read_b64_tr_b16 v[86:87], v13 offset:46080
    s_cmp_gt_u32 s63, 10
    s_cbranch_scc1 L_lp_293_ok
L_lp_293:
    ds_read_b32 v5, v4
    s_waitcnt lgkmcnt(0)
    v_readfirstlane_b32 s63, v5
    s_nop 0
    s_cmp_gt_u32 s63, 10
    s_cbranch_scc0 L_lp_293
L_lp_293_ok:
    buffer_load_dwordx4 v[128:131], v10, s[8:11], s39 offen offset:0 sc1
    s_waitcnt vmcnt(19) lgkmcnt(4)
    v_mfma_f32_32x32x16_bf16 v[32:47], v[72:75], v[180:183], v[32:47]
    ds_read_b64_tr_b16 v[88:89], v12 offset:47104
    ds_read_b64_tr_b16 v[90:91], v12 offset:48128
    v_mfma_f32_32x32x16_bf16 v[48:63], v[76:79], v[180:183], v[48:63]
    ds_read_b64_tr_b16 v[92:93], v13 offset:47104
    ds_read_b64_tr_b16 v[94:95], v13 offset:48128
    buffer_load_dwordx4 v[132:135], v10, s[8:11], s39 offen offset:1024 sc1
    s_waitcnt vmcnt(19) lgkmcnt(4)
    v_mfma_f32_32x32x16_bf16 v[32:47], v[80:83], v[184:187], v[32:47]
    ds_read_b64_tr_b16 v[64:65], v12 offset:49152
    ds_read_b64_tr_b16 v[66:67], v12 offset:50176
    v_mfma_f32_32x32x16_bf16 v[48:63], v[84:87], v[184:187], v[48:63]
    ds_read_b64_tr_b16 v[68:69], v13 offset:49152
    ds_read_b64_tr_b16 v[70:71], v13 offset:50176
    buffer_load_dwordx4 v[136:139], v10, s[8:11], s39 offen offset:2048 sc1
    s_waitcnt vmcnt(19) lgkmcnt(4)
    v_mfma_f32_32x32x16_bf16 v[32:47], v[88:91], v[188:191], v[32:47]
    ds_read_b64_tr_b16 v[72:73], v12 offset:51200
    ds_read_b64_tr_b16 v[74:75], v12 offset:52224
    v_mfma_f32_32x32x16_bf16 v[48:63], v[92:95], v[188:191], v[48:63]
    ds_read_b64_tr_b16 v[76:77], v13 offset:51200
    ds_read_b64_tr_b16 v[78:79], v13 offset:52224
    buffer_load_dwordx4 v[140:143], v10, s[8:11], s39 offen offset:3072 sc1
    s_add_u32 s39, s39, 4096
    s_waitcnt vmcnt(19) lgkmcnt(4)
    v_mfma_f32_32x32x16_bf16 v[32:47], v[64:67], v[192:195], v[32:47]
    ds_read_b64_tr_b16 v[80:81], v12 offset:53248
    ds_read_b64_tr_b16 v[82:83], v12 offset:54272
    v_mfma_f32_32x32x16_bf16 v[48:63], v[68:71], v[192:195], v[48:63]
    ds_read_b64_tr_b16 v[84:85], v13 offset:53248
    ds_read_b64_tr_b16 v[86:87], v13 offset:54272
    s_cmp_gt_u32 s63, 11
    s_cbranch_scc1 L_lp_294_ok
L_lp_294:
    ds_read_b32 v5, v4
    s_waitcnt lgkmcnt(0)
    v_readfirstlane_b32 s63, v5
    s_nop 0
    s_cmp_gt_u32 s63, 11
    s_cbranch_scc0 L_lp_294
L_lp_294_ok:
    buffer_load_dwordx4 v[144:147], v10, s[8:11], s39 offen offset:0 sc1
    s_waitcnt vmcnt(19) lgkmcnt(4)
    v_mfma_f32_32x32x16_bf16 v[32:47], v[72:75], v[196:199], v[32:47]
    ds_read_b64_tr_b16 v[88:89], v12 offset:55296
    ds_read_b64_tr_b16 v[90:91], v12 offset:56320
    v_mfma_f32_32x32x16_bf16 v[48:63], v[76:79], v[196:199], v[48:63]
    ds_read_b64_tr_b16 v[92:93], v13 offset:55296
    ds_read_b64_tr_b16 v[94:95], v13 offset:56320
    buffer_load_dwordx4 v[148:151], v10, s[8:11], s39 offen offset:1024 sc1
    s_waitcnt vmcnt(19) lgkmcnt(4)
    v_mfma_f32_32x32x16_bf16 v[32:47], v[80:83], v[200:203], v[32:47]
    ds_read_b64_tr_b16 v[64:65], v12 offset:57344
    ds_read_b64_tr_b16 v[66:67], v12 offset:58368
    v_mfma_f32_32x32x16_bf16 v[48:63], v[84:87], v[200:203], v[48:63]
    ds_read_b64_tr_b16 v[68:69], v13 offset:57344
    ds_read_b64_tr_b16 v[70:71], v13 offset:58368
    buffer_load_dwordx4 v[152:155], v10, s[8:11], s39 offen offset:2048 sc1
    s_waitcnt vmcnt(19) lgkmcnt(4)
    v_mfma_f32_32x32x16_bf16 v[32:47], v[88:91], v[204:207], v[32:47]
    ds_read_b64_tr_b16 v[72:73], v12 offset:59392
    ds_read_b64_tr_b16 v[74:75], v12 offset:60416
    v_mfma_f32_32x32x16_bf16 v[48:63], v[92:95], v[204:207], v[48:63]
    ds_read_b64_tr_b16 v[76:77], v13 offset:59392
    ds_read_b64_tr_b16 v[78:79], v13 offset:60416
    buffer_load_dwordx4 v[156:159], v10, s[8:11], s39 offen offset:3072 sc1
    s_add_u32 s39, s39, 4096
    s_waitcnt vmcnt(19) lgkmcnt(4)
    v_mfma_f32_32x32x16_bf16 v[32:47], v[64:67], v[208:211], v[32:47]
    ds_read_b64_tr_b16 v[80:81], v12 offset:61440
    ds_read_b64_tr_b16 v[82:83], v12 offset:62464
    v_mfma_f32_32x32x16_bf16 v[48:63], v[68:71], v[208:211], v[48:63]
    ds_read_b64_tr_b16 v[84:85], v13 offset:61440
    ds_read_b64_tr_b16 v[86:87], v13 offset:62464
    s_cmp_gt_u32 s63, 12
    s_cbranch_scc1 L_lp_295_ok
L_lp_295:
    ds_read_b32 v5, v4
    s_waitcnt lgkmcnt(0)
    v_readfirstlane_b32 s63, v5
    s_nop 0
    s_cmp_gt_u32 s63, 12
    s_cbranch_scc0 L_lp_295
L_lp_295_ok:
    buffer_load_dwordx4 v[160:163], v10, s[8:11], s39 offen offset:0 sc1
    s_waitcnt vmcnt(19) lgkmcnt(4)
    v_mfma_f32_32x32x16_bf16 v[32:47], v[72:75], v[212:215], v[32:47]
    ds_read_b64_tr_b16 v[88:89], v12 offset:63488
    ds_read_b64_tr_b16 v[90:91], v12 offset:64512
    v_mfma_f32_32x32x16_bf16 v[48:63], v[76:79], v[212:215], v[48:63]
    ds_read_b64_tr_b16 v[92:93], v13 offset:63488
    ds_read_b64_tr_b16 v[94:95], v13 offset:64512
    buffer_load_dwordx4 v[164:167], v10, s[8:11], s39 offen offset:1024 sc1
    s_waitcnt vmcnt(19) lgkmcnt(4)
    v_mfma_f32_32x32x16_bf16 v[32:47], v[80:83], v[216:219], v[32:47]
    ds_read_b64_tr_b16 v[64:65], v14 offset:0
    ds_read_b64_tr_b16 v[66:67], v14 offset:1024
    v_mfma_f32_32x32x16_bf16 v[48:63], v[84:87], v[216:219], v[48:63]
    ds_read_b64_tr_b16 v[68:69], v15 offset:0
    ds_read_b64_tr_b16 v[70:71], v15 offset:1024
    buffer_load_dwordx4 v[168:171], v10, s[8:11], s39 offen offset:2048 sc1
    s_waitcnt vmcnt(19) lgkmcnt(4)
    v_mfma_f32_32x32x16_bf16 v[32:47], v[88:91], v[220:223], v[32:47]
    ds_read_b64_tr_b16 v[72:73], v14 offset:2048
    ds_read_b64_tr_b16 v[74:75], v14 offset:3072
    v_mfma_f32_32x32x16_bf16 v[48:63], v[92:95], v[220:223], v[48:63]
    ds_read_b64_tr_b16 v[76:77], v15 offset:2048
    ds_read_b64_tr_b16 v[78:79], v15 offset:3072
    buffer_load_dwordx4 v[172:175], v10, s[8:11], s39 offen offset:3072 sc1
    s_add_u32 s39, s39, 4096
    s_waitcnt vmcnt(19) lgkmcnt(4)
    v_mfma_f32_32x32x16_bf16 v[32:47], v[64:67], v[96:99], v[32:47]
    ds_read_b64_tr_b16 v[80:81], v14 offset:4096
    ds_read_b64_tr_b16 v[82:83], v14 offset:5120
    v_mfma_f32_32x32x16_bf16 v[48:63], v[68:71], v[96:99], v[48:63]
    ds_read_b64_tr_b16 v[84:85], v15 offset:4096
    ds_read_b64_tr_b16 v[86:87], v15 offset:5120
    s_cmp_gt_u32 s63, 13
    s_cbranch_scc1 L_lp_296_ok
L_lp_296:
    ds_read_b32 v5, v4
    s_waitcnt lgkmcnt(0)
    v_readfirstlane_b32 s63, v5
    s_nop 0
    s_cmp_gt_u32 s63, 13
    s_cbranch_scc0 L_lp_296
L_lp_296_ok:
    buffer_load_dwordx4 v[176:179], v10, s[8:11], s39 offen offset:0 sc1
    s_waitcnt vmcnt(19) lgkmcnt(4)
    v_mfma_f32_32x32x16_bf16 v[32:47], v[72:75], v[100:103], v[32:47]
    ds_read_b64_tr_b16 v[88:89], v14 offset:6144
    ds_read_b64_tr_b16 v[90:91], v14 offset:7168
    v_mfma_f32_32x32x16_bf16 v[48:63], v[76:79], v[100:103], v[48:63]
    ds_read_b64_tr_b16 v[92:93], v15 offset:6144
    ds_read_b64_tr_b16 v[94:95], v15 offset:7168
    buffer_load_dwordx4 v[180:183], v10, s[8:11], s39 offen offset:1024 sc1
    s_waitcnt vmcnt(19) lgkmcnt(4)
    v_mfma_f32_32x32x16_bf16 v[32:47], v[80:83], v[104:107], v[32:47]
    ds_read_b64_tr_b16 v[64:65], v14 offset:8192
    ds_read_b64_tr_b16 v[66:67], v14 offset:9216
    v_mfma_f32_32x32x16_bf16 v[48:63], v[84:87], v[104:107], v[48:63]
    ds_read_b64_tr_b16 v[68:69], v15 offset:8192
    ds_read_b64_tr_b16 v[70:71], v15 offset:9216
    buffer_load_dwordx4 v[184:187], v10, s[8:11], s39 offen offset:2048 sc1
    s_waitcnt vmcnt(19) lgkmcnt(4)
    v_mfma_f32_32x32x16_bf16 v[32:47], v[88:91], v[108:111], v[32:47]
    ds_read_b64_tr_b16 v[72:73], v14 offset:10240
    ds_read_b64_tr_b16 v[74:75], v14 offset:11264
    v_mfma_f32_32x32x16_bf16 v[48:63], v[92:95], v[108:111], v[48:63]
    ds_read_b64_tr_b16 v[76:77], v15 offset:10240
    ds_read_b64_tr_b16 v[78:79], v15 offset:11264
    buffer_load_dwordx4 v[188:191], v10, s[8:11], s39 offen offset:3072 sc1
    s_add_u32 s39, s39, 4096
    s_waitcnt vmcnt(19) lgkmcnt(4)
    v_mfma_f32_32x32x16_bf16 v[32:47], v[64:67], v[112:115], v[32:47]
    ds_read_b64_tr_b16 v[80:81], v14 offset:12288
    ds_read_b64_tr_b16 v[82:83], v14 offset:13312
    v_mfma_f32_32x32x16_bf16 v[48:63], v[68:71], v[112:115], v[48:63]
    ds_read_b64_tr_b16 v[84:85], v15 offset:12288
    ds_read_b64_tr_b16 v[86:87], v15 offset:13312
    s_cmp_gt_u32 s63, 14
    s_cbranch_scc1 L_lp_297_ok
L_lp_297:
    ds_read_b32 v5, v4
    s_waitcnt lgkmcnt(0)
    v_readfirstlane_b32 s63, v5
    s_nop 0
    s_cmp_gt_u32 s63, 14
    s_cbranch_scc0 L_lp_297
L_lp_297_ok:
    buffer_load_dwordx4 v[192:195], v10, s[8:11], s39 offen offset:0 sc1
    s_waitcnt vmcnt(19) lgkmcnt(4)
    v_mfma_f32_32x32x16_bf16 v[32:47], v[72:75], v[116:119], v[32:47]
    ds_read_b64_tr_b16 v[88:89], v14 offset:14336
    ds_read_b64_tr_b16 v[90:91], v14 offset:15360
    v_mfma_f32_32x32x16_bf16 v[48:63], v[76:79], v[116:119], v[48:63]
    ds_read_b64_tr_b16 v[92:93], v15 offset:14336
    ds_read_b64_tr_b16 v[94:95], v15 offset:15360
    buffer_load_dwordx4 v[196:199], v10, s[8:11], s39 offen offset:1024 sc1
    s_waitcnt vmcnt(19) lgkmcnt(4)
    v_mfma_f32_32x32x16_bf16 v[32:47], v[80:83], v[120:123], v[32:47]
    ds_read_b64_tr_b16 v[64:65], v14 offset:16384
    ds_read_b64_tr_b16 v[66:67], v14 offset:17408
    v_mfma_f32_32x32x16_bf16 v[48:63], v[84:87], v[120:123], v[48:63]
    ds_read_b64_tr_b16 v[68:69], v15 offset:16384
    ds_read_b64_tr_b16 v[70:71], v15 offset:17408
    buffer_load_dwordx4 v[200:203], v10, s[8:11], s39 offen offset:2048 sc1
    s_waitcnt vmcnt(19) lgkmcnt(4)
    v_mfma_f32_32x32x16_bf16 v[32:47], v[88:91], v[124:127], v[32:47]
    ds_read_b64_tr_b16 v[72:73], v14 offset:18432
    ds_read_b64_tr_b16 v[74:75], v14 offset:19456
    v_mfma_f32_32x32x16_bf16 v[48:63], v[92:95], v[124:127], v[48:63]
    ds_read_b64_tr_b16 v[76:77], v15 offset:18432
    ds_read_b64_tr_b16 v[78:79], v15 offset:19456
    buffer_load_dwordx4 v[204:207], v10, s[8:11], s39 offen offset:3072 sc1
    s_add_u32 s39, s39, 4096
    s_waitcnt vmcnt(19) lgkmcnt(4)
    v_mfma_f32_32x32x16_bf16 v[32:47], v[64:67], v[128:131], v[32:47]
    ds_read_b64_tr_b16 v[80:81], v14 offset:20480
    ds_read_b64_tr_b16 v[82:83], v14 offset:21504
    v_mfma_f32_32x32x16_bf16 v[48:63], v[68:71], v[128:131], v[48:63]
    ds_read_b64_tr_b16 v[84:85], v15 offset:20480
    ds_read_b64_tr_b16 v[86:87], v15 offset:21504
    s_cmp_gt_u32 s63, 15
    s_cbranch_scc1 L_lp_298_ok
L_lp_298:
    ds_read_b32 v5, v4
    s_waitcnt lgkmcnt(0)
    v_readfirstlane_b32 s63, v5
    s_nop 0
    s_cmp_gt_u32 s63, 15
    s_cbranch_scc0 L_lp_298
L_lp_298_ok:
    buffer_load_dwordx4 v[208:211], v10, s[8:11], s39 offen offset:0 sc1
    s_waitcnt vmcnt(19) lgkmcnt(4)
    v_mfma_f32_32x32x16_bf16 v[32:47], v[72:75], v[132:135], v[32:47]
    ds_read_b64_tr_b16 v[88:89], v14 offset:22528
    ds_read_b64_tr_b16 v[90:91], v14 offset:23552
    v_mfma_f32_32x32x16_bf16 v[48:63], v[76:79], v[132:135], v[48:63]
    ds_read_b64_tr_b16 v[92:93], v15 offset:22528
    ds_read_b64_tr_b16 v[94:95], v15 offset:23552
    buffer_load_dwordx4 v[212:215], v10, s[8:11], s39 offen offset:1024 sc1
    s_waitcnt vmcnt(19) lgkmcnt(4)
    v_mfma_f32_32x32x16_bf16 v[32:47], v[80:83], v[136:139], v[32:47]
    ds_read_b64_tr_b16 v[64:65], v14 offset:24576
    ds_read_b64_tr_b16 v[66:67], v14 offset:25600
    v_mfma_f32_32x32x16_bf16 v[48:63], v[84:87], v[136:139], v[48:63]
    ds_read_b64_tr_b16 v[68:69], v15 offset:24576
    ds_read_b64_tr_b16 v[70:71], v15 offset:25600
    buffer_load_dwordx4 v[216:219], v10, s[8:11], s39 offen offset:2048 sc1
    s_waitcnt vmcnt(19) lgkmcnt(4)
    v_mfma_f32_32x32x16_bf16 v[32:47], v[88:91], v[140:143], v[32:47]
    ds_read_b64_tr_b16 v[72:73], v14 offset:26624
    ds_read_b64_tr_b16 v[74:75], v14 offset:27648
    v_mfma_f32_32x32x16_bf16 v[48:63], v[92:95], v[140:143], v[48:63]
    ds_read_b64_tr_b16 v[76:77], v15 offset:26624
    ds_read_b64_tr_b16 v[78:79], v15 offset:27648
    buffer_load_dwordx4 v[220:223], v10, s[8:11], s39 offen offset:3072 sc1
    s_waitcnt vmcnt(19) lgkmcnt(4)
    v_mfma_f32_32x32x16_bf16 v[32:47], v[64:67], v[144:147], v[32:47]
    ds_read_b64_tr_b16 v[80:81], v14 offset:28672
    ds_read_b64_tr_b16 v[82:83], v14 offset:29696
    v_mfma_f32_32x32x16_bf16 v[48:63], v[68:71], v[144:147], v[48:63]
    ds_read_b64_tr_b16 v[84:85], v15 offset:28672
    ds_read_b64_tr_b16 v[86:87], v15 offset:29696
    s_waitcnt vmcnt(18) lgkmcnt(4)
    v_mfma_f32_32x32x16_bf16 v[32:47], v[72:75], v[148:151], v[32:47]
    ds_read_b64_tr_b16 v[88:89], v14 offset:30720
    ds_read_b64_tr_b16 v[90:91], v14 offset:31744
    v_mfma_f32_32x32x16_bf16 v[48:63], v[76:79], v[148:151], v[48:63]
    ds_read_b64_tr_b16 v[92:93], v15 offset:30720
    ds_read_b64_tr_b16 v[94:95], v15 offset:31744
    s_waitcnt vmcnt(17) lgkmcnt(4)
    v_mfma_f32_32x32x16_bf16 v[32:47], v[80:83], v[152:155], v[32:47]
    ds_read_b64_tr_b16 v[64:65], v16 offset:0
    ds_read_b64_tr_b16 v[66:67], v16 offset:1024
    v_mfma_f32_32x32x16_bf16 v[48:63], v[84:87], v[152:155], v[48:63]
    ds_read_b64_tr_b16 v[68:69], v17 offset:0
    ds_read_b64_tr_b16 v[70:71], v17 offset:1024
    s_waitcnt vmcnt(16) lgkmcnt(4)
    v_mfma_f32_32x32x16_bf16 v[32:47], v[88:91], v[156:159], v[32:47]
    ds_read_b64_tr_b16 v[72:73], v16 offset:2048
    ds_read_b64_tr_b16 v[74:75], v16 offset:3072
    v_mfma_f32_32x32x16_bf16 v[48:63], v[92:95], v[156:159], v[48:63]
    ds_read_b64_tr_b16 v[76:77], v17 offset:2048
    ds_read_b64_tr_b16 v[78:79], v17 offset:3072
    s_waitcnt vmcnt(15) lgkmcnt(4)
    v_mfma_f32_32x32x16_bf16 v[32:47], v[64:67], v[160:163], v[32:47]
    ds_read_b64_tr_b16 v[80:81], v16 offset:4096
    ds_read_b64_tr_b16 v[82:83], v16 offset:5120
    s_lshl_b32 s31, s30, 5
    v_add_u32 v9, s31, v2
    v_mfma_f32_32x32x16_bf16 v[48:63], v[68:71], v[160:163], v[48:63]
    ds_read_b64_tr_b16 v[84:85], v17 offset:4096
    ds_read_b64_tr_b16 v[86:87], v17 offset:5120
    v_lshlrev_b32 v9, 11, v9
    v_lshl_add_u32 v9, v3, 4, v9
    s_waitcnt vmcnt(14) lgkmcnt(4)
    v_mfma_f32_32x32x16_bf16 v[32:47], v[72:75], v[164:167], v[32:47]
    ds_read_b64_tr_b16 v[88:89], v16 offset:6144
    ds_read_b64_tr_b16 v[90:91], v16 offset:7168
    s_lshl_b32 s31, s5, 7
    v_add_u32 v9, s31, v9
    v_mfma_f32_32x32x16_bf16 v[48:63], v[76:79], v[164:167], v[48:63]
    ds_read_b64_tr_b16 v[92:93], v17 offset:6144
    ds_read_b64_tr_b16 v[94:95], v17 offset:7168
    s_waitcnt vmcnt(13) lgkmcnt(4)
    v_mfma_f32_32x32x16_bf16 v[32:47], v[80:83], v[168:171], v[32:47]
    ds_read_b64_tr_b16 v[64:65], v16 offset:8192
    ds_read_b64_tr_b16 v[66:67], v16 offset:9216
    v_mfma_f32_32x32x16_bf16 v[48:63], v[84:87], v[168:171], v[48:63]
    ds_read_b64_tr_b16 v[68:69], v17 offset:8192
    ds_read_b64_tr_b16 v[70:71], v17 offset:9216
    s_waitcnt vmcnt(12) lgkmcnt(4)
    v_mfma_f32_32x32x16_bf16 v[32:47], v[88:91], v[172:175], v[32:47]
    ds_read_b64_tr_b16 v[72:73], v16 offset:10240
    ds_read_b64_tr_b16 v[74:75], v16 offset:11264
    v_mfma_f32_32x32x16_bf16 v[48:63], v[92:95], v[172:175], v[48:63]
    ds_read_b64_tr_b16 v[76:77], v17 offset:10240
    ds_read_b64_tr_b16 v[78:79], v17 offset:11264
    s_waitcnt vmcnt(11) lgkmcnt(4)
    v_mfma_f32_32x32x16_bf16 v[32:47], v[64:67], v[176:179], v[32:47]
    ds_read_b64_tr_b16 v[80:81], v16 offset:12288
    ds_read_b64_tr_b16 v[82:83], v16 offset:13312
    v_mfma_f32_32x32x16_bf16 v[48:63], v[68:71], v[176:179], v[48:63]
    ds_read_b64_tr_b16 v[84:85], v17 offset:12288
    ds_read_b64_tr_b16 v[86:87], v17 offset:13312
    s_waitcnt vmcnt(10) lgkmcnt(4)
    v_mfma_f32_32x32x16_bf16 v[32:47], v[72:75], v[180:183], v[32:47]
    ds_read_b64_tr_b16 v[88:89], v16 offset:14336
    ds_read_b64_tr_b16 v[90:91], v16 offset:15360
    v_mfma_f32_32x32x16_bf16 v[48:63], v[76:79], v[180:183], v[48:63]
    ds_read_b64_tr_b16 v[92:93], v17 offset:14336
    ds_read_b64_tr_b16 v[94:95], v17 offset:15360
    s_waitcnt vmcnt(9) lgkmcnt(4)
    v_mfma_f32_32x32x16_bf16 v[32:47], v[80:83], v[184:187], v[32:47]
    ds_read_b64_tr_b16 v[64:65], v16 offset:16384
    ds_read_b64_tr_b16 v[66:67], v16 offset:17408
    v_mfma_f32_32x32x16_bf16 v[48:63], v[84:87], v[184:187], v[48:63]
    ds_read_b64_tr_b16 v[68:69], v17 offset:16384
    ds_read_b64_tr_b16 v[70:71], v17 offset:17408
    s_waitcnt vmcnt(8) lgkmcnt(4)
    v_mfma_f32_32x32x16_bf16 v[32:47], v[88:91], v[188:191], v[32:47]
    ds_read_b64_tr_b16 v[72:73], v16 offset:18432
    ds_read_b64_tr_b16 v[74:75], v16 offset:19456
    v_mfma_f32_32x32x16_bf16 v[48:63], v[92:95], v[188:191], v[48:63]
    ds_read_b64_tr_b16 v[76:77], v17 offset:18432
    ds_read_b64_tr_b16 v[78:79], v17 offset:19456
    s_waitcnt vmcnt(7) lgkmcnt(4)
    v_mfma_f32_32x32x16_bf16 v[32:47], v[64:67], v[192:195], v[32:47]
    ds_read_b64_tr_b16 v[80:81], v16 offset:20480
    ds_read_b64_tr_b16 v[82:83], v16 offset:21504
    v_mfma_f32_32x32x16_bf16 v[48:63], v[68:71], v[192:195], v[48:63]
    ds_read_b64_tr_b16 v[84:85], v17 offset:20480
    ds_read_b64_tr_b16 v[86:87], v17 offset:21504
    s_waitcnt vmcnt(6) lgkmcnt(4)
    v_mfma_f32_32x32x16_bf16 v[32:47], v[72:75], v[196:199], v[32:47]
    ds_read_b64_tr_b16 v[88:89], v16 offset:22528
    ds_read_b64_tr_b16 v[90:91], v16 offset:23552
    v_mfma_f32_32x32x16_bf16 v[48:63], v[76:79], v[196:199], v[48:63]
    ds_read_b64_tr_b16 v[92:93], v17 offset:22528
    ds_read_b64_tr_b16 v[94:95], v17 offset:23552
    s_waitcnt vmcnt(5) lgkmcnt(4)
    v_mfma_f32_32x32x16_bf16 v[32:47], v[80:83], v[200:203], v[32:47]
    s_barrier
    ds_read_b64_tr_b16 v[64:65], v14 offset:32768
    ds_read_b64_tr_b16 v[66:67], v14 offset:33792
    v_mfma_f32_32x32x16_bf16 v[48:63], v[84:87], v[200:203], v[48:63]
    ds_read_b64_tr_b16 v[68:69], v15 offset:32768
    ds_read_b64_tr_b16 v[70:71], v15 offset:33792
    s_waitcnt vmcnt(4) lgkmcnt(4)
    v_mfma_f32_32x32x16_bf16 v[32:47], v[88:91], v[204:207], v[32:47]
    ds_read_b64_tr_b16 v[72:73], v14 offset:34816
    ds_read_b64_tr_b16 v[74:75], v14 offset:35840
    v_mfma_f32_32x32x16_bf16 v[48:63], v[92:95], v[204:207], v[48:63]
    ds_read_b64_tr_b16 v[76:77], v15 offset:34816
    ds_read_b64_tr_b16 v[78:79], v15 offset:35840
    s_waitcnt vmcnt(3) lgkmcnt(4)
    v_mfma_f32_32x32x16_bf16 v[32:47], v[64:67], v[208:211], v[32:47]
    ds_read_b64_tr_b16 v[80:81], v14 offset:36864
    ds_read_b64_tr_b16 v[82:83], v14 offset:37888
    v_mfma_f32_32x32x16_bf16 v[48:63], v[68:71], v[208:211], v[48:63]
    ds_read_b64_tr_b16 v[84:85], v15 offset:36864
    ds_read_b64_tr_b16 v[86:87], v15 offset:37888
    s_waitcnt vmcnt(2) lgkmcnt(4)
    v_mfma_f32_32x32x16_bf16 v[32:47], v[72:75], v[212:215], v[32:47]
    ds_read_b64_tr_b16 v[88:89], v14 offset:38912
    ds_read_b64_tr_b16 v[90:91], v14 offset:39936
    v_mfma_f32_32x32x16_bf16 v[48:63], v[76:79], v[212:215], v[48:63]
    ds_read_b64_tr_b16 v[92:93], v15 offset:38912
    ds_read_b64_tr_b16 v[94:95], v15 offset:39936
    s_waitcnt vmcnt(1) lgkmcnt(4)
    v_mfma_f32_32x32x16_bf16 v[32:47], v[80:83], v[216:219], v[32:47]
    v_mfma_f32_32x32x16_bf16 v[48:63], v[84:87], v[216:219], v[48:63]
    s_waitcnt vmcnt(0) lgkmcnt(0)
    v_mfma_f32_32x32x16_bf16 v[32:47], v[88:91], v[220:223], v[32:47]
    s_barrier
    v_mfma_f32_32x32x16_bf16 v[48:63], v[92:95], v[220:223], v[48:63]
    s_nop 9
    v_cvt_pk_bf16_f32 v96, v32, v33
    v_cvt_pk_bf16_f32 v97, v34, v35
    v_cvt_pk_bf16_f32 v98, v36, v37
    v_cvt_pk_bf16_f32 v99, v38, v39
    s_nop 0
    v_permlane32_swap_b32 v96, v98
    v_permlane32_swap_b32 v97, v99
    buffer_store_dwordx4 v[96:99], v9, s[24:27], 0 offen offset:0
    v_cvt_pk_bf16_f32 v100, v40, v41
    v_cvt_pk_bf16_f32 v101, v42, v43
    v_cvt_pk_bf16_f32 v102, v44, v45
    v_cvt_pk_bf16_f32 v103, v46, v47
    s_nop 0
    v_permlane32_swap_b32 v100, v102
    v_permlane32_swap_b32 v101, v103
    buffer_store_dwordx4 v[100:103], v9, s[24:27], 0 offen offset:32
    v_cvt_pk_bf16_f32 v104, v48, v49
    v_cvt_pk_bf16_f32 v105, v50, v51
    v_cvt_pk_bf16_f32 v106, v52, v53
    v_cvt_pk_bf16_f32 v107, v54, v55
    s_nop 0
    v_permlane32_swap_b32 v104, v106
    v_permlane32_swap_b32 v105, v107
    buffer_store_dwordx4 v[104:107], v9, s[24:27], 0 offen offset:64
    v_cvt_pk_bf16_f32 v108, v56, v57
    v_cvt_pk_bf16_f32 v109, v58, v59
    v_cvt_pk_bf16_f32 v110, v60, v61
    v_cvt_pk_bf16_f32 v111, v62, v63
    s_nop 0
    v_permlane32_swap_b32 v108, v110
    v_permlane32_swap_b32 v109, v111
    buffer_store_dwordx4 v[108:111], v9, s[24:27], 0 offen offset:96
    s_branch L_wb1_end_282
L_wb1_ld_281:
    s_sub_u32 s30, s3, 4
    v_lshrrev_b32 v6, 3, v1
    v_and_b32 v7, 7, v1
    s_lshl_b32 s31, s30, 4
    v_lshrrev_b32 v5, 1, v6
    v_and_b32 v5, 1, v5
    v_lshlrev_b32 v5, 2, v5
    v_xor_b32 v5, v5, v7
    v_lshlrev_b32 v5, 4, v5
    s_lshl_b32 s32, s5, 7
    v_add_u32 v5, s32, v5
    v_add_u32 v4, s31, v6
    v_lshl_add_u32 v12, v4, 11, v5
    v_add_u32 v13, 15360, v12
    v_lshlrev_b32 v8, 4, v1
    s_lshl_b32 s35, s30, 11
    s_add_u32 m0, s35, 98304
    s_mov_b32 s38, 1966080
    buffer_load_dwordx4 v12, s[12:15], s38 offen offset:0 lds
    buffer_load_dwordx4 v13, s[12:15], s38 offen offset:1024 lds
    s_barrier
    s_cmp_lg_u32 s3, 7
    s_cbranch_scc1 L_rp_299_ok
    v_and_b32 v4, 15, v1
    v_lshlrev_b32 v4, 2, v4
    s_lshl_b32 s52, s4, 8
    s_add_u32 s52, s52, 0x280a000
    s_mov_b32 s53, 0
    v_mov_b32 v6, 163784
L_rp_299:
    buffer_load_dword v5, v4, s[16:19], s52 offen sc1
    s_waitcnt vmcnt(0)
    v_cmp_ne_u32 vcc, 1, v5
    s_nop 0
    s_or_b32 s63, vcc_lo, 0x10000
    s_ff1_i32_b32 s63, s63
    s_add_u32 s53, s53, 1
    s_cmp_lt_u32 s53, 0x40000
    s_cselect_b32 s63, s63, 16
    v_mov_b32 v7, s63
    ds_write_b32 v6, v7
    s_cmp_lt_u32 s63, 16
    s_cbranch_scc1 L_rp_299
L_rp_299_ok:
    s_waitcnt vmcnt(0)
    s_barrier
    s_barrier
L_wb1_end_282:
mega_exit:
    s_endpgm
.section .rodata,"a"
.p2align 6
.amdhsa_kernel interleave_layers__linear_kernel_hedgehog__grouped_kv_mqa__prompt_kernel
  .amdhsa_next_free_vgpr 256
  .amdhsa_next_free_sgpr 100
  .amdhsa_accum_offset 256
  .amdhsa_group_segment_fixed_size 0
  .amdhsa_kernarg_size 96
  .amdhsa_user_sgpr_count 2
  .amdhsa_user_sgpr_kernarg_segment_ptr 1
  .amdhsa_system_sgpr_workgroup_id_x 1
.end_amdhsa_kernel
```
